```python
import torch

def _softmax(x, axis=-1):
    return torch.softmax(x, dim=axis)
def _gelu(x):
    return torch.nn.functional.gelu(x, approximate="tanh")
def _silu(x):
    return torch.nn.functional.silu(x)
def _sigmoid(x):
    return torch.sigmoid(x)
def _layernorm(x, axis=-1, eps=1e-5):
    m = x.mean(dim=axis, keepdim=True)
    v = x.var(dim=axis, keepdim=True, unbiased=False)
    return (x - m) / torch.sqrt(v + eps)
def _scatter_add(tgt, idx, src, axis=0):
    return tgt.clone().index_add_(axis, idx, src)
def _segment_sum(src, seg, n):
    out = torch.zeros((n,) + src.shape[1:], dtype=src.dtype)
    return out.index_add_(0, seg, src)
def _pad(x, pw):
    flat = tuple(v for pair in reversed(pw) for v in pair)
    return torch.nn.functional.pad(x, flat)

kernel_name = 'parallel_sum__spectral_gfnet__dense_activation_gelu__prompt'

def setup_inputs():

    _w = (lambda a: (lambda t: t.to(torch.bfloat16) if t.is_floating_point() else t)(torch.as_tensor(a)))
    def _A_setup():
        B, S, D = 1, 2048, 576
        Df = D // 2 + 1
        return {
            "x": _w((lambda *s: torch.randn(*s, dtype=torch.bfloat16) * 0.05)(B, S, D)),
            "w_r": _w((lambda *s: torch.randn(*s, dtype=torch.bfloat16) * 0.8)(S, Df) * 0.02),
            "w_i": _w((lambda *s: torch.randn(*s, dtype=torch.bfloat16) * 0.8)(S, Df) * 0.02),
        }
    _A_in = _A_setup()

    def _B_setup():
        B, S, D, F = 1, 2048, 576, 4608
        return {
            "x": _w((lambda *s: torch.randn(*s, dtype=torch.bfloat16) * 0.05)(B, S, D)),
            "w1": _w((lambda *s: torch.randn(*s, dtype=torch.bfloat16) * 0.4)(D, F) * (D ** -0.5)),
            "b1": _w((lambda *s: torch.randn(*s, dtype=torch.bfloat16) * 12.8)(F) * 0.01),
            "w2": _w((lambda *s: torch.randn(*s, dtype=torch.bfloat16) * 0.2)(F, D) * (F ** -0.5)),
            "b2": _w((lambda *s: torch.randn(*s, dtype=torch.bfloat16) * 1.6)(D) * 0.01),
        }
    _B_in = _B_setup()

    return {
        "A_x": _A_in["x"],
        "A_w_r": _A_in["w_r"],
        "A_w_i": _A_in["w_i"],
        "B_x": _B_in["x"],
        "B_w1": _B_in["w1"],
        "B_b1": _B_in["b1"],
        "B_w2": _B_in["w2"],
        "B_b2": _B_in["b2"],
    }

def reference(A_x, A_w_r, A_w_i, B_x, B_w1, B_b1, B_w2, B_b2):
    def _A_ref(x, w_r, w_i):
        B, S, D = x.shape
        X = (lambda x, axes=(-2,-1): torch.fft.rfft2(x.float(), dim=axes))(x, axes=(-2, -1))
        W = w_r + 1j * w_i
        X = X * W
        y = (lambda x, s, axes=(-2,-1): torch.fft.irfft2(x, s=s, dim=axes).to(torch.bfloat16))(X, (S, D), axes=(-2, -1))
        return y

    def _B_ref(x, w1, b1, w2, b2):
        h = torch.einsum("bsd,df->bsf", x, w1) + b1
        h = _gelu(h)
        return torch.einsum("bsf,fd->bsd", h, w2) + b2

    x = A_x
    xn = _layernorm(x, axis=-1)
    return x + _A_ref(xn, A_w_r, A_w_i) + _B_ref(xn, B_w1, B_b1, B_w2, B_b2)
```

```asm
; @launch kernel=fused_kernel grid=(256,1,1) block=(512,1,1) lds=163840
.amdgcn_target "amdgcn-amd-amdhsa--gfx950"
.text
.globl fused_kernel
.p2align 8
.type fused_kernel,@function
fused_kernel:
    s_cmp_ge_u32 s2, 256
    s_cbranch_scc1 fused_kernel_end
    s_load_dwordx16 s[48:63], s[0:1], 0
    s_load_dwordx2 s[46:47], s[0:1], 80
    s_memrealtime s[100:101]
    v_lshrrev_b32 v8, 6, v0
    v_and_b32 v9, 63, v0
    v_readfirstlane_b32 s22, v8
    s_and_b32 s20, s2, 1
    s_lshl_b32 s20, s20, 2
    s_bfe_u32 s33, s2, 0x20003
    s_add_u32 s20, s20, s33
    s_bfe_u32 s21, s2, 0x20001
    s_lshl_b32 s21, s21, 3
    s_lshr_b32 s33, s2, 5
    s_add_u32 s21, s21, s33
    s_and_b32 s38, s22, 3
    s_lshr_b32 s39, s22, 2
    s_add_u32 s23, s22, s21
    s_and_b32 s23, s23, 7
    s_mul_i32 s24, s20, 663552
    s_mul_i32 s25, s22, 36864
    s_add_u32 s25, s25, s24
    s_add_u32 s26, s25, 294912
    s_mul_i32 s27, s38, 18432
    s_add_u32 s27, s27, s24
    s_add_u32 s27, s27, 589824
    s_lshl_b32 s37, s20, 6
    s_lshl_b32 s33, s21, 1
    s_add_u32 s37, s37, s33
    s_mul_i32 s37, s37, 36864
    s_add_u32 s37, s37, 0x1460000
    s_mov_b32 s28, s24
    s_mov_b32 s40, s37
    s_mov_b32 s41, s24
    s_lshl_b32 s42, s21, 1
    s_mul_i32 s33, s42, 3641
    s_lshr_b32 s33, s33, 16
    s_mul_i32 s33, s33, 18
    s_sub_u32 s42, s42, s33
    v_lshlrev_b32 v1, 4, v9
    v_add_u32 v2, 73728, v1
    v_lshrrev_b32 v16, 4, v9
    s_lshl_b32 s33, s22, 7
    s_add_u32 s33, s33, 147456
    v_lshl_add_u32 v3, v16, 4, s33
    s_lshl_b32 s33, s38, 6
    s_add_u32 s33, s33, 149504
    v_lshl_add_u32 v7, v16, 4, s33
    s_lshl_b32 s33, s22, 10
    v_add_u32 v4, s33, v2
    s_lshr_b32 s33, s38, 1
    s_lshl_b32 s33, s33, 10
    s_and_b32 s34, s38, 1
    s_lshl_b32 s34, s34, 3
    s_add_u32 s33, s33, s34
    s_add_u32 s33, s33, 16384
    v_add_u32 v6, s33, v2
    v_mov_b32 v5, 0xbdd2d3e8
    v_and_b32 v248, 15, v9
    v_lshrrev_b32 v249, 4, v9
    v_xor_b32 v16, v249, v248
    v_lshl_add_u32 v17, v249, 4, v16
    v_lshlrev_b32 v10, 4, v17
    v_xor_b32 v11, 64, v10
    v_add_u32 v14, 0x10000, v10
    v_add_u32 v15, 0x10000, v11
    v_add_u32 v8, 0x10000, v2
    s_mov_b32 s33, 36864
    v_mul_lo_u32 v250, v249, s33
    v_lshl_add_u32 v250, v248, 3, v250
    s_lshl_b32 s28, s22, 3
    s_lshl_b32 s28, s28, 5
    s_add_u32 s28, s28, s21
    s_mul_i32 s28, s28, 1152
    s_add_u32 s29, s28, 147456
    v_and_b32 v16, 3, v248
    v_lshrrev_b32 v17, 3, v248
    v_lshl_add_u32 v18, v17, 2, v16
    v_lshlrev_b32 v19, 4, v16
    v_lshl_add_u32 v19, v17, 6, v19
    v_bfe_u32 v20, v248, 2, 1
    v_lshlrev_b32 v20, 3, v20
    v_lshl_add_u32 v19, v19, 4, v20
    s_lshr_b32 s33, s38, 1
    s_lshl_b32 s33, s33, 2
    v_add_u32 v21, s33, v249
    v_xor_b32 v21, v21, v18
    v_lshl_add_u32 v21, v21, 4, v19
    s_lshl_b32 s33, s39, 1
    s_and_b32 s34, s38, 1
    s_add_u32 s33, s33, s34
    s_mul_i32 s33, s33, 18432
    v_add_u32 v251, s33, v21
    s_lshl_b32 s34, s34, 3
    v_add_u32 v21, s34, v249
    v_xor_b32 v21, v21, v18
    v_lshl_add_u32 v21, v21, 4, v19
    s_lshr_b32 s33, s38, 1
    s_mul_i32 s33, s33, 18432
    s_add_u32 s33, s33, 73728
    v_add_u32 v252, s33, v21
    s_and_b32 s43, s20, 1
    s_cmp_eq_u32 s43, s39
    s_cselect_b32 s45, 1, 0
    s_lshl_b32 s36, s22, 12
    s_add_u32 s36, s36, 110592
    s_lshl_b32 s32, s22, 5
    s_add_u32 s32, s32, s21
    s_mov_b32 s88, 7456541
    s_movk_i32 s89, 576
    s_mov_b32 s90, 0x3ae38e39
    s_waitcnt lgkmcnt(0)
    s_sub_u32 s98, s100, 2048
    s_subb_u32 s99, s101, 0
    s_mov_b32 s12, s46
    s_and_b32 s13, s47, 0xffff
    s_mov_b32 s14, 0x10000000
    s_mov_b32 s15, 0x20000
    s_mov_b32 s4, s48
    s_and_b32 s5, s49, 0xffff
    s_mov_b32 s6, 0x240000
    s_mov_b32 s7, 0x20000
    s_mov_b32 s64, s56
    s_and_b32 s65, s57, 0xffff
    s_mov_b32 s66, 0x510000
    s_mov_b32 s67, 0x20000
    s_mov_b32 s68, s60
    s_and_b32 s69, s61, 0xffff
    s_mov_b32 s70, 0x510000
    s_mov_b32 s71, 0x20000
    s_mov_b32 s72, s50
    s_and_b32 s73, s51, 0xffff
    s_mov_b32 s74, 0x121000
    s_mov_b32 s75, 0x20000
    s_mov_b32 s76, s52
    s_and_b32 s77, s53, 0xffff
    s_mov_b32 s78, 0x121000
    s_mov_b32 s79, 0x20000
    s_mov_b32 s16, s58
    s_and_b32 s17, s59, 0xffff
    s_mov_b32 s18, 0x2400
    s_mov_b32 s19, 0x20000
    s_cmp_lg_u32 s22, 0
    s_cbranch_scc1 fused_kernel_n0
    s_or_b32 s86, s86, 1
    v_mov_b32 v246, s86
    v_mov_b32 v247, 0
    v_lshrrev_b32 v12, 2, v1
    v_add_u32 v12, 149760, v12
    s_mov_b64 exec, 0xffff
    ds_write_b32 v12, v247
    s_mov_b64 exec, -1
    s_waitcnt lgkmcnt(0)
fused_kernel_n0:
    s_barrier
    s_cmp_lg_u32 s39, 0
    s_cbranch_scc1 fused_kernel_nt1
    v_lshrrev_b32 v244, 3, v9
    v_and_b32 v245, 6, v244
    v_xor_b32 v245, v245, v9
    v_and_b32 v245, 7, v245
    v_lshlrev_b32 v245, 4, v245
    s_sub_u32 s94, s32, 162
    s_cselect_b32 s94, s32, s94
    s_mul_i32 s92, s94, 7282
    s_lshr_b32 s92, s92, 16
    s_mul_i32 s93, s92, 9
    s_sub_u32 s93, s94, s93
    s_mul_i32 s96, s93, 73728
    s_lshl_b32 s94, s92, 10
    s_add_u32 s96, s96, s94
    s_mul_i32 s94, s20, 663552
    s_add_u32 s96, s96, s94
    s_lshl_b32 s93, s93, 7
    s_cmp_ge_u32 s32, 162
    s_cbranch_scc1 L0
    s_add_u32 s96, s96, 0xa40000
    s_mul_i32 s92, s92, 294912
    s_add_u32 s92, s92, s93
    s_mul_i32 s93, s20, 1152
    s_add_u32 s92, s92, s93
    s_movk_i32 s93, 9216
    v_mad_u32_u24 v244, v244, s93, v245
    s_add_u32 s94, s92, 0
    buffer_load_dwordx4 v[52:55], v244, s[64:67], s94 offen
    s_add_u32 s94, s92, 73728
    buffer_load_dwordx4 v[56:59], v244, s[64:67], s94 offen
    s_add_u32 s94, s92, 147456
    buffer_load_dwordx4 v[60:63], v244, s[64:67], s94 offen
    s_add_u32 s94, s92, 221184
    buffer_load_dwordx4 v[64:67], v244, s[64:67], s94 offen
    s_branch L1
L0:
    s_add_u32 s96, s96, 0xf50000
    s_mul_i32 s92, s92, 36864
    s_add_u32 s92, s92, s93
    s_mul_i32 s93, s20, 663552
    s_add_u32 s92, s92, s93
    s_movk_i32 s93, 1152
    v_mad_u32_u24 v244, v244, s93, v245
    s_add_u32 s94, s92, 0
    buffer_load_dwordx4 v[52:55], v244, s[68:71], s94 offen
    s_add_u32 s94, s92, 9216
    buffer_load_dwordx4 v[56:59], v244, s[68:71], s94 offen
    s_add_u32 s94, s92, 18432
    buffer_load_dwordx4 v[60:63], v244, s[68:71], s94 offen
    s_add_u32 s94, s92, 27648
    buffer_load_dwordx4 v[64:67], v244, s[68:71], s94 offen
L1:
    s_add_u32 s32, s32, 128
    s_cmp_ge_u32 s32, 162
    s_cbranch_scc1 fused_kernel_nt1
    v_lshrrev_b32 v244, 3, v9
    v_and_b32 v245, 6, v244
    v_xor_b32 v245, v245, v9
    v_and_b32 v245, 7, v245
    v_lshlrev_b32 v245, 4, v245
    s_sub_u32 s50, s32, 162
    s_cselect_b32 s50, s32, s50
    s_mul_i32 s48, s50, 7282
    s_lshr_b32 s48, s48, 16
    s_mul_i32 s49, s48, 9
    s_sub_u32 s49, s50, s49
    s_mul_i32 s52, s49, 73728
    s_lshl_b32 s50, s48, 10
    s_add_u32 s52, s52, s50
    s_mul_i32 s50, s20, 663552
    s_add_u32 s52, s52, s50
    s_lshl_b32 s49, s49, 7
    s_cmp_ge_u32 s32, 162
    s_cbranch_scc1 L2
    s_add_u32 s52, s52, 0xa40000
    s_mul_i32 s48, s48, 294912
    s_add_u32 s48, s48, s49
    s_mul_i32 s49, s20, 1152
    s_add_u32 s48, s48, s49
    s_movk_i32 s49, 9216
    v_mad_u32_u24 v244, v244, s49, v245
    s_add_u32 s50, s48, 0
    buffer_load_dwordx4 v[68:71], v244, s[64:67], s50 offen
    s_add_u32 s50, s48, 73728
    buffer_load_dwordx4 v[72:75], v244, s[64:67], s50 offen
    s_add_u32 s50, s48, 147456
    buffer_load_dwordx4 v[76:79], v244, s[64:67], s50 offen
    s_add_u32 s50, s48, 221184
    buffer_load_dwordx4 v[80:83], v244, s[64:67], s50 offen
    s_branch L3
L2:
    s_add_u32 s52, s52, 0xf50000
    s_mul_i32 s48, s48, 36864
    s_add_u32 s48, s48, s49
    s_mul_i32 s49, s20, 663552
    s_add_u32 s48, s48, s49
    s_movk_i32 s49, 1152
    v_mad_u32_u24 v244, v244, s49, v245
    s_add_u32 s50, s48, 0
    buffer_load_dwordx4 v[68:71], v244, s[68:71], s50 offen
    s_add_u32 s50, s48, 9216
    buffer_load_dwordx4 v[72:75], v244, s[68:71], s50 offen
    s_add_u32 s50, s48, 18432
    buffer_load_dwordx4 v[76:79], v244, s[68:71], s50 offen
    s_add_u32 s50, s48, 27648
    buffer_load_dwordx4 v[80:83], v244, s[68:71], s50 offen
L3:
fused_kernel_nt1:
    buffer_load_dwordx2 v[16:17], v250, s[4:7], s28 offen offset:0
    buffer_load_dwordx2 v[18:19], v250, s[4:7], s28 offen offset:128
    buffer_load_dwordx2 v[20:21], v250, s[4:7], s28 offen offset:256
    buffer_load_dwordx2 v[22:23], v250, s[4:7], s28 offen offset:384
    buffer_load_dwordx2 v[24:25], v250, s[4:7], s28 offen offset:512
    buffer_load_dwordx2 v[26:27], v250, s[4:7], s28 offen offset:640
    buffer_load_dwordx2 v[28:29], v250, s[4:7], s28 offen offset:768
    buffer_load_dwordx2 v[30:31], v250, s[4:7], s28 offen offset:896
    buffer_load_dwordx2 v[32:33], v250, s[4:7], s28 offen offset:1024
    buffer_load_dwordx2 v[34:35], v250, s[4:7], s29 offen offset:0
    buffer_load_dwordx2 v[36:37], v250, s[4:7], s29 offen offset:128
    buffer_load_dwordx2 v[38:39], v250, s[4:7], s29 offen offset:256
    buffer_load_dwordx2 v[40:41], v250, s[4:7], s29 offen offset:384
    buffer_load_dwordx2 v[42:43], v250, s[4:7], s29 offen offset:512
    buffer_load_dwordx2 v[44:45], v250, s[4:7], s29 offen offset:640
    buffer_load_dwordx2 v[46:47], v250, s[4:7], s29 offen offset:768
    buffer_load_dwordx2 v[48:49], v250, s[4:7], s29 offen offset:896
    buffer_load_dwordx2 v[50:51], v250, s[4:7], s29 offen offset:1024
    v_min_u32 v12, 287, v0
    v_lshlrev_b32 v12, 2, v12
    s_mul_i32 s33, s20, 1152
    buffer_load_dword v94, v12, s[16:19], s33 offen
    s_cmp_lg_u32 s39, 0
    s_cbranch_scc1 fused_kernel_nt1b
    s_waitcnt vmcnt(19)
    v_add_u32 v245, s36, v1
    ds_write_b128 v245, v[52:55] offset:0
    ds_write_b128 v245, v[56:59] offset:1024
    ds_write_b128 v245, v[60:63] offset:2048
    ds_write_b128 v245, v[64:67] offset:3072
    v_bfe_u32 v244, v9, 2, 4
    v_bfe_u32 v245, v244, 1, 2
    v_lshlrev_b32 v245, 5, v245
    v_lshl_add_u32 v244, v244, 7, v245
    v_and_b32 v245, 3, v9
    v_lshl_add_u32 v244, v245, 3, v244
    v_add_u32 v244, s36, v244
    s_waitcnt lgkmcnt(0)
    ds_read_b64_tr_b16 v[52:53], v244 offset:0
    ds_read_b64_tr_b16 v[54:55], v244 offset:2048
    v_xor_b32 v244, 32, v244
    ds_read_b64_tr_b16 v[56:57], v244 offset:0
    ds_read_b64_tr_b16 v[58:59], v244 offset:2048
    v_xor_b32 v244, 96, v244
    ds_read_b64_tr_b16 v[60:61], v244 offset:0
    ds_read_b64_tr_b16 v[62:63], v244 offset:2048
    v_xor_b32 v244, 32, v244
    ds_read_b64_tr_b16 v[64:65], v244 offset:0
    ds_read_b64_tr_b16 v[66:67], v244 offset:2048
    s_waitcnt lgkmcnt(6)
    buffer_store_dwordx4 v[52:55], v1, s[12:15], s96 offen sc1
    s_waitcnt lgkmcnt(4)
    s_add_u32 s96, s96, 18432
    buffer_store_dwordx4 v[56:59], v1, s[12:15], s96 offen sc1
    s_waitcnt lgkmcnt(2)
    s_add_u32 s96, s96, 18432
    buffer_store_dwordx4 v[60:63], v1, s[12:15], s96 offen sc1
    s_waitcnt lgkmcnt(0)
    s_add_u32 s96, s96, 18432
    buffer_store_dwordx4 v[64:67], v1, s[12:15], s96 offen sc1
    s_cmp_ge_u32 s32, 162
    s_cbranch_scc1 fused_kernel_nt1b
    v_add_u32 v245, s36, v1
    ds_write_b128 v245, v[68:71] offset:0
    ds_write_b128 v245, v[72:75] offset:1024
    ds_write_b128 v245, v[76:79] offset:2048
    ds_write_b128 v245, v[80:83] offset:3072
    v_bfe_u32 v244, v9, 2, 4
    v_bfe_u32 v245, v244, 1, 2
    v_lshlrev_b32 v245, 5, v245
    v_lshl_add_u32 v244, v244, 7, v245
    v_and_b32 v245, 3, v9
    v_lshl_add_u32 v244, v245, 3, v244
    v_add_u32 v244, s36, v244
    s_waitcnt lgkmcnt(0)
    ds_read_b64_tr_b16 v[68:69], v244 offset:0
    ds_read_b64_tr_b16 v[70:71], v244 offset:2048
    v_xor_b32 v244, 32, v244
    ds_read_b64_tr_b16 v[72:73], v244 offset:0
    ds_read_b64_tr_b16 v[74:75], v244 offset:2048
    v_xor_b32 v244, 96, v244
    ds_read_b64_tr_b16 v[76:77], v244 offset:0
    ds_read_b64_tr_b16 v[78:79], v244 offset:2048
    v_xor_b32 v244, 32, v244
    ds_read_b64_tr_b16 v[80:81], v244 offset:0
    ds_read_b64_tr_b16 v[82:83], v244 offset:2048
    s_waitcnt lgkmcnt(6)
    buffer_store_dwordx4 v[68:71], v1, s[12:15], s52 offen sc1
    s_waitcnt lgkmcnt(4)
    s_add_u32 s52, s52, 18432
    buffer_store_dwordx4 v[72:75], v1, s[12:15], s52 offen sc1
    s_waitcnt lgkmcnt(2)
    s_add_u32 s52, s52, 18432
    buffer_store_dwordx4 v[76:79], v1, s[12:15], s52 offen sc1
    s_waitcnt lgkmcnt(0)
    s_add_u32 s52, s52, 18432
    buffer_store_dwordx4 v[80:83], v1, s[12:15], s52 offen sc1
fused_kernel_nt1b:
    s_lshr_b32 s37, s20, 1
    s_mul_i32 s37, s37, 9
    s_add_u32 s62, s37, 8
    s_add_u32 s37, s37, s22
    s_lshl_b32 s91, s37, 4
    v_add_u32 v182, s91, v248
    v_lshrrev_b32 v180, 1, v182
    v_and_b32 v181, 1, v182
    v_cmp_eq_u32 vcc, 1, v182
    v_mov_b32 v183, 288
    v_lshlrev_b32 v185, 2, v181
    v_cndmask_b32 v180, v180, v183, vcc
    v_cndmask_b32 v181, v181, 0, vcc
    v_mul_u32_u24 v181, 144, v181
    v_and_b32 v182, 1, v180
    v_mul_u32_u24 v182, 0x8000, v182
    v_lshl_or_b32 v178, v182, 16, v182
    v_and_b32 v182, 3, v180
    v_add_u32 v182, v182, v185
    v_mov_b32 v183, 0x6c
    v_lshrrev_b32 v182, v182, v183
    v_and_b32 v182, 1, v182
    v_mul_u32_u24 v182, 0x8000, v182
    v_lshl_or_b32 v177, v182, 16, v182
    v_lshlrev_b32 v182, 4, v180
    v_mul_hi_u32 v183, v182, s88
    v_mul_u32_u24 v183, s89, v183
    v_sub_u32 v184, v182, v183
    v_mul_u32_u24 v182, v180, v249
    v_lshlrev_b32 v182, 2, v182
    v_mul_hi_u32 v183, v182, s88
    v_mul_u32_u24 v183, s89, v183
    v_sub_u32 v182, v182, v183
    v_add_u32 v182, v182, v181
    v_cvt_f32_u32 v182, v182
    v_cvt_f32_u32 v180, v180
    v_cvt_f32_u32 v184, v184
    v_mul_f32 v176, s90, v184
    v_add_f32 v176, v176, v176
    v_add_f32 v183, v182, v184
    v_mul_f32 v168, s90, v182
    v_fmamk_f32 v186, v180, 0x3f800000, v182
    v_mul_f32 v169, s90, v186
    v_fmamk_f32 v186, v180, 0x40000000, v182
    v_mul_f32 v170, s90, v186
    v_fmamk_f32 v186, v180, 0x40400000, v182
    v_mul_f32 v171, s90, v186
    v_mul_f32 v172, s90, v183
    v_fmamk_f32 v186, v180, 0x3f800000, v183
    v_mul_f32 v173, s90, v186
    v_fmamk_f32 v186, v180, 0x40000000, v183
    v_mul_f32 v174, s90, v186
    v_fmamk_f32 v186, v180, 0x40400000, v183
    v_mul_f32 v175, s90, v186
    v_cos_f32 v180, v168
    v_cos_f32 v181, v169
    v_cos_f32 v182, v170
    v_cos_f32 v183, v171
    v_cos_f32 v184, v172
    v_cos_f32 v185, v173
    v_cos_f32 v186, v174
    v_cos_f32 v187, v175
    v_cvt_pk_f16_f32 v96, v180, v181
    v_cvt_pk_f16_f32 v97, v182, v183
    v_cvt_pk_f16_f32 v98, v184, v185
    v_cvt_pk_f16_f32 v99, v186, v187
    v_fmamk_f32 v188, v176, 0x3f800000, v168
    v_fmamk_f32 v189, v176, 0x3f800000, v169
    v_fmamk_f32 v190, v176, 0x3f800000, v170
    v_fmamk_f32 v191, v176, 0x3f800000, v171
    v_fmamk_f32 v192, v176, 0x3f800000, v172
    v_fmamk_f32 v193, v176, 0x3f800000, v173
    v_fmamk_f32 v194, v176, 0x3f800000, v174
    v_fmamk_f32 v195, v176, 0x3f800000, v175
    v_cos_f32 v180, v188
    v_cos_f32 v181, v189
    v_cos_f32 v182, v190
    v_cos_f32 v183, v191
    v_cos_f32 v184, v192
    v_cos_f32 v185, v193
    v_cos_f32 v186, v194
    v_cos_f32 v187, v195
    v_cvt_pk_f16_f32 v100, v180, v181
    v_cvt_pk_f16_f32 v101, v182, v183
    v_cvt_pk_f16_f32 v102, v184, v185
    v_cvt_pk_f16_f32 v103, v186, v187
    v_fmamk_f32 v188, v176, 0x40000000, v168
    v_fmamk_f32 v189, v176, 0x40000000, v169
    v_fmamk_f32 v190, v176, 0x40000000, v170
    v_fmamk_f32 v191, v176, 0x40000000, v171
    v_fmamk_f32 v192, v176, 0x40000000, v172
    v_fmamk_f32 v193, v176, 0x40000000, v173
    v_fmamk_f32 v194, v176, 0x40000000, v174
    v_fmamk_f32 v195, v176, 0x40000000, v175
    v_cos_f32 v180, v188
    v_cos_f32 v181, v189
    v_cos_f32 v182, v190
    v_cos_f32 v183, v191
    v_cos_f32 v184, v192
    v_cos_f32 v185, v193
    v_cos_f32 v186, v194
    v_cos_f32 v187, v195
    v_cvt_pk_f16_f32 v104, v180, v181
    v_cvt_pk_f16_f32 v105, v182, v183
    v_cvt_pk_f16_f32 v106, v184, v185
    v_cvt_pk_f16_f32 v107, v186, v187
    v_fmamk_f32 v188, v176, 0x40400000, v168
    v_fmamk_f32 v189, v176, 0x40400000, v169
    v_fmamk_f32 v190, v176, 0x40400000, v170
    v_fmamk_f32 v191, v176, 0x40400000, v171
    v_fmamk_f32 v192, v176, 0x40400000, v172
    v_fmamk_f32 v193, v176, 0x40400000, v173
    v_fmamk_f32 v194, v176, 0x40400000, v174
    v_fmamk_f32 v195, v176, 0x40400000, v175
    v_cos_f32 v180, v188
    v_cos_f32 v181, v189
    v_cos_f32 v182, v190
    v_cos_f32 v183, v191
    v_cos_f32 v184, v192
    v_cos_f32 v185, v193
    v_cos_f32 v186, v194
    v_cos_f32 v187, v195
    v_cvt_pk_f16_f32 v108, v180, v181
    v_cvt_pk_f16_f32 v109, v182, v183
    v_cvt_pk_f16_f32 v110, v184, v185
    v_cvt_pk_f16_f32 v111, v186, v187
    v_fmamk_f32 v188, v176, 0x40800000, v168
    v_fmamk_f32 v189, v176, 0x40800000, v169
    v_fmamk_f32 v190, v176, 0x40800000, v170
    v_fmamk_f32 v191, v176, 0x40800000, v171
    v_cos_f32 v180, v188
    v_cos_f32 v181, v189
    v_cos_f32 v182, v190
    v_cos_f32 v183, v191
    v_cvt_pk_f16_f32 v112, v180, v181
    v_cvt_pk_f16_f32 v113, v182, v183
    v_xor_b32_dpp v114, v96, v177 quad_perm:[0,1,3,2] row_mask:0xf bank_mask:0xf
    v_xor_b32_dpp v115, v97, v177 quad_perm:[0,1,3,2] row_mask:0xf bank_mask:0xf
    v_xor_b32_dpp v116, v98, v177 quad_perm:[0,1,3,2] row_mask:0xf bank_mask:0xf
    v_xor_b32_dpp v117, v99, v177 quad_perm:[0,1,3,2] row_mask:0xf bank_mask:0xf
    v_xor_b32_dpp v118, v100, v177 quad_perm:[0,1,3,2] row_mask:0xf bank_mask:0xf
    v_xor_b32_dpp v119, v101, v177 quad_perm:[0,1,3,2] row_mask:0xf bank_mask:0xf
    v_xor_b32_dpp v120, v102, v177 quad_perm:[0,1,3,2] row_mask:0xf bank_mask:0xf
    v_xor_b32_dpp v121, v103, v177 quad_perm:[0,1,3,2] row_mask:0xf bank_mask:0xf
    v_xor_b32_dpp v122, v104, v177 quad_perm:[0,1,3,2] row_mask:0xf bank_mask:0xf
    v_xor_b32_dpp v123, v105, v177 quad_perm:[0,1,3,2] row_mask:0xf bank_mask:0xf
    v_xor_b32_dpp v124, v106, v177 quad_perm:[0,1,3,2] row_mask:0xf bank_mask:0xf
    v_xor_b32_dpp v125, v107, v177 quad_perm:[0,1,3,2] row_mask:0xf bank_mask:0xf
    v_xor_b32_dpp v126, v108, v177 quad_perm:[0,1,3,2] row_mask:0xf bank_mask:0xf
    v_xor_b32_dpp v127, v109, v177 quad_perm:[0,1,3,2] row_mask:0xf bank_mask:0xf
    v_xor_b32_dpp v128, v110, v177 quad_perm:[0,1,3,2] row_mask:0xf bank_mask:0xf
    v_xor_b32_dpp v129, v111, v177 quad_perm:[0,1,3,2] row_mask:0xf bank_mask:0xf
    v_xor_b32_dpp v130, v112, v177 quad_perm:[0,1,3,2] row_mask:0xf bank_mask:0xf
    v_xor_b32_dpp v131, v113, v177 quad_perm:[0,1,3,2] row_mask:0xf bank_mask:0xf
    v_xor_b32 v132, v178, v96
    v_xor_b32 v133, v178, v97
    v_xor_b32 v134, v178, v98
    v_xor_b32 v135, v178, v99
    v_xor_b32 v136, v178, v100
    v_xor_b32 v137, v178, v101
    v_xor_b32 v138, v178, v102
    v_xor_b32 v139, v178, v103
    v_xor_b32 v140, v178, v104
    v_xor_b32 v141, v178, v105
    v_xor_b32 v142, v178, v106
    v_xor_b32 v143, v178, v107
    v_xor_b32 v144, v178, v108
    v_xor_b32 v145, v178, v109
    v_xor_b32 v146, v178, v110
    v_xor_b32 v147, v178, v111
    v_xor_b32 v148, v178, v112
    v_xor_b32 v149, v178, v113
    v_xor_b32 v150, v178, v114
    v_xor_b32 v151, v178, v115
    v_xor_b32 v152, v178, v116
    v_xor_b32 v153, v178, v117
    v_xor_b32 v154, v178, v118
    v_xor_b32 v155, v178, v119
    v_xor_b32 v156, v178, v120
    v_xor_b32 v157, v178, v121
    v_xor_b32 v158, v178, v122
    v_xor_b32 v159, v178, v123
    v_xor_b32 v160, v178, v124
    v_xor_b32 v161, v178, v125
    v_xor_b32 v162, v178, v126
    v_xor_b32 v163, v178, v127
    v_xor_b32 v164, v178, v128
    v_xor_b32 v165, v178, v129
    v_xor_b32 v166, v178, v130
    v_xor_b32 v167, v178, v131
    s_cmp_lg_u32 s39, 0
    s_cbranch_scc1 fused_kernel_w1
    s_cmp_ge_u32 s32, 162
    s_cbranch_scc1 fused_kernel_w3
    s_waitcnt vmcnt(8)
    s_branch fused_kernel_w2
fused_kernel_w3:
    s_waitcnt vmcnt(4)
    s_branch fused_kernel_w2
fused_kernel_w1:
    s_waitcnt vmcnt(0)
fused_kernel_w2:
    v_lshlrev_b32 v168, 16, v16
    v_and_b32 v169, 0xffff0000, v16
    v_lshlrev_b32 v170, 16, v17
    v_and_b32 v171, 0xffff0000, v17
    v_lshlrev_b32 v172, 16, v18
    v_and_b32 v173, 0xffff0000, v18
    v_lshlrev_b32 v174, 16, v19
    v_and_b32 v175, 0xffff0000, v19
    v_lshlrev_b32 v176, 16, v20
    v_and_b32 v177, 0xffff0000, v20
    v_lshlrev_b32 v178, 16, v21
    v_and_b32 v179, 0xffff0000, v21
    v_lshlrev_b32 v180, 16, v22
    v_and_b32 v181, 0xffff0000, v22
    v_lshlrev_b32 v182, 16, v23
    v_and_b32 v183, 0xffff0000, v23
    v_lshlrev_b32 v184, 16, v24
    v_and_b32 v185, 0xffff0000, v24
    v_lshlrev_b32 v186, 16, v25
    v_and_b32 v187, 0xffff0000, v25
    v_lshlrev_b32 v188, 16, v26
    v_and_b32 v189, 0xffff0000, v26
    v_lshlrev_b32 v190, 16, v27
    v_and_b32 v191, 0xffff0000, v27
    v_lshlrev_b32 v192, 16, v28
    v_and_b32 v193, 0xffff0000, v28
    v_lshlrev_b32 v194, 16, v29
    v_and_b32 v195, 0xffff0000, v29
    v_lshlrev_b32 v196, 16, v30
    v_and_b32 v197, 0xffff0000, v30
    v_lshlrev_b32 v198, 16, v31
    v_and_b32 v199, 0xffff0000, v31
    v_lshlrev_b32 v200, 16, v32
    v_and_b32 v201, 0xffff0000, v32
    v_lshlrev_b32 v202, 16, v33
    v_and_b32 v203, 0xffff0000, v33
    v_pk_add_f32 v[204:205], v[168:169], v[170:171]
    v_pk_add_f32 v[206:207], v[172:173], v[174:175]
    v_pk_add_f32 v[204:205], v[204:205], v[176:177]
    v_pk_add_f32 v[206:207], v[206:207], v[178:179]
    v_pk_add_f32 v[204:205], v[204:205], v[180:181]
    v_pk_add_f32 v[206:207], v[206:207], v[182:183]
    v_pk_add_f32 v[204:205], v[204:205], v[184:185]
    v_pk_add_f32 v[206:207], v[206:207], v[186:187]
    v_pk_add_f32 v[204:205], v[204:205], v[188:189]
    v_pk_add_f32 v[206:207], v[206:207], v[190:191]
    v_pk_add_f32 v[204:205], v[204:205], v[192:193]
    v_pk_add_f32 v[206:207], v[206:207], v[194:195]
    v_pk_add_f32 v[204:205], v[204:205], v[196:197]
    v_pk_add_f32 v[206:207], v[206:207], v[198:199]
    v_pk_add_f32 v[204:205], v[204:205], v[200:201]
    v_pk_add_f32 v[206:207], v[206:207], v[202:203]
    v_pk_add_f32 v[204:205], v[204:205], v[206:207]
    v_add_f32 v204, v204, v205
    s_nop 1
    v_add_f32_dpp v204, v204, v204 row_ror:8 row_mask:0xf bank_mask:0xf
    s_nop 1
    v_add_f32_dpp v204, v204, v204 row_ror:4 row_mask:0xf bank_mask:0xf
    s_nop 1
    v_add_f32_dpp v204, v204, v204 row_ror:2 row_mask:0xf bank_mask:0xf
    s_nop 1
    v_add_f32_dpp v204, v204, v204 row_ror:1 row_mask:0xf bank_mask:0xf
    v_mul_f32 v204, s90, v204
    v_sub_f32 v206, 0, v204
    v_sub_f32 v207, 0, v204
    v_cvt_pk_bf16_f32 v205, v206, v206
    v_lshlrev_b32 v208, 16, v205
    v_lshlrev_b32 v209, 16, v205
    v_pk_add_f32 v[214:215], v[168:169], v[206:207]
    v_pk_mul_f32 v[210:211], v[214:215], v[214:215]
    v_pk_add_f32 v[216:217], v[170:171], v[206:207]
    v_pk_mul_f32 v[212:213], v[216:217], v[216:217]
    v_pk_add_f32 v[218:219], v[172:173], v[206:207]
    v_pk_fma_f32 v[210:211], v[218:219], v[218:219], v[210:211]
    v_pk_add_f32 v[220:221], v[174:175], v[206:207]
    v_pk_fma_f32 v[212:213], v[220:221], v[220:221], v[212:213]
    v_pk_add_f32 v[214:215], v[176:177], v[206:207]
    v_pk_fma_f32 v[210:211], v[214:215], v[214:215], v[210:211]
    v_pk_add_f32 v[216:217], v[178:179], v[206:207]
    v_pk_fma_f32 v[212:213], v[216:217], v[216:217], v[212:213]
    v_pk_add_f32 v[218:219], v[180:181], v[206:207]
    v_pk_fma_f32 v[210:211], v[218:219], v[218:219], v[210:211]
    v_pk_add_f32 v[220:221], v[182:183], v[206:207]
    v_pk_fma_f32 v[212:213], v[220:221], v[220:221], v[212:213]
    v_pk_add_f32 v[214:215], v[184:185], v[206:207]
    v_pk_fma_f32 v[210:211], v[214:215], v[214:215], v[210:211]
    v_pk_add_f32 v[216:217], v[186:187], v[206:207]
    v_pk_fma_f32 v[212:213], v[216:217], v[216:217], v[212:213]
    v_pk_add_f32 v[218:219], v[188:189], v[206:207]
    v_pk_fma_f32 v[210:211], v[218:219], v[218:219], v[210:211]
    v_pk_add_f32 v[220:221], v[190:191], v[206:207]
    v_pk_fma_f32 v[212:213], v[220:221], v[220:221], v[212:213]
    v_pk_add_f32 v[214:215], v[192:193], v[206:207]
    v_pk_fma_f32 v[210:211], v[214:215], v[214:215], v[210:211]
    v_pk_add_f32 v[216:217], v[194:195], v[206:207]
    v_pk_fma_f32 v[212:213], v[216:217], v[216:217], v[212:213]
    v_pk_add_f32 v[218:219], v[196:197], v[206:207]
    v_pk_fma_f32 v[210:211], v[218:219], v[218:219], v[210:211]
    v_pk_add_f32 v[220:221], v[198:199], v[206:207]
    v_pk_fma_f32 v[212:213], v[220:221], v[220:221], v[212:213]
    v_pk_add_f32 v[214:215], v[200:201], v[206:207]
    v_pk_fma_f32 v[210:211], v[214:215], v[214:215], v[210:211]
    v_pk_add_f32 v[216:217], v[202:203], v[206:207]
    v_pk_fma_f32 v[212:213], v[216:217], v[216:217], v[212:213]
    v_pk_add_f32 v[210:211], v[210:211], v[212:213]
    v_add_f32 v210, v210, v211
    s_nop 1
    v_add_f32_dpp v210, v210, v210 row_ror:8 row_mask:0xf bank_mask:0xf
    s_nop 1
    v_add_f32_dpp v210, v210, v210 row_ror:4 row_mask:0xf bank_mask:0xf
    s_nop 1
    v_add_f32_dpp v210, v210, v210 row_ror:2 row_mask:0xf bank_mask:0xf
    s_nop 1
    v_add_f32_dpp v210, v210, v210 row_ror:1 row_mask:0xf bank_mask:0xf
    v_mul_f32 v210, s90, v210
    v_cvt_pk_bf16_f32 v210, v210, v210
    v_lshlrev_b32 v210, 16, v210
    v_add_f32 v210, 0x3727c5ac, v210
    v_cvt_pk_bf16_f32 v210, v210, v210
    v_lshlrev_b32 v210, 16, v210
    v_sqrt_f32 v210, v210
    s_nop 0
    v_cvt_pk_bf16_f32 v210, v210, v210
    v_lshlrev_b32 v210, 16, v210
    v_rcp_f32 v210, v210
    s_nop 0
    v_mov_b32 v211, v210
    v_pk_add_f32 v[168:169], v[168:169], v[208:209]
    v_pk_add_f32 v[170:171], v[170:171], v[208:209]
    v_cvt_pk_bf16_f32 v16, v168, v169
    v_cvt_pk_bf16_f32 v17, v170, v171
    v_lshlrev_b32 v168, 16, v16
    v_and_b32 v169, 0xffff0000, v16
    v_lshlrev_b32 v170, 16, v17
    v_and_b32 v171, 0xffff0000, v17
    v_pk_mul_f32 v[168:169], v[168:169], v[210:211]
    v_pk_mul_f32 v[170:171], v[170:171], v[210:211]
    v_cvt_pk_bf16_f32 v16, v168, v169
    v_cvt_pk_bf16_f32 v17, v170, v171
    ds_write_b64 v251, v[16:17] offset:0
    v_pk_add_f32 v[172:173], v[172:173], v[208:209]
    v_pk_add_f32 v[174:175], v[174:175], v[208:209]
    v_cvt_pk_bf16_f32 v18, v172, v173
    v_cvt_pk_bf16_f32 v19, v174, v175
    v_lshlrev_b32 v172, 16, v18
    v_and_b32 v173, 0xffff0000, v18
    v_lshlrev_b32 v174, 16, v19
    v_and_b32 v175, 0xffff0000, v19
    v_pk_mul_f32 v[172:173], v[172:173], v[210:211]
    v_pk_mul_f32 v[174:175], v[174:175], v[210:211]
    v_cvt_pk_bf16_f32 v18, v172, v173
    v_cvt_pk_bf16_f32 v19, v174, v175
    ds_write_b64 v251, v[18:19] offset:2048
    v_pk_add_f32 v[176:177], v[176:177], v[208:209]
    v_pk_add_f32 v[178:179], v[178:179], v[208:209]
    v_cvt_pk_bf16_f32 v20, v176, v177
    v_cvt_pk_bf16_f32 v21, v178, v179
    v_lshlrev_b32 v176, 16, v20
    v_and_b32 v177, 0xffff0000, v20
    v_lshlrev_b32 v178, 16, v21
    v_and_b32 v179, 0xffff0000, v21
    v_pk_mul_f32 v[176:177], v[176:177], v[210:211]
    v_pk_mul_f32 v[178:179], v[178:179], v[210:211]
    v_cvt_pk_bf16_f32 v20, v176, v177
    v_cvt_pk_bf16_f32 v21, v178, v179
    ds_write_b64 v251, v[20:21] offset:4096
    v_pk_add_f32 v[180:181], v[180:181], v[208:209]
    v_pk_add_f32 v[182:183], v[182:183], v[208:209]
    v_cvt_pk_bf16_f32 v22, v180, v181
    v_cvt_pk_bf16_f32 v23, v182, v183
    v_lshlrev_b32 v180, 16, v22
    v_and_b32 v181, 0xffff0000, v22
    v_lshlrev_b32 v182, 16, v23
    v_and_b32 v183, 0xffff0000, v23
    v_pk_mul_f32 v[180:181], v[180:181], v[210:211]
    v_pk_mul_f32 v[182:183], v[182:183], v[210:211]
    v_cvt_pk_bf16_f32 v22, v180, v181
    v_cvt_pk_bf16_f32 v23, v182, v183
    ds_write_b64 v251, v[22:23] offset:6144
    v_pk_add_f32 v[184:185], v[184:185], v[208:209]
    v_pk_add_f32 v[186:187], v[186:187], v[208:209]
    v_cvt_pk_bf16_f32 v24, v184, v185
    v_cvt_pk_bf16_f32 v25, v186, v187
    v_lshlrev_b32 v184, 16, v24
    v_and_b32 v185, 0xffff0000, v24
    v_lshlrev_b32 v186, 16, v25
    v_and_b32 v187, 0xffff0000, v25
    v_pk_mul_f32 v[184:185], v[184:185], v[210:211]
    v_pk_mul_f32 v[186:187], v[186:187], v[210:211]
    v_cvt_pk_bf16_f32 v24, v184, v185
    v_cvt_pk_bf16_f32 v25, v186, v187
    ds_write_b64 v251, v[24:25] offset:8192
    v_pk_add_f32 v[188:189], v[188:189], v[208:209]
    v_pk_add_f32 v[190:191], v[190:191], v[208:209]
    v_cvt_pk_bf16_f32 v26, v188, v189
    v_cvt_pk_bf16_f32 v27, v190, v191
    v_lshlrev_b32 v188, 16, v26
    v_and_b32 v189, 0xffff0000, v26
    v_lshlrev_b32 v190, 16, v27
    v_and_b32 v191, 0xffff0000, v27
    v_pk_mul_f32 v[188:189], v[188:189], v[210:211]
    v_pk_mul_f32 v[190:191], v[190:191], v[210:211]
    v_cvt_pk_bf16_f32 v26, v188, v189
    v_cvt_pk_bf16_f32 v27, v190, v191
    ds_write_b64 v251, v[26:27] offset:10240
    v_pk_add_f32 v[192:193], v[192:193], v[208:209]
    v_pk_add_f32 v[194:195], v[194:195], v[208:209]
    v_cvt_pk_bf16_f32 v28, v192, v193
    v_cvt_pk_bf16_f32 v29, v194, v195
    v_lshlrev_b32 v192, 16, v28
    v_and_b32 v193, 0xffff0000, v28
    v_lshlrev_b32 v194, 16, v29
    v_and_b32 v195, 0xffff0000, v29
    v_pk_mul_f32 v[192:193], v[192:193], v[210:211]
    v_pk_mul_f32 v[194:195], v[194:195], v[210:211]
    v_cvt_pk_bf16_f32 v28, v192, v193
    v_cvt_pk_bf16_f32 v29, v194, v195
    ds_write_b64 v251, v[28:29] offset:12288
    v_pk_add_f32 v[196:197], v[196:197], v[208:209]
    v_pk_add_f32 v[198:199], v[198:199], v[208:209]
    v_cvt_pk_bf16_f32 v30, v196, v197
    v_cvt_pk_bf16_f32 v31, v198, v199
    v_lshlrev_b32 v196, 16, v30
    v_and_b32 v197, 0xffff0000, v30
    v_lshlrev_b32 v198, 16, v31
    v_and_b32 v199, 0xffff0000, v31
    v_pk_mul_f32 v[196:197], v[196:197], v[210:211]
    v_pk_mul_f32 v[198:199], v[198:199], v[210:211]
    v_cvt_pk_bf16_f32 v30, v196, v197
    v_cvt_pk_bf16_f32 v31, v198, v199
    ds_write_b64 v251, v[30:31] offset:14336
    v_pk_add_f32 v[200:201], v[200:201], v[208:209]
    v_pk_add_f32 v[202:203], v[202:203], v[208:209]
    v_cvt_pk_bf16_f32 v32, v200, v201
    v_cvt_pk_bf16_f32 v33, v202, v203
    v_lshlrev_b32 v200, 16, v32
    v_and_b32 v201, 0xffff0000, v32
    v_lshlrev_b32 v202, 16, v33
    v_and_b32 v203, 0xffff0000, v33
    v_pk_mul_f32 v[200:201], v[200:201], v[210:211]
    v_pk_mul_f32 v[202:203], v[202:203], v[210:211]
    v_cvt_pk_bf16_f32 v32, v200, v201
    v_cvt_pk_bf16_f32 v33, v202, v203
    ds_write_b64 v251, v[32:33] offset:16384
    s_cmp_eq_u32 s45, 0
    s_cbranch_scc1 fused_kernel_l0
    v_lshlrev_b32 v168, 16, v16
    v_and_b32 v169, 0xffff0000, v16
    v_lshlrev_b32 v170, 16, v17
    v_and_b32 v171, 0xffff0000, v17
    v_cvt_pk_f16_f32 v168, v168, v169
    v_cvt_pk_f16_f32 v169, v170, v171
    ds_write_b64 v252, v[168:169] offset:0
    v_lshlrev_b32 v172, 16, v18
    v_and_b32 v173, 0xffff0000, v18
    v_lshlrev_b32 v174, 16, v19
    v_and_b32 v175, 0xffff0000, v19
    v_cvt_pk_f16_f32 v172, v172, v173
    v_cvt_pk_f16_f32 v173, v174, v175
    ds_write_b64 v252, v[172:173] offset:2048
    v_lshlrev_b32 v176, 16, v20
    v_and_b32 v177, 0xffff0000, v20
    v_lshlrev_b32 v178, 16, v21
    v_and_b32 v179, 0xffff0000, v21
    v_cvt_pk_f16_f32 v176, v176, v177
    v_cvt_pk_f16_f32 v177, v178, v179
    ds_write_b64 v252, v[176:177] offset:4096
    v_lshlrev_b32 v180, 16, v22
    v_and_b32 v181, 0xffff0000, v22
    v_lshlrev_b32 v182, 16, v23
    v_and_b32 v183, 0xffff0000, v23
    v_cvt_pk_f16_f32 v180, v180, v181
    v_cvt_pk_f16_f32 v181, v182, v183
    ds_write_b64 v252, v[180:181] offset:6144
    v_lshlrev_b32 v184, 16, v24
    v_and_b32 v185, 0xffff0000, v24
    v_lshlrev_b32 v186, 16, v25
    v_and_b32 v187, 0xffff0000, v25
    v_cvt_pk_f16_f32 v184, v184, v185
    v_cvt_pk_f16_f32 v185, v186, v187
    ds_write_b64 v252, v[184:185] offset:8192
    v_lshlrev_b32 v188, 16, v26
    v_and_b32 v189, 0xffff0000, v26
    v_lshlrev_b32 v190, 16, v27
    v_and_b32 v191, 0xffff0000, v27
    v_cvt_pk_f16_f32 v188, v188, v189
    v_cvt_pk_f16_f32 v189, v190, v191
    ds_write_b64 v252, v[188:189] offset:10240
    v_lshlrev_b32 v192, 16, v28
    v_and_b32 v193, 0xffff0000, v28
    v_lshlrev_b32 v194, 16, v29
    v_and_b32 v195, 0xffff0000, v29
    v_cvt_pk_f16_f32 v192, v192, v193
    v_cvt_pk_f16_f32 v193, v194, v195
    ds_write_b64 v252, v[192:193] offset:12288
    v_lshlrev_b32 v196, 16, v30
    v_and_b32 v197, 0xffff0000, v30
    v_lshlrev_b32 v198, 16, v31
    v_and_b32 v199, 0xffff0000, v31
    v_cvt_pk_f16_f32 v196, v196, v197
    v_cvt_pk_f16_f32 v197, v198, v199
    ds_write_b64 v252, v[196:197] offset:14336
    v_lshlrev_b32 v200, 16, v32
    v_and_b32 v201, 0xffff0000, v32
    v_lshlrev_b32 v202, 16, v33
    v_and_b32 v203, 0xffff0000, v33
    v_cvt_pk_f16_f32 v200, v200, v201
    v_cvt_pk_f16_f32 v201, v202, v203
    ds_write_b64 v252, v[200:201] offset:16384
fused_kernel_l0:
    s_waitcnt vmcnt(0)
    s_cmp_lg_u32 s39, 0
    s_cbranch_scc1 fused_kernel_g1
    v_mov_b32 v12, 149760
    v_mov_b32 v13, 1
    s_mov_b64 exec, 1
    ds_add_rtn_u32 v13, v12, v13
    s_waitcnt lgkmcnt(0)
    v_readfirstlane_b32 s35, v13
    s_mov_b64 exec, -1
    s_nop 1
    s_cmp_lg_u32 s35, 3
    s_cbranch_scc1 fused_kernel_g1
    s_lshl_b32 s33, s20, 8
    s_lshl_b32 s34, s21, 3
    s_add_u32 s33, s33, s34
    s_add_u32 s33, s33, 0xa20000
    v_mov_b32 v12, s100
    v_mov_b32 v13, s101
    s_mov_b64 exec, 1
    buffer_store_dwordx2 v[12:13], v1, s[12:15], s33 offen sc1
    s_mov_b64 exec, -1
fused_kernel_g1:
    s_cmp_ge_u32 s2, 128
    s_cbranch_scc1 fused_kernel_nw
    s_lshr_b32 s33, s2, 5
    s_lshl_b32 s33, s33, 2
    s_add_u32 s33, s33, s38
    s_lshl_b32 s34, s39, 4
    s_add_u32 s33, s33, s34
    s_lshl_b32 s33, s33, 6
    s_and_b32 s34, s2, 31
    s_lshl_b32 s34, s34, 1
    s_add_u32 s33, s33, s34
    s_mul_i32 s33, s33, 578
    v_lshlrev_b32 v12, 2, v9
    buffer_load_dword v84, v12, s[72:75], s33 offen offset:0
    buffer_load_dword v85, v12, s[72:75], s33 offen offset:256
    buffer_load_dword v86, v12, s[72:75], s33 offen offset:512
    buffer_load_dword v87, v12, s[72:75], s33 offen offset:768
    s_mov_b32 exec_hi, 1
    buffer_load_dword v88, v12, s[72:75], s33 offen offset:1024
    s_mov_b32 exec_hi, -1
    buffer_load_dword v89, v12, s[76:79], s33 offen offset:0
    buffer_load_dword v90, v12, s[76:79], s33 offen offset:256
    buffer_load_dword v91, v12, s[76:79], s33 offen offset:512
    buffer_load_dword v92, v12, s[76:79], s33 offen offset:768
    s_mov_b32 exec_hi, 1
    buffer_load_dword v93, v12, s[76:79], s33 offen offset:1024
    s_mov_b32 exec_hi, -1
fused_kernel_nw:
    s_cmp_eq_u32 s39, 0
    s_cbranch_scc1 fused_kernel_nt2
    s_lshl_b32 s63, s38, 5
    s_add_u32 s63, s63, s21
    s_add_u32 s63, s63, 162
    v_lshrrev_b32 v240, 3, v9
    v_and_b32 v241, 6, v240
    v_xor_b32 v241, v241, v9
    v_and_b32 v241, 7, v241
    v_lshlrev_b32 v241, 4, v241
    s_sub_u32 s50, s63, 162
    s_cselect_b32 s50, s63, s50
    s_mul_i32 s48, s50, 7282
    s_lshr_b32 s48, s48, 16
    s_mul_i32 s49, s48, 9
    s_sub_u32 s49, s50, s49
    s_mul_i32 s52, s49, 73728
    s_lshl_b32 s50, s48, 10
    s_add_u32 s52, s52, s50
    s_mul_i32 s50, s20, 663552
    s_add_u32 s52, s52, s50
    s_lshl_b32 s49, s49, 7
    s_cmp_ge_u32 s63, 162
    s_cbranch_scc1 L4
    s_add_u32 s52, s52, 0xa40000
    s_mul_i32 s48, s48, 294912
    s_add_u32 s48, s48, s49
    s_mul_i32 s49, s20, 1152
    s_add_u32 s48, s48, s49
    s_movk_i32 s49, 9216
    v_mad_u32_u24 v240, v240, s49, v241
    s_add_u32 s50, s48, 0
    buffer_load_dwordx4 v[68:71], v240, s[64:67], s50 offen
    s_add_u32 s50, s48, 73728
    buffer_load_dwordx4 v[72:75], v240, s[64:67], s50 offen
    s_add_u32 s50, s48, 147456
    buffer_load_dwordx4 v[76:79], v240, s[64:67], s50 offen
    s_add_u32 s50, s48, 221184
    buffer_load_dwordx4 v[80:83], v240, s[64:67], s50 offen
    s_branch L5
L4:
    s_add_u32 s52, s52, 0xf50000
    s_mul_i32 s48, s48, 36864
    s_add_u32 s48, s48, s49
    s_mul_i32 s49, s20, 663552
    s_add_u32 s48, s48, s49
    s_movk_i32 s49, 1152
    v_mad_u32_u24 v240, v240, s49, v241
    s_add_u32 s50, s48, 0
    buffer_load_dwordx4 v[68:71], v240, s[68:71], s50 offen
    s_add_u32 s50, s48, 9216
    buffer_load_dwordx4 v[72:75], v240, s[68:71], s50 offen
    s_add_u32 s50, s48, 18432
    buffer_load_dwordx4 v[76:79], v240, s[68:71], s50 offen
    s_add_u32 s50, s48, 27648
    buffer_load_dwordx4 v[80:83], v240, s[68:71], s50 offen
L5:
    s_add_u32 s63, s63, 128
    s_cmp_ge_u32 s63, 324
    s_cbranch_scc1 fused_kernel_nt2
    v_lshrrev_b32 v240, 3, v9
    v_and_b32 v241, 6, v240
    v_xor_b32 v241, v241, v9
    v_and_b32 v241, 7, v241
    v_lshlrev_b32 v241, 4, v241
    s_sub_u32 s55, s63, 162
    s_cselect_b32 s55, s63, s55
    s_mul_i32 s53, s55, 7282
    s_lshr_b32 s53, s53, 16
    s_mul_i32 s54, s53, 9
    s_sub_u32 s54, s55, s54
    s_mul_i32 s57, s54, 73728
    s_lshl_b32 s55, s53, 10
    s_add_u32 s57, s57, s55
    s_mul_i32 s55, s20, 663552
    s_add_u32 s57, s57, s55
    s_lshl_b32 s54, s54, 7
    s_cmp_ge_u32 s63, 162
    s_cbranch_scc1 L6
    s_add_u32 s57, s57, 0xa40000
    s_mul_i32 s53, s53, 294912
    s_add_u32 s53, s53, s54
    s_mul_i32 s54, s20, 1152
    s_add_u32 s53, s53, s54
    s_movk_i32 s54, 9216
    v_mad_u32_u24 v240, v240, s54, v241
    s_add_u32 s55, s53, 0
    buffer_load_dwordx4 v[224:227], v240, s[64:67], s55 offen
    s_add_u32 s55, s53, 73728
    buffer_load_dwordx4 v[228:231], v240, s[64:67], s55 offen
    s_add_u32 s55, s53, 147456
    buffer_load_dwordx4 v[232:235], v240, s[64:67], s55 offen
    s_add_u32 s55, s53, 221184
    buffer_load_dwordx4 v[236:239], v240, s[64:67], s55 offen
    s_branch L7
L6:
    s_add_u32 s57, s57, 0xf50000
    s_mul_i32 s53, s53, 36864
    s_add_u32 s53, s53, s54
    s_mul_i32 s54, s20, 663552
    s_add_u32 s53, s53, s54
    s_movk_i32 s54, 1152
    v_mad_u32_u24 v240, v240, s54, v241
    s_add_u32 s55, s53, 0
    buffer_load_dwordx4 v[224:227], v240, s[68:71], s55 offen
    s_add_u32 s55, s53, 9216
    buffer_load_dwordx4 v[228:231], v240, s[68:71], s55 offen
    s_add_u32 s55, s53, 18432
    buffer_load_dwordx4 v[232:235], v240, s[68:71], s55 offen
    s_add_u32 s55, s53, 27648
    buffer_load_dwordx4 v[236:239], v240, s[68:71], s55 offen
L7:
fused_kernel_nt2:
    v_min_u32 v12, 287, v0
    v_lshlrev_b32 v12, 3, v12
    v_add_u32 v12, 147456, v12
    v_lshlrev_b32 v222, 16, v94
    v_and_b32 v223, 0xffff0000, v94
    ds_write_b64 v12, v[222:223]
    v_xor_b32 v251, 128, v251
    v_xor_b32 v252, 64, v252
    v_lshlrev_b32 v168, 16, v34
    v_and_b32 v169, 0xffff0000, v34
    v_lshlrev_b32 v170, 16, v35
    v_and_b32 v171, 0xffff0000, v35
    v_lshlrev_b32 v172, 16, v36
    v_and_b32 v173, 0xffff0000, v36
    v_lshlrev_b32 v174, 16, v37
    v_and_b32 v175, 0xffff0000, v37
    v_lshlrev_b32 v176, 16, v38
    v_and_b32 v177, 0xffff0000, v38
    v_lshlrev_b32 v178, 16, v39
    v_and_b32 v179, 0xffff0000, v39
    v_lshlrev_b32 v180, 16, v40
    v_and_b32 v181, 0xffff0000, v40
    v_lshlrev_b32 v182, 16, v41
    v_and_b32 v183, 0xffff0000, v41
    v_lshlrev_b32 v184, 16, v42
    v_and_b32 v185, 0xffff0000, v42
    v_lshlrev_b32 v186, 16, v43
    v_and_b32 v187, 0xffff0000, v43
    v_lshlrev_b32 v188, 16, v44
    v_and_b32 v189, 0xffff0000, v44
    v_lshlrev_b32 v190, 16, v45
    v_and_b32 v191, 0xffff0000, v45
    v_lshlrev_b32 v192, 16, v46
    v_and_b32 v193, 0xffff0000, v46
    v_lshlrev_b32 v194, 16, v47
    v_and_b32 v195, 0xffff0000, v47
    v_lshlrev_b32 v196, 16, v48
    v_and_b32 v197, 0xffff0000, v48
    v_lshlrev_b32 v198, 16, v49
    v_and_b32 v199, 0xffff0000, v49
    v_lshlrev_b32 v200, 16, v50
    v_and_b32 v201, 0xffff0000, v50
    v_lshlrev_b32 v202, 16, v51
    v_and_b32 v203, 0xffff0000, v51
    v_pk_add_f32 v[204:205], v[168:169], v[170:171]
    v_pk_add_f32 v[206:207], v[172:173], v[174:175]
    v_pk_add_f32 v[204:205], v[204:205], v[176:177]
    v_pk_add_f32 v[206:207], v[206:207], v[178:179]
    v_pk_add_f32 v[204:205], v[204:205], v[180:181]
    v_pk_add_f32 v[206:207], v[206:207], v[182:183]
    v_pk_add_f32 v[204:205], v[204:205], v[184:185]
    v_pk_add_f32 v[206:207], v[206:207], v[186:187]
    v_pk_add_f32 v[204:205], v[204:205], v[188:189]
    v_pk_add_f32 v[206:207], v[206:207], v[190:191]
    v_pk_add_f32 v[204:205], v[204:205], v[192:193]
    v_pk_add_f32 v[206:207], v[206:207], v[194:195]
    v_pk_add_f32 v[204:205], v[204:205], v[196:197]
    v_pk_add_f32 v[206:207], v[206:207], v[198:199]
    v_pk_add_f32 v[204:205], v[204:205], v[200:201]
    v_pk_add_f32 v[206:207], v[206:207], v[202:203]
    v_pk_add_f32 v[204:205], v[204:205], v[206:207]
    v_add_f32 v204, v204, v205
    s_nop 1
    v_add_f32_dpp v204, v204, v204 row_ror:8 row_mask:0xf bank_mask:0xf
    s_nop 1
    v_add_f32_dpp v204, v204, v204 row_ror:4 row_mask:0xf bank_mask:0xf
    s_nop 1
    v_add_f32_dpp v204, v204, v204 row_ror:2 row_mask:0xf bank_mask:0xf
    s_nop 1
    v_add_f32_dpp v204, v204, v204 row_ror:1 row_mask:0xf bank_mask:0xf
    v_mul_f32 v204, s90, v204
    v_sub_f32 v206, 0, v204
    v_sub_f32 v207, 0, v204
    v_cvt_pk_bf16_f32 v205, v206, v206
    v_lshlrev_b32 v208, 16, v205
    v_lshlrev_b32 v209, 16, v205
    v_pk_add_f32 v[214:215], v[168:169], v[206:207]
    v_pk_mul_f32 v[210:211], v[214:215], v[214:215]
    v_pk_add_f32 v[216:217], v[170:171], v[206:207]
    v_pk_mul_f32 v[212:213], v[216:217], v[216:217]
    v_pk_add_f32 v[218:219], v[172:173], v[206:207]
    v_pk_fma_f32 v[210:211], v[218:219], v[218:219], v[210:211]
    v_pk_add_f32 v[220:221], v[174:175], v[206:207]
    v_pk_fma_f32 v[212:213], v[220:221], v[220:221], v[212:213]
    v_pk_add_f32 v[214:215], v[176:177], v[206:207]
    v_pk_fma_f32 v[210:211], v[214:215], v[214:215], v[210:211]
    v_pk_add_f32 v[216:217], v[178:179], v[206:207]
    v_pk_fma_f32 v[212:213], v[216:217], v[216:217], v[212:213]
    v_pk_add_f32 v[218:219], v[180:181], v[206:207]
    v_pk_fma_f32 v[210:211], v[218:219], v[218:219], v[210:211]
    v_pk_add_f32 v[220:221], v[182:183], v[206:207]
    v_pk_fma_f32 v[212:213], v[220:221], v[220:221], v[212:213]
    v_pk_add_f32 v[214:215], v[184:185], v[206:207]
    v_pk_fma_f32 v[210:211], v[214:215], v[214:215], v[210:211]
    v_pk_add_f32 v[216:217], v[186:187], v[206:207]
    v_pk_fma_f32 v[212:213], v[216:217], v[216:217], v[212:213]
    v_pk_add_f32 v[218:219], v[188:189], v[206:207]
    v_pk_fma_f32 v[210:211], v[218:219], v[218:219], v[210:211]
    v_pk_add_f32 v[220:221], v[190:191], v[206:207]
    v_pk_fma_f32 v[212:213], v[220:221], v[220:221], v[212:213]
    v_pk_add_f32 v[214:215], v[192:193], v[206:207]
    v_pk_fma_f32 v[210:211], v[214:215], v[214:215], v[210:211]
    v_pk_add_f32 v[216:217], v[194:195], v[206:207]
    v_pk_fma_f32 v[212:213], v[216:217], v[216:217], v[212:213]
    v_pk_add_f32 v[218:219], v[196:197], v[206:207]
    v_pk_fma_f32 v[210:211], v[218:219], v[218:219], v[210:211]
    v_pk_add_f32 v[220:221], v[198:199], v[206:207]
    v_pk_fma_f32 v[212:213], v[220:221], v[220:221], v[212:213]
    v_pk_add_f32 v[214:215], v[200:201], v[206:207]
    v_pk_fma_f32 v[210:211], v[214:215], v[214:215], v[210:211]
    v_pk_add_f32 v[216:217], v[202:203], v[206:207]
    v_pk_fma_f32 v[212:213], v[216:217], v[216:217], v[212:213]
    v_pk_add_f32 v[210:211], v[210:211], v[212:213]
    v_add_f32 v210, v210, v211
    s_nop 1
    v_add_f32_dpp v210, v210, v210 row_ror:8 row_mask:0xf bank_mask:0xf
    s_nop 1
    v_add_f32_dpp v210, v210, v210 row_ror:4 row_mask:0xf bank_mask:0xf
    s_nop 1
    v_add_f32_dpp v210, v210, v210 row_ror:2 row_mask:0xf bank_mask:0xf
    s_nop 1
    v_add_f32_dpp v210, v210, v210 row_ror:1 row_mask:0xf bank_mask:0xf
    v_mul_f32 v210, s90, v210
    v_cvt_pk_bf16_f32 v210, v210, v210
    v_lshlrev_b32 v210, 16, v210
    v_add_f32 v210, 0x3727c5ac, v210
    v_cvt_pk_bf16_f32 v210, v210, v210
    v_lshlrev_b32 v210, 16, v210
    v_sqrt_f32 v210, v210
    s_nop 0
    v_cvt_pk_bf16_f32 v210, v210, v210
    v_lshlrev_b32 v210, 16, v210
    v_rcp_f32 v210, v210
    s_nop 0
    v_mov_b32 v211, v210
    v_pk_add_f32 v[168:169], v[168:169], v[208:209]
    v_pk_add_f32 v[170:171], v[170:171], v[208:209]
    v_cvt_pk_bf16_f32 v34, v168, v169
    v_cvt_pk_bf16_f32 v35, v170, v171
    v_lshlrev_b32 v168, 16, v34
    v_and_b32 v169, 0xffff0000, v34
    v_lshlrev_b32 v170, 16, v35
    v_and_b32 v171, 0xffff0000, v35
    v_pk_mul_f32 v[168:169], v[168:169], v[210:211]
    v_pk_mul_f32 v[170:171], v[170:171], v[210:211]
    v_cvt_pk_bf16_f32 v34, v168, v169
    v_cvt_pk_bf16_f32 v35, v170, v171
    ds_write_b64 v251, v[34:35] offset:0
    v_pk_add_f32 v[172:173], v[172:173], v[208:209]
    v_pk_add_f32 v[174:175], v[174:175], v[208:209]
    v_cvt_pk_bf16_f32 v36, v172, v173
    v_cvt_pk_bf16_f32 v37, v174, v175
    v_lshlrev_b32 v172, 16, v36
    v_and_b32 v173, 0xffff0000, v36
    v_lshlrev_b32 v174, 16, v37
    v_and_b32 v175, 0xffff0000, v37
    v_pk_mul_f32 v[172:173], v[172:173], v[210:211]
    v_pk_mul_f32 v[174:175], v[174:175], v[210:211]
    v_cvt_pk_bf16_f32 v36, v172, v173
    v_cvt_pk_bf16_f32 v37, v174, v175
    ds_write_b64 v251, v[36:37] offset:2048
    v_pk_add_f32 v[176:177], v[176:177], v[208:209]
    v_pk_add_f32 v[178:179], v[178:179], v[208:209]
    v_cvt_pk_bf16_f32 v38, v176, v177
    v_cvt_pk_bf16_f32 v39, v178, v179
    v_lshlrev_b32 v176, 16, v38
    v_and_b32 v177, 0xffff0000, v38
    v_lshlrev_b32 v178, 16, v39
    v_and_b32 v179, 0xffff0000, v39
    v_pk_mul_f32 v[176:177], v[176:177], v[210:211]
    v_pk_mul_f32 v[178:179], v[178:179], v[210:211]
    v_cvt_pk_bf16_f32 v38, v176, v177
    v_cvt_pk_bf16_f32 v39, v178, v179
    ds_write_b64 v251, v[38:39] offset:4096
    v_pk_add_f32 v[180:181], v[180:181], v[208:209]
    v_pk_add_f32 v[182:183], v[182:183], v[208:209]
    v_cvt_pk_bf16_f32 v40, v180, v181
    v_cvt_pk_bf16_f32 v41, v182, v183
    v_lshlrev_b32 v180, 16, v40
    v_and_b32 v181, 0xffff0000, v40
    v_lshlrev_b32 v182, 16, v41
    v_and_b32 v183, 0xffff0000, v41
    v_pk_mul_f32 v[180:181], v[180:181], v[210:211]
    v_pk_mul_f32 v[182:183], v[182:183], v[210:211]
    v_cvt_pk_bf16_f32 v40, v180, v181
    v_cvt_pk_bf16_f32 v41, v182, v183
    ds_write_b64 v251, v[40:41] offset:6144
    v_pk_add_f32 v[184:185], v[184:185], v[208:209]
    v_pk_add_f32 v[186:187], v[186:187], v[208:209]
    v_cvt_pk_bf16_f32 v42, v184, v185
    v_cvt_pk_bf16_f32 v43, v186, v187
    v_lshlrev_b32 v184, 16, v42
    v_and_b32 v185, 0xffff0000, v42
    v_lshlrev_b32 v186, 16, v43
    v_and_b32 v187, 0xffff0000, v43
    v_pk_mul_f32 v[184:185], v[184:185], v[210:211]
    v_pk_mul_f32 v[186:187], v[186:187], v[210:211]
    v_cvt_pk_bf16_f32 v42, v184, v185
    v_cvt_pk_bf16_f32 v43, v186, v187
    ds_write_b64 v251, v[42:43] offset:8192
    v_pk_add_f32 v[188:189], v[188:189], v[208:209]
    v_pk_add_f32 v[190:191], v[190:191], v[208:209]
    v_cvt_pk_bf16_f32 v44, v188, v189
    v_cvt_pk_bf16_f32 v45, v190, v191
    v_lshlrev_b32 v188, 16, v44
    v_and_b32 v189, 0xffff0000, v44
    v_lshlrev_b32 v190, 16, v45
    v_and_b32 v191, 0xffff0000, v45
    v_pk_mul_f32 v[188:189], v[188:189], v[210:211]
    v_pk_mul_f32 v[190:191], v[190:191], v[210:211]
    v_cvt_pk_bf16_f32 v44, v188, v189
    v_cvt_pk_bf16_f32 v45, v190, v191
    ds_write_b64 v251, v[44:45] offset:10240
    v_pk_add_f32 v[192:193], v[192:193], v[208:209]
    v_pk_add_f32 v[194:195], v[194:195], v[208:209]
    v_cvt_pk_bf16_f32 v46, v192, v193
    v_cvt_pk_bf16_f32 v47, v194, v195
    v_lshlrev_b32 v192, 16, v46
    v_and_b32 v193, 0xffff0000, v46
    v_lshlrev_b32 v194, 16, v47
    v_and_b32 v195, 0xffff0000, v47
    v_pk_mul_f32 v[192:193], v[192:193], v[210:211]
    v_pk_mul_f32 v[194:195], v[194:195], v[210:211]
    v_cvt_pk_bf16_f32 v46, v192, v193
    v_cvt_pk_bf16_f32 v47, v194, v195
    ds_write_b64 v251, v[46:47] offset:12288
    v_pk_add_f32 v[196:197], v[196:197], v[208:209]
    v_pk_add_f32 v[198:199], v[198:199], v[208:209]
    v_cvt_pk_bf16_f32 v48, v196, v197
    v_cvt_pk_bf16_f32 v49, v198, v199
    v_lshlrev_b32 v196, 16, v48
    v_and_b32 v197, 0xffff0000, v48
    v_lshlrev_b32 v198, 16, v49
    v_and_b32 v199, 0xffff0000, v49
    v_pk_mul_f32 v[196:197], v[196:197], v[210:211]
    v_pk_mul_f32 v[198:199], v[198:199], v[210:211]
    v_cvt_pk_bf16_f32 v48, v196, v197
    v_cvt_pk_bf16_f32 v49, v198, v199
    ds_write_b64 v251, v[48:49] offset:14336
    v_pk_add_f32 v[200:201], v[200:201], v[208:209]
    v_pk_add_f32 v[202:203], v[202:203], v[208:209]
    v_cvt_pk_bf16_f32 v50, v200, v201
    v_cvt_pk_bf16_f32 v51, v202, v203
    v_lshlrev_b32 v200, 16, v50
    v_and_b32 v201, 0xffff0000, v50
    v_lshlrev_b32 v202, 16, v51
    v_and_b32 v203, 0xffff0000, v51
    v_pk_mul_f32 v[200:201], v[200:201], v[210:211]
    v_pk_mul_f32 v[202:203], v[202:203], v[210:211]
    v_cvt_pk_bf16_f32 v50, v200, v201
    v_cvt_pk_bf16_f32 v51, v202, v203
    ds_write_b64 v251, v[50:51] offset:16384
    s_cmp_eq_u32 s45, 0
    s_cbranch_scc1 fused_kernel_l1
    v_lshlrev_b32 v168, 16, v34
    v_and_b32 v169, 0xffff0000, v34
    v_lshlrev_b32 v170, 16, v35
    v_and_b32 v171, 0xffff0000, v35
    v_cvt_pk_f16_f32 v168, v168, v169
    v_cvt_pk_f16_f32 v169, v170, v171
    ds_write_b64 v252, v[168:169] offset:0
    v_lshlrev_b32 v172, 16, v36
    v_and_b32 v173, 0xffff0000, v36
    v_lshlrev_b32 v174, 16, v37
    v_and_b32 v175, 0xffff0000, v37
    v_cvt_pk_f16_f32 v172, v172, v173
    v_cvt_pk_f16_f32 v173, v174, v175
    ds_write_b64 v252, v[172:173] offset:2048
    v_lshlrev_b32 v176, 16, v38
    v_and_b32 v177, 0xffff0000, v38
    v_lshlrev_b32 v178, 16, v39
    v_and_b32 v179, 0xffff0000, v39
    v_cvt_pk_f16_f32 v176, v176, v177
    v_cvt_pk_f16_f32 v177, v178, v179
    ds_write_b64 v252, v[176:177] offset:4096
    v_lshlrev_b32 v180, 16, v40
    v_and_b32 v181, 0xffff0000, v40
    v_lshlrev_b32 v182, 16, v41
    v_and_b32 v183, 0xffff0000, v41
    v_cvt_pk_f16_f32 v180, v180, v181
    v_cvt_pk_f16_f32 v181, v182, v183
    ds_write_b64 v252, v[180:181] offset:6144
    v_lshlrev_b32 v184, 16, v42
    v_and_b32 v185, 0xffff0000, v42
    v_lshlrev_b32 v186, 16, v43
    v_and_b32 v187, 0xffff0000, v43
    v_cvt_pk_f16_f32 v184, v184, v185
    v_cvt_pk_f16_f32 v185, v186, v187
    ds_write_b64 v252, v[184:185] offset:8192
    v_lshlrev_b32 v188, 16, v44
    v_and_b32 v189, 0xffff0000, v44
    v_lshlrev_b32 v190, 16, v45
    v_and_b32 v191, 0xffff0000, v45
    v_cvt_pk_f16_f32 v188, v188, v189
    v_cvt_pk_f16_f32 v189, v190, v191
    ds_write_b64 v252, v[188:189] offset:10240
    v_lshlrev_b32 v192, 16, v46
    v_and_b32 v193, 0xffff0000, v46
    v_lshlrev_b32 v194, 16, v47
    v_and_b32 v195, 0xffff0000, v47
    v_cvt_pk_f16_f32 v192, v192, v193
    v_cvt_pk_f16_f32 v193, v194, v195
    ds_write_b64 v252, v[192:193] offset:12288
    v_lshlrev_b32 v196, 16, v48
    v_and_b32 v197, 0xffff0000, v48
    v_lshlrev_b32 v198, 16, v49
    v_and_b32 v199, 0xffff0000, v49
    v_cvt_pk_f16_f32 v196, v196, v197
    v_cvt_pk_f16_f32 v197, v198, v199
    ds_write_b64 v252, v[196:197] offset:14336
    v_lshlrev_b32 v200, 16, v50
    v_and_b32 v201, 0xffff0000, v50
    v_lshlrev_b32 v202, 16, v51
    v_and_b32 v203, 0xffff0000, v51
    v_cvt_pk_f16_f32 v200, v200, v201
    v_cvt_pk_f16_f32 v201, v202, v203
    ds_write_b64 v252, v[200:201] offset:16384
fused_kernel_l1:
    s_waitcnt vmcnt(0)
    s_cmp_eq_u32 s39, 0
    s_cbranch_scc1 fused_kernel_nt2b
    v_add_u32 v241, s36, v1
    ds_write_b128 v241, v[68:71] offset:0
    ds_write_b128 v241, v[72:75] offset:1024
    ds_write_b128 v241, v[76:79] offset:2048
    ds_write_b128 v241, v[80:83] offset:3072
    v_bfe_u32 v240, v9, 2, 4
    v_bfe_u32 v241, v240, 1, 2
    v_lshlrev_b32 v241, 5, v241
    v_lshl_add_u32 v240, v240, 7, v241
    v_and_b32 v241, 3, v9
    v_lshl_add_u32 v240, v241, 3, v240
    v_add_u32 v240, s36, v240
    s_waitcnt lgkmcnt(0)
    ds_read_b64_tr_b16 v[68:69], v240 offset:0
    ds_read_b64_tr_b16 v[70:71], v240 offset:2048
    v_xor_b32 v240, 32, v240
    ds_read_b64_tr_b16 v[72:73], v240 offset:0
    ds_read_b64_tr_b16 v[74:75], v240 offset:2048
    v_xor_b32 v240, 96, v240
    ds_read_b64_tr_b16 v[76:77], v240 offset:0
    ds_read_b64_tr_b16 v[78:79], v240 offset:2048
    v_xor_b32 v240, 32, v240
    ds_read_b64_tr_b16 v[80:81], v240 offset:0
    ds_read_b64_tr_b16 v[82:83], v240 offset:2048
    s_waitcnt lgkmcnt(6)
    buffer_store_dwordx4 v[68:71], v1, s[12:15], s52 offen sc1
    s_waitcnt lgkmcnt(4)
    s_add_u32 s52, s52, 18432
    buffer_store_dwordx4 v[72:75], v1, s[12:15], s52 offen sc1
    s_waitcnt lgkmcnt(2)
    s_add_u32 s52, s52, 18432
    buffer_store_dwordx4 v[76:79], v1, s[12:15], s52 offen sc1
    s_waitcnt lgkmcnt(0)
    s_add_u32 s52, s52, 18432
    buffer_store_dwordx4 v[80:83], v1, s[12:15], s52 offen sc1
    s_cmp_ge_u32 s63, 324
    s_cbranch_scc1 fused_kernel_nt2b
    v_add_u32 v241, s36, v1
    ds_write_b128 v241, v[224:227] offset:0
    ds_write_b128 v241, v[228:231] offset:1024
    ds_write_b128 v241, v[232:235] offset:2048
    ds_write_b128 v241, v[236:239] offset:3072
    v_bfe_u32 v240, v9, 2, 4
    v_bfe_u32 v241, v240, 1, 2
    v_lshlrev_b32 v241, 5, v241
    v_lshl_add_u32 v240, v240, 7, v241
    v_and_b32 v241, 3, v9
    v_lshl_add_u32 v240, v241, 3, v240
    v_add_u32 v240, s36, v240
    s_waitcnt lgkmcnt(0)
    ds_read_b64_tr_b16 v[224:225], v240 offset:0
    ds_read_b64_tr_b16 v[226:227], v240 offset:2048
    v_xor_b32 v240, 32, v240
    ds_read_b64_tr_b16 v[228:229], v240 offset:0
    ds_read_b64_tr_b16 v[230:231], v240 offset:2048
    v_xor_b32 v240, 96, v240
    ds_read_b64_tr_b16 v[232:233], v240 offset:0
    ds_read_b64_tr_b16 v[234:235], v240 offset:2048
    v_xor_b32 v240, 32, v240
    ds_read_b64_tr_b16 v[236:237], v240 offset:0
    ds_read_b64_tr_b16 v[238:239], v240 offset:2048
    s_waitcnt lgkmcnt(6)
    buffer_store_dwordx4 v[224:227], v1, s[12:15], s57 offen sc1
    s_waitcnt lgkmcnt(4)
    s_add_u32 s57, s57, 18432
    buffer_store_dwordx4 v[228:231], v1, s[12:15], s57 offen sc1
    s_waitcnt lgkmcnt(2)
    s_add_u32 s57, s57, 18432
    buffer_store_dwordx4 v[232:235], v1, s[12:15], s57 offen sc1
    s_waitcnt lgkmcnt(0)
    s_add_u32 s57, s57, 18432
    buffer_store_dwordx4 v[236:239], v1, s[12:15], s57 offen sc1
fused_kernel_nt2b:
    s_cmp_ge_u32 s2, 128
    s_cbranch_scc1 fused_kernel_nwb
    v_lshlrev_b32 v12, 2, v9
    v_add_u32 v12, s36, v12
    ds_write_b32 v12, v84 offset:0
    ds_write_b32 v12, v85 offset:256
    ds_write_b32 v12, v86 offset:512
    ds_write_b32 v12, v87 offset:768
    s_mov_b32 exec_hi, 1
    ds_write_b32 v12, v88 offset:1024
    s_mov_b32 exec_hi, -1
    ds_write_b32 v12, v89 offset:1160
    ds_write_b32 v12, v90 offset:1416
    ds_write_b32 v12, v91 offset:1672
    ds_write_b32 v12, v92 offset:1928
    s_mov_b32 exec_hi, 1
    ds_write_b32 v12, v93 offset:2184
    s_mov_b32 exec_hi, -1
fused_kernel_nwb:
    s_cmp_lg_u32 s22, 7
    s_cbranch_scc1 fused_kernel_n7
    s_lshl_b32 s91, s62, 4
    v_add_u32 v30, s91, v248
    v_lshrrev_b32 v28, 1, v30
    v_and_b32 v29, 1, v30
    v_cmp_eq_u32 vcc, 1, v30
    v_mov_b32 v31, 288
    v_lshlrev_b32 v33, 2, v29
    v_cndmask_b32 v28, v28, v31, vcc
    v_cndmask_b32 v29, v29, 0, vcc
    v_mul_u32_u24 v29, 144, v29
    v_and_b32 v30, 1, v28
    v_mul_u32_u24 v30, 0x8000, v30
    v_lshl_or_b32 v26, v30, 16, v30
    v_and_b32 v30, 3, v28
    v_add_u32 v30, v30, v33
    v_mov_b32 v31, 0x6c
    v_lshrrev_b32 v30, v30, v31
    v_and_b32 v30, 1, v30
    v_mul_u32_u24 v30, 0x8000, v30
    v_lshl_or_b32 v25, v30, 16, v30
    v_lshlrev_b32 v30, 4, v28
    v_mul_hi_u32 v31, v30, s88
    v_mul_u32_u24 v31, s89, v31
    v_sub_u32 v32, v30, v31
    v_mul_u32_u24 v30, v28, v249
    v_lshlrev_b32 v30, 2, v30
    v_mul_hi_u32 v31, v30, s88
    v_mul_u32_u24 v31, s89, v31
    v_sub_u32 v30, v30, v31
    v_add_u32 v30, v30, v29
    v_cvt_f32_u32 v30, v30
    v_cvt_f32_u32 v28, v28
    v_cvt_f32_u32 v32, v32
    v_mul_f32 v24, s90, v32
    v_add_f32 v24, v24, v24
    v_add_f32 v31, v30, v32
    v_mul_f32 v16, s90, v30
    v_fmamk_f32 v34, v28, 0x3f800000, v30
    v_mul_f32 v17, s90, v34
    v_fmamk_f32 v34, v28, 0x40000000, v30
    v_mul_f32 v18, s90, v34
    v_fmamk_f32 v34, v28, 0x40400000, v30
    v_mul_f32 v19, s90, v34
    v_mul_f32 v20, s90, v31
    v_fmamk_f32 v34, v28, 0x3f800000, v31
    v_mul_f32 v21, s90, v34
    v_fmamk_f32 v34, v28, 0x40000000, v31
    v_mul_f32 v22, s90, v34
    v_fmamk_f32 v34, v28, 0x40400000, v31
    v_mul_f32 v23, s90, v34
    v_cos_f32 v28, v16
    v_cos_f32 v29, v17
    v_cos_f32 v30, v18
    v_cos_f32 v31, v19
    v_cos_f32 v32, v20
    v_cos_f32 v33, v21
    v_cos_f32 v34, v22
    v_cos_f32 v35, v23
    v_cvt_pk_f16_f32 v168, v28, v29
    v_cvt_pk_f16_f32 v169, v30, v31
    v_cvt_pk_f16_f32 v170, v32, v33
    v_cvt_pk_f16_f32 v171, v34, v35
    v_fmamk_f32 v36, v24, 0x3f800000, v16
    v_fmamk_f32 v37, v24, 0x3f800000, v17
    v_fmamk_f32 v38, v24, 0x3f800000, v18
    v_fmamk_f32 v39, v24, 0x3f800000, v19
    v_fmamk_f32 v40, v24, 0x3f800000, v20
    v_fmamk_f32 v41, v24, 0x3f800000, v21
    v_fmamk_f32 v42, v24, 0x3f800000, v22
    v_fmamk_f32 v43, v24, 0x3f800000, v23
    v_cos_f32 v28, v36
    v_cos_f32 v29, v37
    v_cos_f32 v30, v38
    v_cos_f32 v31, v39
    v_cos_f32 v32, v40
    v_cos_f32 v33, v41
    v_cos_f32 v34, v42
    v_cos_f32 v35, v43
    v_cvt_pk_f16_f32 v172, v28, v29
    v_cvt_pk_f16_f32 v173, v30, v31
    v_cvt_pk_f16_f32 v174, v32, v33
    v_cvt_pk_f16_f32 v175, v34, v35
    v_fmamk_f32 v36, v24, 0x40000000, v16
    v_fmamk_f32 v37, v24, 0x40000000, v17
    v_fmamk_f32 v38, v24, 0x40000000, v18
    v_fmamk_f32 v39, v24, 0x40000000, v19
    v_fmamk_f32 v40, v24, 0x40000000, v20
    v_fmamk_f32 v41, v24, 0x40000000, v21
    v_fmamk_f32 v42, v24, 0x40000000, v22
    v_fmamk_f32 v43, v24, 0x40000000, v23
    v_cos_f32 v28, v36
    v_cos_f32 v29, v37
    v_cos_f32 v30, v38
    v_cos_f32 v31, v39
    v_cos_f32 v32, v40
    v_cos_f32 v33, v41
    v_cos_f32 v34, v42
    v_cos_f32 v35, v43
    v_cvt_pk_f16_f32 v176, v28, v29
    v_cvt_pk_f16_f32 v177, v30, v31
    v_cvt_pk_f16_f32 v178, v32, v33
    v_cvt_pk_f16_f32 v179, v34, v35
    v_fmamk_f32 v36, v24, 0x40400000, v16
    v_fmamk_f32 v37, v24, 0x40400000, v17
    v_fmamk_f32 v38, v24, 0x40400000, v18
    v_fmamk_f32 v39, v24, 0x40400000, v19
    v_fmamk_f32 v40, v24, 0x40400000, v20
    v_fmamk_f32 v41, v24, 0x40400000, v21
    v_fmamk_f32 v42, v24, 0x40400000, v22
    v_fmamk_f32 v43, v24, 0x40400000, v23
    v_cos_f32 v28, v36
    v_cos_f32 v29, v37
    v_cos_f32 v30, v38
    v_cos_f32 v31, v39
    v_cos_f32 v32, v40
    v_cos_f32 v33, v41
    v_cos_f32 v34, v42
    v_cos_f32 v35, v43
    v_cvt_pk_f16_f32 v180, v28, v29
    v_cvt_pk_f16_f32 v181, v30, v31
    v_cvt_pk_f16_f32 v182, v32, v33
    v_cvt_pk_f16_f32 v183, v34, v35
    v_fmamk_f32 v36, v24, 0x40800000, v16
    v_fmamk_f32 v37, v24, 0x40800000, v17
    v_fmamk_f32 v38, v24, 0x40800000, v18
    v_fmamk_f32 v39, v24, 0x40800000, v19
    v_cos_f32 v28, v36
    v_cos_f32 v29, v37
    v_cos_f32 v30, v38
    v_cos_f32 v31, v39
    v_cvt_pk_f16_f32 v184, v28, v29
    v_cvt_pk_f16_f32 v185, v30, v31
    v_xor_b32_dpp v186, v168, v25 quad_perm:[0,1,3,2] row_mask:0xf bank_mask:0xf
    v_xor_b32_dpp v187, v169, v25 quad_perm:[0,1,3,2] row_mask:0xf bank_mask:0xf
    v_xor_b32_dpp v188, v170, v25 quad_perm:[0,1,3,2] row_mask:0xf bank_mask:0xf
    v_xor_b32_dpp v189, v171, v25 quad_perm:[0,1,3,2] row_mask:0xf bank_mask:0xf
    v_xor_b32_dpp v190, v172, v25 quad_perm:[0,1,3,2] row_mask:0xf bank_mask:0xf
    v_xor_b32_dpp v191, v173, v25 quad_perm:[0,1,3,2] row_mask:0xf bank_mask:0xf
    v_xor_b32_dpp v192, v174, v25 quad_perm:[0,1,3,2] row_mask:0xf bank_mask:0xf
    v_xor_b32_dpp v193, v175, v25 quad_perm:[0,1,3,2] row_mask:0xf bank_mask:0xf
    v_xor_b32_dpp v194, v176, v25 quad_perm:[0,1,3,2] row_mask:0xf bank_mask:0xf
    v_xor_b32_dpp v195, v177, v25 quad_perm:[0,1,3,2] row_mask:0xf bank_mask:0xf
    v_xor_b32_dpp v196, v178, v25 quad_perm:[0,1,3,2] row_mask:0xf bank_mask:0xf
    v_xor_b32_dpp v197, v179, v25 quad_perm:[0,1,3,2] row_mask:0xf bank_mask:0xf
    v_xor_b32_dpp v198, v180, v25 quad_perm:[0,1,3,2] row_mask:0xf bank_mask:0xf
    v_xor_b32_dpp v199, v181, v25 quad_perm:[0,1,3,2] row_mask:0xf bank_mask:0xf
    v_xor_b32_dpp v200, v182, v25 quad_perm:[0,1,3,2] row_mask:0xf bank_mask:0xf
    v_xor_b32_dpp v201, v183, v25 quad_perm:[0,1,3,2] row_mask:0xf bank_mask:0xf
    v_xor_b32_dpp v202, v184, v25 quad_perm:[0,1,3,2] row_mask:0xf bank_mask:0xf
    v_xor_b32_dpp v203, v185, v25 quad_perm:[0,1,3,2] row_mask:0xf bank_mask:0xf
    v_xor_b32 v204, v26, v168
    v_xor_b32 v205, v26, v169
    v_xor_b32 v206, v26, v170
    v_xor_b32 v207, v26, v171
    v_xor_b32 v208, v26, v172
    v_xor_b32 v209, v26, v173
    v_xor_b32 v210, v26, v174
    v_xor_b32 v211, v26, v175
    v_xor_b32 v212, v26, v176
    v_xor_b32 v213, v26, v177
    v_xor_b32 v214, v26, v178
    v_xor_b32 v215, v26, v179
    v_xor_b32 v216, v26, v180
    v_xor_b32 v217, v26, v181
    v_xor_b32 v218, v26, v182
    v_xor_b32 v219, v26, v183
    v_xor_b32 v220, v26, v184
    v_xor_b32 v221, v26, v185
    v_xor_b32 v222, v26, v186
    v_xor_b32 v223, v26, v187
    v_xor_b32 v224, v26, v188
    v_xor_b32 v225, v26, v189
    v_xor_b32 v226, v26, v190
    v_xor_b32 v227, v26, v191
    v_xor_b32 v228, v26, v192
    v_xor_b32 v229, v26, v193
    v_xor_b32 v230, v26, v194
    v_xor_b32 v231, v26, v195
    v_xor_b32 v232, v26, v196
    v_xor_b32 v233, v26, v197
    v_xor_b32 v234, v26, v198
    v_xor_b32 v235, v26, v199
    v_xor_b32 v236, v26, v200
    v_xor_b32 v237, v26, v201
    v_xor_b32 v238, v26, v202
    v_xor_b32 v239, v26, v203
fused_kernel_n7:
    s_cmp_lg_u32 s22, 0
    s_cbranch_scc1 fused_kernel_n2
    s_lshl_b32 s33, s20, 8
    s_add_u32 s33, s33, 0xa20000
    v_lshlrev_b32 v16, 3, v9
    s_mov_b32 exec_lo, 0xffffffff
    s_mov_b32 exec_hi, 0x0
    s_mov_b32 s35, 100000
fused_kernel_p1_l:
    s_sub_u32 s35, s35, 1
    s_cbranch_scc1 fused_kernel_p1_ok
    buffer_load_dwordx2 v[18:19], v16, s[12:15], s33 offen sc1
    v_mov_b32 v13, s99
    s_waitcnt vmcnt(0)
    v_subrev_co_u32 v18, vcc, s98, v18
    s_nop 1
    v_subb_co_u32 v19, vcc, v19, v13, vcc
    v_lshrrev_b32 v18, 12, v18
    v_or_b32 v18, v18, v19
    v_cmp_ne_u32 vcc, 0, v18
    s_nop 1
    s_cmp_eq_u64 vcc, 0
    s_cbranch_scc1 fused_kernel_p1_ok
    s_sleep 3
    s_branch fused_kernel_p1_l
fused_kernel_p1_ok:
    s_mov_b64 exec, -1
fused_kernel_n2:
    s_waitcnt lgkmcnt(0)
    s_barrier
    s_cmp_lg_u32 s39, 0
    s_cbranch_scc1 fused_kernel_h1
    s_add_u32 s30, s27, 0xa40000
    buffer_load_dwordx4 v[16:19], v1, s[12:15], s30 offen offset:0 sc1
    buffer_load_dwordx4 v[24:27], v1, s[12:15], s30 offen offset:1024 sc1
    buffer_load_dwordx4 v[32:35], v1, s[12:15], s30 offen offset:2048 sc1
    buffer_load_dwordx4 v[40:43], v1, s[12:15], s30 offen offset:3072 sc1
    s_add_u32 s30, s27, 0xa41000
    buffer_load_dwordx4 v[48:51], v1, s[12:15], s30 offen offset:0 sc1
    buffer_load_dwordx4 v[56:59], v1, s[12:15], s30 offen offset:1024 sc1
    buffer_load_dwordx4 v[64:67], v1, s[12:15], s30 offen offset:2048 sc1
    v_add_u32 v12, 73728, v10
    v_add_u32 v13, 73728, v11
    v_lshlrev_b32 v244, 6, v248
    v_lshl_add_u32 v244, v249, 4, v244
    s_lshl_b32 s33, s21, 1
    s_add_u32 s33, s33, s43
    s_mul_i32 s33, s33, 36864
    s_add_u32 s33, s33, 0x240000
    ds_read_b128 v[168:171], v12 offset:0
    ds_read_b128 v[172:175], v12 offset:18432
    ds_read_b128 v[176:179], v13 offset:1024
    ds_read_b128 v[180:183], v13 offset:19456
    ds_read_b128 v[184:187], v12 offset:2048
    ds_read_b128 v[188:191], v12 offset:20480
    s_waitcnt lgkmcnt(5)
    v_mfma_f32_16x16x32_f16 v[240:243], v[168:171], v[96:99], 0
    s_waitcnt lgkmcnt(4)
    v_mfma_f32_16x16x32_f16 v[252:255], v[172:175], v[96:99], 0
    ds_read_b128 v[168:171], v13 offset:3072
    ds_read_b128 v[172:175], v13 offset:21504
    s_waitcnt lgkmcnt(5)
    v_mfma_f32_16x16x32_f16 v[240:243], v[176:179], v[100:103], v[240:243]
    s_waitcnt lgkmcnt(4)
    v_mfma_f32_16x16x32_f16 v[252:255], v[180:183], v[100:103], v[252:255]
    ds_read_b128 v[176:179], v12 offset:4096
    ds_read_b128 v[180:183], v12 offset:22528
    s_waitcnt lgkmcnt(5)
    v_mfma_f32_16x16x32_f16 v[240:243], v[184:187], v[104:107], v[240:243]
    s_waitcnt lgkmcnt(4)
    v_mfma_f32_16x16x32_f16 v[252:255], v[188:191], v[104:107], v[252:255]
    ds_read_b128 v[184:187], v13 offset:5120
    ds_read_b128 v[188:191], v13 offset:23552
    s_waitcnt lgkmcnt(5)
    v_mfma_f32_16x16x32_f16 v[240:243], v[168:171], v[108:111], v[240:243]
    s_waitcnt lgkmcnt(4)
    v_mfma_f32_16x16x32_f16 v[252:255], v[172:175], v[108:111], v[252:255]
    ds_read_b128 v[168:171], v12 offset:6144
    ds_read_b128 v[172:175], v12 offset:24576
    s_waitcnt lgkmcnt(5)
    v_mfma_f32_16x16x32_f16 v[240:243], v[176:179], v[112:115], v[240:243]
    s_waitcnt lgkmcnt(4)
    v_mfma_f32_16x16x32_f16 v[252:255], v[180:183], v[112:115], v[252:255]
    ds_read_b128 v[176:179], v13 offset:7168
    ds_read_b128 v[180:183], v13 offset:25600
    s_waitcnt lgkmcnt(5)
    v_mfma_f32_16x16x32_f16 v[240:243], v[184:187], v[116:119], v[240:243]
    s_waitcnt lgkmcnt(4)
    v_mfma_f32_16x16x32_f16 v[252:255], v[188:191], v[116:119], v[252:255]
    ds_read_b128 v[184:187], v12 offset:8192
    ds_read_b128 v[188:191], v12 offset:26624
    s_waitcnt lgkmcnt(5)
    v_mfma_f32_16x16x32_f16 v[240:243], v[168:171], v[120:123], v[240:243]
    s_waitcnt lgkmcnt(4)
    v_mfma_f32_16x16x32_f16 v[252:255], v[172:175], v[120:123], v[252:255]
    ds_read_b128 v[168:171], v13 offset:9216
    ds_read_b128 v[172:175], v13 offset:27648
    s_waitcnt lgkmcnt(5)
    v_mfma_f32_16x16x32_f16 v[240:243], v[176:179], v[124:127], v[240:243]
    s_waitcnt lgkmcnt(4)
    v_mfma_f32_16x16x32_f16 v[252:255], v[180:183], v[124:127], v[252:255]
    ds_read_b128 v[176:179], v12 offset:10240
    ds_read_b128 v[180:183], v12 offset:28672
    s_waitcnt lgkmcnt(5)
    v_mfma_f32_16x16x32_f16 v[240:243], v[184:187], v[128:131], v[240:243]
    s_waitcnt lgkmcnt(4)
    v_mfma_f32_16x16x32_f16 v[252:255], v[188:191], v[128:131], v[252:255]
    ds_read_b128 v[184:187], v13 offset:11264
    ds_read_b128 v[188:191], v13 offset:29696
    s_waitcnt lgkmcnt(5)
    v_mfma_f32_16x16x32_f16 v[240:243], v[168:171], v[132:135], v[240:243]
    s_waitcnt lgkmcnt(4)
    v_mfma_f32_16x16x32_f16 v[252:255], v[172:175], v[132:135], v[252:255]
    ds_read_b128 v[168:171], v12 offset:12288
    ds_read_b128 v[172:175], v12 offset:30720
    s_waitcnt lgkmcnt(5)
    v_mfma_f32_16x16x32_f16 v[240:243], v[176:179], v[136:139], v[240:243]
    s_waitcnt lgkmcnt(4)
    v_mfma_f32_16x16x32_f16 v[252:255], v[180:183], v[136:139], v[252:255]
    ds_read_b128 v[176:179], v13 offset:13312
    ds_read_b128 v[180:183], v13 offset:31744
    s_waitcnt lgkmcnt(5)
    v_mfma_f32_16x16x32_f16 v[240:243], v[184:187], v[140:143], v[240:243]
    s_waitcnt lgkmcnt(4)
    v_mfma_f32_16x16x32_f16 v[252:255], v[188:191], v[140:143], v[252:255]
    ds_read_b128 v[184:187], v12 offset:14336
    ds_read_b128 v[188:191], v12 offset:32768
    s_waitcnt lgkmcnt(5)
    v_mfma_f32_16x16x32_f16 v[240:243], v[168:171], v[144:147], v[240:243]
    s_waitcnt lgkmcnt(4)
    v_mfma_f32_16x16x32_f16 v[252:255], v[172:175], v[144:147], v[252:255]
    ds_read_b128 v[168:171], v13 offset:15360
    ds_read_b128 v[172:175], v13 offset:33792
    s_waitcnt lgkmcnt(5)
    v_mfma_f32_16x16x32_f16 v[240:243], v[176:179], v[148:151], v[240:243]
    s_waitcnt lgkmcnt(4)
    v_mfma_f32_16x16x32_f16 v[252:255], v[180:183], v[148:151], v[252:255]
    ds_read_b128 v[176:179], v12 offset:16384
    ds_read_b128 v[180:183], v12 offset:34816
    s_waitcnt lgkmcnt(5)
    v_mfma_f32_16x16x32_f16 v[240:243], v[184:187], v[152:155], v[240:243]
    s_waitcnt lgkmcnt(4)
    v_mfma_f32_16x16x32_f16 v[252:255], v[188:191], v[152:155], v[252:255]
    ds_read_b128 v[184:187], v13 offset:17408
    ds_read_b128 v[188:191], v13 offset:35840
    s_waitcnt lgkmcnt(5)
    v_mfma_f32_16x16x32_f16 v[240:243], v[168:171], v[156:159], v[240:243]
    s_waitcnt lgkmcnt(4)
    v_mfma_f32_16x16x32_f16 v[252:255], v[172:175], v[156:159], v[252:255]
    s_waitcnt lgkmcnt(3)
    v_mfma_f32_16x16x32_f16 v[240:243], v[176:179], v[160:163], v[240:243]
    s_waitcnt lgkmcnt(2)
    v_mfma_f32_16x16x32_f16 v[252:255], v[180:183], v[160:163], v[252:255]
    s_waitcnt lgkmcnt(1)
    v_mfma_f32_16x16x32_f16 v[240:243], v[184:187], v[164:167], v[240:243]
    s_waitcnt lgkmcnt(0)
    v_mfma_f32_16x16x32_f16 v[252:255], v[188:191], v[164:167], v[252:255]
    s_nop 5
    v_mul_f32 v240, 0x3d000000, v240
    v_mul_f32 v241, 0x3d000000, v241
    v_mul_f32 v242, 0x3d000000, v242
    v_mul_f32 v243, 0x3d000000, v243
    v_cvt_pk_f16_f32 v168, v240, v241
    v_cvt_pk_f16_f32 v169, v242, v243
    v_mul_f32 v252, 0x3d000000, v252
    v_mul_f32 v253, 0x3d000000, v253
    v_mul_f32 v254, 0x3d000000, v254
    v_mul_f32 v255, 0x3d000000, v255
    v_cvt_pk_f16_f32 v170, v252, v253
    v_cvt_pk_f16_f32 v171, v254, v255
    s_lshl_b32 s34, s37, 10
    s_add_u32 s34, s34, s33
    buffer_store_dwordx4 v[168:171], v244, s[12:15], s34 offen sc1
    s_cmp_ge_u32 s2, 128
    s_cbranch_scc1 fused_kernel_r0_nw
    s_mul_i32 s33, s2, 18560
    s_add_u32 s33, s33, 0x480000
    v_add_u32 v96, 0, v0
    v_and_b32 v97, 1, v96
    v_lshrrev_b32 v98, 1, v96
    v_min_u32 v98, 288, v98
    v_mul_u32_u24 v99, 578, v97
    v_lshl_add_u32 v99, v98, 1, v99
    v_add_u32 v99, 110592, v99
    ds_read_u16 v112, v99 offset:0
    ds_read_u16 v120, v99 offset:1160
    ds_read_u16 v113, v99 offset:4096
    ds_read_u16 v121, v99 offset:5256
    ds_read_u16 v114, v99 offset:8192
    ds_read_u16 v122, v99 offset:9352
    ds_read_u16 v115, v99 offset:12288
    ds_read_u16 v123, v99 offset:13448
    ds_read_u16 v116, v99 offset:16384
    ds_read_u16 v124, v99 offset:17544
    ds_read_u16 v117, v99 offset:20480
    ds_read_u16 v125, v99 offset:21640
    ds_read_u16 v118, v99 offset:24576
    ds_read_u16 v126, v99 offset:25736
    ds_read_u16 v119, v99 offset:28672
    ds_read_u16 v127, v99 offset:29832
    v_lshlrev_b32 v100, 6, v98
    v_lshl_add_u32 v100, v97, 5, v100
    s_waitcnt lgkmcnt(0)
    v_lshl_or_b32 v104, v120, 16, v112
    v_lshl_or_b32 v105, v121, 16, v113
    v_lshl_or_b32 v106, v122, 16, v114
    v_lshl_or_b32 v107, v123, 16, v115
    v_lshl_or_b32 v108, v124, 16, v116
    v_lshl_or_b32 v109, v125, 16, v117
    v_lshl_or_b32 v110, v126, 16, v118
    v_lshl_or_b32 v111, v127, 16, v119
    buffer_store_dwordx4 v[104:107], v100, s[12:15], s33 offen sc1
    buffer_store_dwordx4 v[108:111], v100, s[12:15], s33 offen offset:16 sc1
    s_cmp_ge_u32 s22, 2
    s_cbranch_scc1 fused_kernel_r0_nw
    v_add_u32 v96, 512, v0
    v_and_b32 v97, 1, v96
    v_lshrrev_b32 v98, 1, v96
    v_min_u32 v98, 288, v98
    v_mul_u32_u24 v99, 578, v97
    v_lshl_add_u32 v99, v98, 1, v99
    v_add_u32 v99, 110592, v99
    ds_read_u16 v112, v99 offset:0
    ds_read_u16 v120, v99 offset:1160
    ds_read_u16 v113, v99 offset:4096
    ds_read_u16 v121, v99 offset:5256
    ds_read_u16 v114, v99 offset:8192
    ds_read_u16 v122, v99 offset:9352
    ds_read_u16 v115, v99 offset:12288
    ds_read_u16 v123, v99 offset:13448
    ds_read_u16 v116, v99 offset:16384
    ds_read_u16 v124, v99 offset:17544
    ds_read_u16 v117, v99 offset:20480
    ds_read_u16 v125, v99 offset:21640
    ds_read_u16 v118, v99 offset:24576
    ds_read_u16 v126, v99 offset:25736
    ds_read_u16 v119, v99 offset:28672
    ds_read_u16 v127, v99 offset:29832
    v_lshlrev_b32 v100, 6, v98
    v_lshl_add_u32 v100, v97, 5, v100
    s_waitcnt lgkmcnt(0)
    v_lshl_or_b32 v104, v120, 16, v112
    v_lshl_or_b32 v105, v121, 16, v113
    v_lshl_or_b32 v106, v122, 16, v114
    v_lshl_or_b32 v107, v123, 16, v115
    v_lshl_or_b32 v108, v124, 16, v116
    v_lshl_or_b32 v109, v125, 16, v117
    v_lshl_or_b32 v110, v126, 16, v118
    v_lshl_or_b32 v111, v127, 16, v119
    buffer_store_dwordx4 v[104:107], v100, s[12:15], s33 offen sc1
    buffer_store_dwordx4 v[108:111], v100, s[12:15], s33 offen offset:16 sc1
fused_kernel_r0_nw:
    v_mov_b32 v12, 149796
    v_mov_b32 v13, 1
    s_mov_b64 exec, 1
    ds_add_u32 v12, v13
    s_mov_b64 exec, -1
    ds_read_b128 v[208:211], v7
    ds_read_b128 v[80:83], v10 offset:0
    ds_read_b128 v[84:87], v10 offset:18432
    ds_read_b128 v[88:91], v10 offset:36864
    ds_read_b128 v[92:95], v10 offset:55296
    ds_read_b128 v[96:99], v11 offset:1024
    ds_read_b128 v[100:103], v11 offset:19456
    ds_read_b128 v[104:107], v11 offset:37888
    ds_read_b128 v[108:111], v11 offset:56320
    s_waitcnt vmcnt(7) lgkmcnt(7)
    v_mfma_f32_16x16x32_bf16 v[112:115], v[16:19], v[80:83], v[208:211]
    s_waitcnt vmcnt(6) lgkmcnt(3)
    v_mfma_f32_16x16x32_bf16 v[112:115], v[24:27], v[96:99], v[112:115]
    ds_read_b128 v[80:83], v10 offset:2048
    ds_read_b128 v[96:99], v11 offset:3072
    v_mfma_f32_16x16x32_bf16 v[116:119], v[16:19], v[84:87], v[208:211]
    s_waitcnt lgkmcnt(4)
    v_mfma_f32_16x16x32_bf16 v[116:119], v[24:27], v[100:103], v[116:119]
    ds_read_b128 v[84:87], v10 offset:20480
    ds_read_b128 v[100:103], v11 offset:21504
    v_mfma_f32_16x16x32_bf16 v[120:123], v[16:19], v[88:91], v[208:211]
    s_waitcnt lgkmcnt(5)
    v_mfma_f32_16x16x32_bf16 v[120:123], v[24:27], v[104:107], v[120:123]
    ds_read_b128 v[88:91], v10 offset:38912
    ds_read_b128 v[104:107], v11 offset:39936
    v_mfma_f32_16x16x32_bf16 v[124:127], v[16:19], v[92:95], v[208:211]
    s_waitcnt lgkmcnt(6)
    v_mfma_f32_16x16x32_bf16 v[124:127], v[24:27], v[108:111], v[124:127]
    ds_read_b128 v[92:95], v10 offset:57344
    ds_read_b128 v[108:111], v11 offset:58368
    buffer_load_dwordx4 v[72:75], v1, s[12:15], s30 offen offset:3072 sc1
    s_add_u32 s30, s27, 0xa42000
    buffer_load_dwordx4 v[16:19], v1, s[12:15], s30 offen offset:0 sc1
    s_waitcnt vmcnt(7) lgkmcnt(7)
    v_mfma_f32_16x16x32_bf16 v[112:115], v[32:35], v[80:83], v[112:115]
    s_waitcnt vmcnt(6) lgkmcnt(6)
    v_mfma_f32_16x16x32_bf16 v[112:115], v[40:43], v[96:99], v[112:115]
    ds_read_b128 v[80:83], v10 offset:4096
    ds_read_b128 v[96:99], v11 offset:5120
    s_waitcnt lgkmcnt(7)
    v_mfma_f32_16x16x32_bf16 v[116:119], v[32:35], v[84:87], v[116:119]
    s_waitcnt lgkmcnt(6)
    v_mfma_f32_16x16x32_bf16 v[116:119], v[40:43], v[100:103], v[116:119]
    ds_read_b128 v[84:87], v10 offset:22528
    ds_read_b128 v[100:103], v11 offset:23552
    s_waitcnt lgkmcnt(7)
    v_mfma_f32_16x16x32_bf16 v[120:123], v[32:35], v[88:91], v[120:123]
    s_waitcnt lgkmcnt(6)
    v_mfma_f32_16x16x32_bf16 v[120:123], v[40:43], v[104:107], v[120:123]
    ds_read_b128 v[88:91], v10 offset:40960
    ds_read_b128 v[104:107], v11 offset:41984
    s_waitcnt lgkmcnt(7)
    v_mfma_f32_16x16x32_bf16 v[124:127], v[32:35], v[92:95], v[124:127]
    s_waitcnt lgkmcnt(6)
    v_mfma_f32_16x16x32_bf16 v[124:127], v[40:43], v[108:111], v[124:127]
    ds_read_b128 v[92:95], v10 offset:59392
    ds_read_b128 v[108:111], v11 offset:60416
    buffer_load_dwordx4 v[24:27], v1, s[12:15], s30 offen offset:1024 sc1
    ds_read_b128 v[208:211], v3 offset:0
    ds_read_b128 v[212:215], v3 offset:64
    buffer_load_dwordx4 v[32:35], v1, s[12:15], s30 offen offset:2048 sc1
    s_waitcnt vmcnt(7) lgkmcnt(9)
    v_mfma_f32_16x16x32_bf16 v[112:115], v[48:51], v[80:83], v[112:115]
    s_waitcnt vmcnt(6) lgkmcnt(8)
    v_mfma_f32_16x16x32_bf16 v[112:115], v[56:59], v[96:99], v[112:115]
    ds_read_b128 v[80:83], v10 offset:6144
    ds_read_b128 v[96:99], v11 offset:7168
    s_waitcnt lgkmcnt(9)
    v_mfma_f32_16x16x32_bf16 v[116:119], v[48:51], v[84:87], v[116:119]
    s_waitcnt lgkmcnt(8)
    v_mfma_f32_16x16x32_bf16 v[116:119], v[56:59], v[100:103], v[116:119]
    ds_read_b128 v[84:87], v10 offset:24576
    ds_read_b128 v[100:103], v11 offset:25600
    s_waitcnt lgkmcnt(9)
    v_mfma_f32_16x16x32_bf16 v[120:123], v[48:51], v[88:91], v[120:123]
    s_waitcnt lgkmcnt(8)
    v_mfma_f32_16x16x32_bf16 v[120:123], v[56:59], v[104:107], v[120:123]
    ds_read_b128 v[88:91], v10 offset:43008
    ds_read_b128 v[104:107], v11 offset:44032
    s_waitcnt lgkmcnt(9)
    v_mfma_f32_16x16x32_bf16 v[124:127], v[48:51], v[92:95], v[124:127]
    s_waitcnt lgkmcnt(8)
    v_mfma_f32_16x16x32_bf16 v[124:127], v[56:59], v[108:111], v[124:127]
    ds_read_b128 v[92:95], v10 offset:61440
    ds_read_b128 v[108:111], v11 offset:62464
    buffer_load_dwordx4 v[40:43], v1, s[12:15], s30 offen offset:3072 sc1
    s_add_u32 s30, s27, 0xa43000
    buffer_load_dwordx4 v[48:51], v1, s[12:15], s30 offen offset:0 sc1
    s_waitcnt vmcnt(7) lgkmcnt(7)
    v_mfma_f32_16x16x32_bf16 v[112:115], v[64:67], v[80:83], v[112:115]
    s_waitcnt vmcnt(5) lgkmcnt(6)
    v_mfma_f32_16x16x32_bf16 v[112:115], v[72:75], v[96:99], v[112:115]
    ds_read_b128 v[80:83], v10 offset:8192
    ds_read_b128 v[96:99], v11 offset:9216
    s_waitcnt lgkmcnt(7)
    v_mfma_f32_16x16x32_bf16 v[116:119], v[64:67], v[84:87], v[116:119]
    s_waitcnt lgkmcnt(6)
    v_mfma_f32_16x16x32_bf16 v[116:119], v[72:75], v[100:103], v[116:119]
    ds_read_b128 v[84:87], v10 offset:26624
    ds_read_b128 v[100:103], v11 offset:27648
    s_waitcnt lgkmcnt(7)
    v_mfma_f32_16x16x32_bf16 v[120:123], v[64:67], v[88:91], v[120:123]
    s_waitcnt lgkmcnt(6)
    v_mfma_f32_16x16x32_bf16 v[120:123], v[72:75], v[104:107], v[120:123]
    ds_read_b128 v[88:91], v10 offset:45056
    ds_read_b128 v[104:107], v11 offset:46080
    s_waitcnt lgkmcnt(7)
    v_mfma_f32_16x16x32_bf16 v[124:127], v[64:67], v[92:95], v[124:127]
    s_waitcnt lgkmcnt(6)
    v_mfma_f32_16x16x32_bf16 v[124:127], v[72:75], v[108:111], v[124:127]
    ds_read_b128 v[92:95], v10 offset:63488
    ds_read_b128 v[108:111], v11 offset:64512
    buffer_load_dwordx4 v[56:59], v1, s[12:15], s30 offen offset:1024 sc1
    buffer_load_dwordx4 v[64:67], v1, s[12:15], s30 offen offset:2048 sc1
    s_waitcnt vmcnt(6) lgkmcnt(7)
    v_mfma_f32_16x16x32_bf16 v[112:115], v[16:19], v[80:83], v[112:115]
    s_waitcnt vmcnt(5) lgkmcnt(6)
    v_mfma_f32_16x16x32_bf16 v[112:115], v[24:27], v[96:99], v[112:115]
    ds_read_b128 v[80:83], v10 offset:10240
    ds_read_b128 v[96:99], v11 offset:11264
    s_waitcnt lgkmcnt(7)
    v_mfma_f32_16x16x32_bf16 v[116:119], v[16:19], v[84:87], v[116:119]
    s_waitcnt lgkmcnt(6)
    v_mfma_f32_16x16x32_bf16 v[116:119], v[24:27], v[100:103], v[116:119]
    ds_read_b128 v[84:87], v10 offset:28672
    ds_read_b128 v[100:103], v11 offset:29696
    s_waitcnt lgkmcnt(7)
    v_mfma_f32_16x16x32_bf16 v[120:123], v[16:19], v[88:91], v[120:123]
    s_waitcnt lgkmcnt(6)
    v_mfma_f32_16x16x32_bf16 v[120:123], v[24:27], v[104:107], v[120:123]
    ds_read_b128 v[88:91], v10 offset:47104
    ds_read_b128 v[104:107], v11 offset:48128
    s_waitcnt lgkmcnt(7)
    v_mfma_f32_16x16x32_bf16 v[124:127], v[16:19], v[92:95], v[124:127]
    s_waitcnt lgkmcnt(6)
    v_mfma_f32_16x16x32_bf16 v[124:127], v[24:27], v[108:111], v[124:127]
    ds_read_b128 v[92:95], v14 offset:0
    ds_read_b128 v[108:111], v15 offset:1024
    buffer_load_dwordx4 v[72:75], v1, s[12:15], s30 offen offset:3072 sc1
    v_mov_b32 v12, 149764
    v_mov_b32 v13, 1
    s_mov_b64 exec, 1
    ds_add_rtn_u32 v13, v12, v13
    s_waitcnt lgkmcnt(0)
    v_readfirstlane_b32 s35, v13
    s_mov_b64 exec, -1
    s_nop 1
    s_cmp_lg_u32 s35, 7
    s_cbranch_scc1 fused_kernel_r0_g2
    s_lshl_b32 s33, s2, 3
    s_add_u32 s33, s33, 0xa28000
    v_lshlrev_b32 v254, 11, v9
    v_mov_b32 v12, s100
    v_mov_b32 v13, s101
    s_mov_b64 exec, 0xffff
    buffer_store_dwordx2 v[12:13], v254, s[12:15], s33 offen sc1
    s_mov_b64 exec, -1
    s_lshl_b32 s33, s20, 8
    s_lshl_b32 s34, s21, 3
    s_add_u32 s33, s33, s34
    s_add_u32 s33, s33, 0xa20800
    v_mov_b32 v12, s100
    v_mov_b32 v13, s101
    s_mov_b64 exec, 1
    buffer_store_dwordx2 v[12:13], v1, s[12:15], s33 offen sc1
    s_mov_b64 exec, -1
fused_kernel_r0_g2:
    s_add_u32 s30, s27, 0xa44000
    buffer_load_dwordx4 v[16:19], v1, s[12:15], s30 offen offset:0 sc1
    s_waitcnt vmcnt(6) lgkmcnt(7)
    v_mfma_f32_16x16x32_bf16 v[112:115], v[32:35], v[80:83], v[112:115]
    s_waitcnt vmcnt(5) lgkmcnt(6)
    v_mfma_f32_16x16x32_bf16 v[112:115], v[40:43], v[96:99], v[112:115]
    ds_read_b128 v[80:83], v10 offset:12288
    ds_read_b128 v[96:99], v11 offset:13312
    s_waitcnt lgkmcnt(7)
    v_mfma_f32_16x16x32_bf16 v[116:119], v[32:35], v[84:87], v[116:119]
    s_waitcnt lgkmcnt(6)
    v_mfma_f32_16x16x32_bf16 v[116:119], v[40:43], v[100:103], v[116:119]
    ds_read_b128 v[84:87], v10 offset:30720
    ds_read_b128 v[100:103], v11 offset:31744
    s_waitcnt lgkmcnt(7)
    v_mfma_f32_16x16x32_bf16 v[120:123], v[32:35], v[88:91], v[120:123]
    s_waitcnt lgkmcnt(6)
    v_mfma_f32_16x16x32_bf16 v[120:123], v[40:43], v[104:107], v[120:123]
    ds_read_b128 v[88:91], v10 offset:49152
    ds_read_b128 v[104:107], v11 offset:50176
    s_waitcnt lgkmcnt(7)
    v_mfma_f32_16x16x32_bf16 v[124:127], v[32:35], v[92:95], v[124:127]
    s_waitcnt lgkmcnt(6)
    v_mfma_f32_16x16x32_bf16 v[124:127], v[40:43], v[108:111], v[124:127]
    ds_read_b128 v[92:95], v14 offset:2048
    ds_read_b128 v[108:111], v15 offset:3072
    buffer_load_dwordx4 v[24:27], v1, s[12:15], s30 offen offset:1024 sc1
    s_add_u32 s30, s25, 0xa40000
    buffer_load_dwordx4 v[32:35], v1, s[12:15], s30 offen offset:0 sc1
    s_add_u32 s31, s25, 0xa44800
    buffer_load_dwordx4 v[36:39], v1, s[12:15], s31 offen offset:0 sc1
    s_waitcnt vmcnt(7) lgkmcnt(7)
    v_mfma_f32_16x16x32_bf16 v[112:115], v[48:51], v[80:83], v[112:115]
    s_waitcnt vmcnt(6) lgkmcnt(6)
    v_mfma_f32_16x16x32_bf16 v[112:115], v[56:59], v[96:99], v[112:115]
    ds_read_b128 v[80:83], v10 offset:14336
    ds_read_b128 v[96:99], v11 offset:15360
    s_waitcnt lgkmcnt(7)
    v_mfma_f32_16x16x32_bf16 v[116:119], v[48:51], v[84:87], v[116:119]
    s_waitcnt lgkmcnt(6)
    v_mfma_f32_16x16x32_bf16 v[116:119], v[56:59], v[100:103], v[116:119]
    ds_read_b128 v[84:87], v10 offset:32768
    ds_read_b128 v[100:103], v11 offset:33792
    s_waitcnt lgkmcnt(7)
    v_mfma_f32_16x16x32_bf16 v[120:123], v[48:51], v[88:91], v[120:123]
    s_waitcnt lgkmcnt(6)
    v_mfma_f32_16x16x32_bf16 v[120:123], v[56:59], v[104:107], v[120:123]
    ds_read_b128 v[88:91], v10 offset:51200
    ds_read_b128 v[104:107], v11 offset:52224
    s_waitcnt lgkmcnt(7)
    v_mfma_f32_16x16x32_bf16 v[124:127], v[48:51], v[92:95], v[124:127]
    s_waitcnt lgkmcnt(6)
    v_mfma_f32_16x16x32_bf16 v[124:127], v[56:59], v[108:111], v[124:127]
    ds_read_b128 v[92:95], v14 offset:4096
    ds_read_b128 v[108:111], v15 offset:5120
    buffer_load_dwordx4 v[40:43], v1, s[12:15], s30 offen offset:1024 sc1
    buffer_load_dwordx4 v[44:47], v1, s[12:15], s31 offen offset:1024 sc1
    buffer_load_dwordx4 v[48:51], v1, s[12:15], s30 offen offset:2048 sc1
    buffer_load_dwordx4 v[52:55], v1, s[12:15], s31 offen offset:2048 sc1
    s_waitcnt vmcnt(9) lgkmcnt(7)
    v_mfma_f32_16x16x32_bf16 v[112:115], v[64:67], v[80:83], v[112:115]
    s_waitcnt vmcnt(8) lgkmcnt(6)
    v_mfma_f32_16x16x32_bf16 v[112:115], v[72:75], v[96:99], v[112:115]
    ds_read_b128 v[80:83], v10 offset:16384
    ds_read_b128 v[96:99], v11 offset:17408
    s_waitcnt lgkmcnt(7)
    v_mfma_f32_16x16x32_bf16 v[116:119], v[64:67], v[84:87], v[116:119]
    s_waitcnt lgkmcnt(6)
    v_mfma_f32_16x16x32_bf16 v[116:119], v[72:75], v[100:103], v[116:119]
    ds_read_b128 v[84:87], v10 offset:34816
    ds_read_b128 v[100:103], v11 offset:35840
    s_waitcnt lgkmcnt(7)
    v_mfma_f32_16x16x32_bf16 v[120:123], v[64:67], v[88:91], v[120:123]
    s_waitcnt lgkmcnt(6)
    v_mfma_f32_16x16x32_bf16 v[120:123], v[72:75], v[104:107], v[120:123]
    ds_read_b128 v[88:91], v10 offset:53248
    ds_read_b128 v[104:107], v11 offset:54272
    s_waitcnt lgkmcnt(7)
    v_mfma_f32_16x16x32_bf16 v[124:127], v[64:67], v[92:95], v[124:127]
    s_waitcnt lgkmcnt(6)
    v_mfma_f32_16x16x32_bf16 v[124:127], v[72:75], v[108:111], v[124:127]
    ds_read_b128 v[92:95], v14 offset:6144
    ds_read_b128 v[108:111], v15 offset:7168
    buffer_load_dwordx4 v[56:59], v1, s[12:15], s30 offen offset:3072 sc1
    buffer_load_dwordx4 v[60:63], v1, s[12:15], s31 offen offset:3072 sc1
    s_add_u32 s30, s25, 0xa41000
    buffer_load_dwordx4 v[64:67], v1, s[12:15], s30 offen offset:0 sc1
    s_add_u32 s31, s25, 0xa45800
    buffer_load_dwordx4 v[68:71], v1, s[12:15], s31 offen offset:0 sc1
    s_waitcnt vmcnt(11) lgkmcnt(7)
    v_mfma_f32_16x16x32_bf16 v[112:115], v[16:19], v[80:83], v[112:115]
    s_waitcnt vmcnt(10) lgkmcnt(6)
    v_mfma_f32_16x16x32_bf16 v[112:115], v[24:27], v[96:99], v[112:115]
    ds_read_b128 v[80:83], v10 offset:0
    ds_read_b128 v[96:99], v11 offset:1024
    s_waitcnt lgkmcnt(7)
    v_mfma_f32_16x16x32_bf16 v[116:119], v[16:19], v[84:87], v[116:119]
    s_waitcnt lgkmcnt(6)
    v_mfma_f32_16x16x32_bf16 v[116:119], v[24:27], v[100:103], v[116:119]
    ds_read_b128 v[84:87], v10 offset:18432
    ds_read_b128 v[100:103], v11 offset:19456
    s_waitcnt lgkmcnt(7)
    v_mfma_f32_16x16x32_bf16 v[120:123], v[16:19], v[88:91], v[120:123]
    s_waitcnt lgkmcnt(6)
    v_mfma_f32_16x16x32_bf16 v[120:123], v[24:27], v[104:107], v[120:123]
    ds_read_b128 v[88:91], v10 offset:36864
    ds_read_b128 v[104:107], v11 offset:37888
    s_waitcnt lgkmcnt(7)
    v_mfma_f32_16x16x32_bf16 v[124:127], v[16:19], v[92:95], v[124:127]
    s_waitcnt lgkmcnt(6)
    v_mfma_f32_16x16x32_bf16 v[124:127], v[24:27], v[108:111], v[124:127]
    ds_read_b128 v[92:95], v10 offset:55296
    ds_read_b128 v[108:111], v11 offset:56320
    buffer_load_dwordx4 v[72:75], v1, s[12:15], s30 offen offset:1024 sc1
    buffer_load_dwordx4 v[76:79], v1, s[12:15], s31 offen offset:1024 sc1
    buffer_load_dwordx4 v[16:19], v1, s[12:15], s30 offen offset:2048 sc1
    buffer_load_dwordx4 v[20:23], v1, s[12:15], s31 offen offset:2048 sc1
    s_waitcnt vmcnt(13) lgkmcnt(7)
    v_mfma_f32_16x16x32_bf16 v[144:147], v[32:35], v[80:83], v[208:211]
    s_waitcnt vmcnt(11) lgkmcnt(6)
    v_mfma_f32_16x16x32_bf16 v[144:147], v[40:43], v[96:99], v[144:147]
    v_mul_f32 v216, v112, v112
    v_mul_f32 v217, v113, v113
    v_mul_f32 v218, v114, v114
    v_mul_f32 v219, v115, v115
    v_mfma_f32_16x16x32_bf16 v[160:163], v[36:39], v[80:83], v[212:215]
    s_waitcnt vmcnt(10)
    v_mfma_f32_16x16x32_bf16 v[160:163], v[44:47], v[96:99], v[160:163]
    ds_read_b128 v[80:83], v10 offset:2048
    ds_read_b128 v[96:99], v11 offset:3072
    v_fmaak_f32 v216, v216, v5, 0xc0135761
    v_fmaak_f32 v217, v217, v5, 0xc0135761
    v_fmaak_f32 v218, v218, v5, 0xc0135761
    v_fmaak_f32 v219, v219, v5, 0xc0135761
    s_waitcnt lgkmcnt(7)
    v_mfma_f32_16x16x32_bf16 v[148:151], v[32:35], v[84:87], v[208:211]
    s_waitcnt lgkmcnt(6)
    v_mfma_f32_16x16x32_bf16 v[148:151], v[40:43], v[100:103], v[148:151]
    v_mul_f32 v216, v112, v216
    v_mul_f32 v217, v113, v217
    v_mul_f32 v218, v114, v218
    v_mul_f32 v219, v115, v219
    v_mfma_f32_16x16x32_bf16 v[164:167], v[36:39], v[84:87], v[212:215]
    v_mfma_f32_16x16x32_bf16 v[164:167], v[44:47], v[100:103], v[164:167]
    ds_read_b128 v[84:87], v10 offset:20480
    ds_read_b128 v[100:103], v11 offset:21504
    v_exp_f32 v216, v216
    v_exp_f32 v217, v217
    v_exp_f32 v218, v218
    s_waitcnt lgkmcnt(7)
    v_mfma_f32_16x16x32_bf16 v[152:155], v[32:35], v[88:91], v[208:211]
    s_waitcnt lgkmcnt(6)
    v_mfma_f32_16x16x32_bf16 v[152:155], v[40:43], v[104:107], v[152:155]
    v_exp_f32 v219, v219
    v_add_f32 v216, 1.0, v216
    v_mfma_f32_16x16x32_bf16 v[168:171], v[36:39], v[88:91], v[212:215]
    v_mfma_f32_16x16x32_bf16 v[168:171], v[44:47], v[104:107], v[168:171]
    ds_read_b128 v[88:91], v10 offset:38912
    ds_read_b128 v[104:107], v11 offset:39936
    v_add_f32 v217, 1.0, v217
    v_add_f32 v218, 1.0, v218
    v_add_f32 v219, 1.0, v219
    v_rcp_f32 v216, v216
    s_waitcnt lgkmcnt(7)
    v_mfma_f32_16x16x32_bf16 v[156:159], v[32:35], v[92:95], v[208:211]
    s_waitcnt lgkmcnt(6)
    v_mfma_f32_16x16x32_bf16 v[156:159], v[40:43], v[108:111], v[156:159]
    v_rcp_f32 v217, v217
    v_rcp_f32 v218, v218
    v_mfma_f32_16x16x32_bf16 v[172:175], v[36:39], v[92:95], v[212:215]
    v_mfma_f32_16x16x32_bf16 v[172:175], v[44:47], v[108:111], v[172:175]
    ds_read_b128 v[92:95], v10 offset:57344
    ds_read_b128 v[108:111], v11 offset:58368
    v_rcp_f32 v219, v219
    v_mul_f32 v216, v112, v216
    v_mul_f32 v217, v113, v217
    buffer_load_dwordx4 v[24:27], v1, s[12:15], s30 offen offset:3072 sc1
    buffer_load_dwordx4 v[28:31], v1, s[12:15], s31 offen offset:3072 sc1
    s_add_u32 s30, s25, 0xa42000
    buffer_load_dwordx4 v[32:35], v1, s[12:15], s30 offen offset:0 sc1
    s_add_u32 s31, s25, 0xa46800
    buffer_load_dwordx4 v[36:39], v1, s[12:15], s31 offen offset:0 sc1
    s_waitcnt vmcnt(13) lgkmcnt(7)
    v_mfma_f32_16x16x32_bf16 v[144:147], v[48:51], v[80:83], v[144:147]
    s_waitcnt vmcnt(11) lgkmcnt(6)
    v_mfma_f32_16x16x32_bf16 v[144:147], v[56:59], v[96:99], v[144:147]
    v_mul_f32 v218, v114, v218
    v_mul_f32 v219, v115, v219
    v_cvt_pk_bf16_f32 v220, v216, v217
    v_cvt_pk_bf16_f32 v221, v218, v219
    v_mfma_f32_16x16x32_bf16 v[160:163], v[52:55], v[80:83], v[160:163]
    s_waitcnt vmcnt(10)
    v_mfma_f32_16x16x32_bf16 v[160:163], v[60:63], v[96:99], v[160:163]
    ds_read_b128 v[80:83], v10 offset:4096
    ds_read_b128 v[96:99], v11 offset:5120
    v_mov_b32 v12, 149796
fused_kernel_r0_pre:
    ds_read_b32 v13, v12
    s_waitcnt lgkmcnt(0)
    v_readfirstlane_b32 s35, v13
    s_nop 3
    s_cmp_ge_u32 s35, 8
    s_cbranch_scc1 fused_kernel_r0_pre_d
    s_sleep 1
    s_branch fused_kernel_r0_pre
fused_kernel_r0_pre_d:
    ds_write_b64 v6, v[220:221] offset:0
    v_mfma_f32_16x16x32_bf16 v[148:151], v[48:51], v[84:87], v[148:151]
    v_mfma_f32_16x16x32_bf16 v[148:151], v[56:59], v[100:103], v[148:151]
    v_mul_f32 v216, v116, v116
    v_mfma_f32_16x16x32_bf16 v[164:167], v[52:55], v[84:87], v[164:167]
    v_mfma_f32_16x16x32_bf16 v[164:167], v[60:63], v[100:103], v[164:167]
    ds_read_b128 v[84:87], v10 offset:22528
    ds_read_b128 v[100:103], v11 offset:23552
    v_mul_f32 v217, v117, v117
    v_mul_f32 v218, v118, v118
    v_mul_f32 v219, v119, v119
    v_fmaak_f32 v216, v216, v5, 0xc0135761
    v_mfma_f32_16x16x32_bf16 v[152:155], v[48:51], v[88:91], v[152:155]
    v_mfma_f32_16x16x32_bf16 v[152:155], v[56:59], v[104:107], v[152:155]
    v_fmaak_f32 v217, v217, v5, 0xc0135761
    v_fmaak_f32 v218, v218, v5, 0xc0135761
    v_fmaak_f32 v219, v219, v5, 0xc0135761
    v_mul_f32 v216, v116, v216
    v_mfma_f32_16x16x32_bf16 v[168:171], v[52:55], v[88:91], v[168:171]
    v_mfma_f32_16x16x32_bf16 v[168:171], v[60:63], v[104:107], v[168:171]
    ds_read_b128 v[88:91], v10 offset:40960
    ds_read_b128 v[104:107], v11 offset:41984
    v_mul_f32 v217, v117, v217
    v_mul_f32 v218, v118, v218
    v_mul_f32 v219, v119, v219
    v_exp_f32 v216, v216
    v_mfma_f32_16x16x32_bf16 v[156:159], v[48:51], v[92:95], v[156:159]
    v_mfma_f32_16x16x32_bf16 v[156:159], v[56:59], v[108:111], v[156:159]
    v_exp_f32 v217, v217
    v_exp_f32 v218, v218
    v_mfma_f32_16x16x32_bf16 v[172:175], v[52:55], v[92:95], v[172:175]
    v_mfma_f32_16x16x32_bf16 v[172:175], v[60:63], v[108:111], v[172:175]
    ds_read_b128 v[92:95], v10 offset:59392
    ds_read_b128 v[108:111], v11 offset:60416
    v_exp_f32 v219, v219
    v_add_f32 v216, 1.0, v216
    v_add_f32 v217, 1.0, v217
    buffer_load_dwordx4 v[40:43], v1, s[12:15], s30 offen offset:1024 sc1
    buffer_load_dwordx4 v[44:47], v1, s[12:15], s31 offen offset:1024 sc1
    ds_read_b128 v[208:211], v3 offset:1024
    ds_read_b128 v[212:215], v3 offset:1088
    buffer_load_dwordx4 v[48:51], v1, s[12:15], s30 offen offset:2048 sc1
    buffer_load_dwordx4 v[52:55], v1, s[12:15], s31 offen offset:2048 sc1
    s_waitcnt vmcnt(13)
    v_mfma_f32_16x16x32_bf16 v[144:147], v[64:67], v[80:83], v[144:147]
    s_waitcnt vmcnt(11)
    v_mfma_f32_16x16x32_bf16 v[144:147], v[72:75], v[96:99], v[144:147]
    v_add_f32 v218, 1.0, v218
    v_add_f32 v219, 1.0, v219
    v_rcp_f32 v216, v216
    v_mfma_f32_16x16x32_bf16 v[160:163], v[68:71], v[80:83], v[160:163]
    s_waitcnt vmcnt(10)
    v_mfma_f32_16x16x32_bf16 v[160:163], v[76:79], v[96:99], v[160:163]
    ds_read_b128 v[80:83], v10 offset:6144
    ds_read_b128 v[96:99], v11 offset:7168
    v_rcp_f32 v217, v217
    v_rcp_f32 v218, v218
    v_rcp_f32 v219, v219
    s_waitcnt lgkmcnt(9)
    v_mfma_f32_16x16x32_bf16 v[148:151], v[64:67], v[84:87], v[148:151]
    s_waitcnt lgkmcnt(8)
    v_mfma_f32_16x16x32_bf16 v[148:151], v[72:75], v[100:103], v[148:151]
    v_mul_f32 v216, v116, v216
    v_mul_f32 v217, v117, v217
    v_mul_f32 v218, v118, v218
    v_mfma_f32_16x16x32_bf16 v[164:167], v[68:71], v[84:87], v[164:167]
    v_mfma_f32_16x16x32_bf16 v[164:167], v[76:79], v[100:103], v[164:167]
    ds_read_b128 v[84:87], v10 offset:24576
    ds_read_b128 v[100:103], v11 offset:25600
    v_mul_f32 v219, v119, v219
    v_cvt_pk_bf16_f32 v224, v216, v217
    v_cvt_pk_bf16_f32 v225, v218, v219
    ds_write_b64 v6, v[224:225] offset:18432
    s_waitcnt lgkmcnt(10)
    v_mfma_f32_16x16x32_bf16 v[152:155], v[64:67], v[88:91], v[152:155]
    s_waitcnt lgkmcnt(9)
    v_mfma_f32_16x16x32_bf16 v[152:155], v[72:75], v[104:107], v[152:155]
    v_mul_f32 v216, v120, v120
    v_mul_f32 v217, v121, v121
    v_mul_f32 v218, v122, v122
    v_mul_f32 v219, v123, v123
    v_mfma_f32_16x16x32_bf16 v[168:171], v[68:71], v[88:91], v[168:171]
    v_mfma_f32_16x16x32_bf16 v[168:171], v[76:79], v[104:107], v[168:171]
    ds_read_b128 v[88:91], v10 offset:43008
    ds_read_b128 v[104:107], v11 offset:44032
    v_fmaak_f32 v216, v216, v5, 0xc0135761
    v_fmaak_f32 v217, v217, v5, 0xc0135761
    v_fmaak_f32 v218, v218, v5, 0xc0135761
    v_fmaak_f32 v219, v219, v5, 0xc0135761
    v_mul_f32 v216, v120, v216
    s_waitcnt lgkmcnt(10)
    v_mfma_f32_16x16x32_bf16 v[156:159], v[64:67], v[92:95], v[156:159]
    s_waitcnt lgkmcnt(9)
    v_mfma_f32_16x16x32_bf16 v[156:159], v[72:75], v[108:111], v[156:159]
    v_mul_f32 v217, v121, v217
    v_mul_f32 v218, v122, v218
    v_mul_f32 v219, v123, v219
    v_exp_f32 v216, v216
    v_mfma_f32_16x16x32_bf16 v[172:175], v[68:71], v[92:95], v[172:175]
    v_mfma_f32_16x16x32_bf16 v[172:175], v[76:79], v[108:111], v[172:175]
    ds_read_b128 v[92:95], v10 offset:61440
    ds_read_b128 v[108:111], v11 offset:62464
    v_exp_f32 v217, v217
    v_exp_f32 v218, v218
    buffer_load_dwordx4 v[56:59], v1, s[12:15], s30 offen offset:3072 sc1
    buffer_load_dwordx4 v[60:63], v1, s[12:15], s31 offen offset:3072 sc1
    s_add_u32 s30, s25, 0xa43000
    buffer_load_dwordx4 v[64:67], v1, s[12:15], s30 offen offset:0 sc1
    s_add_u32 s31, s25, 0xa47800
    buffer_load_dwordx4 v[68:71], v1, s[12:15], s31 offen offset:0 sc1
    s_waitcnt vmcnt(13) lgkmcnt(8)
    v_mfma_f32_16x16x32_bf16 v[144:147], v[16:19], v[80:83], v[144:147]
    s_waitcnt vmcnt(11) lgkmcnt(7)
    v_mfma_f32_16x16x32_bf16 v[144:147], v[24:27], v[96:99], v[144:147]
    v_exp_f32 v219, v219
    v_add_f32 v216, 1.0, v216
    v_mfma_f32_16x16x32_bf16 v[160:163], v[20:23], v[80:83], v[160:163]
    s_waitcnt vmcnt(10)
    v_mfma_f32_16x16x32_bf16 v[160:163], v[28:31], v[96:99], v[160:163]
    ds_read_b128 v[80:83], v10 offset:8192
    ds_read_b128 v[96:99], v11 offset:9216
    v_add_f32 v217, 1.0, v217
    v_add_f32 v218, 1.0, v218
    v_add_f32 v219, 1.0, v219
    v_rcp_f32 v216, v216
    s_waitcnt lgkmcnt(8)
    v_mfma_f32_16x16x32_bf16 v[148:151], v[16:19], v[84:87], v[148:151]
    s_waitcnt lgkmcnt(7)
    v_mfma_f32_16x16x32_bf16 v[148:151], v[24:27], v[100:103], v[148:151]
    v_rcp_f32 v217, v217
    v_rcp_f32 v218, v218
    v_mfma_f32_16x16x32_bf16 v[164:167], v[20:23], v[84:87], v[164:167]
    v_mfma_f32_16x16x32_bf16 v[164:167], v[28:31], v[100:103], v[164:167]
    ds_read_b128 v[84:87], v10 offset:26624
    ds_read_b128 v[100:103], v11 offset:27648
    v_rcp_f32 v219, v219
    v_mul_f32 v216, v120, v216
    v_mul_f32 v217, v121, v217
    s_waitcnt lgkmcnt(7)
    v_mfma_f32_16x16x32_bf16 v[152:155], v[16:19], v[88:91], v[152:155]
    s_waitcnt lgkmcnt(6)
    v_mfma_f32_16x16x32_bf16 v[152:155], v[24:27], v[104:107], v[152:155]
    v_mul_f32 v218, v122, v218
    v_mul_f32 v219, v123, v219
    v_cvt_pk_bf16_f32 v220, v216, v217
    v_cvt_pk_bf16_f32 v221, v218, v219
    v_mfma_f32_16x16x32_bf16 v[168:171], v[20:23], v[88:91], v[168:171]
    v_mfma_f32_16x16x32_bf16 v[168:171], v[28:31], v[104:107], v[168:171]
    ds_read_b128 v[88:91], v10 offset:45056
    ds_read_b128 v[104:107], v11 offset:46080
    ds_write_b64 v6, v[220:221] offset:36864
    v_mul_f32 v216, v124, v124
    v_mul_f32 v217, v125, v125
    v_mul_f32 v218, v126, v126
    v_mul_f32 v219, v127, v127
    s_waitcnt lgkmcnt(8)
    v_mfma_f32_16x16x32_bf16 v[156:159], v[16:19], v[92:95], v[156:159]
    s_waitcnt lgkmcnt(7)
    v_mfma_f32_16x16x32_bf16 v[156:159], v[24:27], v[108:111], v[156:159]
    v_fmaak_f32 v216, v216, v5, 0xc0135761
    v_fmaak_f32 v217, v217, v5, 0xc0135761
    v_fmaak_f32 v218, v218, v5, 0xc0135761
    v_fmaak_f32 v219, v219, v5, 0xc0135761
    v_mfma_f32_16x16x32_bf16 v[172:175], v[20:23], v[92:95], v[172:175]
    v_mfma_f32_16x16x32_bf16 v[172:175], v[28:31], v[108:111], v[172:175]
    ds_read_b128 v[92:95], v10 offset:63488
    ds_read_b128 v[108:111], v11 offset:64512
    v_mul_f32 v216, v124, v216
    v_mul_f32 v217, v125, v217
    v_mul_f32 v218, v126, v218
    v_mul_f32 v219, v127, v219
    buffer_load_dwordx4 v[72:75], v1, s[12:15], s30 offen offset:1024 sc1
    buffer_load_dwordx4 v[76:79], v1, s[12:15], s31 offen offset:1024 sc1
    buffer_load_dwordx4 v[16:19], v1, s[12:15], s30 offen offset:2048 sc1
    buffer_load_dwordx4 v[20:23], v1, s[12:15], s31 offen offset:2048 sc1
    s_waitcnt vmcnt(13) lgkmcnt(8)
    v_mfma_f32_16x16x32_bf16 v[144:147], v[32:35], v[80:83], v[144:147]
    s_waitcnt vmcnt(11) lgkmcnt(7)
    v_mfma_f32_16x16x32_bf16 v[144:147], v[40:43], v[96:99], v[144:147]
    v_exp_f32 v216, v216
    v_exp_f32 v217, v217
    v_mfma_f32_16x16x32_bf16 v[160:163], v[36:39], v[80:83], v[160:163]
    s_waitcnt vmcnt(10)
    v_mfma_f32_16x16x32_bf16 v[160:163], v[44:47], v[96:99], v[160:163]
    ds_read_b128 v[80:83], v10 offset:10240
    ds_read_b128 v[96:99], v11 offset:11264
    v_exp_f32 v218, v218
    v_exp_f32 v219, v219
    v_add_f32 v216, 1.0, v216
    s_waitcnt lgkmcnt(8)
    v_mfma_f32_16x16x32_bf16 v[148:151], v[32:35], v[84:87], v[148:151]
    s_waitcnt lgkmcnt(7)
    v_mfma_f32_16x16x32_bf16 v[148:151], v[40:43], v[100:103], v[148:151]
    v_add_f32 v217, 1.0, v217
    v_add_f32 v218, 1.0, v218
    v_add_f32 v219, 1.0, v219
    v_rcp_f32 v216, v216
    v_mfma_f32_16x16x32_bf16 v[164:167], v[36:39], v[84:87], v[164:167]
    v_mfma_f32_16x16x32_bf16 v[164:167], v[44:47], v[100:103], v[164:167]
    ds_read_b128 v[84:87], v10 offset:28672
    ds_read_b128 v[100:103], v11 offset:29696
    v_rcp_f32 v217, v217
    v_rcp_f32 v218, v218
    s_waitcnt lgkmcnt(8)
    v_mfma_f32_16x16x32_bf16 v[152:155], v[32:35], v[88:91], v[152:155]
    s_waitcnt lgkmcnt(7)
    v_mfma_f32_16x16x32_bf16 v[152:155], v[40:43], v[104:107], v[152:155]
    v_rcp_f32 v219, v219
    v_mul_f32 v216, v124, v216
    v_mfma_f32_16x16x32_bf16 v[168:171], v[36:39], v[88:91], v[168:171]
    v_mfma_f32_16x16x32_bf16 v[168:171], v[44:47], v[104:107], v[168:171]
    ds_read_b128 v[88:91], v10 offset:47104
    ds_read_b128 v[104:107], v11 offset:48128
    v_mul_f32 v217, v125, v217
    v_mul_f32 v218, v126, v218
    v_mul_f32 v219, v127, v219
    v_cvt_pk_bf16_f32 v224, v216, v217
    v_cvt_pk_bf16_f32 v225, v218, v219
    s_waitcnt lgkmcnt(7)
    v_mfma_f32_16x16x32_bf16 v[156:159], v[32:35], v[92:95], v[156:159]
    s_waitcnt lgkmcnt(6)
    v_mfma_f32_16x16x32_bf16 v[156:159], v[40:43], v[108:111], v[156:159]
    ds_write_b64 v6, v[224:225] offset:55296
    s_nop 0
    s_nop 0
    s_nop 0
    s_waitcnt lgkmcnt(0)
    v_mov_b32 v12, 149808
    v_mov_b32 v13, 1
    s_mov_b64 exec, 1
    ds_add_u32 v12, v13
    s_mov_b64 exec, -1
    v_mfma_f32_16x16x32_bf16 v[172:175], v[36:39], v[92:95], v[172:175]
    v_mfma_f32_16x16x32_bf16 v[172:175], v[44:47], v[108:111], v[172:175]
    ds_read_b128 v[92:95], v14 offset:0
    ds_read_b128 v[108:111], v15 offset:1024
    buffer_load_dwordx4 v[24:27], v1, s[12:15], s30 offen offset:3072 sc1
    buffer_load_dwordx4 v[28:31], v1, s[12:15], s31 offen offset:3072 sc1
    s_add_u32 s30, s25, 0xa44000
    buffer_load_dwordx4 v[32:35], v1, s[12:15], s30 offen offset:0 sc1
    s_add_u32 s31, s25, 0xa48800
    buffer_load_dwordx4 v[36:39], v1, s[12:15], s31 offen offset:0 sc1
    s_waitcnt vmcnt(13)
    v_mfma_f32_16x16x32_bf16 v[144:147], v[48:51], v[80:83], v[144:147]
    s_waitcnt vmcnt(11)
    v_mfma_f32_16x16x32_bf16 v[144:147], v[56:59], v[96:99], v[144:147]
    v_mfma_f32_16x16x32_bf16 v[160:163], v[52:55], v[80:83], v[160:163]
    s_waitcnt vmcnt(10)
    v_mfma_f32_16x16x32_bf16 v[160:163], v[60:63], v[96:99], v[160:163]
    ds_read_b128 v[80:83], v10 offset:12288
    ds_read_b128 v[96:99], v11 offset:13312
    v_mfma_f32_16x16x32_bf16 v[148:151], v[48:51], v[84:87], v[148:151]
    v_mfma_f32_16x16x32_bf16 v[148:151], v[56:59], v[100:103], v[148:151]
    v_mfma_f32_16x16x32_bf16 v[164:167], v[52:55], v[84:87], v[164:167]
    v_mfma_f32_16x16x32_bf16 v[164:167], v[60:63], v[100:103], v[164:167]
    ds_read_b128 v[84:87], v10 offset:30720
    ds_read_b128 v[100:103], v11 offset:31744
    v_mfma_f32_16x16x32_bf16 v[152:155], v[48:51], v[88:91], v[152:155]
    v_mfma_f32_16x16x32_bf16 v[152:155], v[56:59], v[104:107], v[152:155]
    v_mfma_f32_16x16x32_bf16 v[168:171], v[52:55], v[88:91], v[168:171]
    v_mfma_f32_16x16x32_bf16 v[168:171], v[60:63], v[104:107], v[168:171]
    ds_read_b128 v[88:91], v10 offset:49152
    ds_read_b128 v[104:107], v11 offset:50176
    s_waitcnt lgkmcnt(7)
    v_mfma_f32_16x16x32_bf16 v[156:159], v[48:51], v[92:95], v[156:159]
    s_waitcnt lgkmcnt(6)
    v_mfma_f32_16x16x32_bf16 v[156:159], v[56:59], v[108:111], v[156:159]
    v_mfma_f32_16x16x32_bf16 v[172:175], v[52:55], v[92:95], v[172:175]
    v_mfma_f32_16x16x32_bf16 v[172:175], v[60:63], v[108:111], v[172:175]
    ds_read_b128 v[92:95], v14 offset:2048
    ds_read_b128 v[108:111], v15 offset:3072
    buffer_load_dwordx4 v[40:43], v1, s[12:15], s30 offen offset:1024 sc1
    buffer_load_dwordx4 v[44:47], v1, s[12:15], s31 offen offset:1024 sc1
    s_add_u32 s30, s26, 0xa40000
    buffer_load_dwordx4 v[48:51], v1, s[12:15], s30 offen offset:0 sc1
    s_add_u32 s31, s26, 0xa44800
    buffer_load_dwordx4 v[52:55], v1, s[12:15], s31 offen offset:0 sc1
    s_waitcnt vmcnt(13) lgkmcnt(7)
    v_mfma_f32_16x16x32_bf16 v[144:147], v[64:67], v[80:83], v[144:147]
    s_waitcnt vmcnt(11) lgkmcnt(6)
    v_mfma_f32_16x16x32_bf16 v[144:147], v[72:75], v[96:99], v[144:147]
    v_mfma_f32_16x16x32_bf16 v[160:163], v[68:71], v[80:83], v[160:163]
    s_waitcnt vmcnt(10)
    v_mfma_f32_16x16x32_bf16 v[160:163], v[76:79], v[96:99], v[160:163]
    ds_read_b128 v[80:83], v10 offset:14336
    ds_read_b128 v[96:99], v11 offset:15360
    s_waitcnt lgkmcnt(7)
    v_mfma_f32_16x16x32_bf16 v[148:151], v[64:67], v[84:87], v[148:151]
    s_waitcnt lgkmcnt(6)
    v_mfma_f32_16x16x32_bf16 v[148:151], v[72:75], v[100:103], v[148:151]
    v_mfma_f32_16x16x32_bf16 v[164:167], v[68:71], v[84:87], v[164:167]
    v_mfma_f32_16x16x32_bf16 v[164:167], v[76:79], v[100:103], v[164:167]
    ds_read_b128 v[84:87], v10 offset:32768
    ds_read_b128 v[100:103], v11 offset:33792
    s_waitcnt lgkmcnt(7)
    v_mfma_f32_16x16x32_bf16 v[152:155], v[64:67], v[88:91], v[152:155]
    s_waitcnt lgkmcnt(6)
    v_mfma_f32_16x16x32_bf16 v[152:155], v[72:75], v[104:107], v[152:155]
    v_mfma_f32_16x16x32_bf16 v[168:171], v[68:71], v[88:91], v[168:171]
    v_mfma_f32_16x16x32_bf16 v[168:171], v[76:79], v[104:107], v[168:171]
    ds_read_b128 v[88:91], v10 offset:51200
    ds_read_b128 v[104:107], v11 offset:52224
    s_waitcnt lgkmcnt(7)
    v_mfma_f32_16x16x32_bf16 v[156:159], v[64:67], v[92:95], v[156:159]
    s_waitcnt lgkmcnt(6)
    v_mfma_f32_16x16x32_bf16 v[156:159], v[72:75], v[108:111], v[156:159]
    v_mfma_f32_16x16x32_bf16 v[172:175], v[68:71], v[92:95], v[172:175]
    v_mfma_f32_16x16x32_bf16 v[172:175], v[76:79], v[108:111], v[172:175]
    ds_read_b128 v[92:95], v14 offset:4096
    ds_read_b128 v[108:111], v15 offset:5120
    buffer_load_dwordx4 v[56:59], v1, s[12:15], s30 offen offset:1024 sc1
    buffer_load_dwordx4 v[60:63], v1, s[12:15], s31 offen offset:1024 sc1
    buffer_load_dwordx4 v[64:67], v1, s[12:15], s30 offen offset:2048 sc1
    buffer_load_dwordx4 v[68:71], v1, s[12:15], s31 offen offset:2048 sc1
    s_waitcnt vmcnt(13) lgkmcnt(7)
    v_mfma_f32_16x16x32_bf16 v[144:147], v[16:19], v[80:83], v[144:147]
    s_waitcnt vmcnt(11) lgkmcnt(6)
    v_mfma_f32_16x16x32_bf16 v[144:147], v[24:27], v[96:99], v[144:147]
    v_mfma_f32_16x16x32_bf16 v[160:163], v[20:23], v[80:83], v[160:163]
    s_waitcnt vmcnt(10)
    v_mfma_f32_16x16x32_bf16 v[160:163], v[28:31], v[96:99], v[160:163]
    ds_read_b128 v[80:83], v10 offset:16384
    ds_read_b128 v[96:99], v11 offset:17408
    s_waitcnt lgkmcnt(7)
    v_mfma_f32_16x16x32_bf16 v[148:151], v[16:19], v[84:87], v[148:151]
    s_waitcnt lgkmcnt(6)
    v_mfma_f32_16x16x32_bf16 v[148:151], v[24:27], v[100:103], v[148:151]
    v_mfma_f32_16x16x32_bf16 v[164:167], v[20:23], v[84:87], v[164:167]
    v_mfma_f32_16x16x32_bf16 v[164:167], v[28:31], v[100:103], v[164:167]
    ds_read_b128 v[84:87], v10 offset:34816
    ds_read_b128 v[100:103], v11 offset:35840
    s_waitcnt lgkmcnt(7)
    v_mfma_f32_16x16x32_bf16 v[152:155], v[16:19], v[88:91], v[152:155]
    s_waitcnt lgkmcnt(6)
    v_mfma_f32_16x16x32_bf16 v[152:155], v[24:27], v[104:107], v[152:155]
    v_mfma_f32_16x16x32_bf16 v[168:171], v[20:23], v[88:91], v[168:171]
    v_mfma_f32_16x16x32_bf16 v[168:171], v[28:31], v[104:107], v[168:171]
    ds_read_b128 v[88:91], v10 offset:53248
    ds_read_b128 v[104:107], v11 offset:54272
    s_waitcnt lgkmcnt(7)
    v_mfma_f32_16x16x32_bf16 v[156:159], v[16:19], v[92:95], v[156:159]
    s_waitcnt lgkmcnt(6)
    v_mfma_f32_16x16x32_bf16 v[156:159], v[24:27], v[108:111], v[156:159]
    v_mfma_f32_16x16x32_bf16 v[172:175], v[20:23], v[92:95], v[172:175]
    v_mfma_f32_16x16x32_bf16 v[172:175], v[28:31], v[108:111], v[172:175]
    ds_read_b128 v[92:95], v14 offset:6144
    ds_read_b128 v[108:111], v15 offset:7168
    buffer_load_dwordx4 v[72:75], v1, s[12:15], s30 offen offset:3072 sc1
    buffer_load_dwordx4 v[76:79], v1, s[12:15], s31 offen offset:3072 sc1
    s_add_u32 s30, s26, 0xa41000
    buffer_load_dwordx4 v[16:19], v1, s[12:15], s30 offen offset:0 sc1
    s_add_u32 s31, s26, 0xa45800
    buffer_load_dwordx4 v[20:23], v1, s[12:15], s31 offen offset:0 sc1
    s_waitcnt vmcnt(13) lgkmcnt(7)
    v_mfma_f32_16x16x32_bf16 v[144:147], v[32:35], v[80:83], v[144:147]
    s_waitcnt vmcnt(11) lgkmcnt(6)
    v_mfma_f32_16x16x32_bf16 v[144:147], v[40:43], v[96:99], v[144:147]
    v_mfma_f32_16x16x32_bf16 v[160:163], v[36:39], v[80:83], v[160:163]
    s_waitcnt vmcnt(10)
    v_mfma_f32_16x16x32_bf16 v[160:163], v[44:47], v[96:99], v[160:163]
    ds_read_b128 v[80:83], v10 offset:0
    ds_read_b128 v[96:99], v11 offset:1024
    s_waitcnt lgkmcnt(7)
    v_mfma_f32_16x16x32_bf16 v[148:151], v[32:35], v[84:87], v[148:151]
    s_waitcnt lgkmcnt(6)
    v_mfma_f32_16x16x32_bf16 v[148:151], v[40:43], v[100:103], v[148:151]
    v_mfma_f32_16x16x32_bf16 v[164:167], v[36:39], v[84:87], v[164:167]
    v_mfma_f32_16x16x32_bf16 v[164:167], v[44:47], v[100:103], v[164:167]
    ds_read_b128 v[84:87], v10 offset:18432
    ds_read_b128 v[100:103], v11 offset:19456
    s_waitcnt lgkmcnt(7)
    v_mfma_f32_16x16x32_bf16 v[152:155], v[32:35], v[88:91], v[152:155]
    s_waitcnt lgkmcnt(6)
    v_mfma_f32_16x16x32_bf16 v[152:155], v[40:43], v[104:107], v[152:155]
    v_mfma_f32_16x16x32_bf16 v[168:171], v[36:39], v[88:91], v[168:171]
    v_mfma_f32_16x16x32_bf16 v[168:171], v[44:47], v[104:107], v[168:171]
    ds_read_b128 v[88:91], v10 offset:36864
    ds_read_b128 v[104:107], v11 offset:37888
    s_waitcnt lgkmcnt(7)
    v_mfma_f32_16x16x32_bf16 v[156:159], v[32:35], v[92:95], v[156:159]
    s_waitcnt lgkmcnt(6)
    v_mfma_f32_16x16x32_bf16 v[156:159], v[40:43], v[108:111], v[156:159]
    v_mfma_f32_16x16x32_bf16 v[172:175], v[36:39], v[92:95], v[172:175]
    v_mfma_f32_16x16x32_bf16 v[172:175], v[44:47], v[108:111], v[172:175]
    ds_read_b128 v[92:95], v10 offset:55296
    ds_read_b128 v[108:111], v11 offset:56320
    buffer_load_dwordx4 v[24:27], v1, s[12:15], s30 offen offset:1024 sc1
    buffer_load_dwordx4 v[28:31], v1, s[12:15], s31 offen offset:1024 sc1
    buffer_load_dwordx4 v[32:35], v1, s[12:15], s30 offen offset:2048 sc1
    buffer_load_dwordx4 v[36:39], v1, s[12:15], s31 offen offset:2048 sc1
    s_waitcnt vmcnt(13) lgkmcnt(7)
    v_mfma_f32_16x16x32_bf16 v[112:115], v[48:51], v[80:83], v[208:211]
    s_waitcnt vmcnt(11) lgkmcnt(6)
    v_mfma_f32_16x16x32_bf16 v[112:115], v[56:59], v[96:99], v[112:115]
    v_mul_f32 v216, v144, v144
    v_mul_f32 v217, v145, v145
    v_mul_f32 v218, v146, v146
    v_mul_f32 v219, v147, v147
    v_mfma_f32_16x16x32_bf16 v[128:131], v[52:55], v[80:83], v[212:215]
    s_waitcnt vmcnt(10)
    v_mfma_f32_16x16x32_bf16 v[128:131], v[60:63], v[96:99], v[128:131]
    ds_read_b128 v[80:83], v10 offset:2048
    ds_read_b128 v[96:99], v11 offset:3072
    v_fmaak_f32 v216, v216, v5, 0xc0135761
    v_fmaak_f32 v217, v217, v5, 0xc0135761
    v_fmaak_f32 v218, v218, v5, 0xc0135761
    v_fmaak_f32 v219, v219, v5, 0xc0135761
    s_waitcnt lgkmcnt(7)
    v_mfma_f32_16x16x32_bf16 v[116:119], v[48:51], v[84:87], v[208:211]
    s_waitcnt lgkmcnt(6)
    v_mfma_f32_16x16x32_bf16 v[116:119], v[56:59], v[100:103], v[116:119]
    v_mul_f32 v216, v144, v216
    v_mul_f32 v217, v145, v217
    v_mul_f32 v218, v146, v218
    v_mul_f32 v219, v147, v219
    v_mfma_f32_16x16x32_bf16 v[132:135], v[52:55], v[84:87], v[212:215]
    v_mfma_f32_16x16x32_bf16 v[132:135], v[60:63], v[100:103], v[132:135]
    ds_read_b128 v[84:87], v10 offset:20480
    ds_read_b128 v[100:103], v11 offset:21504
    v_exp_f32 v216, v216
    v_exp_f32 v217, v217
    v_exp_f32 v218, v218
    s_waitcnt lgkmcnt(7)
    v_mfma_f32_16x16x32_bf16 v[120:123], v[48:51], v[88:91], v[208:211]
    s_waitcnt lgkmcnt(6)
    v_mfma_f32_16x16x32_bf16 v[120:123], v[56:59], v[104:107], v[120:123]
    v_exp_f32 v219, v219
    v_add_f32 v216, 1.0, v216
    v_mfma_f32_16x16x32_bf16 v[136:139], v[52:55], v[88:91], v[212:215]
    v_mfma_f32_16x16x32_bf16 v[136:139], v[60:63], v[104:107], v[136:139]
    ds_read_b128 v[88:91], v10 offset:38912
    ds_read_b128 v[104:107], v11 offset:39936
    v_add_f32 v217, 1.0, v217
    v_add_f32 v218, 1.0, v218
    v_add_f32 v219, 1.0, v219
    v_rcp_f32 v216, v216
    s_waitcnt lgkmcnt(7)
    v_mfma_f32_16x16x32_bf16 v[124:127], v[48:51], v[92:95], v[208:211]
    s_waitcnt lgkmcnt(6)
    v_mfma_f32_16x16x32_bf16 v[124:127], v[56:59], v[108:111], v[124:127]
    v_rcp_f32 v217, v217
    v_rcp_f32 v218, v218
    v_mfma_f32_16x16x32_bf16 v[140:143], v[52:55], v[92:95], v[212:215]
    v_mfma_f32_16x16x32_bf16 v[140:143], v[60:63], v[108:111], v[140:143]
    ds_read_b128 v[92:95], v10 offset:57344
    ds_read_b128 v[108:111], v11 offset:58368
    v_rcp_f32 v219, v219
    v_mul_f32 v216, v144, v216
    v_mul_f32 v217, v145, v217
    buffer_load_dwordx4 v[40:43], v1, s[12:15], s30 offen offset:3072 sc1
    buffer_load_dwordx4 v[44:47], v1, s[12:15], s31 offen offset:3072 sc1
    s_add_u32 s30, s26, 0xa42000
    buffer_load_dwordx4 v[48:51], v1, s[12:15], s30 offen offset:0 sc1
    s_add_u32 s31, s26, 0xa46800
    buffer_load_dwordx4 v[52:55], v1, s[12:15], s31 offen offset:0 sc1
    s_waitcnt vmcnt(13) lgkmcnt(7)
    v_mfma_f32_16x16x32_bf16 v[112:115], v[64:67], v[80:83], v[112:115]
    s_waitcnt vmcnt(11) lgkmcnt(6)
    v_mfma_f32_16x16x32_bf16 v[112:115], v[72:75], v[96:99], v[112:115]
    v_mul_f32 v218, v146, v218
    v_mul_f32 v219, v147, v219
    v_cvt_pk_bf16_f32 v220, v216, v217
    v_cvt_pk_bf16_f32 v221, v218, v219
    v_mfma_f32_16x16x32_bf16 v[128:131], v[68:71], v[80:83], v[128:131]
    s_waitcnt vmcnt(10)
    v_mfma_f32_16x16x32_bf16 v[128:131], v[76:79], v[96:99], v[128:131]
    ds_read_b128 v[80:83], v10 offset:4096
    ds_read_b128 v[96:99], v11 offset:5120
    v_mul_f32 v216, v160, v160
    v_mul_f32 v217, v161, v161
    v_mul_f32 v218, v162, v162
    v_mul_f32 v219, v163, v163
    s_waitcnt lgkmcnt(7)
    v_mfma_f32_16x16x32_bf16 v[116:119], v[64:67], v[84:87], v[116:119]
    s_waitcnt lgkmcnt(6)
    v_mfma_f32_16x16x32_bf16 v[116:119], v[72:75], v[100:103], v[116:119]
    v_fmaak_f32 v216, v216, v5, 0xc0135761
    v_fmaak_f32 v217, v217, v5, 0xc0135761
    v_fmaak_f32 v218, v218, v5, 0xc0135761
    v_fmaak_f32 v219, v219, v5, 0xc0135761
    v_mfma_f32_16x16x32_bf16 v[132:135], v[68:71], v[84:87], v[132:135]
    v_mfma_f32_16x16x32_bf16 v[132:135], v[76:79], v[100:103], v[132:135]
    ds_read_b128 v[84:87], v10 offset:22528
    ds_read_b128 v[100:103], v11 offset:23552
    v_mul_f32 v216, v160, v216
    v_mul_f32 v217, v161, v217
    v_mul_f32 v218, v162, v218
    v_mul_f32 v219, v163, v219
    v_exp_f32 v216, v216
    s_waitcnt lgkmcnt(7)
    v_mfma_f32_16x16x32_bf16 v[120:123], v[64:67], v[88:91], v[120:123]
    s_waitcnt lgkmcnt(6)
    v_mfma_f32_16x16x32_bf16 v[120:123], v[72:75], v[104:107], v[120:123]
    v_exp_f32 v217, v217
    v_exp_f32 v218, v218
    v_mfma_f32_16x16x32_bf16 v[136:139], v[68:71], v[88:91], v[136:139]
    v_mfma_f32_16x16x32_bf16 v[136:139], v[76:79], v[104:107], v[136:139]
    ds_read_b128 v[88:91], v10 offset:40960
    ds_read_b128 v[104:107], v11 offset:41984
    v_exp_f32 v219, v219
    v_add_f32 v216, 1.0, v216
    s_waitcnt lgkmcnt(7)
    v_mfma_f32_16x16x32_bf16 v[124:127], v[64:67], v[92:95], v[124:127]
    s_waitcnt lgkmcnt(6)
    v_mfma_f32_16x16x32_bf16 v[124:127], v[72:75], v[108:111], v[124:127]
    v_add_f32 v217, 1.0, v217
    v_add_f32 v218, 1.0, v218
    v_add_f32 v219, 1.0, v219
    v_rcp_f32 v216, v216
    v_mfma_f32_16x16x32_bf16 v[140:143], v[68:71], v[92:95], v[140:143]
    v_mfma_f32_16x16x32_bf16 v[140:143], v[76:79], v[108:111], v[140:143]
    ds_read_b128 v[92:95], v10 offset:59392
    ds_read_b128 v[108:111], v11 offset:60416
    v_rcp_f32 v217, v217
    v_rcp_f32 v218, v218
    buffer_load_dwordx4 v[56:59], v1, s[12:15], s30 offen offset:1024 sc1
    buffer_load_dwordx4 v[60:63], v1, s[12:15], s31 offen offset:1024 sc1
    buffer_load_dwordx4 v[64:67], v1, s[12:15], s30 offen offset:2048 sc1
    buffer_load_dwordx4 v[68:71], v1, s[12:15], s31 offen offset:2048 sc1
    s_waitcnt vmcnt(13) lgkmcnt(7)
    v_mfma_f32_16x16x32_bf16 v[112:115], v[16:19], v[80:83], v[112:115]
    s_waitcnt vmcnt(11) lgkmcnt(6)
    v_mfma_f32_16x16x32_bf16 v[112:115], v[24:27], v[96:99], v[112:115]
    v_rcp_f32 v219, v219
    v_mul_f32 v216, v160, v216
    v_mul_f32 v217, v161, v217
    v_mfma_f32_16x16x32_bf16 v[128:131], v[20:23], v[80:83], v[128:131]
    s_waitcnt vmcnt(10)
    v_mfma_f32_16x16x32_bf16 v[128:131], v[28:31], v[96:99], v[128:131]
    ds_read_b128 v[80:83], v10 offset:6144
    ds_read_b128 v[96:99], v11 offset:7168
    v_mul_f32 v218, v162, v218
    v_mul_f32 v219, v163, v219
    v_cvt_pk_bf16_f32 v222, v216, v217
    v_cvt_pk_bf16_f32 v223, v218, v219
    s_waitcnt lgkmcnt(7)
    v_mfma_f32_16x16x32_bf16 v[116:119], v[16:19], v[84:87], v[116:119]
    s_waitcnt lgkmcnt(6)
    v_mfma_f32_16x16x32_bf16 v[116:119], v[24:27], v[100:103], v[116:119]
    ds_write_b128 v4, v[220:223] offset:0
    v_mul_f32 v216, v148, v148
    v_mul_f32 v217, v149, v149
    v_mul_f32 v218, v150, v150
    v_mfma_f32_16x16x32_bf16 v[132:135], v[20:23], v[84:87], v[132:135]
    v_mfma_f32_16x16x32_bf16 v[132:135], v[28:31], v[100:103], v[132:135]
    ds_read_b128 v[84:87], v10 offset:24576
    ds_read_b128 v[100:103], v11 offset:25600
    v_mul_f32 v219, v151, v151
    v_fmaak_f32 v216, v216, v5, 0xc0135761
    v_fmaak_f32 v217, v217, v5, 0xc0135761
    v_fmaak_f32 v218, v218, v5, 0xc0135761
    v_fmaak_f32 v219, v219, v5, 0xc0135761
    s_waitcnt lgkmcnt(8)
    v_mfma_f32_16x16x32_bf16 v[120:123], v[16:19], v[88:91], v[120:123]
    s_waitcnt lgkmcnt(7)
    v_mfma_f32_16x16x32_bf16 v[120:123], v[24:27], v[104:107], v[120:123]
    v_mul_f32 v216, v148, v216
    v_mul_f32 v217, v149, v217
    v_mul_f32 v218, v150, v218
    v_mul_f32 v219, v151, v219
    v_mfma_f32_16x16x32_bf16 v[136:139], v[20:23], v[88:91], v[136:139]
    v_mfma_f32_16x16x32_bf16 v[136:139], v[28:31], v[104:107], v[136:139]
    ds_read_b128 v[88:91], v10 offset:43008
    ds_read_b128 v[104:107], v11 offset:44032
    v_exp_f32 v216, v216
    v_exp_f32 v217, v217
    s_waitcnt lgkmcnt(8)
    v_mfma_f32_16x16x32_bf16 v[124:127], v[16:19], v[92:95], v[124:127]
    s_waitcnt lgkmcnt(7)
    v_mfma_f32_16x16x32_bf16 v[124:127], v[24:27], v[108:111], v[124:127]
    v_exp_f32 v218, v218
    v_exp_f32 v219, v219
    v_mfma_f32_16x16x32_bf16 v[140:143], v[20:23], v[92:95], v[140:143]
    v_mfma_f32_16x16x32_bf16 v[140:143], v[28:31], v[108:111], v[140:143]
    ds_read_b128 v[92:95], v10 offset:61440
    ds_read_b128 v[108:111], v11 offset:62464
    v_add_f32 v216, 1.0, v216
    v_add_f32 v217, 1.0, v217
    v_add_f32 v218, 1.0, v218
    v_add_f32 v219, 1.0, v219
    v_rcp_f32 v216, v216
    buffer_load_dwordx4 v[72:75], v1, s[12:15], s30 offen offset:3072 sc1
    buffer_load_dwordx4 v[76:79], v1, s[12:15], s31 offen offset:3072 sc1
    s_add_u32 s30, s26, 0xa43000
    buffer_load_dwordx4 v[16:19], v1, s[12:15], s30 offen offset:0 sc1
    s_add_u32 s31, s26, 0xa47800
    buffer_load_dwordx4 v[20:23], v1, s[12:15], s31 offen offset:0 sc1
    s_waitcnt vmcnt(13) lgkmcnt(8)
    v_mfma_f32_16x16x32_bf16 v[112:115], v[32:35], v[80:83], v[112:115]
    s_waitcnt vmcnt(11) lgkmcnt(7)
    v_mfma_f32_16x16x32_bf16 v[112:115], v[40:43], v[96:99], v[112:115]
    v_rcp_f32 v217, v217
    v_rcp_f32 v218, v218
    v_mfma_f32_16x16x32_bf16 v[128:131], v[36:39], v[80:83], v[128:131]
    s_waitcnt vmcnt(10)
    v_mfma_f32_16x16x32_bf16 v[128:131], v[44:47], v[96:99], v[128:131]
    ds_read_b128 v[80:83], v10 offset:8192
    ds_read_b128 v[96:99], v11 offset:9216
    v_rcp_f32 v219, v219
    v_mul_f32 v216, v148, v216
    s_waitcnt lgkmcnt(7)
    v_mfma_f32_16x16x32_bf16 v[116:119], v[32:35], v[84:87], v[116:119]
    s_waitcnt lgkmcnt(6)
    v_mfma_f32_16x16x32_bf16 v[116:119], v[40:43], v[100:103], v[116:119]
    v_mul_f32 v217, v149, v217
    v_mul_f32 v218, v150, v218
    v_mul_f32 v219, v151, v219
    v_cvt_pk_bf16_f32 v224, v216, v217
    v_mfma_f32_16x16x32_bf16 v[132:135], v[36:39], v[84:87], v[132:135]
    v_mfma_f32_16x16x32_bf16 v[132:135], v[44:47], v[100:103], v[132:135]
    ds_read_b128 v[84:87], v10 offset:26624
    ds_read_b128 v[100:103], v11 offset:27648
    v_cvt_pk_bf16_f32 v225, v218, v219
    v_mul_f32 v216, v164, v164
    v_mul_f32 v217, v165, v165
    v_mul_f32 v218, v166, v166
    v_mul_f32 v219, v167, v167
    s_waitcnt lgkmcnt(7)
    v_mfma_f32_16x16x32_bf16 v[120:123], v[32:35], v[88:91], v[120:123]
    s_waitcnt lgkmcnt(6)
    v_mfma_f32_16x16x32_bf16 v[120:123], v[40:43], v[104:107], v[120:123]
    v_fmaak_f32 v216, v216, v5, 0xc0135761
    v_fmaak_f32 v217, v217, v5, 0xc0135761
    v_fmaak_f32 v218, v218, v5, 0xc0135761
    v_fmaak_f32 v219, v219, v5, 0xc0135761
    v_mfma_f32_16x16x32_bf16 v[136:139], v[36:39], v[88:91], v[136:139]
    v_mfma_f32_16x16x32_bf16 v[136:139], v[44:47], v[104:107], v[136:139]
    ds_read_b128 v[88:91], v10 offset:45056
    ds_read_b128 v[104:107], v11 offset:46080
    v_mul_f32 v216, v164, v216
    v_mul_f32 v217, v165, v217
    v_mul_f32 v218, v166, v218
    v_mul_f32 v219, v167, v219
    s_waitcnt lgkmcnt(7)
    v_mfma_f32_16x16x32_bf16 v[124:127], v[32:35], v[92:95], v[124:127]
    s_waitcnt lgkmcnt(6)
    v_mfma_f32_16x16x32_bf16 v[124:127], v[40:43], v[108:111], v[124:127]
    v_exp_f32 v216, v216
    v_exp_f32 v217, v217
    v_mfma_f32_16x16x32_bf16 v[140:143], v[36:39], v[92:95], v[140:143]
    v_mfma_f32_16x16x32_bf16 v[140:143], v[44:47], v[108:111], v[140:143]
    ds_read_b128 v[92:95], v10 offset:63488
    ds_read_b128 v[108:111], v11 offset:64512
    v_exp_f32 v218, v218
    v_exp_f32 v219, v219
    v_add_f32 v216, 1.0, v216
    buffer_load_dwordx4 v[24:27], v1, s[12:15], s30 offen offset:1024 sc1
    buffer_load_dwordx4 v[28:31], v1, s[12:15], s31 offen offset:1024 sc1
    buffer_load_dwordx4 v[32:35], v1, s[12:15], s30 offen offset:2048 sc1
    buffer_load_dwordx4 v[36:39], v1, s[12:15], s31 offen offset:2048 sc1
    s_waitcnt vmcnt(13) lgkmcnt(7)
    v_mfma_f32_16x16x32_bf16 v[112:115], v[48:51], v[80:83], v[112:115]
    s_waitcnt vmcnt(11) lgkmcnt(6)
    v_mfma_f32_16x16x32_bf16 v[112:115], v[56:59], v[96:99], v[112:115]
    v_add_f32 v217, 1.0, v217
    v_add_f32 v218, 1.0, v218
    v_add_f32 v219, 1.0, v219
    v_rcp_f32 v216, v216
    v_mfma_f32_16x16x32_bf16 v[128:131], v[52:55], v[80:83], v[128:131]
    s_waitcnt vmcnt(10)
    v_mfma_f32_16x16x32_bf16 v[128:131], v[60:63], v[96:99], v[128:131]
    ds_read_b128 v[80:83], v10 offset:10240
    ds_read_b128 v[96:99], v11 offset:11264
    v_rcp_f32 v217, v217
    v_rcp_f32 v218, v218
    s_waitcnt lgkmcnt(7)
    v_mfma_f32_16x16x32_bf16 v[116:119], v[48:51], v[84:87], v[116:119]
    s_waitcnt lgkmcnt(6)
    v_mfma_f32_16x16x32_bf16 v[116:119], v[56:59], v[100:103], v[116:119]
    v_rcp_f32 v219, v219
    v_mul_f32 v216, v164, v216
    v_mfma_f32_16x16x32_bf16 v[132:135], v[52:55], v[84:87], v[132:135]
    v_mfma_f32_16x16x32_bf16 v[132:135], v[60:63], v[100:103], v[132:135]
    ds_read_b128 v[84:87], v10 offset:28672
    ds_read_b128 v[100:103], v11 offset:29696
    v_mul_f32 v217, v165, v217
    v_mul_f32 v218, v166, v218
    v_mul_f32 v219, v167, v219
    v_cvt_pk_bf16_f32 v226, v216, v217
    v_cvt_pk_bf16_f32 v227, v218, v219
    s_waitcnt lgkmcnt(7)
    v_mfma_f32_16x16x32_bf16 v[120:123], v[48:51], v[88:91], v[120:123]
    s_waitcnt lgkmcnt(6)
    v_mfma_f32_16x16x32_bf16 v[120:123], v[56:59], v[104:107], v[120:123]
    ds_write_b128 v4, v[224:227] offset:18432
    v_mul_f32 v216, v152, v152
    v_mul_f32 v217, v153, v153
    v_mul_f32 v218, v154, v154
    v_mfma_f32_16x16x32_bf16 v[136:139], v[52:55], v[88:91], v[136:139]
    v_mfma_f32_16x16x32_bf16 v[136:139], v[60:63], v[104:107], v[136:139]
    ds_read_b128 v[88:91], v10 offset:47104
    ds_read_b128 v[104:107], v11 offset:48128
    v_mul_f32 v219, v155, v155
    v_fmaak_f32 v216, v216, v5, 0xc0135761
    v_fmaak_f32 v217, v217, v5, 0xc0135761
    v_fmaak_f32 v218, v218, v5, 0xc0135761
    s_waitcnt lgkmcnt(8)
    v_mfma_f32_16x16x32_bf16 v[124:127], v[48:51], v[92:95], v[124:127]
    s_waitcnt lgkmcnt(7)
    v_mfma_f32_16x16x32_bf16 v[124:127], v[56:59], v[108:111], v[124:127]
    v_fmaak_f32 v219, v219, v5, 0xc0135761
    v_mul_f32 v216, v152, v216
    v_mul_f32 v217, v153, v217
    v_mul_f32 v218, v154, v218
    v_mfma_f32_16x16x32_bf16 v[140:143], v[52:55], v[92:95], v[140:143]
    v_mfma_f32_16x16x32_bf16 v[140:143], v[60:63], v[108:111], v[140:143]
    ds_read_b128 v[92:95], v14 offset:0
    ds_read_b128 v[108:111], v15 offset:1024
    v_mul_f32 v219, v155, v219
    v_exp_f32 v216, v216
    v_exp_f32 v217, v217
    buffer_load_dwordx4 v[40:43], v1, s[12:15], s30 offen offset:3072 sc1
    buffer_load_dwordx4 v[44:47], v1, s[12:15], s31 offen offset:3072 sc1
    s_add_u32 s30, s26, 0xa44000
    buffer_load_dwordx4 v[48:51], v1, s[12:15], s30 offen offset:0 sc1
    s_add_u32 s31, s26, 0xa48800
    buffer_load_dwordx4 v[52:55], v1, s[12:15], s31 offen offset:0 sc1
    s_waitcnt vmcnt(13) lgkmcnt(8)
    v_mfma_f32_16x16x32_bf16 v[112:115], v[64:67], v[80:83], v[112:115]
    s_waitcnt vmcnt(11) lgkmcnt(7)
    v_mfma_f32_16x16x32_bf16 v[112:115], v[72:75], v[96:99], v[112:115]
    v_exp_f32 v218, v218
    v_exp_f32 v219, v219
    v_mfma_f32_16x16x32_bf16 v[128:131], v[68:71], v[80:83], v[128:131]
    s_waitcnt vmcnt(10)
    v_mfma_f32_16x16x32_bf16 v[128:131], v[76:79], v[96:99], v[128:131]
    ds_read_b128 v[80:83], v10 offset:12288
    ds_read_b128 v[96:99], v11 offset:13312
    v_add_f32 v216, 1.0, v216
    v_add_f32 v217, 1.0, v217
    v_add_f32 v218, 1.0, v218
    v_add_f32 v219, 1.0, v219
    s_waitcnt lgkmcnt(8)
    v_mfma_f32_16x16x32_bf16 v[116:119], v[64:67], v[84:87], v[116:119]
    s_waitcnt lgkmcnt(7)
    v_mfma_f32_16x16x32_bf16 v[116:119], v[72:75], v[100:103], v[116:119]
    v_rcp_f32 v216, v216
    v_rcp_f32 v217, v217
    v_mfma_f32_16x16x32_bf16 v[132:135], v[68:71], v[84:87], v[132:135]
    v_mfma_f32_16x16x32_bf16 v[132:135], v[76:79], v[100:103], v[132:135]
    ds_read_b128 v[84:87], v10 offset:30720
    ds_read_b128 v[100:103], v11 offset:31744
    v_rcp_f32 v218, v218
    v_rcp_f32 v219, v219
    v_mul_f32 v216, v152, v216
    s_waitcnt lgkmcnt(7)
    v_mfma_f32_16x16x32_bf16 v[120:123], v[64:67], v[88:91], v[120:123]
    s_waitcnt lgkmcnt(6)
    v_mfma_f32_16x16x32_bf16 v[120:123], v[72:75], v[104:107], v[120:123]
    v_mul_f32 v217, v153, v217
    v_mul_f32 v218, v154, v218
    v_mul_f32 v219, v155, v219
    v_cvt_pk_bf16_f32 v220, v216, v217
    v_mfma_f32_16x16x32_bf16 v[136:139], v[68:71], v[88:91], v[136:139]
    v_mfma_f32_16x16x32_bf16 v[136:139], v[76:79], v[104:107], v[136:139]
    ds_read_b128 v[88:91], v10 offset:49152
    ds_read_b128 v[104:107], v11 offset:50176
    v_cvt_pk_bf16_f32 v221, v218, v219
    v_mul_f32 v216, v168, v168
    v_mul_f32 v217, v169, v169
    v_mul_f32 v218, v170, v170
    s_waitcnt lgkmcnt(7)
    v_mfma_f32_16x16x32_bf16 v[124:127], v[64:67], v[92:95], v[124:127]
    s_waitcnt lgkmcnt(6)
    v_mfma_f32_16x16x32_bf16 v[124:127], v[72:75], v[108:111], v[124:127]
    v_mul_f32 v219, v171, v171
    v_fmaak_f32 v216, v216, v5, 0xc0135761
    v_fmaak_f32 v217, v217, v5, 0xc0135761
    v_fmaak_f32 v218, v218, v5, 0xc0135761
    v_mfma_f32_16x16x32_bf16 v[140:143], v[68:71], v[92:95], v[140:143]
    v_mfma_f32_16x16x32_bf16 v[140:143], v[76:79], v[108:111], v[140:143]
    ds_read_b128 v[92:95], v14 offset:2048
    ds_read_b128 v[108:111], v15 offset:3072
    v_fmaak_f32 v219, v219, v5, 0xc0135761
    v_mul_f32 v216, v168, v216
    v_mul_f32 v217, v169, v217
    v_mul_f32 v218, v170, v218
    v_mul_f32 v219, v171, v219
    buffer_load_dwordx4 v[56:59], v1, s[12:15], s30 offen offset:1024 sc1
    buffer_load_dwordx4 v[60:63], v1, s[12:15], s31 offen offset:1024 sc1
    s_cmp_lg_u32 s22, 0
    s_cbranch_scc1 fused_kernel_r0_n5
    s_lshl_b32 s33, s20, 8
    s_add_u32 s33, s33, 0xa20800
    v_lshrrev_b32 v244, 1, v1
    s_mov_b32 exec_lo, 0xffffffff
    s_mov_b32 exec_hi, 0x0
    s_mov_b32 s35, 100000
fused_kernel_r0_p5_l:
    s_sub_u32 s35, s35, 1
    s_cbranch_scc1 fused_kernel_r0_p5_ok
    buffer_load_dwordx2 v[246:247], v244, s[12:15], s33 offen sc1
    v_mov_b32 v13, s99
    s_waitcnt vmcnt(0)
    v_subrev_co_u32 v246, vcc, s98, v246
    s_nop 1
    v_subb_co_u32 v247, vcc, v247, v13, vcc
    v_lshrrev_b32 v246, 12, v246
    v_or_b32 v246, v246, v247
    v_cmp_ne_u32 vcc, 0, v246
    s_nop 1
    s_cmp_eq_u64 vcc, 0
    s_cbranch_scc1 fused_kernel_r0_p5_ok
    s_sleep 8
    s_branch fused_kernel_r0_p5_l
fused_kernel_r0_p5_ok:
    s_mov_b64 exec, -1
    v_mov_b32 v12, 149792
    v_mov_b32 v13, 1
    ds_write_b32 v12, v13
fused_kernel_r0_n5:
    v_mov_b32 v12, 149792
fused_kernel_r0_w5:
    ds_read_b32 v13, v12
    s_waitcnt lgkmcnt(0)
    v_readfirstlane_b32 s35, v13
    s_nop 3
    s_cmp_ge_u32 s35, 1
    s_cbranch_scc1 fused_kernel_r0_w5_d
    s_sleep 1
    s_branch fused_kernel_r0_w5
fused_kernel_r0_w5_d:
    s_add_u32 s33, s38, 0
    s_mov_b32 s34, 0
    s_add_u32 s33, s33, s42
    s_sub_u32 s35, s33, 18
    s_cselect_b32 s33, s33, s35
    s_lshl_b32 s33, s33, 1
    s_add_u32 s33, s33, s34
    s_mul_i32 s23, s33, 18432
    s_add_u32 s23, s23, s41
    s_lshl_b32 s33, s33, 10
    s_add_u32 s64, s33, s40
    s_add_u32 s30, s23, 0xf54000
    buffer_load_dwordx4 v[64:67], v1, s[12:15], s30 offen offset:0 sc1
    s_add_u32 s31, s23, 0xf58800
    buffer_load_dwordx4 v[68:71], v1, s[12:15], s31 offen offset:0 sc1
    s_waitcnt vmcnt(13)
    v_mfma_f32_16x16x32_bf16 v[112:115], v[16:19], v[80:83], v[112:115]
    s_waitcnt vmcnt(11)
    v_mfma_f32_16x16x32_bf16 v[112:115], v[24:27], v[96:99], v[112:115]
    v_exp_f32 v216, v216
    v_exp_f32 v217, v217
    v_mfma_f32_16x16x32_bf16 v[128:131], v[20:23], v[80:83], v[128:131]
    s_waitcnt vmcnt(10)
    v_mfma_f32_16x16x32_bf16 v[128:131], v[28:31], v[96:99], v[128:131]
    ds_read_b128 v[80:83], v10 offset:14336
    ds_read_b128 v[96:99], v11 offset:15360
    v_exp_f32 v218, v218
    v_exp_f32 v219, v219
    v_mfma_f32_16x16x32_bf16 v[116:119], v[16:19], v[84:87], v[116:119]
    v_mfma_f32_16x16x32_bf16 v[116:119], v[24:27], v[100:103], v[116:119]
    v_add_f32 v216, 1.0, v216
    v_add_f32 v217, 1.0, v217
    v_add_f32 v218, 1.0, v218
    v_add_f32 v219, 1.0, v219
    v_mfma_f32_16x16x32_bf16 v[132:135], v[20:23], v[84:87], v[132:135]
    v_mfma_f32_16x16x32_bf16 v[132:135], v[28:31], v[100:103], v[132:135]
    ds_read_b128 v[84:87], v10 offset:32768
    ds_read_b128 v[100:103], v11 offset:33792
    v_rcp_f32 v216, v216
    v_rcp_f32 v217, v217
    v_rcp_f32 v218, v218
    v_mfma_f32_16x16x32_bf16 v[120:123], v[16:19], v[88:91], v[120:123]
    v_mfma_f32_16x16x32_bf16 v[120:123], v[24:27], v[104:107], v[120:123]
    v_rcp_f32 v219, v219
    v_mul_f32 v216, v168, v216
    v_mfma_f32_16x16x32_bf16 v[136:139], v[20:23], v[88:91], v[136:139]
    v_mfma_f32_16x16x32_bf16 v[136:139], v[28:31], v[104:107], v[136:139]
    ds_read_b128 v[88:91], v10 offset:51200
    ds_read_b128 v[104:107], v11 offset:52224
    v_mul_f32 v217, v169, v217
    v_mul_f32 v218, v170, v218
    v_mul_f32 v219, v171, v219
    v_cvt_pk_bf16_f32 v222, v216, v217
    v_mfma_f32_16x16x32_bf16 v[124:127], v[16:19], v[92:95], v[124:127]
    v_mfma_f32_16x16x32_bf16 v[124:127], v[24:27], v[108:111], v[124:127]
    v_cvt_pk_bf16_f32 v223, v218, v219
    ds_write_b128 v4, v[220:223] offset:36864
    v_mul_f32 v216, v156, v156
    v_mul_f32 v217, v157, v157
    v_mfma_f32_16x16x32_bf16 v[140:143], v[20:23], v[92:95], v[140:143]
    v_mfma_f32_16x16x32_bf16 v[140:143], v[28:31], v[108:111], v[140:143]
    ds_read_b128 v[92:95], v14 offset:4096
    ds_read_b128 v[108:111], v15 offset:5120
    v_mul_f32 v218, v158, v158
    v_mul_f32 v219, v159, v159
    v_fmaak_f32 v216, v216, v5, 0xc0135761
    v_fmaak_f32 v217, v217, v5, 0xc0135761
    v_fmaak_f32 v218, v218, v5, 0xc0135761
    buffer_load_dwordx4 v[72:75], v1, s[12:15], s30 offen offset:1024 sc1
    buffer_load_dwordx4 v[76:79], v1, s[12:15], s31 offen offset:1024 sc1
    s_add_u32 s30, s23, 0xf50000
    buffer_load_dwordx4 v[16:19], v1, s[12:15], s30 offen offset:0 sc1
    s_add_u32 s31, s23, 0xf54800
    buffer_load_dwordx4 v[20:23], v1, s[12:15], s31 offen offset:0 sc1
    s_waitcnt vmcnt(13) lgkmcnt(8)
    v_mfma_f32_16x16x32_bf16 v[112:115], v[32:35], v[80:83], v[112:115]
    s_waitcnt vmcnt(11) lgkmcnt(7)
    v_mfma_f32_16x16x32_bf16 v[112:115], v[40:43], v[96:99], v[112:115]
    v_fmaak_f32 v219, v219, v5, 0xc0135761
    v_mul_f32 v216, v156, v216
    v_mul_f32 v217, v157, v217
    v_mul_f32 v218, v158, v218
    v_mfma_f32_16x16x32_bf16 v[128:131], v[36:39], v[80:83], v[128:131]
    s_waitcnt vmcnt(10)
    v_mfma_f32_16x16x32_bf16 v[128:131], v[44:47], v[96:99], v[128:131]
    ds_read_b128 v[80:83], v10 offset:16384
    ds_read_b128 v[96:99], v11 offset:17408
    v_mul_f32 v219, v159, v219
    v_exp_f32 v216, v216
    v_exp_f32 v217, v217
    s_waitcnt lgkmcnt(8)
    v_mfma_f32_16x16x32_bf16 v[116:119], v[32:35], v[84:87], v[116:119]
    s_waitcnt lgkmcnt(7)
    v_mfma_f32_16x16x32_bf16 v[116:119], v[40:43], v[100:103], v[116:119]
    v_exp_f32 v218, v218
    v_exp_f32 v219, v219
    v_mfma_f32_16x16x32_bf16 v[132:135], v[36:39], v[84:87], v[132:135]
    v_mfma_f32_16x16x32_bf16 v[132:135], v[44:47], v[100:103], v[132:135]
    ds_read_b128 v[84:87], v10 offset:34816
    ds_read_b128 v[100:103], v11 offset:35840
    v_add_f32 v216, 1.0, v216
    v_add_f32 v217, 1.0, v217
    v_add_f32 v218, 1.0, v218
    v_add_f32 v219, 1.0, v219
    s_waitcnt lgkmcnt(8)
    v_mfma_f32_16x16x32_bf16 v[120:123], v[32:35], v[88:91], v[120:123]
    s_waitcnt lgkmcnt(7)
    v_mfma_f32_16x16x32_bf16 v[120:123], v[40:43], v[104:107], v[120:123]
    v_rcp_f32 v216, v216
    v_rcp_f32 v217, v217
    v_mfma_f32_16x16x32_bf16 v[136:139], v[36:39], v[88:91], v[136:139]
    v_mfma_f32_16x16x32_bf16 v[136:139], v[44:47], v[104:107], v[136:139]
    ds_read_b128 v[88:91], v10 offset:53248
    ds_read_b128 v[104:107], v11 offset:54272
    v_rcp_f32 v218, v218
    v_rcp_f32 v219, v219
    s_waitcnt lgkmcnt(7)
    v_mfma_f32_16x16x32_bf16 v[124:127], v[32:35], v[92:95], v[124:127]
    s_waitcnt lgkmcnt(6)
    v_mfma_f32_16x16x32_bf16 v[124:127], v[40:43], v[108:111], v[124:127]
    v_mul_f32 v216, v156, v216
    v_mul_f32 v217, v157, v217
    v_mul_f32 v218, v158, v218
    v_mul_f32 v219, v159, v219
    v_mfma_f32_16x16x32_bf16 v[140:143], v[36:39], v[92:95], v[140:143]
    v_mfma_f32_16x16x32_bf16 v[140:143], v[44:47], v[108:111], v[140:143]
    ds_read_b128 v[92:95], v14 offset:6144
    ds_read_b128 v[108:111], v15 offset:7168
    v_cvt_pk_bf16_f32 v224, v216, v217
    v_cvt_pk_bf16_f32 v225, v218, v219
    v_mul_f32 v216, v172, v172
    v_mul_f32 v217, v173, v173
    v_mul_f32 v218, v174, v174
    buffer_load_dwordx4 v[24:27], v1, s[12:15], s30 offen offset:1024 sc1
    buffer_load_dwordx4 v[28:31], v1, s[12:15], s31 offen offset:1024 sc1
    buffer_load_dwordx4 v[32:35], v1, s[12:15], s30 offen offset:2048 sc1
    buffer_load_dwordx4 v[36:39], v1, s[12:15], s31 offen offset:2048 sc1
    v_mov_b32 v12, 149808
fused_kernel_r0_pg2:
    ds_read_b32 v13, v12
    s_waitcnt lgkmcnt(0)
    v_readfirstlane_b32 s35, v13
    s_nop 3
    s_cmp_ge_u32 s35, 4
    s_cbranch_scc1 fused_kernel_r0_pg2_d
    s_sleep 1
    s_branch fused_kernel_r0_pg2
fused_kernel_r0_pg2_d:
    s_waitcnt vmcnt(13)
    v_mfma_f32_16x16x32_bf16 v[112:115], v[48:51], v[80:83], v[112:115]
    s_waitcnt vmcnt(11)
    v_mfma_f32_16x16x32_bf16 v[112:115], v[56:59], v[96:99], v[112:115]
    v_mul_f32 v219, v175, v175
    v_fmaak_f32 v216, v216, v5, 0xc0135761
    v_fmaak_f32 v217, v217, v5, 0xc0135761
    v_fmaak_f32 v218, v218, v5, 0xc0135761
    v_mfma_f32_16x16x32_bf16 v[128:131], v[52:55], v[80:83], v[128:131]
    s_waitcnt vmcnt(10)
    v_mfma_f32_16x16x32_bf16 v[128:131], v[60:63], v[96:99], v[128:131]
    ds_read_b128 v[80:83], v2 offset:16384
    ds_read_b128 v[96:99], v2 offset:17408
    v_fmaak_f32 v219, v219, v5, 0xc0135761
    v_mul_f32 v216, v172, v216
    v_mul_f32 v217, v173, v217
    v_mul_f32 v218, v174, v218
    v_mfma_f32_16x16x32_bf16 v[116:119], v[48:51], v[84:87], v[116:119]
    v_mfma_f32_16x16x32_bf16 v[116:119], v[56:59], v[100:103], v[116:119]
    v_mul_f32 v219, v175, v219
    v_exp_f32 v216, v216
    v_exp_f32 v217, v217
    v_mfma_f32_16x16x32_bf16 v[132:135], v[52:55], v[84:87], v[132:135]
    v_mfma_f32_16x16x32_bf16 v[132:135], v[60:63], v[100:103], v[132:135]
    ds_read_b128 v[84:87], v2 offset:34816
    ds_read_b128 v[100:103], v2 offset:35840
    v_exp_f32 v218, v218
    v_exp_f32 v219, v219
    v_mfma_f32_16x16x32_bf16 v[120:123], v[48:51], v[88:91], v[120:123]
    v_mfma_f32_16x16x32_bf16 v[120:123], v[56:59], v[104:107], v[120:123]
    v_add_f32 v216, 1.0, v216
    v_add_f32 v217, 1.0, v217
    v_add_f32 v218, 1.0, v218
    v_add_f32 v219, 1.0, v219
    v_mfma_f32_16x16x32_bf16 v[136:139], v[52:55], v[88:91], v[136:139]
    v_mfma_f32_16x16x32_bf16 v[136:139], v[60:63], v[104:107], v[136:139]
    ds_read_b128 v[88:91], v2 offset:53248
    ds_read_b128 v[104:107], v2 offset:54272
    v_rcp_f32 v216, v216
    v_rcp_f32 v217, v217
    v_mfma_f32_16x16x32_bf16 v[124:127], v[48:51], v[92:95], v[124:127]
    v_mfma_f32_16x16x32_bf16 v[124:127], v[56:59], v[108:111], v[124:127]
    v_rcp_f32 v218, v218
    v_rcp_f32 v219, v219
    v_mfma_f32_16x16x32_bf16 v[140:143], v[52:55], v[92:95], v[140:143]
    v_mfma_f32_16x16x32_bf16 v[140:143], v[60:63], v[108:111], v[140:143]
    ds_read_b128 v[92:95], v8 offset:6144
    ds_read_b128 v[108:111], v8 offset:7168
    v_mul_f32 v216, v172, v216
    v_mul_f32 v217, v173, v217
    v_mul_f32 v218, v174, v218
    v_mul_f32 v219, v175, v219
    v_cvt_pk_bf16_f32 v226, v216, v217
    buffer_load_dwordx4 v[40:43], v1, s[12:15], s30 offen offset:3072 sc1
    buffer_load_dwordx4 v[44:47], v1, s[12:15], s31 offen offset:3072 sc1
    s_add_u32 s30, s23, 0xf51000
    buffer_load_dwordx4 v[48:51], v1, s[12:15], s30 offen offset:0 sc1
    s_add_u32 s31, s23, 0xf55800
    buffer_load_dwordx4 v[52:55], v1, s[12:15], s31 offen offset:0 sc1
    v_cvt_pk_bf16_f32 v227, v218, v219
    ds_write_b128 v4, v[224:227] offset:55296
    s_nop 0
    s_nop 0
    s_nop 0
    s_waitcnt lgkmcnt(0)
    v_mov_b32 v12, 149800
    v_mov_b32 v13, 1
    s_mov_b64 exec, 1
    ds_add_u32 v12, v13
    s_mov_b64 exec, -1
    v_mov_b32 v12, 149800
fused_kernel_r0_pg0:
    ds_read_b32 v13, v12
    s_waitcnt lgkmcnt(0)
    v_readfirstlane_b32 s35, v13
    s_nop 3
    s_cmp_ge_u32 s35, 4
    s_cbranch_scc1 fused_kernel_r0_pg0_d
    s_sleep 1
    s_branch fused_kernel_r0_pg0
fused_kernel_r0_pg0_d:
    s_waitcnt vmcnt(13)
    v_mfma_f32_16x16x32_bf16 v[176:179], v[64:67], v[80:83], 0
    s_waitcnt vmcnt(11)
    v_mfma_f32_16x16x32_bf16 v[176:179], v[72:75], v[96:99], v[176:179]
    v_mul_f32 v216, v112, v112
    v_mul_f32 v217, v113, v113
    v_mul_f32 v218, v114, v114
    v_mul_f32 v219, v115, v115
    v_mfma_f32_16x16x32_bf16 v[192:195], v[68:71], v[80:83], 0
    s_waitcnt vmcnt(10)
    v_mfma_f32_16x16x32_bf16 v[192:195], v[76:79], v[96:99], v[192:195]
    ds_read_b128 v[80:83], v2 offset:0
    ds_read_b128 v[96:99], v2 offset:1024
    v_fmaak_f32 v216, v216, v5, 0xc0135761
    v_fmaak_f32 v217, v217, v5, 0xc0135761
    v_fmaak_f32 v218, v218, v5, 0xc0135761
    v_fmaak_f32 v219, v219, v5, 0xc0135761
    v_mfma_f32_16x16x32_bf16 v[180:183], v[64:67], v[84:87], 0
    v_mfma_f32_16x16x32_bf16 v[180:183], v[72:75], v[100:103], v[180:183]
    v_mul_f32 v216, v112, v216
    v_mul_f32 v217, v113, v217
    v_mul_f32 v218, v114, v218
    v_mul_f32 v219, v115, v219
    v_mfma_f32_16x16x32_bf16 v[196:199], v[68:71], v[84:87], 0
    v_mfma_f32_16x16x32_bf16 v[196:199], v[76:79], v[100:103], v[196:199]
    ds_read_b128 v[84:87], v2 offset:18432
    ds_read_b128 v[100:103], v2 offset:19456
    v_exp_f32 v216, v216
    v_exp_f32 v217, v217
    v_exp_f32 v218, v218
    v_mfma_f32_16x16x32_bf16 v[184:187], v[64:67], v[88:91], 0
    v_mfma_f32_16x16x32_bf16 v[184:187], v[72:75], v[104:107], v[184:187]
    v_exp_f32 v219, v219
    v_add_f32 v216, 1.0, v216
    v_mfma_f32_16x16x32_bf16 v[200:203], v[68:71], v[88:91], 0
    v_mfma_f32_16x16x32_bf16 v[200:203], v[76:79], v[104:107], v[200:203]
    ds_read_b128 v[88:91], v2 offset:36864
    ds_read_b128 v[104:107], v2 offset:37888
    v_add_f32 v217, 1.0, v217
    v_add_f32 v218, 1.0, v218
    v_add_f32 v219, 1.0, v219
    v_rcp_f32 v216, v216
    v_mfma_f32_16x16x32_bf16 v[188:191], v[64:67], v[92:95], 0
    v_mfma_f32_16x16x32_bf16 v[188:191], v[72:75], v[108:111], v[188:191]
    v_rcp_f32 v217, v217
    v_rcp_f32 v218, v218
    v_mfma_f32_16x16x32_bf16 v[204:207], v[68:71], v[92:95], 0
    v_mfma_f32_16x16x32_bf16 v[204:207], v[76:79], v[108:111], v[204:207]
    ds_read_b128 v[92:95], v2 offset:55296
    ds_read_b128 v[108:111], v2 offset:56320
    v_rcp_f32 v219, v219
    v_mul_f32 v216, v112, v216
    v_mul_f32 v217, v113, v217
    buffer_load_dwordx4 v[56:59], v1, s[12:15], s30 offen offset:1024 sc1
    buffer_load_dwordx4 v[60:63], v1, s[12:15], s31 offen offset:1024 sc1
    buffer_load_dwordx4 v[64:67], v1, s[12:15], s30 offen offset:2048 sc1
    buffer_load_dwordx4 v[68:71], v1, s[12:15], s31 offen offset:2048 sc1
    s_waitcnt vmcnt(13) lgkmcnt(7)
    v_mfma_f32_16x16x32_bf16 v[176:179], v[16:19], v[80:83], v[176:179]
    s_waitcnt vmcnt(11) lgkmcnt(6)
    v_mfma_f32_16x16x32_bf16 v[176:179], v[24:27], v[96:99], v[176:179]
    v_mul_f32 v218, v114, v218
    v_mul_f32 v219, v115, v219
    v_cvt_pk_bf16_f32 v220, v216, v217
    v_cvt_pk_bf16_f32 v221, v218, v219
    v_mfma_f32_16x16x32_bf16 v[192:195], v[20:23], v[80:83], v[192:195]
    s_waitcnt vmcnt(10)
    v_mfma_f32_16x16x32_bf16 v[192:195], v[28:31], v[96:99], v[192:195]
    ds_read_b128 v[80:83], v2 offset:2048
    ds_read_b128 v[96:99], v2 offset:3072
    v_mul_f32 v216, v128, v128
    v_mul_f32 v217, v129, v129
    v_mul_f32 v218, v130, v130
    v_mul_f32 v219, v131, v131
    s_waitcnt lgkmcnt(7)
    v_mfma_f32_16x16x32_bf16 v[180:183], v[16:19], v[84:87], v[180:183]
    s_waitcnt lgkmcnt(6)
    v_mfma_f32_16x16x32_bf16 v[180:183], v[24:27], v[100:103], v[180:183]
    v_fmaak_f32 v216, v216, v5, 0xc0135761
    v_fmaak_f32 v217, v217, v5, 0xc0135761
    v_fmaak_f32 v218, v218, v5, 0xc0135761
    v_fmaak_f32 v219, v219, v5, 0xc0135761
    v_mfma_f32_16x16x32_bf16 v[196:199], v[20:23], v[84:87], v[196:199]
    v_mfma_f32_16x16x32_bf16 v[196:199], v[28:31], v[100:103], v[196:199]
    ds_read_b128 v[84:87], v2 offset:20480
    ds_read_b128 v[100:103], v2 offset:21504
    v_mul_f32 v216, v128, v216
    v_mul_f32 v217, v129, v217
    v_mul_f32 v218, v130, v218
    v_mul_f32 v219, v131, v219
    v_exp_f32 v216, v216
    s_waitcnt lgkmcnt(7)
    v_mfma_f32_16x16x32_bf16 v[184:187], v[16:19], v[88:91], v[184:187]
    s_waitcnt lgkmcnt(6)
    v_mfma_f32_16x16x32_bf16 v[184:187], v[24:27], v[104:107], v[184:187]
    v_exp_f32 v217, v217
    v_exp_f32 v218, v218
    v_mfma_f32_16x16x32_bf16 v[200:203], v[20:23], v[88:91], v[200:203]
    v_mfma_f32_16x16x32_bf16 v[200:203], v[28:31], v[104:107], v[200:203]
    ds_read_b128 v[88:91], v2 offset:38912
    ds_read_b128 v[104:107], v2 offset:39936
    v_exp_f32 v219, v219
    v_add_f32 v216, 1.0, v216
    s_waitcnt lgkmcnt(7)
    v_mfma_f32_16x16x32_bf16 v[188:191], v[16:19], v[92:95], v[188:191]
    s_waitcnt lgkmcnt(6)
    v_mfma_f32_16x16x32_bf16 v[188:191], v[24:27], v[108:111], v[188:191]
    v_add_f32 v217, 1.0, v217
    v_add_f32 v218, 1.0, v218
    v_add_f32 v219, 1.0, v219
    v_rcp_f32 v216, v216
    v_mfma_f32_16x16x32_bf16 v[204:207], v[20:23], v[92:95], v[204:207]
    v_mfma_f32_16x16x32_bf16 v[204:207], v[28:31], v[108:111], v[204:207]
    ds_read_b128 v[92:95], v2 offset:57344
    ds_read_b128 v[108:111], v2 offset:58368
    v_rcp_f32 v217, v217
    v_rcp_f32 v218, v218
    buffer_load_dwordx4 v[72:75], v1, s[12:15], s30 offen offset:3072 sc1
    buffer_load_dwordx4 v[76:79], v1, s[12:15], s31 offen offset:3072 sc1
    s_add_u32 s33, s38, 4
    s_mov_b32 s34, 0
    s_add_u32 s33, s33, s42
    s_sub_u32 s35, s33, 18
    s_cselect_b32 s33, s33, s35
    s_lshl_b32 s33, s33, 1
    s_add_u32 s33, s33, s34
    s_mul_i32 s23, s33, 18432
    s_add_u32 s23, s23, s41
    s_lshl_b32 s33, s33, 10
    s_add_u32 s65, s33, s40
    s_add_u32 s30, s23, 0xf54000
    buffer_load_dwordx4 v[16:19], v1, s[12:15], s30 offen offset:0 sc1
    s_add_u32 s31, s23, 0xf58800
    buffer_load_dwordx4 v[20:23], v1, s[12:15], s31 offen offset:0 sc1
    v_mov_b32 v12, 149812
fused_kernel_r0_pg3:
    ds_read_b32 v13, v12
    s_waitcnt lgkmcnt(0)
    v_readfirstlane_b32 s35, v13
    s_nop 3
    s_cmp_ge_u32 s35, 4
    s_cbranch_scc1 fused_kernel_r0_pg3_d
    s_sleep 1
    s_branch fused_kernel_r0_pg3
fused_kernel_r0_pg3_d:
    s_waitcnt vmcnt(13)
    v_mfma_f32_16x16x32_bf16 v[176:179], v[32:35], v[80:83], v[176:179]
    s_waitcnt vmcnt(11)
    v_mfma_f32_16x16x32_bf16 v[176:179], v[40:43], v[96:99], v[176:179]
    v_rcp_f32 v219, v219
    v_mul_f32 v216, v128, v216
    v_mul_f32 v217, v129, v217
    v_mfma_f32_16x16x32_bf16 v[192:195], v[36:39], v[80:83], v[192:195]
    s_waitcnt vmcnt(10)
    v_mfma_f32_16x16x32_bf16 v[192:195], v[44:47], v[96:99], v[192:195]
    ds_read_b128 v[80:83], v2 offset:4096
    ds_read_b128 v[96:99], v2 offset:5120
    v_mul_f32 v218, v130, v218
    v_mul_f32 v219, v131, v219
    v_cvt_pk_bf16_f32 v222, v216, v217
    v_cvt_pk_bf16_f32 v223, v218, v219
    v_mfma_f32_16x16x32_bf16 v[180:183], v[32:35], v[84:87], v[180:183]
    v_mfma_f32_16x16x32_bf16 v[180:183], v[40:43], v[100:103], v[180:183]
    ds_write_b128 v4, v[220:223] offset:8192
    v_mul_f32 v216, v116, v116
    v_mul_f32 v217, v117, v117
    v_mul_f32 v218, v118, v118
    v_mfma_f32_16x16x32_bf16 v[196:199], v[36:39], v[84:87], v[196:199]
    v_mfma_f32_16x16x32_bf16 v[196:199], v[44:47], v[100:103], v[196:199]
    ds_read_b128 v[84:87], v2 offset:22528
    ds_read_b128 v[100:103], v2 offset:23552
    v_mul_f32 v219, v119, v119
    v_fmaak_f32 v216, v216, v5, 0xc0135761
    v_fmaak_f32 v217, v217, v5, 0xc0135761
    v_fmaak_f32 v218, v218, v5, 0xc0135761
    v_fmaak_f32 v219, v219, v5, 0xc0135761
    v_mfma_f32_16x16x32_bf16 v[184:187], v[32:35], v[88:91], v[184:187]
    v_mfma_f32_16x16x32_bf16 v[184:187], v[40:43], v[104:107], v[184:187]
    v_mul_f32 v216, v116, v216
    v_mul_f32 v217, v117, v217
    v_mul_f32 v218, v118, v218
    v_mul_f32 v219, v119, v219
    v_mfma_f32_16x16x32_bf16 v[200:203], v[36:39], v[88:91], v[200:203]
    v_mfma_f32_16x16x32_bf16 v[200:203], v[44:47], v[104:107], v[200:203]
    ds_read_b128 v[88:91], v2 offset:40960
    ds_read_b128 v[104:107], v2 offset:41984
    v_exp_f32 v216, v216
    v_exp_f32 v217, v217
    v_mfma_f32_16x16x32_bf16 v[188:191], v[32:35], v[92:95], v[188:191]
    v_mfma_f32_16x16x32_bf16 v[188:191], v[40:43], v[108:111], v[188:191]
    v_exp_f32 v218, v218
    v_exp_f32 v219, v219
    v_mfma_f32_16x16x32_bf16 v[204:207], v[36:39], v[92:95], v[204:207]
    v_mfma_f32_16x16x32_bf16 v[204:207], v[44:47], v[108:111], v[204:207]
    ds_read_b128 v[92:95], v2 offset:59392
    ds_read_b128 v[108:111], v2 offset:60416
    v_add_f32 v216, 1.0, v216
    v_add_f32 v217, 1.0, v217
    v_add_f32 v218, 1.0, v218
    v_add_f32 v219, 1.0, v219
    v_rcp_f32 v216, v216
    buffer_load_dwordx4 v[24:27], v1, s[12:15], s30 offen offset:1024 sc1
    buffer_load_dwordx4 v[28:31], v1, s[12:15], s31 offen offset:1024 sc1
    s_add_u32 s30, s23, 0xf50000
    buffer_load_dwordx4 v[32:35], v1, s[12:15], s30 offen offset:0 sc1
    s_add_u32 s31, s23, 0xf54800
    buffer_load_dwordx4 v[36:39], v1, s[12:15], s31 offen offset:0 sc1
    s_waitcnt vmcnt(13) lgkmcnt(8)
    v_mfma_f32_16x16x32_bf16 v[176:179], v[48:51], v[80:83], v[176:179]
    s_waitcnt vmcnt(11) lgkmcnt(7)
    v_mfma_f32_16x16x32_bf16 v[176:179], v[56:59], v[96:99], v[176:179]
    v_rcp_f32 v217, v217
    v_rcp_f32 v218, v218
    v_mfma_f32_16x16x32_bf16 v[192:195], v[52:55], v[80:83], v[192:195]
    s_waitcnt vmcnt(10)
    v_mfma_f32_16x16x32_bf16 v[192:195], v[60:63], v[96:99], v[192:195]
    ds_read_b128 v[80:83], v2 offset:6144
    ds_read_b128 v[96:99], v2 offset:7168
    v_rcp_f32 v219, v219
    v_mul_f32 v216, v116, v216
    s_waitcnt lgkmcnt(7)
    v_mfma_f32_16x16x32_bf16 v[180:183], v[48:51], v[84:87], v[180:183]
    s_waitcnt lgkmcnt(6)
    v_mfma_f32_16x16x32_bf16 v[180:183], v[56:59], v[100:103], v[180:183]
    v_mul_f32 v217, v117, v217
    v_mul_f32 v218, v118, v218
    v_mul_f32 v219, v119, v219
    v_cvt_pk_bf16_f32 v224, v216, v217
    v_mfma_f32_16x16x32_bf16 v[196:199], v[52:55], v[84:87], v[196:199]
    v_mfma_f32_16x16x32_bf16 v[196:199], v[60:63], v[100:103], v[196:199]
    ds_read_b128 v[84:87], v2 offset:24576
    ds_read_b128 v[100:103], v2 offset:25600
    v_cvt_pk_bf16_f32 v225, v218, v219
    v_mul_f32 v216, v132, v132
    v_mul_f32 v217, v133, v133
    v_mul_f32 v218, v134, v134
    v_mul_f32 v219, v135, v135
    s_waitcnt lgkmcnt(7)
    v_mfma_f32_16x16x32_bf16 v[184:187], v[48:51], v[88:91], v[184:187]
    s_waitcnt lgkmcnt(6)
    v_mfma_f32_16x16x32_bf16 v[184:187], v[56:59], v[104:107], v[184:187]
    v_fmaak_f32 v216, v216, v5, 0xc0135761
    v_fmaak_f32 v217, v217, v5, 0xc0135761
    v_fmaak_f32 v218, v218, v5, 0xc0135761
    v_fmaak_f32 v219, v219, v5, 0xc0135761
    v_mfma_f32_16x16x32_bf16 v[200:203], v[52:55], v[88:91], v[200:203]
    v_mfma_f32_16x16x32_bf16 v[200:203], v[60:63], v[104:107], v[200:203]
    ds_read_b128 v[88:91], v2 offset:43008
    ds_read_b128 v[104:107], v2 offset:44032
    v_mul_f32 v216, v132, v216
    v_mul_f32 v217, v133, v217
    v_mul_f32 v218, v134, v218
    v_mul_f32 v219, v135, v219
    s_waitcnt lgkmcnt(7)
    v_mfma_f32_16x16x32_bf16 v[188:191], v[48:51], v[92:95], v[188:191]
    s_waitcnt lgkmcnt(6)
    v_mfma_f32_16x16x32_bf16 v[188:191], v[56:59], v[108:111], v[188:191]
    v_exp_f32 v216, v216
    v_exp_f32 v217, v217
    v_mfma_f32_16x16x32_bf16 v[204:207], v[52:55], v[92:95], v[204:207]
    v_mfma_f32_16x16x32_bf16 v[204:207], v[60:63], v[108:111], v[204:207]
    ds_read_b128 v[92:95], v2 offset:61440
    ds_read_b128 v[108:111], v2 offset:62464
    v_exp_f32 v218, v218
    v_exp_f32 v219, v219
    v_add_f32 v216, 1.0, v216
    buffer_load_dwordx4 v[40:43], v1, s[12:15], s30 offen offset:1024 sc1
    buffer_load_dwordx4 v[44:47], v1, s[12:15], s31 offen offset:1024 sc1
    buffer_load_dwordx4 v[48:51], v1, s[12:15], s30 offen offset:2048 sc1
    buffer_load_dwordx4 v[52:55], v1, s[12:15], s31 offen offset:2048 sc1
    s_waitcnt vmcnt(13) lgkmcnt(7)
    v_mfma_f32_16x16x32_bf16 v[176:179], v[64:67], v[80:83], v[176:179]
    s_waitcnt vmcnt(11) lgkmcnt(6)
    v_mfma_f32_16x16x32_bf16 v[176:179], v[72:75], v[96:99], v[176:179]
    v_add_f32 v217, 1.0, v217
    v_add_f32 v218, 1.0, v218
    v_add_f32 v219, 1.0, v219
    v_rcp_f32 v216, v216
    v_mfma_f32_16x16x32_bf16 v[192:195], v[68:71], v[80:83], v[192:195]
    s_waitcnt vmcnt(10)
    v_mfma_f32_16x16x32_bf16 v[192:195], v[76:79], v[96:99], v[192:195]
    ds_read_b128 v[80:83], v2 offset:16384
    ds_read_b128 v[96:99], v2 offset:17408
    v_rcp_f32 v217, v217
    v_rcp_f32 v218, v218
    s_waitcnt lgkmcnt(7)
    v_mfma_f32_16x16x32_bf16 v[180:183], v[64:67], v[84:87], v[180:183]
    s_waitcnt lgkmcnt(6)
    v_mfma_f32_16x16x32_bf16 v[180:183], v[72:75], v[100:103], v[180:183]
    v_rcp_f32 v219, v219
    v_mul_f32 v216, v132, v216
    v_mfma_f32_16x16x32_bf16 v[196:199], v[68:71], v[84:87], v[196:199]
    v_mfma_f32_16x16x32_bf16 v[196:199], v[76:79], v[100:103], v[196:199]
    ds_read_b128 v[84:87], v2 offset:34816
    ds_read_b128 v[100:103], v2 offset:35840
    v_mul_f32 v217, v133, v217
    v_mul_f32 v218, v134, v218
    v_mul_f32 v219, v135, v219
    v_cvt_pk_bf16_f32 v226, v216, v217
    v_cvt_pk_bf16_f32 v227, v218, v219
    s_waitcnt lgkmcnt(7)
    v_mfma_f32_16x16x32_bf16 v[184:187], v[64:67], v[88:91], v[184:187]
    s_waitcnt lgkmcnt(6)
    v_mfma_f32_16x16x32_bf16 v[184:187], v[72:75], v[104:107], v[184:187]
    ds_write_b128 v4, v[224:227] offset:26624
    v_mul_f32 v216, v120, v120
    v_mul_f32 v217, v121, v121
    v_mul_f32 v218, v122, v122
    v_mfma_f32_16x16x32_bf16 v[200:203], v[68:71], v[88:91], v[200:203]
    v_mfma_f32_16x16x32_bf16 v[200:203], v[76:79], v[104:107], v[200:203]
    ds_read_b128 v[88:91], v2 offset:53248
    ds_read_b128 v[104:107], v2 offset:54272
    v_mul_f32 v219, v123, v123
    v_fmaak_f32 v216, v216, v5, 0xc0135761
    v_fmaak_f32 v217, v217, v5, 0xc0135761
    v_fmaak_f32 v218, v218, v5, 0xc0135761
    s_waitcnt lgkmcnt(8)
    v_mfma_f32_16x16x32_bf16 v[188:191], v[64:67], v[92:95], v[188:191]
    s_waitcnt lgkmcnt(7)
    v_mfma_f32_16x16x32_bf16 v[188:191], v[72:75], v[108:111], v[188:191]
    v_fmaak_f32 v219, v219, v5, 0xc0135761
    v_mul_f32 v216, v120, v216
    v_mul_f32 v217, v121, v217
    v_mul_f32 v218, v122, v218
    v_mfma_f32_16x16x32_bf16 v[204:207], v[68:71], v[92:95], v[204:207]
    v_mfma_f32_16x16x32_bf16 v[204:207], v[76:79], v[108:111], v[204:207]
    ds_read_b128 v[92:95], v8 offset:6144
    ds_read_b128 v[108:111], v8 offset:7168
    v_mul_f32 v219, v123, v219
    v_exp_f32 v216, v216
    v_exp_f32 v217, v217
    buffer_load_dwordx4 v[56:59], v1, s[12:15], s30 offen offset:3072 sc1
    buffer_load_dwordx4 v[60:63], v1, s[12:15], s31 offen offset:3072 sc1
    s_add_u32 s30, s23, 0xf51000
    buffer_load_dwordx4 v[64:67], v1, s[12:15], s30 offen offset:0 sc1
    s_add_u32 s31, s23, 0xf55800
    buffer_load_dwordx4 v[68:71], v1, s[12:15], s31 offen offset:0 sc1
    s_waitcnt vmcnt(13) lgkmcnt(8)
    v_mfma_f32_16x16x32_bf16 v[144:147], v[16:19], v[80:83], 0
    s_waitcnt vmcnt(11) lgkmcnt(7)
    v_mfma_f32_16x16x32_bf16 v[144:147], v[24:27], v[96:99], v[144:147]
    v_exp_f32 v218, v218
    v_exp_f32 v219, v219
    v_mfma_f32_16x16x32_bf16 v[160:163], v[20:23], v[80:83], 0
    s_waitcnt vmcnt(10)
    v_mfma_f32_16x16x32_bf16 v[160:163], v[28:31], v[96:99], v[160:163]
    ds_read_b128 v[80:83], v2 offset:0
    ds_read_b128 v[96:99], v2 offset:1024
    v_add_f32 v216, 1.0, v216
    v_add_f32 v217, 1.0, v217
    v_add_f32 v218, 1.0, v218
    v_add_f32 v219, 1.0, v219
    s_waitcnt lgkmcnt(8)
    v_mfma_f32_16x16x32_bf16 v[148:151], v[16:19], v[84:87], 0
    s_waitcnt lgkmcnt(7)
    v_mfma_f32_16x16x32_bf16 v[148:151], v[24:27], v[100:103], v[148:151]
    v_rcp_f32 v216, v216
    v_rcp_f32 v217, v217
    v_mfma_f32_16x16x32_bf16 v[164:167], v[20:23], v[84:87], 0
    v_mfma_f32_16x16x32_bf16 v[164:167], v[28:31], v[100:103], v[164:167]
    ds_read_b128 v[84:87], v2 offset:18432
    ds_read_b128 v[100:103], v2 offset:19456
    v_rcp_f32 v218, v218
    v_rcp_f32 v219, v219
    v_mul_f32 v216, v120, v216
    s_waitcnt lgkmcnt(7)
    v_mfma_f32_16x16x32_bf16 v[152:155], v[16:19], v[88:91], 0
    s_waitcnt lgkmcnt(6)
    v_mfma_f32_16x16x32_bf16 v[152:155], v[24:27], v[104:107], v[152:155]
    v_mul_f32 v217, v121, v217
    v_mul_f32 v218, v122, v218
    v_mul_f32 v219, v123, v219
    v_cvt_pk_bf16_f32 v220, v216, v217
    v_mfma_f32_16x16x32_bf16 v[168:171], v[20:23], v[88:91], 0
    v_mfma_f32_16x16x32_bf16 v[168:171], v[28:31], v[104:107], v[168:171]
    ds_read_b128 v[88:91], v2 offset:36864
    ds_read_b128 v[104:107], v2 offset:37888
    v_cvt_pk_bf16_f32 v221, v218, v219
    v_mul_f32 v216, v136, v136
    v_mul_f32 v217, v137, v137
    v_mul_f32 v218, v138, v138
    s_waitcnt lgkmcnt(7)
    v_mfma_f32_16x16x32_bf16 v[156:159], v[16:19], v[92:95], 0
    s_waitcnt lgkmcnt(6)
    v_mfma_f32_16x16x32_bf16 v[156:159], v[24:27], v[108:111], v[156:159]
    v_mul_f32 v219, v139, v139
    v_fmaak_f32 v216, v216, v5, 0xc0135761
    v_fmaak_f32 v217, v217, v5, 0xc0135761
    v_fmaak_f32 v218, v218, v5, 0xc0135761
    v_mfma_f32_16x16x32_bf16 v[172:175], v[20:23], v[92:95], 0
    v_mfma_f32_16x16x32_bf16 v[172:175], v[28:31], v[108:111], v[172:175]
    ds_read_b128 v[92:95], v2 offset:55296
    ds_read_b128 v[108:111], v2 offset:56320
    v_fmaak_f32 v219, v219, v5, 0xc0135761
    v_mul_f32 v216, v136, v216
    v_mul_f32 v217, v137, v217
    v_mul_f32 v218, v138, v218
    v_mul_f32 v219, v139, v219
    buffer_load_dwordx4 v[72:75], v1, s[12:15], s30 offen offset:1024 sc1
    buffer_load_dwordx4 v[76:79], v1, s[12:15], s31 offen offset:1024 sc1
    buffer_load_dwordx4 v[16:19], v1, s[12:15], s30 offen offset:2048 sc1
    buffer_load_dwordx4 v[20:23], v1, s[12:15], s31 offen offset:2048 sc1
    s_waitcnt vmcnt(13) lgkmcnt(7)
    v_mfma_f32_16x16x32_bf16 v[144:147], v[32:35], v[80:83], v[144:147]
    s_waitcnt vmcnt(11) lgkmcnt(6)
    v_mfma_f32_16x16x32_bf16 v[144:147], v[40:43], v[96:99], v[144:147]
    v_exp_f32 v216, v216
    v_exp_f32 v217, v217
    v_mfma_f32_16x16x32_bf16 v[160:163], v[36:39], v[80:83], v[160:163]
    s_waitcnt vmcnt(10)
    v_mfma_f32_16x16x32_bf16 v[160:163], v[44:47], v[96:99], v[160:163]
    ds_read_b128 v[80:83], v2 offset:2048
    ds_read_b128 v[96:99], v2 offset:3072
    v_exp_f32 v218, v218
    v_exp_f32 v219, v219
    s_waitcnt lgkmcnt(7)
    v_mfma_f32_16x16x32_bf16 v[148:151], v[32:35], v[84:87], v[148:151]
    s_waitcnt lgkmcnt(6)
    v_mfma_f32_16x16x32_bf16 v[148:151], v[40:43], v[100:103], v[148:151]
    v_add_f32 v216, 1.0, v216
    v_add_f32 v217, 1.0, v217
    v_add_f32 v218, 1.0, v218
    v_add_f32 v219, 1.0, v219
    v_mfma_f32_16x16x32_bf16 v[164:167], v[36:39], v[84:87], v[164:167]
    v_mfma_f32_16x16x32_bf16 v[164:167], v[44:47], v[100:103], v[164:167]
    ds_read_b128 v[84:87], v2 offset:20480
    ds_read_b128 v[100:103], v2 offset:21504
    v_rcp_f32 v216, v216
    v_rcp_f32 v217, v217
    v_rcp_f32 v218, v218
    s_waitcnt lgkmcnt(7)
    v_mfma_f32_16x16x32_bf16 v[152:155], v[32:35], v[88:91], v[152:155]
    s_waitcnt lgkmcnt(6)
    v_mfma_f32_16x16x32_bf16 v[152:155], v[40:43], v[104:107], v[152:155]
    v_rcp_f32 v219, v219
    v_mul_f32 v216, v136, v216
    v_mfma_f32_16x16x32_bf16 v[168:171], v[36:39], v[88:91], v[168:171]
    v_mfma_f32_16x16x32_bf16 v[168:171], v[44:47], v[104:107], v[168:171]
    ds_read_b128 v[88:91], v2 offset:38912
    ds_read_b128 v[104:107], v2 offset:39936
    v_mul_f32 v217, v137, v217
    v_mul_f32 v218, v138, v218
    v_mul_f32 v219, v139, v219
    v_cvt_pk_bf16_f32 v222, v216, v217
    s_waitcnt lgkmcnt(7)
    v_mfma_f32_16x16x32_bf16 v[156:159], v[32:35], v[92:95], v[156:159]
    s_waitcnt lgkmcnt(6)
    v_mfma_f32_16x16x32_bf16 v[156:159], v[40:43], v[108:111], v[156:159]
    v_cvt_pk_bf16_f32 v223, v218, v219
    ds_write_b128 v4, v[220:223] offset:45056
    v_mul_f32 v216, v124, v124
    v_mul_f32 v217, v125, v125
    v_mfma_f32_16x16x32_bf16 v[172:175], v[36:39], v[92:95], v[172:175]
    v_mfma_f32_16x16x32_bf16 v[172:175], v[44:47], v[108:111], v[172:175]
    ds_read_b128 v[92:95], v2 offset:57344
    ds_read_b128 v[108:111], v2 offset:58368
    v_mul_f32 v218, v126, v126
    v_mul_f32 v219, v127, v127
    v_fmaak_f32 v216, v216, v5, 0xc0135761
    v_fmaak_f32 v217, v217, v5, 0xc0135761
    v_fmaak_f32 v218, v218, v5, 0xc0135761
    buffer_load_dwordx4 v[24:27], v1, s[12:15], s30 offen offset:3072 sc1
    buffer_load_dwordx4 v[28:31], v1, s[12:15], s31 offen offset:3072 sc1
    s_add_u32 s33, s38, 0
    s_mov_b32 s34, 0
    s_add_u32 s33, s33, s42
    s_sub_u32 s35, s33, 18
    s_cselect_b32 s33, s33, s35
    s_lshl_b32 s33, s33, 1
    s_add_u32 s33, s33, s34
    s_mul_i32 s23, s33, 18432
    s_add_u32 s23, s23, s41
    s_lshl_b32 s33, s33, 10
    s_add_u32 s64, s33, s40
    s_add_u32 s30, s23, 0xf53000
    buffer_load_dwordx4 v[32:35], v1, s[12:15], s30 offen offset:0 sc1
    s_add_u32 s31, s23, 0xf57800
    buffer_load_dwordx4 v[36:39], v1, s[12:15], s31 offen offset:0 sc1
    s_waitcnt vmcnt(13) lgkmcnt(8)
    v_mfma_f32_16x16x32_bf16 v[144:147], v[48:51], v[80:83], v[144:147]
    s_waitcnt vmcnt(11) lgkmcnt(7)
    v_mfma_f32_16x16x32_bf16 v[144:147], v[56:59], v[96:99], v[144:147]
    v_fmaak_f32 v219, v219, v5, 0xc0135761
    v_mul_f32 v216, v124, v216
    v_mul_f32 v217, v125, v217
    v_mul_f32 v218, v126, v218
    v_mfma_f32_16x16x32_bf16 v[160:163], v[52:55], v[80:83], v[160:163]
    s_waitcnt vmcnt(10)
    v_mfma_f32_16x16x32_bf16 v[160:163], v[60:63], v[96:99], v[160:163]
    ds_read_b128 v[80:83], v2 offset:4096
    ds_read_b128 v[96:99], v2 offset:5120
    v_mul_f32 v219, v127, v219
    v_exp_f32 v216, v216
    v_exp_f32 v217, v217
    s_waitcnt lgkmcnt(8)
    v_mfma_f32_16x16x32_bf16 v[148:151], v[48:51], v[84:87], v[148:151]
    s_waitcnt lgkmcnt(7)
    v_mfma_f32_16x16x32_bf16 v[148:151], v[56:59], v[100:103], v[148:151]
    v_exp_f32 v218, v218
    v_exp_f32 v219, v219
    v_mfma_f32_16x16x32_bf16 v[164:167], v[52:55], v[84:87], v[164:167]
    v_mfma_f32_16x16x32_bf16 v[164:167], v[60:63], v[100:103], v[164:167]
    ds_read_b128 v[84:87], v2 offset:22528
    ds_read_b128 v[100:103], v2 offset:23552
    v_add_f32 v216, 1.0, v216
    v_add_f32 v217, 1.0, v217
    v_add_f32 v218, 1.0, v218
    v_add_f32 v219, 1.0, v219
    s_waitcnt lgkmcnt(8)
    v_mfma_f32_16x16x32_bf16 v[152:155], v[48:51], v[88:91], v[152:155]
    s_waitcnt lgkmcnt(7)
    v_mfma_f32_16x16x32_bf16 v[152:155], v[56:59], v[104:107], v[152:155]
    v_rcp_f32 v216, v216
    v_rcp_f32 v217, v217
    v_mfma_f32_16x16x32_bf16 v[168:171], v[52:55], v[88:91], v[168:171]
    v_mfma_f32_16x16x32_bf16 v[168:171], v[60:63], v[104:107], v[168:171]
    ds_read_b128 v[88:91], v2 offset:40960
    ds_read_b128 v[104:107], v2 offset:41984
    v_rcp_f32 v218, v218
    v_rcp_f32 v219, v219
    s_waitcnt lgkmcnt(7)
    v_mfma_f32_16x16x32_bf16 v[156:159], v[48:51], v[92:95], v[156:159]
    s_waitcnt lgkmcnt(6)
    v_mfma_f32_16x16x32_bf16 v[156:159], v[56:59], v[108:111], v[156:159]
    v_mul_f32 v216, v124, v216
    v_mul_f32 v217, v125, v217
    v_mul_f32 v218, v126, v218
    v_mul_f32 v219, v127, v219
    v_mfma_f32_16x16x32_bf16 v[172:175], v[52:55], v[92:95], v[172:175]
    v_mfma_f32_16x16x32_bf16 v[172:175], v[60:63], v[108:111], v[172:175]
    ds_read_b128 v[92:95], v2 offset:59392
    ds_read_b128 v[108:111], v2 offset:60416
    v_cvt_pk_bf16_f32 v224, v216, v217
    v_cvt_pk_bf16_f32 v225, v218, v219
    v_mul_f32 v216, v140, v140
    v_mul_f32 v217, v141, v141
    v_mul_f32 v218, v142, v142
    buffer_load_dwordx4 v[40:43], v1, s[12:15], s30 offen offset:1024 sc1
    buffer_load_dwordx4 v[44:47], v1, s[12:15], s31 offen offset:1024 sc1
    buffer_load_dwordx4 v[48:51], v1, s[12:15], s30 offen offset:2048 sc1
    buffer_load_dwordx4 v[52:55], v1, s[12:15], s31 offen offset:2048 sc1
    s_waitcnt vmcnt(13) lgkmcnt(7)
    v_mfma_f32_16x16x32_bf16 v[144:147], v[64:67], v[80:83], v[144:147]
    s_waitcnt vmcnt(11) lgkmcnt(6)
    v_mfma_f32_16x16x32_bf16 v[144:147], v[72:75], v[96:99], v[144:147]
    v_mul_f32 v219, v143, v143
    v_fmaak_f32 v216, v216, v5, 0xc0135761
    v_fmaak_f32 v217, v217, v5, 0xc0135761
    v_fmaak_f32 v218, v218, v5, 0xc0135761
    v_mfma_f32_16x16x32_bf16 v[160:163], v[68:71], v[80:83], v[160:163]
    s_waitcnt vmcnt(10)
    v_mfma_f32_16x16x32_bf16 v[160:163], v[76:79], v[96:99], v[160:163]
    ds_read_b128 v[80:83], v2 offset:6144
    ds_read_b128 v[96:99], v2 offset:7168
    v_fmaak_f32 v219, v219, v5, 0xc0135761
    v_mul_f32 v216, v140, v216
    v_mul_f32 v217, v141, v217
    v_mul_f32 v218, v142, v218
    s_waitcnt lgkmcnt(7)
    v_mfma_f32_16x16x32_bf16 v[148:151], v[64:67], v[84:87], v[148:151]
    s_waitcnt lgkmcnt(6)
    v_mfma_f32_16x16x32_bf16 v[148:151], v[72:75], v[100:103], v[148:151]
    v_mul_f32 v219, v143, v219
    v_exp_f32 v216, v216
    v_exp_f32 v217, v217
    v_mfma_f32_16x16x32_bf16 v[164:167], v[68:71], v[84:87], v[164:167]
    v_mfma_f32_16x16x32_bf16 v[164:167], v[76:79], v[100:103], v[164:167]
    ds_read_b128 v[84:87], v2 offset:24576
    ds_read_b128 v[100:103], v2 offset:25600
    v_exp_f32 v218, v218
    v_exp_f32 v219, v219
    s_waitcnt lgkmcnt(7)
    v_mfma_f32_16x16x32_bf16 v[152:155], v[64:67], v[88:91], v[152:155]
    s_waitcnt lgkmcnt(6)
    v_mfma_f32_16x16x32_bf16 v[152:155], v[72:75], v[104:107], v[152:155]
    v_add_f32 v216, 1.0, v216
    v_add_f32 v217, 1.0, v217
    v_add_f32 v218, 1.0, v218
    v_add_f32 v219, 1.0, v219
    v_mfma_f32_16x16x32_bf16 v[168:171], v[68:71], v[88:91], v[168:171]
    v_mfma_f32_16x16x32_bf16 v[168:171], v[76:79], v[104:107], v[168:171]
    ds_read_b128 v[88:91], v2 offset:43008
    ds_read_b128 v[104:107], v2 offset:44032
    v_rcp_f32 v216, v216
    v_rcp_f32 v217, v217
    s_waitcnt lgkmcnt(7)
    v_mfma_f32_16x16x32_bf16 v[156:159], v[64:67], v[92:95], v[156:159]
    s_waitcnt lgkmcnt(6)
    v_mfma_f32_16x16x32_bf16 v[156:159], v[72:75], v[108:111], v[156:159]
    v_rcp_f32 v218, v218
    v_rcp_f32 v219, v219
    v_mfma_f32_16x16x32_bf16 v[172:175], v[68:71], v[92:95], v[172:175]
    v_mfma_f32_16x16x32_bf16 v[172:175], v[76:79], v[108:111], v[172:175]
    ds_read_b128 v[92:95], v2 offset:61440
    ds_read_b128 v[108:111], v2 offset:62464
    v_mul_f32 v216, v140, v216
    v_mul_f32 v217, v141, v217
    v_mul_f32 v218, v142, v218
    v_mul_f32 v219, v143, v219
    v_cvt_pk_bf16_f32 v226, v216, v217
    buffer_load_dwordx4 v[56:59], v1, s[12:15], s30 offen offset:3072 sc1
    buffer_load_dwordx4 v[60:63], v1, s[12:15], s31 offen offset:3072 sc1
    s_add_u32 s30, s23, 0xf52000
    buffer_load_dwordx4 v[64:67], v1, s[12:15], s30 offen offset:0 sc1
    s_add_u32 s31, s23, 0xf56800
    buffer_load_dwordx4 v[68:71], v1, s[12:15], s31 offen offset:0 sc1
    v_mov_b32 v12, 149816
fused_kernel_r0_pg4:
    ds_read_b32 v13, v12
    s_waitcnt lgkmcnt(0)
    v_readfirstlane_b32 s35, v13
    s_nop 3
    s_cmp_ge_u32 s35, 4
    s_cbranch_scc1 fused_kernel_r0_pg4_d
    s_sleep 1
    s_branch fused_kernel_r0_pg4
fused_kernel_r0_pg4_d:
    s_waitcnt vmcnt(13)
    v_mfma_f32_16x16x32_bf16 v[144:147], v[16:19], v[80:83], v[144:147]
    s_waitcnt vmcnt(11)
    v_mfma_f32_16x16x32_bf16 v[144:147], v[24:27], v[96:99], v[144:147]
    v_cvt_pk_bf16_f32 v227, v218, v219
    ds_write_b128 v4, v[224:227] offset:63488
    s_nop 0
    s_nop 0
    s_nop 0
    s_waitcnt lgkmcnt(0)
    v_mov_b32 v12, 149804
    v_mov_b32 v13, 1
    s_mov_b64 exec, 1
    ds_add_u32 v12, v13
    s_mov_b64 exec, -1
    v_mfma_f32_16x16x32_bf16 v[160:163], v[20:23], v[80:83], v[160:163]
    s_waitcnt vmcnt(10)
    v_mfma_f32_16x16x32_bf16 v[160:163], v[28:31], v[96:99], v[160:163]
    ds_read_b128 v[80:83], v2 offset:12288
    ds_read_b128 v[96:99], v2 offset:13312
    v_mfma_f32_16x16x32_bf16 v[148:151], v[16:19], v[84:87], v[148:151]
    v_mfma_f32_16x16x32_bf16 v[148:151], v[24:27], v[100:103], v[148:151]
    v_mfma_f32_16x16x32_bf16 v[164:167], v[20:23], v[84:87], v[164:167]
    v_mfma_f32_16x16x32_bf16 v[164:167], v[28:31], v[100:103], v[164:167]
    ds_read_b128 v[84:87], v2 offset:30720
    ds_read_b128 v[100:103], v2 offset:31744
    v_mfma_f32_16x16x32_bf16 v[152:155], v[16:19], v[88:91], v[152:155]
    v_mfma_f32_16x16x32_bf16 v[152:155], v[24:27], v[104:107], v[152:155]
    v_mfma_f32_16x16x32_bf16 v[168:171], v[20:23], v[88:91], v[168:171]
    v_mfma_f32_16x16x32_bf16 v[168:171], v[28:31], v[104:107], v[168:171]
    ds_read_b128 v[88:91], v2 offset:49152
    ds_read_b128 v[104:107], v2 offset:50176
    v_mfma_f32_16x16x32_bf16 v[156:159], v[16:19], v[92:95], v[156:159]
    v_mfma_f32_16x16x32_bf16 v[156:159], v[24:27], v[108:111], v[156:159]
    v_mfma_f32_16x16x32_bf16 v[172:175], v[20:23], v[92:95], v[172:175]
    v_mfma_f32_16x16x32_bf16 v[172:175], v[28:31], v[108:111], v[172:175]
    ds_read_b128 v[92:95], v8 offset:2048
    ds_read_b128 v[108:111], v8 offset:3072
    buffer_load_dwordx4 v[72:75], v1, s[12:15], s30 offen offset:1024 sc1
    buffer_load_dwordx4 v[76:79], v1, s[12:15], s31 offen offset:1024 sc1
    buffer_load_dwordx4 v[16:19], v1, s[12:15], s30 offen offset:2048 sc1
    buffer_load_dwordx4 v[20:23], v1, s[12:15], s31 offen offset:2048 sc1
    s_waitcnt vmcnt(13) lgkmcnt(7)
    v_mfma_f32_16x16x32_bf16 v[176:179], v[32:35], v[80:83], v[176:179]
    s_waitcnt vmcnt(11) lgkmcnt(6)
    v_mfma_f32_16x16x32_bf16 v[176:179], v[40:43], v[96:99], v[176:179]
    v_mfma_f32_16x16x32_bf16 v[192:195], v[36:39], v[80:83], v[192:195]
    s_waitcnt vmcnt(10)
    v_mfma_f32_16x16x32_bf16 v[192:195], v[44:47], v[96:99], v[192:195]
    ds_read_b128 v[80:83], v2 offset:14336
    ds_read_b128 v[96:99], v2 offset:15360
    s_waitcnt lgkmcnt(7)
    v_mfma_f32_16x16x32_bf16 v[180:183], v[32:35], v[84:87], v[180:183]
    s_waitcnt lgkmcnt(6)
    v_mfma_f32_16x16x32_bf16 v[180:183], v[40:43], v[100:103], v[180:183]
    v_mfma_f32_16x16x32_bf16 v[196:199], v[36:39], v[84:87], v[196:199]
    v_mfma_f32_16x16x32_bf16 v[196:199], v[44:47], v[100:103], v[196:199]
    ds_read_b128 v[84:87], v2 offset:32768
    ds_read_b128 v[100:103], v2 offset:33792
    s_waitcnt lgkmcnt(7)
    v_mfma_f32_16x16x32_bf16 v[184:187], v[32:35], v[88:91], v[184:187]
    s_waitcnt lgkmcnt(6)
    v_mfma_f32_16x16x32_bf16 v[184:187], v[40:43], v[104:107], v[184:187]
    v_mfma_f32_16x16x32_bf16 v[200:203], v[36:39], v[88:91], v[200:203]
    v_mfma_f32_16x16x32_bf16 v[200:203], v[44:47], v[104:107], v[200:203]
    ds_read_b128 v[88:91], v2 offset:51200
    ds_read_b128 v[104:107], v2 offset:52224
    s_waitcnt lgkmcnt(7)
    v_mfma_f32_16x16x32_bf16 v[188:191], v[32:35], v[92:95], v[188:191]
    s_waitcnt lgkmcnt(6)
    v_mfma_f32_16x16x32_bf16 v[188:191], v[40:43], v[108:111], v[188:191]
    v_mfma_f32_16x16x32_bf16 v[204:207], v[36:39], v[92:95], v[204:207]
    v_mfma_f32_16x16x32_bf16 v[204:207], v[44:47], v[108:111], v[204:207]
    ds_read_b128 v[92:95], v8 offset:4096
    ds_read_b128 v[108:111], v8 offset:5120
    buffer_load_dwordx4 v[24:27], v1, s[12:15], s30 offen offset:3072 sc1
    buffer_load_dwordx4 v[28:31], v1, s[12:15], s31 offen offset:3072 sc1
    s_add_u32 s33, s38, 4
    s_mov_b32 s34, 0
    s_add_u32 s33, s33, s42
    s_sub_u32 s35, s33, 18
    s_cselect_b32 s33, s33, s35
    s_lshl_b32 s33, s33, 1
    s_add_u32 s33, s33, s34
    s_mul_i32 s23, s33, 18432
    s_add_u32 s23, s23, s41
    s_lshl_b32 s33, s33, 10
    s_add_u32 s65, s33, s40
    s_add_u32 s30, s23, 0xf53000
    buffer_load_dwordx4 v[32:35], v1, s[12:15], s30 offen offset:0 sc1
    s_add_u32 s31, s23, 0xf57800
    buffer_load_dwordx4 v[36:39], v1, s[12:15], s31 offen offset:0 sc1
    v_mov_b32 v12, 149804
fused_kernel_r0_pg1:
    ds_read_b32 v13, v12
    s_waitcnt lgkmcnt(0)
    v_readfirstlane_b32 s35, v13
    s_nop 3
    s_cmp_ge_u32 s35, 4
    s_cbranch_scc1 fused_kernel_r0_pg1_d
    s_sleep 1
    s_branch fused_kernel_r0_pg1
fused_kernel_r0_pg1_d:
    s_waitcnt vmcnt(13)
    v_mfma_f32_16x16x32_bf16 v[176:179], v[48:51], v[80:83], v[176:179]
    s_waitcnt vmcnt(11)
    v_mfma_f32_16x16x32_bf16 v[176:179], v[56:59], v[96:99], v[176:179]
    v_mfma_f32_16x16x32_bf16 v[192:195], v[52:55], v[80:83], v[192:195]
    s_waitcnt vmcnt(10)
    v_mfma_f32_16x16x32_bf16 v[192:195], v[60:63], v[96:99], v[192:195]
    ds_read_b128 v[80:83], v2 offset:8192
    ds_read_b128 v[96:99], v2 offset:9216
    v_mfma_f32_16x16x32_bf16 v[180:183], v[48:51], v[84:87], v[180:183]
    v_mfma_f32_16x16x32_bf16 v[180:183], v[56:59], v[100:103], v[180:183]
    v_mfma_f32_16x16x32_bf16 v[196:199], v[52:55], v[84:87], v[196:199]
    v_mfma_f32_16x16x32_bf16 v[196:199], v[60:63], v[100:103], v[196:199]
    ds_read_b128 v[84:87], v2 offset:26624
    ds_read_b128 v[100:103], v2 offset:27648
    v_mfma_f32_16x16x32_bf16 v[184:187], v[48:51], v[88:91], v[184:187]
    v_mfma_f32_16x16x32_bf16 v[184:187], v[56:59], v[104:107], v[184:187]
    v_mfma_f32_16x16x32_bf16 v[200:203], v[52:55], v[88:91], v[200:203]
    v_mfma_f32_16x16x32_bf16 v[200:203], v[60:63], v[104:107], v[200:203]
    ds_read_b128 v[88:91], v2 offset:45056
    ds_read_b128 v[104:107], v2 offset:46080
    v_mfma_f32_16x16x32_bf16 v[188:191], v[48:51], v[92:95], v[188:191]
    v_mfma_f32_16x16x32_bf16 v[188:191], v[56:59], v[108:111], v[188:191]
    v_mfma_f32_16x16x32_bf16 v[204:207], v[52:55], v[92:95], v[204:207]
    v_mfma_f32_16x16x32_bf16 v[204:207], v[60:63], v[108:111], v[204:207]
    ds_read_b128 v[92:95], v2 offset:63488
    ds_read_b128 v[108:111], v2 offset:64512
    buffer_load_dwordx4 v[40:43], v1, s[12:15], s30 offen offset:1024 sc1
    buffer_load_dwordx4 v[44:47], v1, s[12:15], s31 offen offset:1024 sc1
    buffer_load_dwordx4 v[48:51], v1, s[12:15], s30 offen offset:2048 sc1
    buffer_load_dwordx4 v[52:55], v1, s[12:15], s31 offen offset:2048 sc1
    s_waitcnt vmcnt(13) lgkmcnt(7)
    v_mfma_f32_16x16x32_bf16 v[176:179], v[64:67], v[80:83], v[176:179]
    s_waitcnt vmcnt(11) lgkmcnt(6)
    v_mfma_f32_16x16x32_bf16 v[176:179], v[72:75], v[96:99], v[176:179]
    v_mfma_f32_16x16x32_bf16 v[192:195], v[68:71], v[80:83], v[192:195]
    s_waitcnt vmcnt(10)
    v_mfma_f32_16x16x32_bf16 v[192:195], v[76:79], v[96:99], v[192:195]
    ds_read_b128 v[80:83], v2 offset:10240
    ds_read_b128 v[96:99], v2 offset:11264
    s_waitcnt lgkmcnt(7)
    v_mfma_f32_16x16x32_bf16 v[180:183], v[64:67], v[84:87], v[180:183]
    s_waitcnt lgkmcnt(6)
    v_mfma_f32_16x16x32_bf16 v[180:183], v[72:75], v[100:103], v[180:183]
    v_mfma_f32_16x16x32_bf16 v[196:199], v[68:71], v[84:87], v[196:199]
    v_mfma_f32_16x16x32_bf16 v[196:199], v[76:79], v[100:103], v[196:199]
    ds_read_b128 v[84:87], v2 offset:28672
    ds_read_b128 v[100:103], v2 offset:29696
    s_waitcnt lgkmcnt(7)
    v_mfma_f32_16x16x32_bf16 v[184:187], v[64:67], v[88:91], v[184:187]
    s_waitcnt lgkmcnt(6)
    v_mfma_f32_16x16x32_bf16 v[184:187], v[72:75], v[104:107], v[184:187]
    v_mfma_f32_16x16x32_bf16 v[200:203], v[68:71], v[88:91], v[200:203]
    v_mfma_f32_16x16x32_bf16 v[200:203], v[76:79], v[104:107], v[200:203]
    ds_read_b128 v[88:91], v2 offset:47104
    ds_read_b128 v[104:107], v2 offset:48128
    s_waitcnt lgkmcnt(7)
    v_mfma_f32_16x16x32_bf16 v[188:191], v[64:67], v[92:95], v[188:191]
    s_waitcnt lgkmcnt(6)
    v_mfma_f32_16x16x32_bf16 v[188:191], v[72:75], v[108:111], v[188:191]
    v_mfma_f32_16x16x32_bf16 v[204:207], v[68:71], v[92:95], v[204:207]
    v_mfma_f32_16x16x32_bf16 v[204:207], v[76:79], v[108:111], v[204:207]
    ds_read_b128 v[92:95], v8 offset:0
    ds_read_b128 v[108:111], v8 offset:1024
    buffer_load_dwordx4 v[56:59], v1, s[12:15], s30 offen offset:3072 sc1
    buffer_load_dwordx4 v[60:63], v1, s[12:15], s31 offen offset:3072 sc1
    s_add_u32 s30, s23, 0xf52000
    buffer_load_dwordx4 v[64:67], v1, s[12:15], s30 offen offset:0 sc1
    s_add_u32 s31, s23, 0xf56800
    buffer_load_dwordx4 v[68:71], v1, s[12:15], s31 offen offset:0 sc1
    s_waitcnt vmcnt(13) lgkmcnt(7)
    v_mfma_f32_16x16x32_bf16 v[176:179], v[16:19], v[80:83], v[176:179]
    s_waitcnt vmcnt(11) lgkmcnt(6)
    v_mfma_f32_16x16x32_bf16 v[176:179], v[24:27], v[96:99], v[176:179]
    v_mfma_f32_16x16x32_bf16 v[192:195], v[20:23], v[80:83], v[192:195]
    s_waitcnt vmcnt(10)
    v_mfma_f32_16x16x32_bf16 v[192:195], v[28:31], v[96:99], v[192:195]
    ds_read_b128 v[80:83], v2 offset:12288
    ds_read_b128 v[96:99], v2 offset:13312
    s_waitcnt lgkmcnt(7)
    v_mfma_f32_16x16x32_bf16 v[180:183], v[16:19], v[84:87], v[180:183]
    s_waitcnt lgkmcnt(6)
    v_mfma_f32_16x16x32_bf16 v[180:183], v[24:27], v[100:103], v[180:183]
    v_mfma_f32_16x16x32_bf16 v[196:199], v[20:23], v[84:87], v[196:199]
    v_mfma_f32_16x16x32_bf16 v[196:199], v[28:31], v[100:103], v[196:199]
    ds_read_b128 v[84:87], v2 offset:30720
    ds_read_b128 v[100:103], v2 offset:31744
    s_waitcnt lgkmcnt(7)
    v_mfma_f32_16x16x32_bf16 v[184:187], v[16:19], v[88:91], v[184:187]
    s_waitcnt lgkmcnt(6)
    v_mfma_f32_16x16x32_bf16 v[184:187], v[24:27], v[104:107], v[184:187]
    v_mfma_f32_16x16x32_bf16 v[200:203], v[20:23], v[88:91], v[200:203]
    v_mfma_f32_16x16x32_bf16 v[200:203], v[28:31], v[104:107], v[200:203]
    ds_read_b128 v[88:91], v2 offset:49152
    ds_read_b128 v[104:107], v2 offset:50176
    s_waitcnt lgkmcnt(7)
    v_mfma_f32_16x16x32_bf16 v[188:191], v[16:19], v[92:95], v[188:191]
    s_waitcnt lgkmcnt(6)
    v_mfma_f32_16x16x32_bf16 v[188:191], v[24:27], v[108:111], v[188:191]
    v_mfma_f32_16x16x32_bf16 v[204:207], v[20:23], v[92:95], v[204:207]
    v_mfma_f32_16x16x32_bf16 v[204:207], v[28:31], v[108:111], v[204:207]
    ds_read_b128 v[92:95], v8 offset:2048
    ds_read_b128 v[108:111], v8 offset:3072
    buffer_load_dwordx4 v[72:75], v1, s[12:15], s30 offen offset:1024 sc1
    buffer_load_dwordx4 v[76:79], v1, s[12:15], s31 offen offset:1024 sc1
    buffer_load_dwordx4 v[16:19], v1, s[12:15], s30 offen offset:2048 sc1
    buffer_load_dwordx4 v[20:23], v1, s[12:15], s31 offen offset:2048 sc1
    s_waitcnt vmcnt(13) lgkmcnt(7)
    v_mfma_f32_16x16x32_bf16 v[144:147], v[32:35], v[80:83], v[144:147]
    s_waitcnt vmcnt(11) lgkmcnt(6)
    v_mfma_f32_16x16x32_bf16 v[144:147], v[40:43], v[96:99], v[144:147]
    v_cvt_pk_bf16_f32 v220, v176, v177
    v_cvt_pk_bf16_f32 v221, v178, v179
    v_cvt_pk_bf16_f32 v222, v180, v181
    v_cvt_pk_bf16_f32 v223, v182, v183
    v_mfma_f32_16x16x32_bf16 v[160:163], v[36:39], v[80:83], v[160:163]
    s_waitcnt vmcnt(10)
    v_mfma_f32_16x16x32_bf16 v[160:163], v[44:47], v[96:99], v[160:163]
    ds_read_b128 v[80:83], v2 offset:14336
    ds_read_b128 v[96:99], v2 offset:15360
    s_add_u32 s34, s64, 0
    buffer_store_dwordx4 v[220:223], v1, s[12:15], s34 offen offset:0 sc1
    v_cvt_pk_bf16_f32 v224, v184, v185
    v_cvt_pk_bf16_f32 v225, v186, v187
    v_cvt_pk_bf16_f32 v226, v188, v189
    s_waitcnt lgkmcnt(7)
    v_mfma_f32_16x16x32_bf16 v[148:151], v[32:35], v[84:87], v[148:151]
    s_waitcnt lgkmcnt(6)
    v_mfma_f32_16x16x32_bf16 v[148:151], v[40:43], v[100:103], v[148:151]
    v_cvt_pk_bf16_f32 v227, v190, v191
    s_add_u32 s34, s64, 36864
    buffer_store_dwordx4 v[224:227], v1, s[12:15], s34 offen offset:0 sc1
    v_cvt_pk_bf16_f32 v220, v192, v193
    v_cvt_pk_bf16_f32 v221, v194, v195
    v_mfma_f32_16x16x32_bf16 v[164:167], v[36:39], v[84:87], v[164:167]
    v_mfma_f32_16x16x32_bf16 v[164:167], v[44:47], v[100:103], v[164:167]
    ds_read_b128 v[84:87], v2 offset:32768
    ds_read_b128 v[100:103], v2 offset:33792
    v_cvt_pk_bf16_f32 v222, v196, v197
    v_cvt_pk_bf16_f32 v223, v198, v199
    s_add_u32 s34, s64, 0
    buffer_store_dwordx4 v[220:223], v1, s[12:15], s34 offen offset:1024 sc1
    v_cvt_pk_bf16_f32 v224, v200, v201
    s_waitcnt lgkmcnt(7)
    v_mfma_f32_16x16x32_bf16 v[152:155], v[32:35], v[88:91], v[152:155]
    s_waitcnt lgkmcnt(6)
    v_mfma_f32_16x16x32_bf16 v[152:155], v[40:43], v[104:107], v[152:155]
    v_cvt_pk_bf16_f32 v225, v202, v203
    v_cvt_pk_bf16_f32 v226, v204, v205
    v_cvt_pk_bf16_f32 v227, v206, v207
    s_add_u32 s34, s64, 36864
    buffer_store_dwordx4 v[224:227], v1, s[12:15], s34 offen offset:1024 sc1
    v_mfma_f32_16x16x32_bf16 v[168:171], v[36:39], v[88:91], v[168:171]
    v_mfma_f32_16x16x32_bf16 v[168:171], v[44:47], v[104:107], v[168:171]
    ds_read_b128 v[88:91], v2 offset:51200
    ds_read_b128 v[104:107], v2 offset:52224
    s_waitcnt lgkmcnt(7)
    v_mfma_f32_16x16x32_bf16 v[156:159], v[32:35], v[92:95], v[156:159]
    s_waitcnt lgkmcnt(6)
    v_mfma_f32_16x16x32_bf16 v[156:159], v[40:43], v[108:111], v[156:159]
    v_mfma_f32_16x16x32_bf16 v[172:175], v[36:39], v[92:95], v[172:175]
    v_mfma_f32_16x16x32_bf16 v[172:175], v[44:47], v[108:111], v[172:175]
    ds_read_b128 v[92:95], v8 offset:4096
    ds_read_b128 v[108:111], v8 offset:5120
    buffer_load_dwordx4 v[24:27], v1, s[12:15], s30 offen offset:3072 sc1
    buffer_load_dwordx4 v[28:31], v1, s[12:15], s31 offen offset:3072 sc1
    s_add_u32 s33, s38, 8
    s_mov_b32 s34, 0
    s_add_u32 s33, s33, s42
    s_sub_u32 s35, s33, 18
    s_cselect_b32 s33, s33, s35
    s_lshl_b32 s33, s33, 1
    s_add_u32 s33, s33, s34
    s_mul_i32 s23, s33, 18432
    s_add_u32 s23, s23, s41
    s_lshl_b32 s33, s33, 10
    s_add_u32 s66, s33, s40
    s_add_u32 s30, s23, 0xf54000
    buffer_load_dwordx4 v[32:35], v1, s[12:15], s30 offen offset:0 sc1
    s_add_u32 s31, s23, 0xf58800
    buffer_load_dwordx4 v[36:39], v1, s[12:15], s31 offen offset:0 sc1
    s_waitcnt vmcnt(17) lgkmcnt(7)
    v_mfma_f32_16x16x32_bf16 v[144:147], v[48:51], v[80:83], v[144:147]
    s_waitcnt vmcnt(15) lgkmcnt(6)
    v_mfma_f32_16x16x32_bf16 v[144:147], v[56:59], v[96:99], v[144:147]
    v_mfma_f32_16x16x32_bf16 v[160:163], v[52:55], v[80:83], v[160:163]
    s_waitcnt vmcnt(14)
    v_mfma_f32_16x16x32_bf16 v[160:163], v[60:63], v[96:99], v[160:163]
    ds_read_b128 v[80:83], v2 offset:8192
    ds_read_b128 v[96:99], v2 offset:9216
    s_waitcnt lgkmcnt(7)
    v_mfma_f32_16x16x32_bf16 v[148:151], v[48:51], v[84:87], v[148:151]
    s_waitcnt lgkmcnt(6)
    v_mfma_f32_16x16x32_bf16 v[148:151], v[56:59], v[100:103], v[148:151]
    v_mfma_f32_16x16x32_bf16 v[164:167], v[52:55], v[84:87], v[164:167]
    v_mfma_f32_16x16x32_bf16 v[164:167], v[60:63], v[100:103], v[164:167]
    ds_read_b128 v[84:87], v2 offset:26624
    ds_read_b128 v[100:103], v2 offset:27648
    s_waitcnt lgkmcnt(7)
    v_mfma_f32_16x16x32_bf16 v[152:155], v[48:51], v[88:91], v[152:155]
    s_waitcnt lgkmcnt(6)
    v_mfma_f32_16x16x32_bf16 v[152:155], v[56:59], v[104:107], v[152:155]
    v_mfma_f32_16x16x32_bf16 v[168:171], v[52:55], v[88:91], v[168:171]
    v_mfma_f32_16x16x32_bf16 v[168:171], v[60:63], v[104:107], v[168:171]
    ds_read_b128 v[88:91], v2 offset:45056
    ds_read_b128 v[104:107], v2 offset:46080
    s_waitcnt lgkmcnt(7)
    v_mfma_f32_16x16x32_bf16 v[156:159], v[48:51], v[92:95], v[156:159]
    s_waitcnt lgkmcnt(6)
    v_mfma_f32_16x16x32_bf16 v[156:159], v[56:59], v[108:111], v[156:159]
    v_mfma_f32_16x16x32_bf16 v[172:175], v[52:55], v[92:95], v[172:175]
    v_mfma_f32_16x16x32_bf16 v[172:175], v[60:63], v[108:111], v[172:175]
    ds_read_b128 v[92:95], v2 offset:63488
    ds_read_b128 v[108:111], v2 offset:64512
    buffer_load_dwordx4 v[40:43], v1, s[12:15], s30 offen offset:1024 sc1
    buffer_load_dwordx4 v[44:47], v1, s[12:15], s31 offen offset:1024 sc1
    s_add_u32 s30, s23, 0xf50000
    buffer_load_dwordx4 v[48:51], v1, s[12:15], s30 offen offset:0 sc1
    s_add_u32 s31, s23, 0xf54800
    buffer_load_dwordx4 v[52:55], v1, s[12:15], s31 offen offset:0 sc1
    s_waitcnt vmcnt(17) lgkmcnt(7)
    v_mfma_f32_16x16x32_bf16 v[144:147], v[64:67], v[80:83], v[144:147]
    s_waitcnt vmcnt(15) lgkmcnt(6)
    v_mfma_f32_16x16x32_bf16 v[144:147], v[72:75], v[96:99], v[144:147]
    v_mfma_f32_16x16x32_bf16 v[160:163], v[68:71], v[80:83], v[160:163]
    s_waitcnt vmcnt(14)
    v_mfma_f32_16x16x32_bf16 v[160:163], v[76:79], v[96:99], v[160:163]
    ds_read_b128 v[80:83], v2 offset:10240
    ds_read_b128 v[96:99], v2 offset:11264
    s_waitcnt lgkmcnt(7)
    v_mfma_f32_16x16x32_bf16 v[148:151], v[64:67], v[84:87], v[148:151]
    s_waitcnt lgkmcnt(6)
    v_mfma_f32_16x16x32_bf16 v[148:151], v[72:75], v[100:103], v[148:151]
    v_mfma_f32_16x16x32_bf16 v[164:167], v[68:71], v[84:87], v[164:167]
    v_mfma_f32_16x16x32_bf16 v[164:167], v[76:79], v[100:103], v[164:167]
    ds_read_b128 v[84:87], v2 offset:28672
    ds_read_b128 v[100:103], v2 offset:29696
    s_waitcnt lgkmcnt(7)
    v_mfma_f32_16x16x32_bf16 v[152:155], v[64:67], v[88:91], v[152:155]
    s_waitcnt lgkmcnt(6)
    v_mfma_f32_16x16x32_bf16 v[152:155], v[72:75], v[104:107], v[152:155]
    v_mfma_f32_16x16x32_bf16 v[168:171], v[68:71], v[88:91], v[168:171]
    v_mfma_f32_16x16x32_bf16 v[168:171], v[76:79], v[104:107], v[168:171]
    ds_read_b128 v[88:91], v2 offset:47104
    ds_read_b128 v[104:107], v2 offset:48128
    s_waitcnt lgkmcnt(7)
    v_mfma_f32_16x16x32_bf16 v[156:159], v[64:67], v[92:95], v[156:159]
    s_waitcnt lgkmcnt(6)
    v_mfma_f32_16x16x32_bf16 v[156:159], v[72:75], v[108:111], v[156:159]
    v_mfma_f32_16x16x32_bf16 v[172:175], v[68:71], v[92:95], v[172:175]
    v_mfma_f32_16x16x32_bf16 v[172:175], v[76:79], v[108:111], v[172:175]
    ds_read_b128 v[92:95], v8 offset:0
    ds_read_b128 v[108:111], v8 offset:1024
    buffer_load_dwordx4 v[56:59], v1, s[12:15], s30 offen offset:1024 sc1
    buffer_load_dwordx4 v[60:63], v1, s[12:15], s31 offen offset:1024 sc1
    buffer_load_dwordx4 v[64:67], v1, s[12:15], s30 offen offset:2048 sc1
    buffer_load_dwordx4 v[68:71], v1, s[12:15], s31 offen offset:2048 sc1
    s_waitcnt vmcnt(17) lgkmcnt(7)
    v_mfma_f32_16x16x32_bf16 v[144:147], v[16:19], v[80:83], v[144:147]
    s_waitcnt vmcnt(11) lgkmcnt(6)
    v_mfma_f32_16x16x32_bf16 v[144:147], v[24:27], v[96:99], v[144:147]
    v_mfma_f32_16x16x32_bf16 v[160:163], v[20:23], v[80:83], v[160:163]
    s_waitcnt vmcnt(10)
    v_mfma_f32_16x16x32_bf16 v[160:163], v[28:31], v[96:99], v[160:163]
    ds_read_b128 v[80:83], v2 offset:16384
    ds_read_b128 v[96:99], v2 offset:17408
    s_waitcnt lgkmcnt(7)
    v_mfma_f32_16x16x32_bf16 v[148:151], v[16:19], v[84:87], v[148:151]
    s_waitcnt lgkmcnt(6)
    v_mfma_f32_16x16x32_bf16 v[148:151], v[24:27], v[100:103], v[148:151]
    v_mfma_f32_16x16x32_bf16 v[164:167], v[20:23], v[84:87], v[164:167]
    v_mfma_f32_16x16x32_bf16 v[164:167], v[28:31], v[100:103], v[164:167]
    ds_read_b128 v[84:87], v2 offset:34816
    ds_read_b128 v[100:103], v2 offset:35840
    s_waitcnt lgkmcnt(7)
    v_mfma_f32_16x16x32_bf16 v[152:155], v[16:19], v[88:91], v[152:155]
    s_waitcnt lgkmcnt(6)
    v_mfma_f32_16x16x32_bf16 v[152:155], v[24:27], v[104:107], v[152:155]
    v_mfma_f32_16x16x32_bf16 v[168:171], v[20:23], v[88:91], v[168:171]
    v_mfma_f32_16x16x32_bf16 v[168:171], v[28:31], v[104:107], v[168:171]
    ds_read_b128 v[88:91], v2 offset:53248
    ds_read_b128 v[104:107], v2 offset:54272
    s_waitcnt lgkmcnt(7)
    v_mfma_f32_16x16x32_bf16 v[156:159], v[16:19], v[92:95], v[156:159]
    s_waitcnt lgkmcnt(6)
    v_mfma_f32_16x16x32_bf16 v[156:159], v[24:27], v[108:111], v[156:159]
    v_mfma_f32_16x16x32_bf16 v[172:175], v[20:23], v[92:95], v[172:175]
    v_mfma_f32_16x16x32_bf16 v[172:175], v[28:31], v[108:111], v[172:175]
    ds_read_b128 v[92:95], v8 offset:6144
    ds_read_b128 v[108:111], v8 offset:7168
    buffer_load_dwordx4 v[72:75], v1, s[12:15], s30 offen offset:3072 sc1
    buffer_load_dwordx4 v[76:79], v1, s[12:15], s31 offen offset:3072 sc1
    s_add_u32 s30, s23, 0xf51000
    buffer_load_dwordx4 v[16:19], v1, s[12:15], s30 offen offset:0 sc1
    s_add_u32 s31, s23, 0xf55800
    buffer_load_dwordx4 v[20:23], v1, s[12:15], s31 offen offset:0 sc1
    s_waitcnt vmcnt(13) lgkmcnt(7)
    v_mfma_f32_16x16x32_bf16 v[112:115], v[32:35], v[80:83], 0
    s_waitcnt vmcnt(11) lgkmcnt(6)
    v_mfma_f32_16x16x32_bf16 v[112:115], v[40:43], v[96:99], v[112:115]
    v_cvt_pk_bf16_f32 v220, v144, v145
    v_cvt_pk_bf16_f32 v221, v146, v147
    v_cvt_pk_bf16_f32 v222, v148, v149
    v_cvt_pk_bf16_f32 v223, v150, v151
    v_mfma_f32_16x16x32_bf16 v[128:131], v[36:39], v[80:83], 0
    s_waitcnt vmcnt(10)
    v_mfma_f32_16x16x32_bf16 v[128:131], v[44:47], v[96:99], v[128:131]
    ds_read_b128 v[80:83], v2 offset:0
    ds_read_b128 v[96:99], v2 offset:1024
    s_add_u32 s34, s65, 0
    buffer_store_dwordx4 v[220:223], v1, s[12:15], s34 offen offset:0 sc1
    v_cvt_pk_bf16_f32 v224, v152, v153
    v_cvt_pk_bf16_f32 v225, v154, v155
    v_cvt_pk_bf16_f32 v226, v156, v157
    s_waitcnt lgkmcnt(7)
    v_mfma_f32_16x16x32_bf16 v[116:119], v[32:35], v[84:87], 0
    s_waitcnt lgkmcnt(6)
    v_mfma_f32_16x16x32_bf16 v[116:119], v[40:43], v[100:103], v[116:119]
    v_cvt_pk_bf16_f32 v227, v158, v159
    s_add_u32 s34, s65, 36864
    buffer_store_dwordx4 v[224:227], v1, s[12:15], s34 offen offset:0 sc1
    v_cvt_pk_bf16_f32 v220, v160, v161
    v_cvt_pk_bf16_f32 v221, v162, v163
    v_mfma_f32_16x16x32_bf16 v[132:135], v[36:39], v[84:87], 0
    v_mfma_f32_16x16x32_bf16 v[132:135], v[44:47], v[100:103], v[132:135]
    ds_read_b128 v[84:87], v2 offset:18432
    ds_read_b128 v[100:103], v2 offset:19456
    v_cvt_pk_bf16_f32 v222, v164, v165
    v_cvt_pk_bf16_f32 v223, v166, v167
    s_add_u32 s34, s65, 0
    buffer_store_dwordx4 v[220:223], v1, s[12:15], s34 offen offset:1024 sc1
    v_cvt_pk_bf16_f32 v224, v168, v169
    s_waitcnt lgkmcnt(7)
    v_mfma_f32_16x16x32_bf16 v[120:123], v[32:35], v[88:91], 0
    s_waitcnt lgkmcnt(6)
    v_mfma_f32_16x16x32_bf16 v[120:123], v[40:43], v[104:107], v[120:123]
    v_cvt_pk_bf16_f32 v225, v170, v171
    v_cvt_pk_bf16_f32 v226, v172, v173
    v_cvt_pk_bf16_f32 v227, v174, v175
    s_add_u32 s34, s65, 36864
    buffer_store_dwordx4 v[224:227], v1, s[12:15], s34 offen offset:1024 sc1
    v_mfma_f32_16x16x32_bf16 v[136:139], v[36:39], v[88:91], 0
    v_mfma_f32_16x16x32_bf16 v[136:139], v[44:47], v[104:107], v[136:139]
    ds_read_b128 v[88:91], v2 offset:36864
    ds_read_b128 v[104:107], v2 offset:37888
    s_waitcnt lgkmcnt(7)
    v_mfma_f32_16x16x32_bf16 v[124:127], v[32:35], v[92:95], 0
    s_waitcnt lgkmcnt(6)
    v_mfma_f32_16x16x32_bf16 v[124:127], v[40:43], v[108:111], v[124:127]
    v_mfma_f32_16x16x32_bf16 v[140:143], v[36:39], v[92:95], 0
    v_mfma_f32_16x16x32_bf16 v[140:143], v[44:47], v[108:111], v[140:143]
    ds_read_b128 v[92:95], v2 offset:55296
    ds_read_b128 v[108:111], v2 offset:56320
    buffer_load_dwordx4 v[24:27], v1, s[12:15], s30 offen offset:1024 sc1
    buffer_load_dwordx4 v[28:31], v1, s[12:15], s31 offen offset:1024 sc1
    buffer_load_dwordx4 v[32:35], v1, s[12:15], s30 offen offset:2048 sc1
    buffer_load_dwordx4 v[36:39], v1, s[12:15], s31 offen offset:2048 sc1
    s_waitcnt vmcnt(17) lgkmcnt(7)
    v_mfma_f32_16x16x32_bf16 v[112:115], v[48:51], v[80:83], v[112:115]
    s_waitcnt vmcnt(15) lgkmcnt(6)
    v_mfma_f32_16x16x32_bf16 v[112:115], v[56:59], v[96:99], v[112:115]
    v_mfma_f32_16x16x32_bf16 v[128:131], v[52:55], v[80:83], v[128:131]
    s_waitcnt vmcnt(14)
    v_mfma_f32_16x16x32_bf16 v[128:131], v[60:63], v[96:99], v[128:131]
    ds_read_b128 v[80:83], v2 offset:2048
    ds_read_b128 v[96:99], v2 offset:3072
    s_waitcnt lgkmcnt(7)
    v_mfma_f32_16x16x32_bf16 v[116:119], v[48:51], v[84:87], v[116:119]
    s_waitcnt lgkmcnt(6)
    v_mfma_f32_16x16x32_bf16 v[116:119], v[56:59], v[100:103], v[116:119]
    v_mfma_f32_16x16x32_bf16 v[132:135], v[52:55], v[84:87], v[132:135]
    v_mfma_f32_16x16x32_bf16 v[132:135], v[60:63], v[100:103], v[132:135]
    ds_read_b128 v[84:87], v2 offset:20480
    ds_read_b128 v[100:103], v2 offset:21504
    s_waitcnt lgkmcnt(7)
    v_mfma_f32_16x16x32_bf16 v[120:123], v[48:51], v[88:91], v[120:123]
    s_waitcnt lgkmcnt(6)
    v_mfma_f32_16x16x32_bf16 v[120:123], v[56:59], v[104:107], v[120:123]
    v_mfma_f32_16x16x32_bf16 v[136:139], v[52:55], v[88:91], v[136:139]
    v_mfma_f32_16x16x32_bf16 v[136:139], v[60:63], v[104:107], v[136:139]
    ds_read_b128 v[88:91], v2 offset:38912
    ds_read_b128 v[104:107], v2 offset:39936
    s_waitcnt lgkmcnt(7)
    v_mfma_f32_16x16x32_bf16 v[124:127], v[48:51], v[92:95], v[124:127]
    s_waitcnt lgkmcnt(6)
    v_mfma_f32_16x16x32_bf16 v[124:127], v[56:59], v[108:111], v[124:127]
    v_mfma_f32_16x16x32_bf16 v[140:143], v[52:55], v[92:95], v[140:143]
    v_mfma_f32_16x16x32_bf16 v[140:143], v[60:63], v[108:111], v[140:143]
    ds_read_b128 v[92:95], v2 offset:57344
    ds_read_b128 v[108:111], v2 offset:58368
    buffer_load_dwordx4 v[40:43], v1, s[12:15], s30 offen offset:3072 sc1
    buffer_load_dwordx4 v[44:47], v1, s[12:15], s31 offen offset:3072 sc1
    s_add_u32 s30, s23, 0xf53000
    buffer_load_dwordx4 v[48:51], v1, s[12:15], s30 offen offset:0 sc1
    s_add_u32 s31, s23, 0xf57800
    buffer_load_dwordx4 v[52:55], v1, s[12:15], s31 offen offset:0 sc1
    s_waitcnt vmcnt(17) lgkmcnt(7)
    v_mfma_f32_16x16x32_bf16 v[112:115], v[64:67], v[80:83], v[112:115]
    s_waitcnt vmcnt(15) lgkmcnt(6)
    v_mfma_f32_16x16x32_bf16 v[112:115], v[72:75], v[96:99], v[112:115]
    v_mfma_f32_16x16x32_bf16 v[128:131], v[68:71], v[80:83], v[128:131]
    s_waitcnt vmcnt(14)
    v_mfma_f32_16x16x32_bf16 v[128:131], v[76:79], v[96:99], v[128:131]
    ds_read_b128 v[80:83], v2 offset:4096
    ds_read_b128 v[96:99], v2 offset:5120
    s_waitcnt lgkmcnt(7)
    v_mfma_f32_16x16x32_bf16 v[116:119], v[64:67], v[84:87], v[116:119]
    s_waitcnt lgkmcnt(6)
    v_mfma_f32_16x16x32_bf16 v[116:119], v[72:75], v[100:103], v[116:119]
    v_mfma_f32_16x16x32_bf16 v[132:135], v[68:71], v[84:87], v[132:135]
    v_mfma_f32_16x16x32_bf16 v[132:135], v[76:79], v[100:103], v[132:135]
    ds_read_b128 v[84:87], v2 offset:22528
    ds_read_b128 v[100:103], v2 offset:23552
    s_waitcnt lgkmcnt(7)
    v_mfma_f32_16x16x32_bf16 v[120:123], v[64:67], v[88:91], v[120:123]
    s_waitcnt lgkmcnt(6)
    v_mfma_f32_16x16x32_bf16 v[120:123], v[72:75], v[104:107], v[120:123]
    v_mfma_f32_16x16x32_bf16 v[136:139], v[68:71], v[88:91], v[136:139]
    v_mfma_f32_16x16x32_bf16 v[136:139], v[76:79], v[104:107], v[136:139]
    ds_read_b128 v[88:91], v2 offset:40960
    ds_read_b128 v[104:107], v2 offset:41984
    s_waitcnt lgkmcnt(7)
    v_mfma_f32_16x16x32_bf16 v[124:127], v[64:67], v[92:95], v[124:127]
    s_waitcnt lgkmcnt(6)
    v_mfma_f32_16x16x32_bf16 v[124:127], v[72:75], v[108:111], v[124:127]
    v_mfma_f32_16x16x32_bf16 v[140:143], v[68:71], v[92:95], v[140:143]
    v_mfma_f32_16x16x32_bf16 v[140:143], v[76:79], v[108:111], v[140:143]
    ds_read_b128 v[92:95], v2 offset:59392
    ds_read_b128 v[108:111], v2 offset:60416
    buffer_load_dwordx4 v[56:59], v1, s[12:15], s30 offen offset:1024 sc1
    buffer_load_dwordx4 v[60:63], v1, s[12:15], s31 offen offset:1024 sc1
    buffer_load_dwordx4 v[64:67], v1, s[12:15], s30 offen offset:2048 sc1
    buffer_load_dwordx4 v[68:71], v1, s[12:15], s31 offen offset:2048 sc1
    s_waitcnt vmcnt(17) lgkmcnt(7)
    v_mfma_f32_16x16x32_bf16 v[112:115], v[16:19], v[80:83], v[112:115]
    s_waitcnt vmcnt(11) lgkmcnt(6)
    v_mfma_f32_16x16x32_bf16 v[112:115], v[24:27], v[96:99], v[112:115]
    v_mfma_f32_16x16x32_bf16 v[128:131], v[20:23], v[80:83], v[128:131]
    s_waitcnt vmcnt(10)
    v_mfma_f32_16x16x32_bf16 v[128:131], v[28:31], v[96:99], v[128:131]
    ds_read_b128 v[80:83], v2 offset:6144
    ds_read_b128 v[96:99], v2 offset:7168
    s_waitcnt lgkmcnt(7)
    v_mfma_f32_16x16x32_bf16 v[116:119], v[16:19], v[84:87], v[116:119]
    s_waitcnt lgkmcnt(6)
    v_mfma_f32_16x16x32_bf16 v[116:119], v[24:27], v[100:103], v[116:119]
    v_mfma_f32_16x16x32_bf16 v[132:135], v[20:23], v[84:87], v[132:135]
    v_mfma_f32_16x16x32_bf16 v[132:135], v[28:31], v[100:103], v[132:135]
    ds_read_b128 v[84:87], v2 offset:24576
    ds_read_b128 v[100:103], v2 offset:25600
    s_waitcnt lgkmcnt(7)
    v_mfma_f32_16x16x32_bf16 v[120:123], v[16:19], v[88:91], v[120:123]
    s_waitcnt lgkmcnt(6)
    v_mfma_f32_16x16x32_bf16 v[120:123], v[24:27], v[104:107], v[120:123]
    v_mfma_f32_16x16x32_bf16 v[136:139], v[20:23], v[88:91], v[136:139]
    v_mfma_f32_16x16x32_bf16 v[136:139], v[28:31], v[104:107], v[136:139]
    ds_read_b128 v[88:91], v2 offset:43008
    ds_read_b128 v[104:107], v2 offset:44032
    s_waitcnt lgkmcnt(7)
    v_mfma_f32_16x16x32_bf16 v[124:127], v[16:19], v[92:95], v[124:127]
    s_waitcnt lgkmcnt(6)
    v_mfma_f32_16x16x32_bf16 v[124:127], v[24:27], v[108:111], v[124:127]
    v_mfma_f32_16x16x32_bf16 v[140:143], v[20:23], v[92:95], v[140:143]
    v_mfma_f32_16x16x32_bf16 v[140:143], v[28:31], v[108:111], v[140:143]
    ds_read_b128 v[92:95], v2 offset:61440
    ds_read_b128 v[108:111], v2 offset:62464
    buffer_load_dwordx4 v[72:75], v1, s[12:15], s30 offen offset:3072 sc1
    buffer_load_dwordx4 v[76:79], v1, s[12:15], s31 offen offset:3072 sc1
    s_add_u32 s30, s23, 0xf52000
    buffer_load_dwordx4 v[16:19], v1, s[12:15], s30 offen offset:0 sc1
    s_add_u32 s31, s23, 0xf56800
    buffer_load_dwordx4 v[20:23], v1, s[12:15], s31 offen offset:0 sc1
    s_waitcnt vmcnt(13) lgkmcnt(7)
    v_mfma_f32_16x16x32_bf16 v[112:115], v[32:35], v[80:83], v[112:115]
    s_waitcnt vmcnt(11) lgkmcnt(6)
    v_mfma_f32_16x16x32_bf16 v[112:115], v[40:43], v[96:99], v[112:115]
    v_mfma_f32_16x16x32_bf16 v[128:131], v[36:39], v[80:83], v[128:131]
    s_waitcnt vmcnt(10)
    v_mfma_f32_16x16x32_bf16 v[128:131], v[44:47], v[96:99], v[128:131]
    ds_read_b128 v[80:83], v2 offset:12288
    ds_read_b128 v[96:99], v2 offset:13312
    s_waitcnt lgkmcnt(7)
    v_mfma_f32_16x16x32_bf16 v[116:119], v[32:35], v[84:87], v[116:119]
    s_waitcnt lgkmcnt(6)
    v_mfma_f32_16x16x32_bf16 v[116:119], v[40:43], v[100:103], v[116:119]
    v_mfma_f32_16x16x32_bf16 v[132:135], v[36:39], v[84:87], v[132:135]
    v_mfma_f32_16x16x32_bf16 v[132:135], v[44:47], v[100:103], v[132:135]
    ds_read_b128 v[84:87], v2 offset:30720
    ds_read_b128 v[100:103], v2 offset:31744
    s_waitcnt lgkmcnt(7)
    v_mfma_f32_16x16x32_bf16 v[120:123], v[32:35], v[88:91], v[120:123]
    s_waitcnt lgkmcnt(6)
    v_mfma_f32_16x16x32_bf16 v[120:123], v[40:43], v[104:107], v[120:123]
    v_mfma_f32_16x16x32_bf16 v[136:139], v[36:39], v[88:91], v[136:139]
    v_mfma_f32_16x16x32_bf16 v[136:139], v[44:47], v[104:107], v[136:139]
    ds_read_b128 v[88:91], v2 offset:49152
    ds_read_b128 v[104:107], v2 offset:50176
    s_waitcnt lgkmcnt(7)
    v_mfma_f32_16x16x32_bf16 v[124:127], v[32:35], v[92:95], v[124:127]
    s_waitcnt lgkmcnt(6)
    v_mfma_f32_16x16x32_bf16 v[124:127], v[40:43], v[108:111], v[124:127]
    v_mfma_f32_16x16x32_bf16 v[140:143], v[36:39], v[92:95], v[140:143]
    v_mfma_f32_16x16x32_bf16 v[140:143], v[44:47], v[108:111], v[140:143]
    ds_read_b128 v[92:95], v8 offset:2048
    ds_read_b128 v[108:111], v8 offset:3072
    buffer_load_dwordx4 v[24:27], v1, s[12:15], s30 offen offset:1024 sc1
    buffer_load_dwordx4 v[28:31], v1, s[12:15], s31 offen offset:1024 sc1
    buffer_load_dwordx4 v[32:35], v1, s[12:15], s30 offen offset:2048 sc1
    buffer_load_dwordx4 v[36:39], v1, s[12:15], s31 offen offset:2048 sc1
    s_waitcnt vmcnt(13) lgkmcnt(7)
    v_mfma_f32_16x16x32_bf16 v[112:115], v[48:51], v[80:83], v[112:115]
    s_waitcnt vmcnt(11) lgkmcnt(6)
    v_mfma_f32_16x16x32_bf16 v[112:115], v[56:59], v[96:99], v[112:115]
    v_mfma_f32_16x16x32_bf16 v[128:131], v[52:55], v[80:83], v[128:131]
    s_waitcnt vmcnt(10)
    v_mfma_f32_16x16x32_bf16 v[128:131], v[60:63], v[96:99], v[128:131]
    ds_read_b128 v[80:83], v2 offset:14336
    ds_read_b128 v[96:99], v2 offset:15360
    s_waitcnt lgkmcnt(7)
    v_mfma_f32_16x16x32_bf16 v[116:119], v[48:51], v[84:87], v[116:119]
    s_waitcnt lgkmcnt(6)
    v_mfma_f32_16x16x32_bf16 v[116:119], v[56:59], v[100:103], v[116:119]
    v_mfma_f32_16x16x32_bf16 v[132:135], v[52:55], v[84:87], v[132:135]
    v_mfma_f32_16x16x32_bf16 v[132:135], v[60:63], v[100:103], v[132:135]
    ds_read_b128 v[84:87], v2 offset:32768
    ds_read_b128 v[100:103], v2 offset:33792
    s_waitcnt lgkmcnt(7)
    v_mfma_f32_16x16x32_bf16 v[120:123], v[48:51], v[88:91], v[120:123]
    s_waitcnt lgkmcnt(6)
    v_mfma_f32_16x16x32_bf16 v[120:123], v[56:59], v[104:107], v[120:123]
    v_mfma_f32_16x16x32_bf16 v[136:139], v[52:55], v[88:91], v[136:139]
    v_mfma_f32_16x16x32_bf16 v[136:139], v[60:63], v[104:107], v[136:139]
    ds_read_b128 v[88:91], v2 offset:51200
    ds_read_b128 v[104:107], v2 offset:52224
    s_waitcnt lgkmcnt(7)
    v_mfma_f32_16x16x32_bf16 v[124:127], v[48:51], v[92:95], v[124:127]
    s_waitcnt lgkmcnt(6)
    v_mfma_f32_16x16x32_bf16 v[124:127], v[56:59], v[108:111], v[124:127]
    v_mfma_f32_16x16x32_bf16 v[140:143], v[52:55], v[92:95], v[140:143]
    v_mfma_f32_16x16x32_bf16 v[140:143], v[60:63], v[108:111], v[140:143]
    ds_read_b128 v[92:95], v8 offset:4096
    ds_read_b128 v[108:111], v8 offset:5120
    buffer_load_dwordx4 v[40:43], v1, s[12:15], s30 offen offset:3072 sc1
    buffer_load_dwordx4 v[44:47], v1, s[12:15], s31 offen offset:3072 sc1
    s_lshr_b32 s33, s38, 1
    s_add_u32 s33, s33, 16
    s_and_b32 s34, s38, 1
    s_add_u32 s33, s33, s42
    s_sub_u32 s35, s33, 18
    s_cselect_b32 s33, s33, s35
    s_lshl_b32 s33, s33, 1
    s_add_u32 s33, s33, s34
    s_mul_i32 s23, s33, 18432
    s_add_u32 s23, s23, s41
    s_lshl_b32 s33, s33, 10
    s_add_u32 s67, s33, s40
    s_add_u32 s30, s23, 0xf54000
    buffer_load_dwordx4 v[48:51], v1, s[12:15], s30 offen offset:0 sc1
    s_waitcnt vmcnt(12) lgkmcnt(7)
    v_mfma_f32_16x16x32_bf16 v[112:115], v[64:67], v[80:83], v[112:115]
    s_waitcnt vmcnt(10) lgkmcnt(6)
    v_mfma_f32_16x16x32_bf16 v[112:115], v[72:75], v[96:99], v[112:115]
    v_mfma_f32_16x16x32_bf16 v[128:131], v[68:71], v[80:83], v[128:131]
    s_waitcnt vmcnt(9)
    v_mfma_f32_16x16x32_bf16 v[128:131], v[76:79], v[96:99], v[128:131]
    ds_read_b128 v[80:83], v2 offset:8192
    ds_read_b128 v[96:99], v2 offset:9216
    s_waitcnt lgkmcnt(7)
    v_mfma_f32_16x16x32_bf16 v[116:119], v[64:67], v[84:87], v[116:119]
    s_waitcnt lgkmcnt(6)
    v_mfma_f32_16x16x32_bf16 v[116:119], v[72:75], v[100:103], v[116:119]
    v_mfma_f32_16x16x32_bf16 v[132:135], v[68:71], v[84:87], v[132:135]
    v_mfma_f32_16x16x32_bf16 v[132:135], v[76:79], v[100:103], v[132:135]
    ds_read_b128 v[84:87], v2 offset:26624
    ds_read_b128 v[100:103], v2 offset:27648
    s_waitcnt lgkmcnt(7)
    v_mfma_f32_16x16x32_bf16 v[120:123], v[64:67], v[88:91], v[120:123]
    s_waitcnt lgkmcnt(6)
    v_mfma_f32_16x16x32_bf16 v[120:123], v[72:75], v[104:107], v[120:123]
    v_mfma_f32_16x16x32_bf16 v[136:139], v[68:71], v[88:91], v[136:139]
    v_mfma_f32_16x16x32_bf16 v[136:139], v[76:79], v[104:107], v[136:139]
    ds_read_b128 v[88:91], v2 offset:45056
    ds_read_b128 v[104:107], v2 offset:46080
    s_waitcnt lgkmcnt(7)
    v_mfma_f32_16x16x32_bf16 v[124:127], v[64:67], v[92:95], v[124:127]
    s_waitcnt lgkmcnt(6)
    v_mfma_f32_16x16x32_bf16 v[124:127], v[72:75], v[108:111], v[124:127]
    v_mfma_f32_16x16x32_bf16 v[140:143], v[68:71], v[92:95], v[140:143]
    v_mfma_f32_16x16x32_bf16 v[140:143], v[76:79], v[108:111], v[140:143]
    ds_read_b128 v[92:95], v2 offset:63488
    ds_read_b128 v[108:111], v2 offset:64512
    buffer_load_dwordx4 v[56:59], v1, s[12:15], s30 offen offset:1024 sc1
    s_add_u32 s30, s23, 0xf50000
    buffer_load_dwordx4 v[64:67], v1, s[12:15], s30 offen offset:0 sc1
    s_waitcnt vmcnt(10) lgkmcnt(7)
    v_mfma_f32_16x16x32_bf16 v[112:115], v[16:19], v[80:83], v[112:115]
    s_waitcnt vmcnt(8) lgkmcnt(6)
    v_mfma_f32_16x16x32_bf16 v[112:115], v[24:27], v[96:99], v[112:115]
    v_mfma_f32_16x16x32_bf16 v[128:131], v[20:23], v[80:83], v[128:131]
    s_waitcnt vmcnt(7)
    v_mfma_f32_16x16x32_bf16 v[128:131], v[28:31], v[96:99], v[128:131]
    ds_read_b128 v[80:83], v2 offset:10240
    ds_read_b128 v[96:99], v2 offset:11264
    s_waitcnt lgkmcnt(7)
    v_mfma_f32_16x16x32_bf16 v[116:119], v[16:19], v[84:87], v[116:119]
    s_waitcnt lgkmcnt(6)
    v_mfma_f32_16x16x32_bf16 v[116:119], v[24:27], v[100:103], v[116:119]
    v_mfma_f32_16x16x32_bf16 v[132:135], v[20:23], v[84:87], v[132:135]
    v_mfma_f32_16x16x32_bf16 v[132:135], v[28:31], v[100:103], v[132:135]
    ds_read_b128 v[84:87], v2 offset:28672
    ds_read_b128 v[100:103], v2 offset:29696
    s_waitcnt lgkmcnt(7)
    v_mfma_f32_16x16x32_bf16 v[120:123], v[16:19], v[88:91], v[120:123]
    s_waitcnt lgkmcnt(6)
    v_mfma_f32_16x16x32_bf16 v[120:123], v[24:27], v[104:107], v[120:123]
    v_mfma_f32_16x16x32_bf16 v[136:139], v[20:23], v[88:91], v[136:139]
    v_mfma_f32_16x16x32_bf16 v[136:139], v[28:31], v[104:107], v[136:139]
    ds_read_b128 v[88:91], v2 offset:47104
    ds_read_b128 v[104:107], v2 offset:48128
    s_waitcnt lgkmcnt(7)
    v_mfma_f32_16x16x32_bf16 v[124:127], v[16:19], v[92:95], v[124:127]
    s_waitcnt lgkmcnt(6)
    v_mfma_f32_16x16x32_bf16 v[124:127], v[24:27], v[108:111], v[124:127]
    v_mfma_f32_16x16x32_bf16 v[140:143], v[20:23], v[92:95], v[140:143]
    v_mfma_f32_16x16x32_bf16 v[140:143], v[28:31], v[108:111], v[140:143]
    ds_read_b128 v[92:95], v8 offset:0
    ds_read_b128 v[108:111], v8 offset:1024
    buffer_load_dwordx4 v[72:75], v1, s[12:15], s30 offen offset:1024 sc1
    buffer_load_dwordx4 v[16:19], v1, s[12:15], s30 offen offset:2048 sc1
    s_waitcnt vmcnt(8) lgkmcnt(7)
    v_mfma_f32_16x16x32_bf16 v[112:115], v[32:35], v[80:83], v[112:115]
    s_waitcnt vmcnt(6) lgkmcnt(6)
    v_mfma_f32_16x16x32_bf16 v[112:115], v[40:43], v[96:99], v[112:115]
    v_mfma_f32_16x16x32_bf16 v[128:131], v[36:39], v[80:83], v[128:131]
    s_waitcnt vmcnt(5)
    v_mfma_f32_16x16x32_bf16 v[128:131], v[44:47], v[96:99], v[128:131]
    ds_read_b128 v[80:83], v2 offset:16384
    ds_read_b128 v[96:99], v2 offset:17408
    s_waitcnt lgkmcnt(7)
    v_mfma_f32_16x16x32_bf16 v[116:119], v[32:35], v[84:87], v[116:119]
    s_waitcnt lgkmcnt(6)
    v_mfma_f32_16x16x32_bf16 v[116:119], v[40:43], v[100:103], v[116:119]
    v_mfma_f32_16x16x32_bf16 v[132:135], v[36:39], v[84:87], v[132:135]
    v_mfma_f32_16x16x32_bf16 v[132:135], v[44:47], v[100:103], v[132:135]
    ds_read_b128 v[84:87], v2 offset:34816
    ds_read_b128 v[100:103], v2 offset:35840
    s_waitcnt lgkmcnt(7)
    v_mfma_f32_16x16x32_bf16 v[120:123], v[32:35], v[88:91], v[120:123]
    s_waitcnt lgkmcnt(6)
    v_mfma_f32_16x16x32_bf16 v[120:123], v[40:43], v[104:107], v[120:123]
    v_mfma_f32_16x16x32_bf16 v[136:139], v[36:39], v[88:91], v[136:139]
    v_mfma_f32_16x16x32_bf16 v[136:139], v[44:47], v[104:107], v[136:139]
    ds_read_b128 v[88:91], v2 offset:53248
    ds_read_b128 v[104:107], v2 offset:54272
    s_waitcnt lgkmcnt(7)
    v_mfma_f32_16x16x32_bf16 v[124:127], v[32:35], v[92:95], v[124:127]
    s_waitcnt lgkmcnt(6)
    v_mfma_f32_16x16x32_bf16 v[124:127], v[40:43], v[108:111], v[124:127]
    v_mfma_f32_16x16x32_bf16 v[140:143], v[36:39], v[92:95], v[140:143]
    v_mfma_f32_16x16x32_bf16 v[140:143], v[44:47], v[108:111], v[140:143]
    ds_read_b128 v[92:95], v8 offset:6144
    ds_read_b128 v[108:111], v8 offset:7168
    buffer_load_dwordx4 v[24:27], v1, s[12:15], s30 offen offset:3072 sc1
    s_add_u32 s30, s23, 0xf51000
    buffer_load_dwordx4 v[32:35], v1, s[12:15], s30 offen offset:0 sc1
    v_cvt_pk_bf16_f32 v220, v112, v113
    v_cvt_pk_bf16_f32 v221, v114, v115
    v_cvt_pk_bf16_f32 v222, v116, v117
    v_cvt_pk_bf16_f32 v223, v118, v119
    s_add_u32 s34, s66, 0
    buffer_store_dwordx4 v[220:223], v1, s[12:15], s34 offen offset:0 sc1
    v_cvt_pk_bf16_f32 v224, v120, v121
    v_cvt_pk_bf16_f32 v225, v122, v123
    v_cvt_pk_bf16_f32 v226, v124, v125
    v_cvt_pk_bf16_f32 v227, v126, v127
    s_add_u32 s34, s66, 36864
    buffer_store_dwordx4 v[224:227], v1, s[12:15], s34 offen offset:0 sc1
    v_cvt_pk_bf16_f32 v220, v128, v129
    v_cvt_pk_bf16_f32 v221, v130, v131
    v_cvt_pk_bf16_f32 v222, v132, v133
    v_cvt_pk_bf16_f32 v223, v134, v135
    s_add_u32 s34, s66, 0
    buffer_store_dwordx4 v[220:223], v1, s[12:15], s34 offen offset:1024 sc1
    v_cvt_pk_bf16_f32 v224, v136, v137
    v_cvt_pk_bf16_f32 v225, v138, v139
    v_cvt_pk_bf16_f32 v226, v140, v141
    v_cvt_pk_bf16_f32 v227, v142, v143
    s_add_u32 s34, s66, 36864
    buffer_store_dwordx4 v[224:227], v1, s[12:15], s34 offen offset:1024 sc1
    s_cmp_ge_u32 s2, 223
    s_cbranch_scc1 fused_kernel_r0_opt
    s_waitcnt vmcnt(4) lgkmcnt(0)
    s_branch fused_kernel_e0start
fused_kernel_r0_opt:
    s_waitcnt vmcnt(10) lgkmcnt(7)
    v_mfma_f32_16x16x32_bf16 v[176:179], v[48:51], v[80:83], 0
    s_waitcnt vmcnt(9) lgkmcnt(6)
    v_mfma_f32_16x16x32_bf16 v[176:179], v[56:59], v[96:99], v[176:179]
    ds_read_b128 v[80:83], v2 offset:0
    ds_read_b128 v[96:99], v2 offset:1024
    s_waitcnt lgkmcnt(7)
    v_mfma_f32_16x16x32_bf16 v[180:183], v[48:51], v[84:87], 0
    s_waitcnt lgkmcnt(6)
    v_mfma_f32_16x16x32_bf16 v[180:183], v[56:59], v[100:103], v[180:183]
    ds_read_b128 v[84:87], v2 offset:18432
    ds_read_b128 v[100:103], v2 offset:19456
    s_waitcnt lgkmcnt(7)
    v_mfma_f32_16x16x32_bf16 v[184:187], v[48:51], v[88:91], 0
    s_waitcnt lgkmcnt(6)
    v_mfma_f32_16x16x32_bf16 v[184:187], v[56:59], v[104:107], v[184:187]
    ds_read_b128 v[88:91], v2 offset:36864
    ds_read_b128 v[104:107], v2 offset:37888
    s_waitcnt lgkmcnt(7)
    v_mfma_f32_16x16x32_bf16 v[188:191], v[48:51], v[92:95], 0
    s_waitcnt lgkmcnt(6)
    v_mfma_f32_16x16x32_bf16 v[188:191], v[56:59], v[108:111], v[188:191]
    ds_read_b128 v[92:95], v2 offset:55296
    ds_read_b128 v[108:111], v2 offset:56320
    buffer_load_dwordx4 v[40:43], v1, s[12:15], s30 offen offset:1024 sc1
    buffer_load_dwordx4 v[48:51], v1, s[12:15], s30 offen offset:2048 sc1
    s_waitcnt vmcnt(10) lgkmcnt(7)
    v_mfma_f32_16x16x32_bf16 v[176:179], v[64:67], v[80:83], v[176:179]
    s_waitcnt vmcnt(9) lgkmcnt(6)
    v_mfma_f32_16x16x32_bf16 v[176:179], v[72:75], v[96:99], v[176:179]
    ds_read_b128 v[80:83], v2 offset:2048
    ds_read_b128 v[96:99], v2 offset:3072
    s_waitcnt lgkmcnt(7)
    v_mfma_f32_16x16x32_bf16 v[180:183], v[64:67], v[84:87], v[180:183]
    s_waitcnt lgkmcnt(6)
    v_mfma_f32_16x16x32_bf16 v[180:183], v[72:75], v[100:103], v[180:183]
    ds_read_b128 v[84:87], v2 offset:20480
    ds_read_b128 v[100:103], v2 offset:21504
    s_waitcnt lgkmcnt(7)
    v_mfma_f32_16x16x32_bf16 v[184:187], v[64:67], v[88:91], v[184:187]
    s_waitcnt lgkmcnt(6)
    v_mfma_f32_16x16x32_bf16 v[184:187], v[72:75], v[104:107], v[184:187]
    ds_read_b128 v[88:91], v2 offset:38912
    ds_read_b128 v[104:107], v2 offset:39936
    s_waitcnt lgkmcnt(7)
    v_mfma_f32_16x16x32_bf16 v[188:191], v[64:67], v[92:95], v[188:191]
    s_waitcnt lgkmcnt(6)
    v_mfma_f32_16x16x32_bf16 v[188:191], v[72:75], v[108:111], v[188:191]
    ds_read_b128 v[92:95], v2 offset:57344
    ds_read_b128 v[108:111], v2 offset:58368
    buffer_load_dwordx4 v[56:59], v1, s[12:15], s30 offen offset:3072 sc1
    s_add_u32 s30, s23, 0xf53000
    buffer_load_dwordx4 v[64:67], v1, s[12:15], s30 offen offset:0 sc1
    s_waitcnt vmcnt(10) lgkmcnt(7)
    v_mfma_f32_16x16x32_bf16 v[176:179], v[16:19], v[80:83], v[176:179]
    s_waitcnt vmcnt(9) lgkmcnt(6)
    v_mfma_f32_16x16x32_bf16 v[176:179], v[24:27], v[96:99], v[176:179]
    ds_read_b128 v[80:83], v2 offset:4096
    ds_read_b128 v[96:99], v2 offset:5120
    s_waitcnt lgkmcnt(7)
    v_mfma_f32_16x16x32_bf16 v[180:183], v[16:19], v[84:87], v[180:183]
    s_waitcnt lgkmcnt(6)
    v_mfma_f32_16x16x32_bf16 v[180:183], v[24:27], v[100:103], v[180:183]
    ds_read_b128 v[84:87], v2 offset:22528
    ds_read_b128 v[100:103], v2 offset:23552
    s_waitcnt lgkmcnt(7)
    v_mfma_f32_16x16x32_bf16 v[184:187], v[16:19], v[88:91], v[184:187]
    s_waitcnt lgkmcnt(6)
    v_mfma_f32_16x16x32_bf16 v[184:187], v[24:27], v[104:107], v[184:187]
    ds_read_b128 v[88:91], v2 offset:40960
    ds_read_b128 v[104:107], v2 offset:41984
    s_waitcnt lgkmcnt(7)
    v_mfma_f32_16x16x32_bf16 v[188:191], v[16:19], v[92:95], v[188:191]
    s_waitcnt lgkmcnt(6)
    v_mfma_f32_16x16x32_bf16 v[188:191], v[24:27], v[108:111], v[188:191]
    ds_read_b128 v[92:95], v2 offset:59392
    ds_read_b128 v[108:111], v2 offset:60416
    buffer_load_dwordx4 v[72:75], v1, s[12:15], s30 offen offset:1024 sc1
    buffer_load_dwordx4 v[16:19], v1, s[12:15], s30 offen offset:2048 sc1
    s_waitcnt vmcnt(10) lgkmcnt(7)
    v_mfma_f32_16x16x32_bf16 v[176:179], v[32:35], v[80:83], v[176:179]
    s_waitcnt vmcnt(5) lgkmcnt(6)
    v_mfma_f32_16x16x32_bf16 v[176:179], v[40:43], v[96:99], v[176:179]
    ds_read_b128 v[80:83], v2 offset:6144
    ds_read_b128 v[96:99], v2 offset:7168
    s_waitcnt lgkmcnt(7)
    v_mfma_f32_16x16x32_bf16 v[180:183], v[32:35], v[84:87], v[180:183]
    s_waitcnt lgkmcnt(6)
    v_mfma_f32_16x16x32_bf16 v[180:183], v[40:43], v[100:103], v[180:183]
    ds_read_b128 v[84:87], v2 offset:24576
    ds_read_b128 v[100:103], v2 offset:25600
    s_waitcnt lgkmcnt(7)
    v_mfma_f32_16x16x32_bf16 v[184:187], v[32:35], v[88:91], v[184:187]
    s_waitcnt lgkmcnt(6)
    v_mfma_f32_16x16x32_bf16 v[184:187], v[40:43], v[104:107], v[184:187]
    ds_read_b128 v[88:91], v2 offset:43008
    ds_read_b128 v[104:107], v2 offset:44032
    s_waitcnt lgkmcnt(7)
    v_mfma_f32_16x16x32_bf16 v[188:191], v[32:35], v[92:95], v[188:191]
    s_waitcnt lgkmcnt(6)
    v_mfma_f32_16x16x32_bf16 v[188:191], v[40:43], v[108:111], v[188:191]
    ds_read_b128 v[92:95], v2 offset:61440
    ds_read_b128 v[108:111], v2 offset:62464
    buffer_load_dwordx4 v[24:27], v1, s[12:15], s30 offen offset:3072 sc1
    s_add_u32 s30, s23, 0xf52000
    buffer_load_dwordx4 v[32:35], v1, s[12:15], s30 offen offset:0 sc1
    s_waitcnt vmcnt(6) lgkmcnt(7)
    v_mfma_f32_16x16x32_bf16 v[176:179], v[48:51], v[80:83], v[176:179]
    s_waitcnt vmcnt(5) lgkmcnt(6)
    v_mfma_f32_16x16x32_bf16 v[176:179], v[56:59], v[96:99], v[176:179]
    ds_read_b128 v[80:83], v2 offset:12288
    ds_read_b128 v[96:99], v2 offset:13312
    s_waitcnt lgkmcnt(7)
    v_mfma_f32_16x16x32_bf16 v[180:183], v[48:51], v[84:87], v[180:183]
    s_waitcnt lgkmcnt(6)
    v_mfma_f32_16x16x32_bf16 v[180:183], v[56:59], v[100:103], v[180:183]
    ds_read_b128 v[84:87], v2 offset:30720
    ds_read_b128 v[100:103], v2 offset:31744
    s_waitcnt lgkmcnt(7)
    v_mfma_f32_16x16x32_bf16 v[184:187], v[48:51], v[88:91], v[184:187]
    s_waitcnt lgkmcnt(6)
    v_mfma_f32_16x16x32_bf16 v[184:187], v[56:59], v[104:107], v[184:187]
    ds_read_b128 v[88:91], v2 offset:49152
    ds_read_b128 v[104:107], v2 offset:50176
    s_waitcnt lgkmcnt(7)
    v_mfma_f32_16x16x32_bf16 v[188:191], v[48:51], v[92:95], v[188:191]
    s_waitcnt lgkmcnt(6)
    v_mfma_f32_16x16x32_bf16 v[188:191], v[56:59], v[108:111], v[188:191]
    ds_read_b128 v[92:95], v8 offset:2048
    ds_read_b128 v[108:111], v8 offset:3072
    buffer_load_dwordx4 v[40:43], v1, s[12:15], s30 offen offset:1024 sc1
    buffer_load_dwordx4 v[48:51], v1, s[12:15], s30 offen offset:2048 sc1
    s_waitcnt vmcnt(6) lgkmcnt(7)
    v_mfma_f32_16x16x32_bf16 v[176:179], v[64:67], v[80:83], v[176:179]
    s_waitcnt vmcnt(5) lgkmcnt(6)
    v_mfma_f32_16x16x32_bf16 v[176:179], v[72:75], v[96:99], v[176:179]
    ds_read_b128 v[80:83], v2 offset:14336
    ds_read_b128 v[96:99], v2 offset:15360
    s_waitcnt lgkmcnt(7)
    v_mfma_f32_16x16x32_bf16 v[180:183], v[64:67], v[84:87], v[180:183]
    s_waitcnt lgkmcnt(6)
    v_mfma_f32_16x16x32_bf16 v[180:183], v[72:75], v[100:103], v[180:183]
    ds_read_b128 v[84:87], v2 offset:32768
    ds_read_b128 v[100:103], v2 offset:33792
    s_waitcnt lgkmcnt(7)
    v_mfma_f32_16x16x32_bf16 v[184:187], v[64:67], v[88:91], v[184:187]
    s_waitcnt lgkmcnt(6)
    v_mfma_f32_16x16x32_bf16 v[184:187], v[72:75], v[104:107], v[184:187]
    ds_read_b128 v[88:91], v2 offset:51200
    ds_read_b128 v[104:107], v2 offset:52224
    s_waitcnt lgkmcnt(7)
    v_mfma_f32_16x16x32_bf16 v[188:191], v[64:67], v[92:95], v[188:191]
    s_waitcnt lgkmcnt(6)
    v_mfma_f32_16x16x32_bf16 v[188:191], v[72:75], v[108:111], v[188:191]
    ds_read_b128 v[92:95], v8 offset:4096
    ds_read_b128 v[108:111], v8 offset:5120
    buffer_load_dwordx4 v[56:59], v1, s[12:15], s30 offen offset:3072 sc1
    s_waitcnt vmcnt(5) lgkmcnt(7)
    v_mfma_f32_16x16x32_bf16 v[176:179], v[16:19], v[80:83], v[176:179]
    s_waitcnt vmcnt(4) lgkmcnt(6)
    v_mfma_f32_16x16x32_bf16 v[176:179], v[24:27], v[96:99], v[176:179]
    ds_read_b128 v[80:83], v2 offset:8192
    ds_read_b128 v[96:99], v2 offset:9216
    s_waitcnt lgkmcnt(7)
    v_mfma_f32_16x16x32_bf16 v[180:183], v[16:19], v[84:87], v[180:183]
    s_waitcnt lgkmcnt(6)
    v_mfma_f32_16x16x32_bf16 v[180:183], v[24:27], v[100:103], v[180:183]
    ds_read_b128 v[84:87], v2 offset:26624
    ds_read_b128 v[100:103], v2 offset:27648
    s_waitcnt lgkmcnt(7)
    v_mfma_f32_16x16x32_bf16 v[184:187], v[16:19], v[88:91], v[184:187]
    s_waitcnt lgkmcnt(6)
    v_mfma_f32_16x16x32_bf16 v[184:187], v[24:27], v[104:107], v[184:187]
    ds_read_b128 v[88:91], v2 offset:45056
    ds_read_b128 v[104:107], v2 offset:46080
    s_waitcnt lgkmcnt(7)
    v_mfma_f32_16x16x32_bf16 v[188:191], v[16:19], v[92:95], v[188:191]
    s_waitcnt lgkmcnt(6)
    v_mfma_f32_16x16x32_bf16 v[188:191], v[24:27], v[108:111], v[188:191]
    ds_read_b128 v[92:95], v2 offset:63488
    ds_read_b128 v[108:111], v2 offset:64512
    s_waitcnt vmcnt(3) lgkmcnt(7)
    v_mfma_f32_16x16x32_bf16 v[176:179], v[32:35], v[80:83], v[176:179]
    s_waitcnt vmcnt(2) lgkmcnt(6)
    v_mfma_f32_16x16x32_bf16 v[176:179], v[40:43], v[96:99], v[176:179]
    ds_read_b128 v[80:83], v2 offset:10240
    ds_read_b128 v[96:99], v2 offset:11264
    s_waitcnt lgkmcnt(7)
    v_mfma_f32_16x16x32_bf16 v[180:183], v[32:35], v[84:87], v[180:183]
    s_waitcnt lgkmcnt(6)
    v_mfma_f32_16x16x32_bf16 v[180:183], v[40:43], v[100:103], v[180:183]
    ds_read_b128 v[84:87], v2 offset:28672
    ds_read_b128 v[100:103], v2 offset:29696
    s_waitcnt lgkmcnt(7)
    v_mfma_f32_16x16x32_bf16 v[184:187], v[32:35], v[88:91], v[184:187]
    s_waitcnt lgkmcnt(6)
    v_mfma_f32_16x16x32_bf16 v[184:187], v[40:43], v[104:107], v[184:187]
    ds_read_b128 v[88:91], v2 offset:47104
    ds_read_b128 v[104:107], v2 offset:48128
    s_waitcnt lgkmcnt(7)
    v_mfma_f32_16x16x32_bf16 v[188:191], v[32:35], v[92:95], v[188:191]
    s_waitcnt lgkmcnt(6)
    v_mfma_f32_16x16x32_bf16 v[188:191], v[40:43], v[108:111], v[188:191]
    ds_read_b128 v[92:95], v8 offset:0
    ds_read_b128 v[108:111], v8 offset:1024
    s_waitcnt vmcnt(1) lgkmcnt(7)
    v_mfma_f32_16x16x32_bf16 v[176:179], v[48:51], v[80:83], v[176:179]
    s_waitcnt vmcnt(0) lgkmcnt(6)
    v_mfma_f32_16x16x32_bf16 v[176:179], v[56:59], v[96:99], v[176:179]
    s_waitcnt lgkmcnt(5)
    v_mfma_f32_16x16x32_bf16 v[180:183], v[48:51], v[84:87], v[180:183]
    s_waitcnt lgkmcnt(4)
    v_mfma_f32_16x16x32_bf16 v[180:183], v[56:59], v[100:103], v[180:183]
    s_waitcnt lgkmcnt(3)
    v_mfma_f32_16x16x32_bf16 v[184:187], v[48:51], v[88:91], v[184:187]
    s_waitcnt lgkmcnt(2)
    v_mfma_f32_16x16x32_bf16 v[184:187], v[56:59], v[104:107], v[184:187]
    s_waitcnt lgkmcnt(1)
    v_mfma_f32_16x16x32_bf16 v[188:191], v[48:51], v[92:95], v[188:191]
    s_waitcnt lgkmcnt(0)
    v_mfma_f32_16x16x32_bf16 v[188:191], v[56:59], v[108:111], v[188:191]
    v_cvt_pk_bf16_f32 v220, v176, v177
    v_cvt_pk_bf16_f32 v221, v178, v179
    v_cvt_pk_bf16_f32 v222, v180, v181
    v_cvt_pk_bf16_f32 v223, v182, v183
    s_add_u32 s34, s67, 0
    buffer_store_dwordx4 v[220:223], v1, s[12:15], s34 offen offset:0 sc1
    v_cvt_pk_bf16_f32 v224, v184, v185
    v_cvt_pk_bf16_f32 v225, v186, v187
    v_cvt_pk_bf16_f32 v226, v188, v189
    v_cvt_pk_bf16_f32 v227, v190, v191
    s_add_u32 s34, s67, 36864
    buffer_store_dwordx4 v[224:227], v1, s[12:15], s34 offen offset:0 sc1
fused_kernel_e0start:
    s_load_dwordx2 s[40:41], s[0:1], 0
    s_load_dwordx4 s[44:47], s[0:1], 56
    s_load_dwordx2 s[42:43], s[0:1], 72
    s_mov_b32 s64, 7456541
    s_movk_i32 s65, 576
    s_mov_b32 s66, 0x3ae38e39
    v_lshrrev_b32 v200, 4, v1
    v_and_b32 v220, 15, v200
    v_lshrrev_b32 v221, 4, v200
    s_lshr_b32 s68, s20, 1
    s_mul_i32 s68, s68, 9
    s_add_u32 s69, s68, 8
    s_add_u32 s68, s68, s22
    s_and_b32 s70, s20, 1
    s_lshl_b32 s71, s21, 1
    s_add_u32 s70, s70, s71
    v_bfe_u32 v222, v200, 2, 4
    v_lshlrev_b32 v222, 6, v222
    v_and_b32 v201, 3, v200
    v_lshl_add_u32 v222, v201, 3, v222
    v_and_b32 v201, 1, v221
    v_lshl_add_u32 v222, v201, 5, v222
    v_add_u32 v222, 0x0, v222
    v_xor_b32 v223, 32, v222
    v_and_b32 v224, 3, v220
    v_bfe_u32 v201, v220, 2, 1
    v_lshl_add_u32 v224, v201, 4, v224
    v_bfe_u32 v201, v220, 3, 1
    v_lshl_add_u32 v224, v201, 2, v224
    s_mov_b32 s71, 36864
    v_mul_lo_u32 v224, v224, s71
    v_lshl_add_u32 v224, v221, 3, v224
    v_add_u32 v225, 294912, v224
    v_lshlrev_b32 v226, 3, v221
    s_lshr_b32 s72, s70, 1
    s_and_b32 s73, s70, 1
    s_lshl_b32 s73, s73, 10
    s_add_u32 s72, s72, s73
    s_mul_i32 s72, s72, 1152
    s_lshl_b32 s73, s68, 5
    s_lshl_b32 s75, s69, 5
    s_add_u32 s74, s72, s75
    s_and_b32 s78, s22, 1
    s_mul_i32 s76, s78, 294912
    s_add_u32 s74, s74, s76
    s_add_u32 s72, s72, s73
    s_mul_i32 s76, s70, 36
    s_add_u32 s77, s76, s69
    s_add_u32 s76, s76, s68
    s_lshl_b32 s76, s76, 10
    s_add_u32 s76, s76, 0x1460000
    s_lshl_b32 s77, s77, 10
    s_lshl_b32 s78, s78, 3
    s_add_u32 s77, s77, s78
    s_add_u32 s77, s77, 0x1460000
    v_lshrrev_b32 v240, 6, v1
    v_bfe_u32 v241, v1, 8, 1
    v_lshlrev_b32 v241, 5, v241
    v_and_b32 v242, 48, v1
    v_xor_b32 v241, v241, v242
    v_lshl_add_u32 v240, v240, 12, v241
    s_and_b32 s83, s70, 1
    s_lshl_b32 s83, s83, 11
    s_lshl_b32 s84, s21, 6
    s_add_u32 s83, s83, s84
    s_lshl_b32 s84, s22, 16
    s_add_u32 s83, s83, s84
    s_add_u32 s83, s83, 0x700000
    s_lshl_b32 s84, s22, 10
    s_add_u32 s84, s84, 0x0
    v_add_u32 v241, s84, v1
    s_cmp_lg_u32 s22, 0
    s_cbranch_scc1 fused_kernel_e0_fok
    s_mov_b32 s85, 0xa22000
    v_lshlrev_b32 v252, 1, v1
    s_mov_b32 exec_lo, 0xffffffff
    s_mov_b32 exec_hi, 0xffffffff
    s_mov_b32 s35, 100000
fused_kernel_e0_ea_l:
    s_sub_u32 s35, s35, 1
    s_cbranch_scc1 fused_kernel_e0_ea_ok
    buffer_load_dwordx4 v[244:247], v252, s[12:15], s85 offen offset:0 sc1
    buffer_load_dwordx4 v[248:251], v252, s[12:15], s85 offen offset:16 sc1
    v_mov_b32 v13, s99
    s_waitcnt vmcnt(0)
    v_subrev_co_u32 v244, vcc, s98, v244
    s_nop 1
    v_subb_co_u32 v245, vcc, v245, v13, vcc
    v_lshrrev_b32 v244, 12, v244
    v_or_b32 v244, v244, v245
    v_subrev_co_u32 v246, vcc, s98, v246
    s_nop 1
    v_subb_co_u32 v247, vcc, v247, v13, vcc
    v_lshrrev_b32 v246, 12, v246
    v_or_b32 v246, v246, v247
    v_or_b32 v244, v244, v246
    v_subrev_co_u32 v248, vcc, s98, v248
    s_nop 1
    v_subb_co_u32 v249, vcc, v249, v13, vcc
    v_lshrrev_b32 v248, 12, v248
    v_or_b32 v248, v248, v249
    v_or_b32 v244, v244, v248
    v_subrev_co_u32 v250, vcc, s98, v250
    s_nop 1
    v_subb_co_u32 v251, vcc, v251, v13, vcc
    v_lshrrev_b32 v250, 12, v250
    v_or_b32 v250, v250, v251
    v_or_b32 v244, v244, v250
    v_cmp_ne_u32 vcc, 0, v244
    s_nop 1
    s_cmp_eq_u64 vcc, 0
    s_cbranch_scc1 fused_kernel_e0_ea_ok
    s_sleep 32
    s_branch fused_kernel_e0_ea_l
fused_kernel_e0_ea_ok:
    s_mov_b64 exec, -1
    s_add_u32 s85, s85, 2048
    v_lshrrev_b32 v252, 1, v1
    s_mov_b32 exec_lo, 0xffffffff
    s_mov_b32 exec_hi, 0x1
    s_mov_b32 s35, 100000
fused_kernel_e0_eb_l:
    s_sub_u32 s35, s35, 1
    s_cbranch_scc1 fused_kernel_e0_eb_ok
    buffer_load_dwordx2 v[244:245], v252, s[12:15], s85 offen sc1
    v_mov_b32 v13, s99
    s_waitcnt vmcnt(0)
    v_subrev_co_u32 v244, vcc, s98, v244
    s_nop 1
    v_subb_co_u32 v245, vcc, v245, v13, vcc
    v_lshrrev_b32 v244, 12, v244
    v_or_b32 v244, v244, v245
    v_cmp_ne_u32 vcc, 0, v244
    s_nop 1
    s_cmp_eq_u64 vcc, 0
    s_cbranch_scc1 fused_kernel_e0_eb_ok
    s_sleep 32
    s_branch fused_kernel_e0_eb_l
fused_kernel_e0_eb_ok:
    s_mov_b64 exec, -1
    v_mov_b32 v12, 149820
    v_mov_b32 v13, 1
    ds_write_b32 v12, v13
    s_branch fused_kernel_e0_fok
fused_kernel_e0_ffail:
    v_mov_b32 v12, 149820
    v_mov_b32 v13, 2
    ds_write_b32 v12, v13
fused_kernel_e0_fok:
    s_lshl_b32 s67, s68, 4
    v_add_u32 v200, s67, v220
    v_lshlrev_b32 v208, 4, v200
    v_mul_hi_u32 v209, v208, s64
    v_mul_u32_u24 v209, s65, v209
    v_sub_u32 v208, v208, v209
    v_cvt_f32_u32 v208, v208
    v_mul_f32 v205, s66, v208
    v_lshlrev_b32 v210, 1, v221
    v_add_u32 v208, 0, v210
    v_mul_u32_u24 v208, v208, v200
    v_mul_hi_u32 v209, v208, s64
    v_mul_u32_u24 v209, s65, v209
    v_sub_u32 v208, v208, v209
    v_cvt_f32_u32 v208, v208
    v_mul_f32 v201, s66, v208
    v_add_u32 v208, 1, v210
    v_mul_u32_u24 v208, v208, v200
    v_mul_hi_u32 v209, v208, s64
    v_mul_u32_u24 v209, s65, v209
    v_sub_u32 v208, v208, v209
    v_cvt_f32_u32 v208, v208
    v_mul_f32 v202, s66, v208
    v_add_u32 v208, 8, v210
    v_mul_u32_u24 v208, v208, v200
    v_mul_hi_u32 v209, v208, s64
    v_mul_u32_u24 v209, s65, v209
    v_sub_u32 v208, v208, v209
    v_cvt_f32_u32 v208, v208
    v_mul_f32 v203, s66, v208
    v_add_u32 v208, 9, v210
    v_mul_u32_u24 v208, v208, v200
    v_mul_hi_u32 v209, v208, s64
    v_mul_u32_u24 v209, s65, v209
    v_sub_u32 v208, v208, v209
    v_cvt_f32_u32 v208, v208
    v_mul_f32 v204, s66, v208
    v_and_b32 v206, 1, v200
    v_lshlrev_b32 v206, 4, v206
    v_add_u32 v208, 1, v200
    v_bfe_u32 v208, v208, 1, 1
    v_lshlrev_b32 v208, 31, v208
    v_bfe_u32 v209, v200, 1, 1
    v_lshl_or_b32 v207, v209, 15, v208
    v_cos_f32 v208, v201
    v_sin_f32 v209, -v201
    v_cos_f32 v210, v202
    v_sin_f32 v211, -v202
    v_cos_f32 v212, v203
    v_sin_f32 v213, -v203
    v_cos_f32 v214, v204
    v_sin_f32 v215, -v204
    v_cvt_pk_bf16_f32 v16, v208, v209
    v_cvt_pk_bf16_f32 v17, v210, v211
    v_cvt_pk_bf16_f32 v18, v212, v213
    v_cvt_pk_bf16_f32 v19, v214, v215
    v_alignbit_b32 v52, v16, v16, v206
    v_alignbit_b32 v53, v17, v17, v206
    v_alignbit_b32 v54, v18, v18, v206
    v_alignbit_b32 v55, v19, v19, v206
    v_xor_b32 v52, v207, v52
    v_xor_b32 v53, v207, v53
    v_xor_b32 v54, v207, v54
    v_xor_b32 v55, v207, v55
    v_lshlrev_b32 v208, 27, v206
    v_or_b32 v208, 0x3f803f80, v208
    v_cmp_eq_u32 vcc, 0, v221
    s_nop 1
    v_cndmask_b32 v16, v16, v208, vcc
    v_mov_b32 v12, 149820
fused_kernel_e0_uok:
    ds_read_b32 v13, v12
    s_waitcnt lgkmcnt(0)
    v_readfirstlane_b32 s35, v13
    s_nop 3
    s_cmp_ge_u32 s35, 1
    s_cbranch_scc1 fused_kernel_e0_uok_d
    s_sleep 1
    s_branch fused_kernel_e0_uok
fused_kernel_e0_uok_d:
    s_mov_b32 s86, s35
    s_cmp_lg_u32 s86, 1
    s_cbranch_scc1 fused_kernel_e0_u1
    s_add_u32 s80, s83, 0
    buffer_load_dwordx4 v[136:139], v240, s[12:15], s80 offen sc1
    s_add_u32 s80, s83, 524288
    buffer_load_dwordx4 v[140:143], v240, s[12:15], s80 offen sc1
    s_add_u32 s80, s83, 1048576
    buffer_load_dwordx4 v[144:147], v240, s[12:15], s80 offen sc1
    s_add_u32 s80, s83, 1572864
    buffer_load_dwordx4 v[148:151], v240, s[12:15], s80 offen sc1
    s_add_u32 s80, s83, 2097152
    buffer_load_dwordx4 v[152:155], v240, s[12:15], s80 offen sc1
fused_kernel_e0_u1:
    v_fmamk_f32 v216, v205, 0x3f800000, v201
    v_fmamk_f32 v217, v205, 0x3f800000, v202
    v_fmamk_f32 v218, v205, 0x3f800000, v203
    v_fmamk_f32 v219, v205, 0x3f800000, v204
    v_cos_f32 v208, v216
    v_sin_f32 v209, -v216
    v_cos_f32 v210, v217
    v_sin_f32 v211, -v217
    v_cos_f32 v212, v218
    v_sin_f32 v213, -v218
    v_cos_f32 v214, v219
    v_sin_f32 v215, -v219
    v_cvt_pk_bf16_f32 v20, v208, v209
    v_cvt_pk_bf16_f32 v21, v210, v211
    v_cvt_pk_bf16_f32 v22, v212, v213
    v_cvt_pk_bf16_f32 v23, v214, v215
    v_alignbit_b32 v56, v20, v20, v206
    v_alignbit_b32 v57, v21, v21, v206
    v_alignbit_b32 v58, v22, v22, v206
    v_alignbit_b32 v59, v23, v23, v206
    v_xor_b32 v56, v207, v56
    v_xor_b32 v57, v207, v57
    v_xor_b32 v58, v207, v58
    v_xor_b32 v59, v207, v59
    v_fmamk_f32 v216, v205, 0x40000000, v201
    v_fmamk_f32 v217, v205, 0x40000000, v202
    v_fmamk_f32 v218, v205, 0x40000000, v203
    v_fmamk_f32 v219, v205, 0x40000000, v204
    v_cos_f32 v208, v216
    v_sin_f32 v209, -v216
    v_cos_f32 v210, v217
    v_sin_f32 v211, -v217
    v_cos_f32 v212, v218
    v_sin_f32 v213, -v218
    v_cos_f32 v214, v219
    v_sin_f32 v215, -v219
    v_cvt_pk_bf16_f32 v24, v208, v209
    v_cvt_pk_bf16_f32 v25, v210, v211
    v_cvt_pk_bf16_f32 v26, v212, v213
    v_cvt_pk_bf16_f32 v27, v214, v215
    v_alignbit_b32 v60, v24, v24, v206
    v_alignbit_b32 v61, v25, v25, v206
    v_alignbit_b32 v62, v26, v26, v206
    v_alignbit_b32 v63, v27, v27, v206
    v_xor_b32 v60, v207, v60
    v_xor_b32 v61, v207, v61
    v_xor_b32 v62, v207, v62
    v_xor_b32 v63, v207, v63
    s_waitcnt vmcnt(0) lgkmcnt(0)
    s_cmp_lg_u32 s86, 1
    s_cbranch_scc1 fused_kernel_e0_u2
    ds_write_b128 v241, v[136:139] offset:0
    ds_write_b128 v241, v[140:143] offset:8192
    ds_write_b128 v241, v[144:147] offset:16384
    ds_write_b128 v241, v[148:151] offset:24576
    ds_write_b128 v241, v[152:155] offset:32768
fused_kernel_e0_u2:
    s_barrier
    s_mov_b32 s4, s40
    s_and_b32 s5, s41, 0xffff
    s_mov_b32 s6, 0x240000
    s_mov_b32 s7, 0x20000
    s_mov_b32 s8, s46
    s_and_b32 s9, s47, 0xffff
    s_mov_b32 s10, 0x240000
    s_mov_b32 s11, 0x20000
    s_mov_b32 s16, s44
    s_and_b32 s17, s45, 0xffff
    s_mov_b32 s18, 0x480
    s_mov_b32 s19, 0x20000
    s_lshl_b32 s79, s21, 8
    s_add_u32 s79, s79, 0xa23000
    v_mov_b32 v238, 0
    v_mov_b32 v239, 1
    s_cmp_lg_u32 s22, 0
    s_cbranch_scc1 fused_kernel_e0_noat
    s_lshl_b32 s80, s20, 3
    s_add_u32 s80, s80, s79
    v_mov_b32 v12, s100
    v_mov_b32 v13, s101
    s_mov_b64 exec, 1
    buffer_store_dwordx2 v[12:13], v1, s[12:15], s80 offen sc1
    s_mov_b64 exec, -1
    s_cmp_eq_u32 s86, 1
    s_cbranch_scc1 fused_kernel_e0_noat
    s_mov_b32 s85, 0xa22000
    v_lshlrev_b32 v252, 1, v1
    s_mov_b32 exec_lo, 0xffffffff
    s_mov_b32 exec_hi, 0xffffffff
    s_mov_b32 s35, 100000
fused_kernel_e0_la_l:
    s_sub_u32 s35, s35, 1
    s_cbranch_scc1 fused_kernel_e0_la_ok
    buffer_load_dwordx4 v[244:247], v252, s[12:15], s85 offen offset:0 sc1
    buffer_load_dwordx4 v[248:251], v252, s[12:15], s85 offen offset:16 sc1
    v_mov_b32 v13, s99
    s_waitcnt vmcnt(0)
    v_subrev_co_u32 v244, vcc, s98, v244
    s_nop 1
    v_subb_co_u32 v245, vcc, v245, v13, vcc
    v_lshrrev_b32 v244, 12, v244
    v_or_b32 v244, v244, v245
    v_subrev_co_u32 v246, vcc, s98, v246
    s_nop 1
    v_subb_co_u32 v247, vcc, v247, v13, vcc
    v_lshrrev_b32 v246, 12, v246
    v_or_b32 v246, v246, v247
    v_or_b32 v244, v244, v246
    v_subrev_co_u32 v248, vcc, s98, v248
    s_nop 1
    v_subb_co_u32 v249, vcc, v249, v13, vcc
    v_lshrrev_b32 v248, 12, v248
    v_or_b32 v248, v248, v249
    v_or_b32 v244, v244, v248
    v_subrev_co_u32 v250, vcc, s98, v250
    s_nop 1
    v_subb_co_u32 v251, vcc, v251, v13, vcc
    v_lshrrev_b32 v250, 12, v250
    v_or_b32 v250, v250, v251
    v_or_b32 v244, v244, v250
    v_cmp_ne_u32 vcc, 0, v244
    s_nop 1
    s_cmp_eq_u64 vcc, 0
    s_cbranch_scc1 fused_kernel_e0_la_ok
    s_sleep 32
    s_branch fused_kernel_e0_la_l
fused_kernel_e0_la_ok:
    s_mov_b64 exec, -1
    s_add_u32 s85, s85, 2048
    v_lshrrev_b32 v252, 1, v1
    s_mov_b32 exec_lo, 0xffffffff
    s_mov_b32 exec_hi, 0x1
    s_mov_b32 s35, 100000
fused_kernel_e0_lb_l:
    s_sub_u32 s35, s35, 1
    s_cbranch_scc1 fused_kernel_e0_lb_ok
    buffer_load_dwordx2 v[244:245], v252, s[12:15], s85 offen sc1
    v_mov_b32 v13, s99
    s_waitcnt vmcnt(0)
    v_subrev_co_u32 v244, vcc, s98, v244
    s_nop 1
    v_subb_co_u32 v245, vcc, v245, v13, vcc
    v_lshrrev_b32 v244, 12, v244
    v_or_b32 v244, v244, v245
    v_cmp_ne_u32 vcc, 0, v244
    s_nop 1
    s_cmp_eq_u64 vcc, 0
    s_cbranch_scc1 fused_kernel_e0_lb_ok
    s_sleep 32
    s_branch fused_kernel_e0_lb_l
fused_kernel_e0_lb_ok:
    s_mov_b64 exec, -1
    v_mov_b32 v12, 149768
    v_mov_b32 v13, 1
    ds_write_b32 v12, v13
fused_kernel_e0_noat:
    buffer_load_dwordx2 v[228:229], v224, s[4:7], s72 offen
    buffer_load_dwordx2 v[230:231], v225, s[4:7], s72 offen
    buffer_load_dwordx2 v[232:233], v226, s[16:19], s73 offen
    v_fmamk_f32 v216, v205, 0x40400000, v201
    v_fmamk_f32 v217, v205, 0x40400000, v202
    v_fmamk_f32 v218, v205, 0x40400000, v203
    v_fmamk_f32 v219, v205, 0x40400000, v204
    v_cos_f32 v208, v216
    v_sin_f32 v209, -v216
    v_cos_f32 v210, v217
    v_sin_f32 v211, -v217
    v_cos_f32 v212, v218
    v_sin_f32 v213, -v218
    v_cos_f32 v214, v219
    v_sin_f32 v215, -v219
    v_cvt_pk_bf16_f32 v28, v208, v209
    v_cvt_pk_bf16_f32 v29, v210, v211
    v_cvt_pk_bf16_f32 v30, v212, v213
    v_cvt_pk_bf16_f32 v31, v214, v215
    v_alignbit_b32 v64, v28, v28, v206
    v_alignbit_b32 v65, v29, v29, v206
    v_alignbit_b32 v66, v30, v30, v206
    v_alignbit_b32 v67, v31, v31, v206
    v_xor_b32 v64, v207, v64
    v_xor_b32 v65, v207, v65
    v_xor_b32 v66, v207, v66
    v_xor_b32 v67, v207, v67
    v_fmamk_f32 v216, v205, 0x40800000, v201
    v_fmamk_f32 v217, v205, 0x40800000, v202
    v_fmamk_f32 v218, v205, 0x40800000, v203
    v_fmamk_f32 v219, v205, 0x40800000, v204
    v_cos_f32 v208, v216
    v_sin_f32 v209, -v216
    v_cos_f32 v210, v217
    v_sin_f32 v211, -v217
    v_cos_f32 v212, v218
    v_sin_f32 v213, -v218
    v_cos_f32 v214, v219
    v_sin_f32 v215, -v219
    v_cvt_pk_bf16_f32 v32, v208, v209
    v_cvt_pk_bf16_f32 v33, v210, v211
    v_cvt_pk_bf16_f32 v34, v212, v213
    v_cvt_pk_bf16_f32 v35, v214, v215
    v_alignbit_b32 v68, v32, v32, v206
    v_alignbit_b32 v69, v33, v33, v206
    v_alignbit_b32 v70, v34, v34, v206
    v_alignbit_b32 v71, v35, v35, v206
    v_xor_b32 v68, v207, v68
    v_xor_b32 v69, v207, v69
    v_xor_b32 v70, v207, v70
    v_xor_b32 v71, v207, v71
    v_fmamk_f32 v216, v205, 0x40a00000, v201
    v_fmamk_f32 v217, v205, 0x40a00000, v202
    v_fmamk_f32 v218, v205, 0x40a00000, v203
    v_fmamk_f32 v219, v205, 0x40a00000, v204
    v_cos_f32 v208, v216
    v_sin_f32 v209, -v216
    v_cos_f32 v210, v217
    v_sin_f32 v211, -v217
    v_cos_f32 v212, v218
    v_sin_f32 v213, -v218
    v_cos_f32 v214, v219
    v_sin_f32 v215, -v219
    v_cvt_pk_bf16_f32 v36, v208, v209
    v_cvt_pk_bf16_f32 v37, v210, v211
    v_cvt_pk_bf16_f32 v38, v212, v213
    v_cvt_pk_bf16_f32 v39, v214, v215
    v_alignbit_b32 v72, v36, v36, v206
    v_alignbit_b32 v73, v37, v37, v206
    v_alignbit_b32 v74, v38, v38, v206
    v_alignbit_b32 v75, v39, v39, v206
    v_xor_b32 v72, v207, v72
    v_xor_b32 v73, v207, v73
    v_xor_b32 v74, v207, v74
    v_xor_b32 v75, v207, v75
    v_fmamk_f32 v216, v205, 0x40c00000, v201
    v_fmamk_f32 v217, v205, 0x40c00000, v202
    v_fmamk_f32 v218, v205, 0x40c00000, v203
    v_fmamk_f32 v219, v205, 0x40c00000, v204
    v_cos_f32 v208, v216
    v_sin_f32 v209, -v216
    v_cos_f32 v210, v217
    v_sin_f32 v211, -v217
    v_cos_f32 v212, v218
    v_sin_f32 v213, -v218
    v_cos_f32 v214, v219
    v_sin_f32 v215, -v219
    v_cvt_pk_bf16_f32 v40, v208, v209
    v_cvt_pk_bf16_f32 v41, v210, v211
    v_cvt_pk_bf16_f32 v42, v212, v213
    v_cvt_pk_bf16_f32 v43, v214, v215
    v_alignbit_b32 v76, v40, v40, v206
    v_alignbit_b32 v77, v41, v41, v206
    v_alignbit_b32 v78, v42, v42, v206
    v_alignbit_b32 v79, v43, v43, v206
    v_xor_b32 v76, v207, v76
    v_xor_b32 v77, v207, v77
    v_xor_b32 v78, v207, v78
    v_xor_b32 v79, v207, v79
    v_fmamk_f32 v216, v205, 0x40e00000, v201
    v_fmamk_f32 v217, v205, 0x40e00000, v202
    v_fmamk_f32 v218, v205, 0x40e00000, v203
    v_fmamk_f32 v219, v205, 0x40e00000, v204
    v_cos_f32 v208, v216
    v_sin_f32 v209, -v216
    v_cos_f32 v210, v217
    v_sin_f32 v211, -v217
    v_cos_f32 v212, v218
    v_sin_f32 v213, -v218
    v_cos_f32 v214, v219
    v_sin_f32 v215, -v219
    v_cvt_pk_bf16_f32 v44, v208, v209
    v_cvt_pk_bf16_f32 v45, v210, v211
    v_cvt_pk_bf16_f32 v46, v212, v213
    v_cvt_pk_bf16_f32 v47, v214, v215
    v_alignbit_b32 v80, v44, v44, v206
    v_alignbit_b32 v81, v45, v45, v206
    v_alignbit_b32 v82, v46, v46, v206
    v_alignbit_b32 v83, v47, v47, v206
    v_xor_b32 v80, v207, v80
    v_xor_b32 v81, v207, v81
    v_xor_b32 v82, v207, v82
    v_xor_b32 v83, v207, v83
    s_cmp_eq_u32 s86, 1
    s_cbranch_scc1 fused_kernel_e0_u3
    v_mov_b32 v12, 149768
fused_kernel_e0_uok2:
    ds_read_b32 v13, v12
    s_waitcnt lgkmcnt(0)
    v_readfirstlane_b32 s35, v13
    s_nop 3
    s_cmp_ge_u32 s35, 1
    s_cbranch_scc1 fused_kernel_e0_uok2_d
    s_sleep 1
    s_branch fused_kernel_e0_uok2
fused_kernel_e0_uok2_d:
    s_add_u32 s80, s83, 0
    buffer_load_dwordx4 v[136:139], v240, s[12:15], s80 offen sc1
    s_add_u32 s80, s83, 524288
    buffer_load_dwordx4 v[140:143], v240, s[12:15], s80 offen sc1
    s_add_u32 s80, s83, 1048576
    buffer_load_dwordx4 v[144:147], v240, s[12:15], s80 offen sc1
    s_add_u32 s80, s83, 1572864
    buffer_load_dwordx4 v[148:151], v240, s[12:15], s80 offen sc1
    s_add_u32 s80, s83, 2097152
    buffer_load_dwordx4 v[152:155], v240, s[12:15], s80 offen sc1
    s_waitcnt vmcnt(0)
    ds_write_b128 v241, v[136:139] offset:0
    ds_write_b128 v241, v[140:143] offset:8192
    ds_write_b128 v241, v[144:147] offset:16384
    ds_write_b128 v241, v[148:151] offset:24576
    ds_write_b128 v241, v[152:155] offset:32768
fused_kernel_e0_u3:
    s_cmp_eq_u32 s22, 2
    s_cbranch_scc1 fused_kernel_e0_w2
    s_cmp_eq_u32 s22, 3
    s_cbranch_scc1 fused_kernel_e0_w3
    s_cmp_eq_u32 s22, 1
    s_cbranch_scc1 fused_kernel_e0_plain
    v_lshrrev_b32 v243, 1, v1
    s_mov_b32 exec_lo, 0xff
    s_mov_b32 exec_hi, 0x0
    s_mov_b32 s35, 100000
fused_kernel_e0_pp_l:
    s_sub_u32 s35, s35, 1
    s_cbranch_scc1 fused_kernel_e0_pp_ok
    buffer_load_dwordx2 v[238:239], v243, s[12:15], s79 offen sc1
    v_mov_b32 v13, s99
    s_waitcnt vmcnt(0)
    v_subrev_co_u32 v238, vcc, s98, v238
    s_nop 1
    v_subb_co_u32 v239, vcc, v239, v13, vcc
    v_lshrrev_b32 v238, 12, v238
    v_or_b32 v238, v238, v239
    v_cmp_ne_u32 vcc, 0, v238
    s_nop 1
    s_cmp_eq_u64 vcc, 0
    s_cbranch_scc1 fused_kernel_e0_pp_ok
    s_sleep 4
    s_branch fused_kernel_e0_pp_l
fused_kernel_e0_pp_ok:
    s_mov_b64 exec, -1
    s_waitcnt lgkmcnt(0)
    s_barrier
    s_add_u32 s80, s76, 0x0
    buffer_load_dwordx4 v[88:91], v1, s[12:15], s80 offen sc1
    s_add_u32 s80, s76, 0x240000
    buffer_load_dwordx4 v[92:95], v1, s[12:15], s80 offen sc1
    s_add_u32 s80, s76, 0x480000
    buffer_load_dwordx4 v[96:99], v1, s[12:15], s80 offen sc1
    s_add_u32 s80, s76, 0x6c0000
    buffer_load_dwordx4 v[100:103], v1, s[12:15], s80 offen sc1
    s_add_u32 s80, s76, 0x900000
    buffer_load_dwordx4 v[104:107], v1, s[12:15], s80 offen sc1
    s_add_u32 s80, s76, 0xb40000
    buffer_load_dwordx4 v[108:111], v1, s[12:15], s80 offen sc1
    s_add_u32 s80, s76, 0xd80000
    buffer_load_dwordx4 v[112:115], v1, s[12:15], s80 offen sc1
    s_add_u32 s80, s76, 0xfc0000
    buffer_load_dwordx4 v[116:119], v1, s[12:15], s80 offen sc1
    v_fmamk_f32 v216, v205, 0x41000000, v201
    v_fmamk_f32 v217, v205, 0x41000000, v202
    v_fmamk_f32 v218, v205, 0x41000000, v203
    v_fmamk_f32 v219, v205, 0x41000000, v204
    v_cos_f32 v208, v216
    v_sin_f32 v209, -v216
    v_cos_f32 v210, v217
    v_sin_f32 v211, -v217
    v_cos_f32 v212, v218
    v_sin_f32 v213, -v218
    v_cos_f32 v214, v219
    v_sin_f32 v215, -v219
    v_cvt_pk_bf16_f32 v48, v208, v209
    v_cvt_pk_bf16_f32 v49, v210, v211
    v_cvt_pk_bf16_f32 v50, v212, v213
    v_cvt_pk_bf16_f32 v51, v214, v215
    v_alignbit_b32 v84, v48, v48, v206
    v_alignbit_b32 v85, v49, v49, v206
    v_alignbit_b32 v86, v50, v50, v206
    v_alignbit_b32 v87, v51, v51, v206
    v_xor_b32 v84, v207, v84
    v_xor_b32 v85, v207, v85
    v_xor_b32 v86, v207, v86
    v_xor_b32 v87, v207, v87
    ds_read_b64_tr_b16 v[176:177], v222 offset:0
    ds_read_b64_tr_b16 v[178:179], v222 offset:1024
    ds_read_b64_tr_b16 v[180:181], v223 offset:0
    ds_read_b64_tr_b16 v[182:183], v223 offset:1024
    ds_read_b64_tr_b16 v[184:185], v222 offset:2048
    ds_read_b64_tr_b16 v[186:187], v222 offset:3072
    ds_read_b64_tr_b16 v[188:189], v223 offset:2048
    ds_read_b64_tr_b16 v[190:191], v223 offset:3072
    ds_read_b64_tr_b16 v[192:193], v222 offset:4096
    ds_read_b64_tr_b16 v[194:195], v222 offset:5120
    ds_read_b64_tr_b16 v[196:197], v223 offset:4096
    ds_read_b64_tr_b16 v[198:199], v223 offset:5120
    s_waitcnt lgkmcnt(10)
    v_mfma_f32_16x16x32_bf16 v[160:163], v[16:19], v[176:179], 0
    s_waitcnt lgkmcnt(8)
    v_mfma_f32_16x16x32_bf16 v[164:167], v[16:19], v[180:183], 0
    ds_read_b64_tr_b16 v[176:177], v222 offset:6144
    ds_read_b64_tr_b16 v[178:179], v222 offset:7168
    ds_read_b64_tr_b16 v[180:181], v223 offset:6144
    ds_read_b64_tr_b16 v[182:183], v223 offset:7168
    s_waitcnt lgkmcnt(10)
    v_mfma_f32_16x16x32_bf16 v[160:163], v[20:23], v[184:187], v[160:163]
    s_waitcnt lgkmcnt(8)
    v_mfma_f32_16x16x32_bf16 v[164:167], v[20:23], v[188:191], v[164:167]
    ds_read_b64_tr_b16 v[184:185], v222 offset:8192
    ds_read_b64_tr_b16 v[186:187], v222 offset:9216
    ds_read_b64_tr_b16 v[188:189], v223 offset:8192
    ds_read_b64_tr_b16 v[190:191], v223 offset:9216
    s_waitcnt lgkmcnt(10)
    v_mfma_f32_16x16x32_bf16 v[160:163], v[24:27], v[192:195], v[160:163]
    s_waitcnt lgkmcnt(8)
    v_mfma_f32_16x16x32_bf16 v[164:167], v[24:27], v[196:199], v[164:167]
    ds_read_b64_tr_b16 v[192:193], v222 offset:10240
    ds_read_b64_tr_b16 v[194:195], v222 offset:11264
    ds_read_b64_tr_b16 v[196:197], v223 offset:10240
    ds_read_b64_tr_b16 v[198:199], v223 offset:11264
    s_waitcnt lgkmcnt(10)
    v_mfma_f32_16x16x32_bf16 v[160:163], v[28:31], v[176:179], v[160:163]
    s_waitcnt lgkmcnt(8)
    v_mfma_f32_16x16x32_bf16 v[164:167], v[28:31], v[180:183], v[164:167]
    ds_read_b64_tr_b16 v[176:177], v222 offset:12288
    ds_read_b64_tr_b16 v[178:179], v222 offset:13312
    ds_read_b64_tr_b16 v[180:181], v223 offset:12288
    ds_read_b64_tr_b16 v[182:183], v223 offset:13312
    s_waitcnt lgkmcnt(10)
    v_mfma_f32_16x16x32_bf16 v[160:163], v[32:35], v[184:187], v[160:163]
    s_waitcnt lgkmcnt(8)
    v_mfma_f32_16x16x32_bf16 v[164:167], v[32:35], v[188:191], v[164:167]
    ds_read_b64_tr_b16 v[184:185], v222 offset:14336
    ds_read_b64_tr_b16 v[186:187], v222 offset:15360
    ds_read_b64_tr_b16 v[188:189], v223 offset:14336
    ds_read_b64_tr_b16 v[190:191], v223 offset:15360
    s_waitcnt lgkmcnt(10)
    v_mfma_f32_16x16x32_bf16 v[160:163], v[36:39], v[192:195], v[160:163]
    s_waitcnt lgkmcnt(8)
    v_mfma_f32_16x16x32_bf16 v[164:167], v[36:39], v[196:199], v[164:167]
    ds_read_b64_tr_b16 v[192:193], v222 offset:16384
    ds_read_b64_tr_b16 v[194:195], v222 offset:17408
    ds_read_b64_tr_b16 v[196:197], v223 offset:16384
    ds_read_b64_tr_b16 v[198:199], v223 offset:17408
    s_waitcnt lgkmcnt(10)
    v_mfma_f32_16x16x32_bf16 v[160:163], v[40:43], v[176:179], v[160:163]
    s_waitcnt lgkmcnt(8)
    v_mfma_f32_16x16x32_bf16 v[164:167], v[40:43], v[180:183], v[164:167]
    ds_read_b64_tr_b16 v[176:177], v222 offset:18432
    ds_read_b64_tr_b16 v[178:179], v222 offset:19456
    ds_read_b64_tr_b16 v[180:181], v223 offset:18432
    ds_read_b64_tr_b16 v[182:183], v223 offset:19456
    s_waitcnt lgkmcnt(10)
    v_mfma_f32_16x16x32_bf16 v[160:163], v[44:47], v[184:187], v[160:163]
    s_waitcnt lgkmcnt(8)
    v_mfma_f32_16x16x32_bf16 v[164:167], v[44:47], v[188:191], v[164:167]
    ds_read_b64_tr_b16 v[184:185], v222 offset:20480
    ds_read_b64_tr_b16 v[186:187], v222 offset:21504
    ds_read_b64_tr_b16 v[188:189], v223 offset:20480
    ds_read_b64_tr_b16 v[190:191], v223 offset:21504
    s_waitcnt lgkmcnt(10)
    v_mfma_f32_16x16x32_bf16 v[160:163], v[48:51], v[192:195], v[160:163]
    s_waitcnt lgkmcnt(8)
    v_mfma_f32_16x16x32_bf16 v[164:167], v[48:51], v[196:199], v[164:167]
    ds_read_b64_tr_b16 v[192:193], v222 offset:22528
    ds_read_b64_tr_b16 v[194:195], v222 offset:23552
    ds_read_b64_tr_b16 v[196:197], v223 offset:22528
    ds_read_b64_tr_b16 v[198:199], v223 offset:23552
    s_waitcnt lgkmcnt(10)
    v_mfma_f32_16x16x32_bf16 v[160:163], v[52:55], v[176:179], v[160:163]
    s_waitcnt lgkmcnt(8)
    v_mfma_f32_16x16x32_bf16 v[164:167], v[52:55], v[180:183], v[164:167]
    ds_read_b64_tr_b16 v[176:177], v222 offset:24576
    ds_read_b64_tr_b16 v[178:179], v222 offset:25600
    ds_read_b64_tr_b16 v[180:181], v223 offset:24576
    ds_read_b64_tr_b16 v[182:183], v223 offset:25600
    s_waitcnt lgkmcnt(10)
    v_mfma_f32_16x16x32_bf16 v[160:163], v[56:59], v[184:187], v[160:163]
    s_waitcnt lgkmcnt(8)
    v_mfma_f32_16x16x32_bf16 v[164:167], v[56:59], v[188:191], v[164:167]
    ds_read_b64_tr_b16 v[184:185], v222 offset:26624
    ds_read_b64_tr_b16 v[186:187], v222 offset:27648
    ds_read_b64_tr_b16 v[188:189], v223 offset:26624
    ds_read_b64_tr_b16 v[190:191], v223 offset:27648
    s_waitcnt lgkmcnt(10)
    v_mfma_f32_16x16x32_bf16 v[160:163], v[60:63], v[192:195], v[160:163]
    s_waitcnt lgkmcnt(8)
    v_mfma_f32_16x16x32_bf16 v[164:167], v[60:63], v[196:199], v[164:167]
    ds_read_b64_tr_b16 v[192:193], v222 offset:28672
    ds_read_b64_tr_b16 v[194:195], v222 offset:29696
    ds_read_b64_tr_b16 v[196:197], v223 offset:28672
    ds_read_b64_tr_b16 v[198:199], v223 offset:29696
    s_waitcnt lgkmcnt(10)
    v_mfma_f32_16x16x32_bf16 v[160:163], v[64:67], v[176:179], v[160:163]
    s_waitcnt lgkmcnt(8)
    v_mfma_f32_16x16x32_bf16 v[164:167], v[64:67], v[180:183], v[164:167]
    ds_read_b64_tr_b16 v[176:177], v222 offset:30720
    ds_read_b64_tr_b16 v[178:179], v222 offset:31744
    ds_read_b64_tr_b16 v[180:181], v223 offset:30720
    ds_read_b64_tr_b16 v[182:183], v223 offset:31744
    s_waitcnt lgkmcnt(10)
    v_mfma_f32_16x16x32_bf16 v[160:163], v[68:71], v[184:187], v[160:163]
    s_waitcnt lgkmcnt(8)
    v_mfma_f32_16x16x32_bf16 v[164:167], v[68:71], v[188:191], v[164:167]
    ds_read_b64_tr_b16 v[184:185], v222 offset:32768
    ds_read_b64_tr_b16 v[186:187], v222 offset:33792
    ds_read_b64_tr_b16 v[188:189], v223 offset:32768
    ds_read_b64_tr_b16 v[190:191], v223 offset:33792
    s_waitcnt lgkmcnt(10)
    v_mfma_f32_16x16x32_bf16 v[160:163], v[72:75], v[192:195], v[160:163]
    s_waitcnt lgkmcnt(8)
    v_mfma_f32_16x16x32_bf16 v[164:167], v[72:75], v[196:199], v[164:167]
    ds_read_b64_tr_b16 v[192:193], v222 offset:34816
    ds_read_b64_tr_b16 v[194:195], v222 offset:35840
    ds_read_b64_tr_b16 v[196:197], v223 offset:34816
    ds_read_b64_tr_b16 v[198:199], v223 offset:35840
    s_waitcnt lgkmcnt(10)
    v_mfma_f32_16x16x32_bf16 v[160:163], v[76:79], v[176:179], v[160:163]
    s_waitcnt lgkmcnt(8)
    v_mfma_f32_16x16x32_bf16 v[164:167], v[76:79], v[180:183], v[164:167]
    s_waitcnt lgkmcnt(6)
    v_mfma_f32_16x16x32_bf16 v[160:163], v[80:83], v[184:187], v[160:163]
    s_waitcnt lgkmcnt(4)
    v_mfma_f32_16x16x32_bf16 v[164:167], v[80:83], v[188:191], v[164:167]
    s_waitcnt lgkmcnt(2)
    v_mfma_f32_16x16x32_bf16 v[160:163], v[84:87], v[192:195], v[160:163]
    s_waitcnt lgkmcnt(0)
    v_mfma_f32_16x16x32_bf16 v[164:167], v[84:87], v[196:199], v[164:167]
    s_waitcnt vmcnt(7)
    v_lshlrev_b32 v176, 16, v88
    v_and_b32 v177, 0xffff0000, v88
    v_lshlrev_b32 v178, 16, v89
    v_and_b32 v179, 0xffff0000, v89
    v_lshlrev_b32 v180, 16, v90
    v_and_b32 v181, 0xffff0000, v90
    v_lshlrev_b32 v182, 16, v91
    v_and_b32 v183, 0xffff0000, v91
    s_waitcnt vmcnt(6)
    v_lshlrev_b32 v188, 16, v92
    v_and_b32 v189, 0xffff0000, v92
    v_lshlrev_b32 v190, 16, v93
    v_and_b32 v191, 0xffff0000, v93
    v_lshlrev_b32 v192, 16, v94
    v_and_b32 v193, 0xffff0000, v94
    v_lshlrev_b32 v194, 16, v95
    v_and_b32 v195, 0xffff0000, v95
    v_pk_add_f32 v[176:177], v[176:177], v[188:189]
    v_pk_add_f32 v[178:179], v[178:179], v[190:191]
    v_pk_add_f32 v[180:181], v[180:181], v[192:193]
    v_pk_add_f32 v[182:183], v[182:183], v[194:195]
    s_waitcnt vmcnt(5)
    v_lshlrev_b32 v188, 16, v96
    v_and_b32 v189, 0xffff0000, v96
    v_lshlrev_b32 v190, 16, v97
    v_and_b32 v191, 0xffff0000, v97
    v_lshlrev_b32 v192, 16, v98
    v_and_b32 v193, 0xffff0000, v98
    v_lshlrev_b32 v194, 16, v99
    v_and_b32 v195, 0xffff0000, v99
    v_pk_add_f32 v[176:177], v[176:177], v[188:189]
    v_pk_add_f32 v[178:179], v[178:179], v[190:191]
    v_pk_add_f32 v[180:181], v[180:181], v[192:193]
    v_pk_add_f32 v[182:183], v[182:183], v[194:195]
    s_waitcnt vmcnt(4)
    v_lshlrev_b32 v188, 16, v100
    v_and_b32 v189, 0xffff0000, v100
    v_lshlrev_b32 v190, 16, v101
    v_and_b32 v191, 0xffff0000, v101
    v_lshlrev_b32 v192, 16, v102
    v_and_b32 v193, 0xffff0000, v102
    v_lshlrev_b32 v194, 16, v103
    v_and_b32 v195, 0xffff0000, v103
    v_pk_add_f32 v[176:177], v[176:177], v[188:189]
    v_pk_add_f32 v[178:179], v[178:179], v[190:191]
    v_pk_add_f32 v[180:181], v[180:181], v[192:193]
    v_pk_add_f32 v[182:183], v[182:183], v[194:195]
    s_waitcnt vmcnt(3)
    v_lshlrev_b32 v188, 16, v104
    v_and_b32 v189, 0xffff0000, v104
    v_lshlrev_b32 v190, 16, v105
    v_and_b32 v191, 0xffff0000, v105
    v_lshlrev_b32 v192, 16, v106
    v_and_b32 v193, 0xffff0000, v106
    v_lshlrev_b32 v194, 16, v107
    v_and_b32 v195, 0xffff0000, v107
    v_pk_add_f32 v[176:177], v[176:177], v[188:189]
    v_pk_add_f32 v[178:179], v[178:179], v[190:191]
    v_pk_add_f32 v[180:181], v[180:181], v[192:193]
    v_pk_add_f32 v[182:183], v[182:183], v[194:195]
    s_waitcnt vmcnt(2)
    v_lshlrev_b32 v188, 16, v108
    v_and_b32 v189, 0xffff0000, v108
    v_lshlrev_b32 v190, 16, v109
    v_and_b32 v191, 0xffff0000, v109
    v_lshlrev_b32 v192, 16, v110
    v_and_b32 v193, 0xffff0000, v110
    v_lshlrev_b32 v194, 16, v111
    v_and_b32 v195, 0xffff0000, v111
    v_pk_add_f32 v[176:177], v[176:177], v[188:189]
    v_pk_add_f32 v[178:179], v[178:179], v[190:191]
    v_pk_add_f32 v[180:181], v[180:181], v[192:193]
    v_pk_add_f32 v[182:183], v[182:183], v[194:195]
    s_waitcnt vmcnt(1)
    v_lshlrev_b32 v188, 16, v112
    v_and_b32 v189, 0xffff0000, v112
    v_lshlrev_b32 v190, 16, v113
    v_and_b32 v191, 0xffff0000, v113
    v_lshlrev_b32 v192, 16, v114
    v_and_b32 v193, 0xffff0000, v114
    v_lshlrev_b32 v194, 16, v115
    v_and_b32 v195, 0xffff0000, v115
    v_pk_add_f32 v[176:177], v[176:177], v[188:189]
    v_pk_add_f32 v[178:179], v[178:179], v[190:191]
    v_pk_add_f32 v[180:181], v[180:181], v[192:193]
    v_pk_add_f32 v[182:183], v[182:183], v[194:195]
    s_waitcnt vmcnt(0)
    v_lshlrev_b32 v188, 16, v116
    v_and_b32 v189, 0xffff0000, v116
    v_lshlrev_b32 v190, 16, v117
    v_and_b32 v191, 0xffff0000, v117
    v_lshlrev_b32 v192, 16, v118
    v_and_b32 v193, 0xffff0000, v118
    v_lshlrev_b32 v194, 16, v119
    v_and_b32 v195, 0xffff0000, v119
    v_pk_add_f32 v[176:177], v[176:177], v[188:189]
    v_pk_add_f32 v[178:179], v[178:179], v[190:191]
    v_pk_add_f32 v[180:181], v[180:181], v[192:193]
    v_pk_add_f32 v[182:183], v[182:183], v[194:195]
    v_lshlrev_b32 v196, 16, v232
    v_and_b32 v197, 0xffff0000, v232
    v_lshlrev_b32 v198, 16, v233
    v_and_b32 v199, 0xffff0000, v233
    v_cvt_pk_bf16_f32 v190, v176, v177
    v_lshlrev_b32 v176, 16, v190
    v_and_b32 v177, 0xffff0000, v190
    v_pk_add_f32 v[176:177], v[176:177], v[196:197]
    v_cvt_pk_bf16_f32 v190, v176, v177
    v_lshlrev_b32 v176, 16, v190
    v_and_b32 v177, 0xffff0000, v190
    v_cvt_pk_bf16_f32 v190, v160, v161
    v_lshlrev_b32 v160, 16, v190
    v_and_b32 v161, 0xffff0000, v190
    v_lshlrev_b32 v188, 16, v228
    v_and_b32 v189, 0xffff0000, v228
    v_pk_add_f32 v[160:161], v[160:161], v[188:189]
    v_cvt_pk_bf16_f32 v190, v160, v161
    v_lshlrev_b32 v160, 16, v190
    v_and_b32 v161, 0xffff0000, v190
    v_pk_add_f32 v[160:161], v[160:161], v[176:177]
    v_cvt_pk_bf16_f32 v200, v160, v161
    v_cvt_pk_bf16_f32 v190, v178, v179
    v_lshlrev_b32 v178, 16, v190
    v_and_b32 v179, 0xffff0000, v190
    v_pk_add_f32 v[178:179], v[178:179], v[198:199]
    v_cvt_pk_bf16_f32 v190, v178, v179
    v_lshlrev_b32 v178, 16, v190
    v_and_b32 v179, 0xffff0000, v190
    v_cvt_pk_bf16_f32 v190, v162, v163
    v_lshlrev_b32 v162, 16, v190
    v_and_b32 v163, 0xffff0000, v190
    v_lshlrev_b32 v188, 16, v229
    v_and_b32 v189, 0xffff0000, v229
    v_pk_add_f32 v[162:163], v[162:163], v[188:189]
    v_cvt_pk_bf16_f32 v190, v162, v163
    v_lshlrev_b32 v162, 16, v190
    v_and_b32 v163, 0xffff0000, v190
    v_pk_add_f32 v[162:163], v[162:163], v[178:179]
    v_cvt_pk_bf16_f32 v201, v162, v163
    v_cvt_pk_bf16_f32 v190, v180, v181
    v_lshlrev_b32 v180, 16, v190
    v_and_b32 v181, 0xffff0000, v190
    v_pk_add_f32 v[180:181], v[180:181], v[196:197]
    v_cvt_pk_bf16_f32 v190, v180, v181
    v_lshlrev_b32 v180, 16, v190
    v_and_b32 v181, 0xffff0000, v190
    v_cvt_pk_bf16_f32 v190, v164, v165
    v_lshlrev_b32 v164, 16, v190
    v_and_b32 v165, 0xffff0000, v190
    v_lshlrev_b32 v188, 16, v230
    v_and_b32 v189, 0xffff0000, v230
    v_pk_add_f32 v[164:165], v[164:165], v[188:189]
    v_cvt_pk_bf16_f32 v190, v164, v165
    v_lshlrev_b32 v164, 16, v190
    v_and_b32 v165, 0xffff0000, v190
    v_pk_add_f32 v[164:165], v[164:165], v[180:181]
    v_cvt_pk_bf16_f32 v202, v164, v165
    v_cvt_pk_bf16_f32 v190, v182, v183
    v_lshlrev_b32 v182, 16, v190
    v_and_b32 v183, 0xffff0000, v190
    v_pk_add_f32 v[182:183], v[182:183], v[198:199]
    v_cvt_pk_bf16_f32 v190, v182, v183
    v_lshlrev_b32 v182, 16, v190
    v_and_b32 v183, 0xffff0000, v190
    v_cvt_pk_bf16_f32 v190, v166, v167
    v_lshlrev_b32 v166, 16, v190
    v_and_b32 v167, 0xffff0000, v190
    v_lshlrev_b32 v188, 16, v231
    v_and_b32 v189, 0xffff0000, v231
    v_pk_add_f32 v[166:167], v[166:167], v[188:189]
    v_cvt_pk_bf16_f32 v190, v166, v167
    v_lshlrev_b32 v166, 16, v190
    v_and_b32 v167, 0xffff0000, v190
    v_pk_add_f32 v[166:167], v[166:167], v[182:183]
    v_cvt_pk_bf16_f32 v203, v166, v167
    buffer_store_dwordx2 v[200:201], v224, s[8:11], s72 offen
    buffer_store_dwordx2 v[202:203], v225, s[8:11], s72 offen
    s_endpgm
fused_kernel_e0_w2:
    s_waitcnt lgkmcnt(0)
    s_barrier
    s_add_u32 s80, s76, 0x0
    buffer_load_dwordx4 v[88:91], v1, s[12:15], s80 offen sc1
    s_add_u32 s80, s76, 0x240000
    buffer_load_dwordx4 v[92:95], v1, s[12:15], s80 offen sc1
    s_add_u32 s80, s76, 0x480000
    buffer_load_dwordx4 v[96:99], v1, s[12:15], s80 offen sc1
    s_add_u32 s80, s76, 0x6c0000
    buffer_load_dwordx4 v[100:103], v1, s[12:15], s80 offen sc1
    s_add_u32 s80, s76, 0x900000
    buffer_load_dwordx4 v[104:107], v1, s[12:15], s80 offen sc1
    s_add_u32 s80, s76, 0xb40000
    buffer_load_dwordx4 v[108:111], v1, s[12:15], s80 offen sc1
    s_add_u32 s80, s76, 0xd80000
    buffer_load_dwordx4 v[112:115], v1, s[12:15], s80 offen sc1
    s_add_u32 s80, s76, 0xfc0000
    buffer_load_dwordx4 v[116:119], v1, s[12:15], s80 offen sc1
    s_add_u32 s80, s77, 0x0
    buffer_load_dwordx2 v[120:121], v1, s[12:15], s80 offen sc1
    s_add_u32 s80, s77, 0x240000
    buffer_load_dwordx2 v[122:123], v1, s[12:15], s80 offen sc1
    s_add_u32 s80, s77, 0x480000
    buffer_load_dwordx2 v[124:125], v1, s[12:15], s80 offen sc1
    s_add_u32 s80, s77, 0x6c0000
    buffer_load_dwordx2 v[126:127], v1, s[12:15], s80 offen sc1
    s_add_u32 s80, s77, 0x900000
    buffer_load_dwordx2 v[128:129], v1, s[12:15], s80 offen sc1
    s_add_u32 s80, s77, 0xb40000
    buffer_load_dwordx2 v[130:131], v1, s[12:15], s80 offen sc1
    s_add_u32 s80, s77, 0xd80000
    buffer_load_dwordx2 v[132:133], v1, s[12:15], s80 offen sc1
    s_add_u32 s80, s77, 0xfc0000
    buffer_load_dwordx2 v[134:135], v1, s[12:15], s80 offen sc1
    buffer_load_dwordx2 v[234:235], v224, s[4:7], s74 offen
    buffer_load_dwordx2 v[236:237], v226, s[16:19], s75 offen
    v_fmamk_f32 v216, v205, 0x41000000, v201
    v_fmamk_f32 v217, v205, 0x41000000, v202
    v_fmamk_f32 v218, v205, 0x41000000, v203
    v_fmamk_f32 v219, v205, 0x41000000, v204
    v_cos_f32 v208, v216
    v_sin_f32 v209, -v216
    v_cos_f32 v210, v217
    v_sin_f32 v211, -v217
    v_cos_f32 v212, v218
    v_sin_f32 v213, -v218
    v_cos_f32 v214, v219
    v_sin_f32 v215, -v219
    v_cvt_pk_bf16_f32 v48, v208, v209
    v_cvt_pk_bf16_f32 v49, v210, v211
    v_cvt_pk_bf16_f32 v50, v212, v213
    v_cvt_pk_bf16_f32 v51, v214, v215
    v_alignbit_b32 v84, v48, v48, v206
    v_alignbit_b32 v85, v49, v49, v206
    v_alignbit_b32 v86, v50, v50, v206
    v_alignbit_b32 v87, v51, v51, v206
    v_xor_b32 v84, v207, v84
    v_xor_b32 v85, v207, v85
    v_xor_b32 v86, v207, v86
    v_xor_b32 v87, v207, v87
    ds_read_b64_tr_b16 v[176:177], v222 offset:0
    ds_read_b64_tr_b16 v[178:179], v222 offset:1024
    ds_read_b64_tr_b16 v[180:181], v223 offset:0
    ds_read_b64_tr_b16 v[182:183], v223 offset:1024
    ds_read_b64_tr_b16 v[184:185], v222 offset:2048
    ds_read_b64_tr_b16 v[186:187], v222 offset:3072
    ds_read_b64_tr_b16 v[188:189], v223 offset:2048
    ds_read_b64_tr_b16 v[190:191], v223 offset:3072
    ds_read_b64_tr_b16 v[192:193], v222 offset:4096
    ds_read_b64_tr_b16 v[194:195], v222 offset:5120
    ds_read_b64_tr_b16 v[196:197], v223 offset:4096
    ds_read_b64_tr_b16 v[198:199], v223 offset:5120
    s_waitcnt lgkmcnt(10)
    v_mfma_f32_16x16x32_bf16 v[160:163], v[16:19], v[176:179], 0
    s_waitcnt lgkmcnt(8)
    v_mfma_f32_16x16x32_bf16 v[164:167], v[16:19], v[180:183], 0
    ds_read_b64_tr_b16 v[176:177], v222 offset:6144
    ds_read_b64_tr_b16 v[178:179], v222 offset:7168
    ds_read_b64_tr_b16 v[180:181], v223 offset:6144
    ds_read_b64_tr_b16 v[182:183], v223 offset:7168
    s_waitcnt lgkmcnt(10)
    v_mfma_f32_16x16x32_bf16 v[160:163], v[20:23], v[184:187], v[160:163]
    s_waitcnt lgkmcnt(8)
    v_mfma_f32_16x16x32_bf16 v[164:167], v[20:23], v[188:191], v[164:167]
    ds_read_b64_tr_b16 v[184:185], v222 offset:8192
    ds_read_b64_tr_b16 v[186:187], v222 offset:9216
    ds_read_b64_tr_b16 v[188:189], v223 offset:8192
    ds_read_b64_tr_b16 v[190:191], v223 offset:9216
    s_waitcnt lgkmcnt(10)
    v_mfma_f32_16x16x32_bf16 v[160:163], v[24:27], v[192:195], v[160:163]
    s_waitcnt lgkmcnt(8)
    v_mfma_f32_16x16x32_bf16 v[164:167], v[24:27], v[196:199], v[164:167]
    ds_read_b64_tr_b16 v[192:193], v222 offset:10240
    ds_read_b64_tr_b16 v[194:195], v222 offset:11264
    ds_read_b64_tr_b16 v[196:197], v223 offset:10240
    ds_read_b64_tr_b16 v[198:199], v223 offset:11264
    s_waitcnt lgkmcnt(10)
    v_mfma_f32_16x16x32_bf16 v[160:163], v[28:31], v[176:179], v[160:163]
    s_waitcnt lgkmcnt(8)
    v_mfma_f32_16x16x32_bf16 v[164:167], v[28:31], v[180:183], v[164:167]
    ds_read_b64_tr_b16 v[176:177], v222 offset:12288
    ds_read_b64_tr_b16 v[178:179], v222 offset:13312
    ds_read_b64_tr_b16 v[180:181], v223 offset:12288
    ds_read_b64_tr_b16 v[182:183], v223 offset:13312
    s_waitcnt lgkmcnt(10)
    v_mfma_f32_16x16x32_bf16 v[160:163], v[32:35], v[184:187], v[160:163]
    s_waitcnt lgkmcnt(8)
    v_mfma_f32_16x16x32_bf16 v[164:167], v[32:35], v[188:191], v[164:167]
    ds_read_b64_tr_b16 v[184:185], v222 offset:14336
    ds_read_b64_tr_b16 v[186:187], v222 offset:15360
    ds_read_b64_tr_b16 v[188:189], v223 offset:14336
    ds_read_b64_tr_b16 v[190:191], v223 offset:15360
    s_waitcnt lgkmcnt(10)
    v_mfma_f32_16x16x32_bf16 v[160:163], v[36:39], v[192:195], v[160:163]
    s_waitcnt lgkmcnt(8)
    v_mfma_f32_16x16x32_bf16 v[164:167], v[36:39], v[196:199], v[164:167]
    ds_read_b64_tr_b16 v[192:193], v222 offset:16384
    ds_read_b64_tr_b16 v[194:195], v222 offset:17408
    ds_read_b64_tr_b16 v[196:197], v223 offset:16384
    ds_read_b64_tr_b16 v[198:199], v223 offset:17408
    s_waitcnt lgkmcnt(10)
    v_mfma_f32_16x16x32_bf16 v[160:163], v[40:43], v[176:179], v[160:163]
    s_waitcnt lgkmcnt(8)
    v_mfma_f32_16x16x32_bf16 v[164:167], v[40:43], v[180:183], v[164:167]
    ds_read_b64_tr_b16 v[176:177], v222 offset:18432
    ds_read_b64_tr_b16 v[178:179], v222 offset:19456
    ds_read_b64_tr_b16 v[180:181], v223 offset:18432
    ds_read_b64_tr_b16 v[182:183], v223 offset:19456
    s_waitcnt lgkmcnt(10)
    v_mfma_f32_16x16x32_bf16 v[160:163], v[44:47], v[184:187], v[160:163]
    s_waitcnt lgkmcnt(8)
    v_mfma_f32_16x16x32_bf16 v[164:167], v[44:47], v[188:191], v[164:167]
    ds_read_b64_tr_b16 v[184:185], v222 offset:20480
    ds_read_b64_tr_b16 v[186:187], v222 offset:21504
    ds_read_b64_tr_b16 v[188:189], v223 offset:20480
    ds_read_b64_tr_b16 v[190:191], v223 offset:21504
    s_waitcnt lgkmcnt(10)
    v_mfma_f32_16x16x32_bf16 v[160:163], v[48:51], v[192:195], v[160:163]
    s_waitcnt lgkmcnt(8)
    v_mfma_f32_16x16x32_bf16 v[164:167], v[48:51], v[196:199], v[164:167]
    ds_read_b64_tr_b16 v[192:193], v222 offset:22528
    ds_read_b64_tr_b16 v[194:195], v222 offset:23552
    ds_read_b64_tr_b16 v[196:197], v223 offset:22528
    ds_read_b64_tr_b16 v[198:199], v223 offset:23552
    s_waitcnt lgkmcnt(10)
    v_mfma_f32_16x16x32_bf16 v[160:163], v[52:55], v[176:179], v[160:163]
    s_waitcnt lgkmcnt(8)
    v_mfma_f32_16x16x32_bf16 v[164:167], v[52:55], v[180:183], v[164:167]
    ds_read_b64_tr_b16 v[176:177], v222 offset:24576
    ds_read_b64_tr_b16 v[178:179], v222 offset:25600
    ds_read_b64_tr_b16 v[180:181], v223 offset:24576
    ds_read_b64_tr_b16 v[182:183], v223 offset:25600
    s_waitcnt lgkmcnt(10)
    v_mfma_f32_16x16x32_bf16 v[160:163], v[56:59], v[184:187], v[160:163]
    s_waitcnt lgkmcnt(8)
    v_mfma_f32_16x16x32_bf16 v[164:167], v[56:59], v[188:191], v[164:167]
    ds_read_b64_tr_b16 v[184:185], v222 offset:26624
    ds_read_b64_tr_b16 v[186:187], v222 offset:27648
    ds_read_b64_tr_b16 v[188:189], v223 offset:26624
    ds_read_b64_tr_b16 v[190:191], v223 offset:27648
    s_waitcnt lgkmcnt(10)
    v_mfma_f32_16x16x32_bf16 v[160:163], v[60:63], v[192:195], v[160:163]
    s_waitcnt lgkmcnt(8)
    v_mfma_f32_16x16x32_bf16 v[164:167], v[60:63], v[196:199], v[164:167]
    ds_read_b64_tr_b16 v[192:193], v222 offset:28672
    ds_read_b64_tr_b16 v[194:195], v222 offset:29696
    ds_read_b64_tr_b16 v[196:197], v223 offset:28672
    ds_read_b64_tr_b16 v[198:199], v223 offset:29696
    s_waitcnt lgkmcnt(10)
    v_mfma_f32_16x16x32_bf16 v[160:163], v[64:67], v[176:179], v[160:163]
    s_waitcnt lgkmcnt(8)
    v_mfma_f32_16x16x32_bf16 v[164:167], v[64:67], v[180:183], v[164:167]
    ds_read_b64_tr_b16 v[176:177], v222 offset:30720
    ds_read_b64_tr_b16 v[178:179], v222 offset:31744
    ds_read_b64_tr_b16 v[180:181], v223 offset:30720
    ds_read_b64_tr_b16 v[182:183], v223 offset:31744
    s_waitcnt lgkmcnt(10)
    v_mfma_f32_16x16x32_bf16 v[160:163], v[68:71], v[184:187], v[160:163]
    s_waitcnt lgkmcnt(8)
    v_mfma_f32_16x16x32_bf16 v[164:167], v[68:71], v[188:191], v[164:167]
    ds_read_b64_tr_b16 v[184:185], v222 offset:32768
    ds_read_b64_tr_b16 v[186:187], v222 offset:33792
    ds_read_b64_tr_b16 v[188:189], v223 offset:32768
    ds_read_b64_tr_b16 v[190:191], v223 offset:33792
    s_waitcnt lgkmcnt(10)
    v_mfma_f32_16x16x32_bf16 v[160:163], v[72:75], v[192:195], v[160:163]
    s_waitcnt lgkmcnt(8)
    v_mfma_f32_16x16x32_bf16 v[164:167], v[72:75], v[196:199], v[164:167]
    ds_read_b64_tr_b16 v[192:193], v222 offset:34816
    ds_read_b64_tr_b16 v[194:195], v222 offset:35840
    ds_read_b64_tr_b16 v[196:197], v223 offset:34816
    ds_read_b64_tr_b16 v[198:199], v223 offset:35840
    s_waitcnt lgkmcnt(10)
    v_mfma_f32_16x16x32_bf16 v[160:163], v[76:79], v[176:179], v[160:163]
    s_waitcnt lgkmcnt(8)
    v_mfma_f32_16x16x32_bf16 v[164:167], v[76:79], v[180:183], v[164:167]
    s_waitcnt lgkmcnt(6)
    v_mfma_f32_16x16x32_bf16 v[160:163], v[80:83], v[184:187], v[160:163]
    s_waitcnt lgkmcnt(4)
    v_mfma_f32_16x16x32_bf16 v[164:167], v[80:83], v[188:191], v[164:167]
    s_waitcnt lgkmcnt(2)
    v_mfma_f32_16x16x32_bf16 v[160:163], v[84:87], v[192:195], v[160:163]
    s_waitcnt lgkmcnt(0)
    v_mfma_f32_16x16x32_bf16 v[164:167], v[84:87], v[196:199], v[164:167]
    s_lshl_b32 s67, s69, 4
    v_add_u32 v200, s67, v220
    v_lshlrev_b32 v208, 4, v200
    v_mul_hi_u32 v209, v208, s64
    v_mul_u32_u24 v209, s65, v209
    v_sub_u32 v208, v208, v209
    v_cvt_f32_u32 v208, v208
    v_mul_f32 v205, s66, v208
    v_lshlrev_b32 v210, 1, v221
    v_add_u32 v208, 0, v210
    v_mul_u32_u24 v208, v208, v200
    v_mul_hi_u32 v209, v208, s64
    v_mul_u32_u24 v209, s65, v209
    v_sub_u32 v208, v208, v209
    v_cvt_f32_u32 v208, v208
    v_mul_f32 v201, s66, v208
    v_add_u32 v208, 1, v210
    v_mul_u32_u24 v208, v208, v200
    v_mul_hi_u32 v209, v208, s64
    v_mul_u32_u24 v209, s65, v209
    v_sub_u32 v208, v208, v209
    v_cvt_f32_u32 v208, v208
    v_mul_f32 v202, s66, v208
    v_add_u32 v208, 8, v210
    v_mul_u32_u24 v208, v208, v200
    v_mul_hi_u32 v209, v208, s64
    v_mul_u32_u24 v209, s65, v209
    v_sub_u32 v208, v208, v209
    v_cvt_f32_u32 v208, v208
    v_mul_f32 v203, s66, v208
    v_add_u32 v208, 9, v210
    v_mul_u32_u24 v208, v208, v200
    v_mul_hi_u32 v209, v208, s64
    v_mul_u32_u24 v209, s65, v209
    v_sub_u32 v208, v208, v209
    v_cvt_f32_u32 v208, v208
    v_mul_f32 v204, s66, v208
    v_and_b32 v206, 1, v200
    v_lshlrev_b32 v206, 4, v206
    v_add_u32 v208, 1, v200
    v_bfe_u32 v208, v208, 1, 1
    v_lshlrev_b32 v208, 31, v208
    v_bfe_u32 v209, v200, 1, 1
    v_lshl_or_b32 v207, v209, 15, v208
    v_cos_f32 v208, v201
    v_sin_f32 v209, -v201
    v_cos_f32 v210, v202
    v_sin_f32 v211, -v202
    v_cos_f32 v212, v203
    v_sin_f32 v213, -v203
    v_cos_f32 v214, v204
    v_sin_f32 v215, -v204
    v_cvt_pk_bf16_f32 v16, v208, v209
    v_cvt_pk_bf16_f32 v17, v210, v211
    v_cvt_pk_bf16_f32 v18, v212, v213
    v_cvt_pk_bf16_f32 v19, v214, v215
    v_alignbit_b32 v52, v16, v16, v206
    v_alignbit_b32 v53, v17, v17, v206
    v_alignbit_b32 v54, v18, v18, v206
    v_alignbit_b32 v55, v19, v19, v206
    v_xor_b32 v52, v207, v52
    v_xor_b32 v53, v207, v53
    v_xor_b32 v54, v207, v54
    v_xor_b32 v55, v207, v55
    v_lshlrev_b32 v208, 27, v206
    v_or_b32 v208, 0x3f803f80, v208
    v_cmp_eq_u32 vcc, 0, v221
    s_nop 1
    v_cndmask_b32 v16, v16, v208, vcc
    v_fmamk_f32 v216, v205, 0x3f800000, v201
    v_fmamk_f32 v217, v205, 0x3f800000, v202
    v_fmamk_f32 v218, v205, 0x3f800000, v203
    v_fmamk_f32 v219, v205, 0x3f800000, v204
    v_cos_f32 v208, v216
    v_sin_f32 v209, -v216
    v_cos_f32 v210, v217
    v_sin_f32 v211, -v217
    v_cos_f32 v212, v218
    v_sin_f32 v213, -v218
    v_cos_f32 v214, v219
    v_sin_f32 v215, -v219
    v_cvt_pk_bf16_f32 v20, v208, v209
    v_cvt_pk_bf16_f32 v21, v210, v211
    v_cvt_pk_bf16_f32 v22, v212, v213
    v_cvt_pk_bf16_f32 v23, v214, v215
    v_alignbit_b32 v56, v20, v20, v206
    v_alignbit_b32 v57, v21, v21, v206
    v_alignbit_b32 v58, v22, v22, v206
    v_alignbit_b32 v59, v23, v23, v206
    v_xor_b32 v56, v207, v56
    v_xor_b32 v57, v207, v57
    v_xor_b32 v58, v207, v58
    v_xor_b32 v59, v207, v59
    v_fmamk_f32 v216, v205, 0x40000000, v201
    v_fmamk_f32 v217, v205, 0x40000000, v202
    v_fmamk_f32 v218, v205, 0x40000000, v203
    v_fmamk_f32 v219, v205, 0x40000000, v204
    v_cos_f32 v208, v216
    v_sin_f32 v209, -v216
    v_cos_f32 v210, v217
    v_sin_f32 v211, -v217
    v_cos_f32 v212, v218
    v_sin_f32 v213, -v218
    v_cos_f32 v214, v219
    v_sin_f32 v215, -v219
    v_cvt_pk_bf16_f32 v24, v208, v209
    v_cvt_pk_bf16_f32 v25, v210, v211
    v_cvt_pk_bf16_f32 v26, v212, v213
    v_cvt_pk_bf16_f32 v27, v214, v215
    v_alignbit_b32 v60, v24, v24, v206
    v_alignbit_b32 v61, v25, v25, v206
    v_alignbit_b32 v62, v26, v26, v206
    v_alignbit_b32 v63, v27, v27, v206
    v_xor_b32 v60, v207, v60
    v_xor_b32 v61, v207, v61
    v_xor_b32 v62, v207, v62
    v_xor_b32 v63, v207, v63
    v_fmamk_f32 v216, v205, 0x40400000, v201
    v_fmamk_f32 v217, v205, 0x40400000, v202
    v_fmamk_f32 v218, v205, 0x40400000, v203
    v_fmamk_f32 v219, v205, 0x40400000, v204
    v_cos_f32 v208, v216
    v_sin_f32 v209, -v216
    v_cos_f32 v210, v217
    v_sin_f32 v211, -v217
    v_cos_f32 v212, v218
    v_sin_f32 v213, -v218
    v_cos_f32 v214, v219
    v_sin_f32 v215, -v219
    v_cvt_pk_bf16_f32 v28, v208, v209
    v_cvt_pk_bf16_f32 v29, v210, v211
    v_cvt_pk_bf16_f32 v30, v212, v213
    v_cvt_pk_bf16_f32 v31, v214, v215
    v_alignbit_b32 v64, v28, v28, v206
    v_alignbit_b32 v65, v29, v29, v206
    v_alignbit_b32 v66, v30, v30, v206
    v_alignbit_b32 v67, v31, v31, v206
    v_xor_b32 v64, v207, v64
    v_xor_b32 v65, v207, v65
    v_xor_b32 v66, v207, v66
    v_xor_b32 v67, v207, v67
    v_fmamk_f32 v216, v205, 0x40800000, v201
    v_fmamk_f32 v217, v205, 0x40800000, v202
    v_fmamk_f32 v218, v205, 0x40800000, v203
    v_fmamk_f32 v219, v205, 0x40800000, v204
    v_cos_f32 v208, v216
    v_sin_f32 v209, -v216
    v_cos_f32 v210, v217
    v_sin_f32 v211, -v217
    v_cos_f32 v212, v218
    v_sin_f32 v213, -v218
    v_cos_f32 v214, v219
    v_sin_f32 v215, -v219
    v_cvt_pk_bf16_f32 v32, v208, v209
    v_cvt_pk_bf16_f32 v33, v210, v211
    v_cvt_pk_bf16_f32 v34, v212, v213
    v_cvt_pk_bf16_f32 v35, v214, v215
    v_alignbit_b32 v68, v32, v32, v206
    v_alignbit_b32 v69, v33, v33, v206
    v_alignbit_b32 v70, v34, v34, v206
    v_alignbit_b32 v71, v35, v35, v206
    v_xor_b32 v68, v207, v68
    v_xor_b32 v69, v207, v69
    v_xor_b32 v70, v207, v70
    v_xor_b32 v71, v207, v71
    v_fmamk_f32 v216, v205, 0x40a00000, v201
    v_fmamk_f32 v217, v205, 0x40a00000, v202
    v_fmamk_f32 v218, v205, 0x40a00000, v203
    v_fmamk_f32 v219, v205, 0x40a00000, v204
    v_cos_f32 v208, v216
    v_sin_f32 v209, -v216
    v_cos_f32 v210, v217
    v_sin_f32 v211, -v217
    v_cos_f32 v212, v218
    v_sin_f32 v213, -v218
    v_cos_f32 v214, v219
    v_sin_f32 v215, -v219
    v_cvt_pk_bf16_f32 v36, v208, v209
    v_cvt_pk_bf16_f32 v37, v210, v211
    v_cvt_pk_bf16_f32 v38, v212, v213
    v_cvt_pk_bf16_f32 v39, v214, v215
    v_alignbit_b32 v72, v36, v36, v206
    v_alignbit_b32 v73, v37, v37, v206
    v_alignbit_b32 v74, v38, v38, v206
    v_alignbit_b32 v75, v39, v39, v206
    v_xor_b32 v72, v207, v72
    v_xor_b32 v73, v207, v73
    v_xor_b32 v74, v207, v74
    v_xor_b32 v75, v207, v75
    v_fmamk_f32 v216, v205, 0x40c00000, v201
    v_fmamk_f32 v217, v205, 0x40c00000, v202
    v_fmamk_f32 v218, v205, 0x40c00000, v203
    v_fmamk_f32 v219, v205, 0x40c00000, v204
    v_cos_f32 v208, v216
    v_sin_f32 v209, -v216
    v_cos_f32 v210, v217
    v_sin_f32 v211, -v217
    v_cos_f32 v212, v218
    v_sin_f32 v213, -v218
    v_cos_f32 v214, v219
    v_sin_f32 v215, -v219
    v_cvt_pk_bf16_f32 v40, v208, v209
    v_cvt_pk_bf16_f32 v41, v210, v211
    v_cvt_pk_bf16_f32 v42, v212, v213
    v_cvt_pk_bf16_f32 v43, v214, v215
    v_alignbit_b32 v76, v40, v40, v206
    v_alignbit_b32 v77, v41, v41, v206
    v_alignbit_b32 v78, v42, v42, v206
    v_alignbit_b32 v79, v43, v43, v206
    v_xor_b32 v76, v207, v76
    v_xor_b32 v77, v207, v77
    v_xor_b32 v78, v207, v78
    v_xor_b32 v79, v207, v79
    v_fmamk_f32 v216, v205, 0x40e00000, v201
    v_fmamk_f32 v217, v205, 0x40e00000, v202
    v_fmamk_f32 v218, v205, 0x40e00000, v203
    v_fmamk_f32 v219, v205, 0x40e00000, v204
    v_cos_f32 v208, v216
    v_sin_f32 v209, -v216
    v_cos_f32 v210, v217
    v_sin_f32 v211, -v217
    v_cos_f32 v212, v218
    v_sin_f32 v213, -v218
    v_cos_f32 v214, v219
    v_sin_f32 v215, -v219
    v_cvt_pk_bf16_f32 v44, v208, v209
    v_cvt_pk_bf16_f32 v45, v210, v211
    v_cvt_pk_bf16_f32 v46, v212, v213
    v_cvt_pk_bf16_f32 v47, v214, v215
    v_alignbit_b32 v80, v44, v44, v206
    v_alignbit_b32 v81, v45, v45, v206
    v_alignbit_b32 v82, v46, v46, v206
    v_alignbit_b32 v83, v47, v47, v206
    v_xor_b32 v80, v207, v80
    v_xor_b32 v81, v207, v81
    v_xor_b32 v82, v207, v82
    v_xor_b32 v83, v207, v83
    v_fmamk_f32 v216, v205, 0x41000000, v201
    v_fmamk_f32 v217, v205, 0x41000000, v202
    v_fmamk_f32 v218, v205, 0x41000000, v203
    v_fmamk_f32 v219, v205, 0x41000000, v204
    v_cos_f32 v208, v216
    v_sin_f32 v209, -v216
    v_cos_f32 v210, v217
    v_sin_f32 v211, -v217
    v_cos_f32 v212, v218
    v_sin_f32 v213, -v218
    v_cos_f32 v214, v219
    v_sin_f32 v215, -v219
    v_cvt_pk_bf16_f32 v48, v208, v209
    v_cvt_pk_bf16_f32 v49, v210, v211
    v_cvt_pk_bf16_f32 v50, v212, v213
    v_cvt_pk_bf16_f32 v51, v214, v215
    v_alignbit_b32 v84, v48, v48, v206
    v_alignbit_b32 v85, v49, v49, v206
    v_alignbit_b32 v86, v50, v50, v206
    v_alignbit_b32 v87, v51, v51, v206
    v_xor_b32 v84, v207, v84
    v_xor_b32 v85, v207, v85
    v_xor_b32 v86, v207, v86
    v_xor_b32 v87, v207, v87
    ds_read_b64_tr_b16 v[176:177], v222 offset:0
    ds_read_b64_tr_b16 v[178:179], v222 offset:1024
    ds_read_b64_tr_b16 v[184:185], v222 offset:2048
    ds_read_b64_tr_b16 v[186:187], v222 offset:3072
    ds_read_b64_tr_b16 v[192:193], v222 offset:4096
    ds_read_b64_tr_b16 v[194:195], v222 offset:5120
    s_waitcnt lgkmcnt(4)
    v_mfma_f32_16x16x32_bf16 v[168:171], v[16:19], v[176:179], 0
    ds_read_b64_tr_b16 v[176:177], v222 offset:6144
    ds_read_b64_tr_b16 v[178:179], v222 offset:7168
    s_waitcnt lgkmcnt(4)
    v_mfma_f32_16x16x32_bf16 v[168:171], v[20:23], v[184:187], v[168:171]
    ds_read_b64_tr_b16 v[184:185], v222 offset:8192
    ds_read_b64_tr_b16 v[186:187], v222 offset:9216
    s_waitcnt lgkmcnt(4)
    v_mfma_f32_16x16x32_bf16 v[168:171], v[24:27], v[192:195], v[168:171]
    ds_read_b64_tr_b16 v[192:193], v222 offset:10240
    ds_read_b64_tr_b16 v[194:195], v222 offset:11264
    s_waitcnt lgkmcnt(4)
    v_mfma_f32_16x16x32_bf16 v[168:171], v[28:31], v[176:179], v[168:171]
    ds_read_b64_tr_b16 v[176:177], v222 offset:12288
    ds_read_b64_tr_b16 v[178:179], v222 offset:13312
    s_waitcnt lgkmcnt(4)
    v_mfma_f32_16x16x32_bf16 v[168:171], v[32:35], v[184:187], v[168:171]
    ds_read_b64_tr_b16 v[184:185], v222 offset:14336
    ds_read_b64_tr_b16 v[186:187], v222 offset:15360
    s_waitcnt lgkmcnt(4)
    v_mfma_f32_16x16x32_bf16 v[168:171], v[36:39], v[192:195], v[168:171]
    ds_read_b64_tr_b16 v[192:193], v222 offset:16384
    ds_read_b64_tr_b16 v[194:195], v222 offset:17408
    s_waitcnt lgkmcnt(4)
    v_mfma_f32_16x16x32_bf16 v[168:171], v[40:43], v[176:179], v[168:171]
    ds_read_b64_tr_b16 v[176:177], v222 offset:18432
    ds_read_b64_tr_b16 v[178:179], v222 offset:19456
    s_waitcnt lgkmcnt(4)
    v_mfma_f32_16x16x32_bf16 v[168:171], v[44:47], v[184:187], v[168:171]
    ds_read_b64_tr_b16 v[184:185], v222 offset:20480
    ds_read_b64_tr_b16 v[186:187], v222 offset:21504
    s_waitcnt lgkmcnt(4)
    v_mfma_f32_16x16x32_bf16 v[168:171], v[48:51], v[192:195], v[168:171]
    ds_read_b64_tr_b16 v[192:193], v222 offset:22528
    ds_read_b64_tr_b16 v[194:195], v222 offset:23552
    s_waitcnt lgkmcnt(4)
    v_mfma_f32_16x16x32_bf16 v[168:171], v[52:55], v[176:179], v[168:171]
    ds_read_b64_tr_b16 v[176:177], v222 offset:24576
    ds_read_b64_tr_b16 v[178:179], v222 offset:25600
    s_waitcnt lgkmcnt(4)
    v_mfma_f32_16x16x32_bf16 v[168:171], v[56:59], v[184:187], v[168:171]
    ds_read_b64_tr_b16 v[184:185], v222 offset:26624
    ds_read_b64_tr_b16 v[186:187], v222 offset:27648
    s_waitcnt lgkmcnt(4)
    v_mfma_f32_16x16x32_bf16 v[168:171], v[60:63], v[192:195], v[168:171]
    ds_read_b64_tr_b16 v[192:193], v222 offset:28672
    ds_read_b64_tr_b16 v[194:195], v222 offset:29696
    s_waitcnt lgkmcnt(4)
    v_mfma_f32_16x16x32_bf16 v[168:171], v[64:67], v[176:179], v[168:171]
    ds_read_b64_tr_b16 v[176:177], v222 offset:30720
    ds_read_b64_tr_b16 v[178:179], v222 offset:31744
    s_waitcnt lgkmcnt(4)
    v_mfma_f32_16x16x32_bf16 v[168:171], v[68:71], v[184:187], v[168:171]
    ds_read_b64_tr_b16 v[184:185], v222 offset:32768
    ds_read_b64_tr_b16 v[186:187], v222 offset:33792
    s_waitcnt lgkmcnt(4)
    v_mfma_f32_16x16x32_bf16 v[168:171], v[72:75], v[192:195], v[168:171]
    ds_read_b64_tr_b16 v[192:193], v222 offset:34816
    ds_read_b64_tr_b16 v[194:195], v222 offset:35840
    s_waitcnt lgkmcnt(4)
    v_mfma_f32_16x16x32_bf16 v[168:171], v[76:79], v[176:179], v[168:171]
    s_waitcnt lgkmcnt(2)
    v_mfma_f32_16x16x32_bf16 v[168:171], v[80:83], v[184:187], v[168:171]
    s_waitcnt lgkmcnt(0)
    v_mfma_f32_16x16x32_bf16 v[168:171], v[84:87], v[192:195], v[168:171]
    s_waitcnt vmcnt(17)
    v_lshlrev_b32 v176, 16, v88
    v_and_b32 v177, 0xffff0000, v88
    v_lshlrev_b32 v178, 16, v89
    v_and_b32 v179, 0xffff0000, v89
    v_lshlrev_b32 v180, 16, v90
    v_and_b32 v181, 0xffff0000, v90
    v_lshlrev_b32 v182, 16, v91
    v_and_b32 v183, 0xffff0000, v91
    s_waitcnt vmcnt(16)
    v_lshlrev_b32 v188, 16, v92
    v_and_b32 v189, 0xffff0000, v92
    v_lshlrev_b32 v190, 16, v93
    v_and_b32 v191, 0xffff0000, v93
    v_lshlrev_b32 v192, 16, v94
    v_and_b32 v193, 0xffff0000, v94
    v_lshlrev_b32 v194, 16, v95
    v_and_b32 v195, 0xffff0000, v95
    v_pk_add_f32 v[176:177], v[176:177], v[188:189]
    v_pk_add_f32 v[178:179], v[178:179], v[190:191]
    v_pk_add_f32 v[180:181], v[180:181], v[192:193]
    v_pk_add_f32 v[182:183], v[182:183], v[194:195]
    s_waitcnt vmcnt(15)
    v_lshlrev_b32 v188, 16, v96
    v_and_b32 v189, 0xffff0000, v96
    v_lshlrev_b32 v190, 16, v97
    v_and_b32 v191, 0xffff0000, v97
    v_lshlrev_b32 v192, 16, v98
    v_and_b32 v193, 0xffff0000, v98
    v_lshlrev_b32 v194, 16, v99
    v_and_b32 v195, 0xffff0000, v99
    v_pk_add_f32 v[176:177], v[176:177], v[188:189]
    v_pk_add_f32 v[178:179], v[178:179], v[190:191]
    v_pk_add_f32 v[180:181], v[180:181], v[192:193]
    v_pk_add_f32 v[182:183], v[182:183], v[194:195]
    s_waitcnt vmcnt(14)
    v_lshlrev_b32 v188, 16, v100
    v_and_b32 v189, 0xffff0000, v100
    v_lshlrev_b32 v190, 16, v101
    v_and_b32 v191, 0xffff0000, v101
    v_lshlrev_b32 v192, 16, v102
    v_and_b32 v193, 0xffff0000, v102
    v_lshlrev_b32 v194, 16, v103
    v_and_b32 v195, 0xffff0000, v103
    v_pk_add_f32 v[176:177], v[176:177], v[188:189]
    v_pk_add_f32 v[178:179], v[178:179], v[190:191]
    v_pk_add_f32 v[180:181], v[180:181], v[192:193]
    v_pk_add_f32 v[182:183], v[182:183], v[194:195]
    s_waitcnt vmcnt(13)
    v_lshlrev_b32 v188, 16, v104
    v_and_b32 v189, 0xffff0000, v104
    v_lshlrev_b32 v190, 16, v105
    v_and_b32 v191, 0xffff0000, v105
    v_lshlrev_b32 v192, 16, v106
    v_and_b32 v193, 0xffff0000, v106
    v_lshlrev_b32 v194, 16, v107
    v_and_b32 v195, 0xffff0000, v107
    v_pk_add_f32 v[176:177], v[176:177], v[188:189]
    v_pk_add_f32 v[178:179], v[178:179], v[190:191]
    v_pk_add_f32 v[180:181], v[180:181], v[192:193]
    v_pk_add_f32 v[182:183], v[182:183], v[194:195]
    s_waitcnt vmcnt(12)
    v_lshlrev_b32 v188, 16, v108
    v_and_b32 v189, 0xffff0000, v108
    v_lshlrev_b32 v190, 16, v109
    v_and_b32 v191, 0xffff0000, v109
    v_lshlrev_b32 v192, 16, v110
    v_and_b32 v193, 0xffff0000, v110
    v_lshlrev_b32 v194, 16, v111
    v_and_b32 v195, 0xffff0000, v111
    v_pk_add_f32 v[176:177], v[176:177], v[188:189]
    v_pk_add_f32 v[178:179], v[178:179], v[190:191]
    v_pk_add_f32 v[180:181], v[180:181], v[192:193]
    v_pk_add_f32 v[182:183], v[182:183], v[194:195]
    s_waitcnt vmcnt(11)
    v_lshlrev_b32 v188, 16, v112
    v_and_b32 v189, 0xffff0000, v112
    v_lshlrev_b32 v190, 16, v113
    v_and_b32 v191, 0xffff0000, v113
    v_lshlrev_b32 v192, 16, v114
    v_and_b32 v193, 0xffff0000, v114
    v_lshlrev_b32 v194, 16, v115
    v_and_b32 v195, 0xffff0000, v115
    v_pk_add_f32 v[176:177], v[176:177], v[188:189]
    v_pk_add_f32 v[178:179], v[178:179], v[190:191]
    v_pk_add_f32 v[180:181], v[180:181], v[192:193]
    v_pk_add_f32 v[182:183], v[182:183], v[194:195]
    s_waitcnt vmcnt(10)
    v_lshlrev_b32 v188, 16, v116
    v_and_b32 v189, 0xffff0000, v116
    v_lshlrev_b32 v190, 16, v117
    v_and_b32 v191, 0xffff0000, v117
    v_lshlrev_b32 v192, 16, v118
    v_and_b32 v193, 0xffff0000, v118
    v_lshlrev_b32 v194, 16, v119
    v_and_b32 v195, 0xffff0000, v119
    v_pk_add_f32 v[176:177], v[176:177], v[188:189]
    v_pk_add_f32 v[178:179], v[178:179], v[190:191]
    v_pk_add_f32 v[180:181], v[180:181], v[192:193]
    v_pk_add_f32 v[182:183], v[182:183], v[194:195]
    v_lshlrev_b32 v196, 16, v232
    v_and_b32 v197, 0xffff0000, v232
    v_lshlrev_b32 v198, 16, v233
    v_and_b32 v199, 0xffff0000, v233
    v_cvt_pk_bf16_f32 v190, v176, v177
    v_lshlrev_b32 v176, 16, v190
    v_and_b32 v177, 0xffff0000, v190
    v_pk_add_f32 v[176:177], v[176:177], v[196:197]
    v_cvt_pk_bf16_f32 v190, v176, v177
    v_lshlrev_b32 v176, 16, v190
    v_and_b32 v177, 0xffff0000, v190
    v_cvt_pk_bf16_f32 v190, v160, v161
    v_lshlrev_b32 v160, 16, v190
    v_and_b32 v161, 0xffff0000, v190
    v_lshlrev_b32 v188, 16, v228
    v_and_b32 v189, 0xffff0000, v228
    v_pk_add_f32 v[160:161], v[160:161], v[188:189]
    v_cvt_pk_bf16_f32 v190, v160, v161
    v_lshlrev_b32 v160, 16, v190
    v_and_b32 v161, 0xffff0000, v190
    v_pk_add_f32 v[160:161], v[160:161], v[176:177]
    v_cvt_pk_bf16_f32 v200, v160, v161
    v_cvt_pk_bf16_f32 v190, v178, v179
    v_lshlrev_b32 v178, 16, v190
    v_and_b32 v179, 0xffff0000, v190
    v_pk_add_f32 v[178:179], v[178:179], v[198:199]
    v_cvt_pk_bf16_f32 v190, v178, v179
    v_lshlrev_b32 v178, 16, v190
    v_and_b32 v179, 0xffff0000, v190
    v_cvt_pk_bf16_f32 v190, v162, v163
    v_lshlrev_b32 v162, 16, v190
    v_and_b32 v163, 0xffff0000, v190
    v_lshlrev_b32 v188, 16, v229
    v_and_b32 v189, 0xffff0000, v229
    v_pk_add_f32 v[162:163], v[162:163], v[188:189]
    v_cvt_pk_bf16_f32 v190, v162, v163
    v_lshlrev_b32 v162, 16, v190
    v_and_b32 v163, 0xffff0000, v190
    v_pk_add_f32 v[162:163], v[162:163], v[178:179]
    v_cvt_pk_bf16_f32 v201, v162, v163
    v_cvt_pk_bf16_f32 v190, v180, v181
    v_lshlrev_b32 v180, 16, v190
    v_and_b32 v181, 0xffff0000, v190
    v_pk_add_f32 v[180:181], v[180:181], v[196:197]
    v_cvt_pk_bf16_f32 v190, v180, v181
    v_lshlrev_b32 v180, 16, v190
    v_and_b32 v181, 0xffff0000, v190
    v_cvt_pk_bf16_f32 v190, v164, v165
    v_lshlrev_b32 v164, 16, v190
    v_and_b32 v165, 0xffff0000, v190
    v_lshlrev_b32 v188, 16, v230
    v_and_b32 v189, 0xffff0000, v230
    v_pk_add_f32 v[164:165], v[164:165], v[188:189]
    v_cvt_pk_bf16_f32 v190, v164, v165
    v_lshlrev_b32 v164, 16, v190
    v_and_b32 v165, 0xffff0000, v190
    v_pk_add_f32 v[164:165], v[164:165], v[180:181]
    v_cvt_pk_bf16_f32 v202, v164, v165
    v_cvt_pk_bf16_f32 v190, v182, v183
    v_lshlrev_b32 v182, 16, v190
    v_and_b32 v183, 0xffff0000, v190
    v_pk_add_f32 v[182:183], v[182:183], v[198:199]
    v_cvt_pk_bf16_f32 v190, v182, v183
    v_lshlrev_b32 v182, 16, v190
    v_and_b32 v183, 0xffff0000, v190
    v_cvt_pk_bf16_f32 v190, v166, v167
    v_lshlrev_b32 v166, 16, v190
    v_and_b32 v167, 0xffff0000, v190
    v_lshlrev_b32 v188, 16, v231
    v_and_b32 v189, 0xffff0000, v231
    v_pk_add_f32 v[166:167], v[166:167], v[188:189]
    v_cvt_pk_bf16_f32 v190, v166, v167
    v_lshlrev_b32 v166, 16, v190
    v_and_b32 v167, 0xffff0000, v190
    v_pk_add_f32 v[166:167], v[166:167], v[182:183]
    v_cvt_pk_bf16_f32 v203, v166, v167
    buffer_store_dwordx2 v[200:201], v224, s[8:11], s72 offen
    buffer_store_dwordx2 v[202:203], v225, s[8:11], s72 offen
    s_waitcnt vmcnt(2)
    v_lshlrev_b32 v184, 16, v120
    v_and_b32 v185, 0xffff0000, v120
    v_lshlrev_b32 v186, 16, v121
    v_and_b32 v187, 0xffff0000, v121
    v_lshlrev_b32 v188, 16, v122
    v_and_b32 v189, 0xffff0000, v122
    v_lshlrev_b32 v190, 16, v123
    v_and_b32 v191, 0xffff0000, v123
    v_pk_add_f32 v[184:185], v[184:185], v[188:189]
    v_pk_add_f32 v[186:187], v[186:187], v[190:191]
    v_lshlrev_b32 v188, 16, v124
    v_and_b32 v189, 0xffff0000, v124
    v_lshlrev_b32 v190, 16, v125
    v_and_b32 v191, 0xffff0000, v125
    v_pk_add_f32 v[184:185], v[184:185], v[188:189]
    v_pk_add_f32 v[186:187], v[186:187], v[190:191]
    v_lshlrev_b32 v188, 16, v126
    v_and_b32 v189, 0xffff0000, v126
    v_lshlrev_b32 v190, 16, v127
    v_and_b32 v191, 0xffff0000, v127
    v_pk_add_f32 v[184:185], v[184:185], v[188:189]
    v_pk_add_f32 v[186:187], v[186:187], v[190:191]
    v_lshlrev_b32 v188, 16, v128
    v_and_b32 v189, 0xffff0000, v128
    v_lshlrev_b32 v190, 16, v129
    v_and_b32 v191, 0xffff0000, v129
    v_pk_add_f32 v[184:185], v[184:185], v[188:189]
    v_pk_add_f32 v[186:187], v[186:187], v[190:191]
    v_lshlrev_b32 v188, 16, v130
    v_and_b32 v189, 0xffff0000, v130
    v_lshlrev_b32 v190, 16, v131
    v_and_b32 v191, 0xffff0000, v131
    v_pk_add_f32 v[184:185], v[184:185], v[188:189]
    v_pk_add_f32 v[186:187], v[186:187], v[190:191]
    v_lshlrev_b32 v188, 16, v132
    v_and_b32 v189, 0xffff0000, v132
    v_lshlrev_b32 v190, 16, v133
    v_and_b32 v191, 0xffff0000, v133
    v_pk_add_f32 v[184:185], v[184:185], v[188:189]
    v_pk_add_f32 v[186:187], v[186:187], v[190:191]
    v_lshlrev_b32 v188, 16, v134
    v_and_b32 v189, 0xffff0000, v134
    v_lshlrev_b32 v190, 16, v135
    v_and_b32 v191, 0xffff0000, v135
    v_pk_add_f32 v[184:185], v[184:185], v[188:189]
    v_pk_add_f32 v[186:187], v[186:187], v[190:191]
    v_lshlrev_b32 v196, 16, v236
    v_and_b32 v197, 0xffff0000, v236
    v_lshlrev_b32 v198, 16, v237
    v_and_b32 v199, 0xffff0000, v237
    v_cvt_pk_bf16_f32 v190, v184, v185
    v_lshlrev_b32 v184, 16, v190
    v_and_b32 v185, 0xffff0000, v190
    v_pk_add_f32 v[184:185], v[184:185], v[196:197]
    v_cvt_pk_bf16_f32 v190, v184, v185
    v_lshlrev_b32 v184, 16, v190
    v_and_b32 v185, 0xffff0000, v190
    v_cvt_pk_bf16_f32 v190, v168, v169
    v_lshlrev_b32 v168, 16, v190
    v_and_b32 v169, 0xffff0000, v190
    v_lshlrev_b32 v188, 16, v234
    v_and_b32 v189, 0xffff0000, v234
    v_pk_add_f32 v[168:169], v[168:169], v[188:189]
    v_cvt_pk_bf16_f32 v190, v168, v169
    v_lshlrev_b32 v168, 16, v190
    v_and_b32 v169, 0xffff0000, v190
    v_pk_add_f32 v[168:169], v[168:169], v[184:185]
    v_cvt_pk_bf16_f32 v204, v168, v169
    v_cvt_pk_bf16_f32 v190, v186, v187
    v_lshlrev_b32 v186, 16, v190
    v_and_b32 v187, 0xffff0000, v190
    v_pk_add_f32 v[186:187], v[186:187], v[198:199]
    v_cvt_pk_bf16_f32 v190, v186, v187
    v_lshlrev_b32 v186, 16, v190
    v_and_b32 v187, 0xffff0000, v190
    v_cvt_pk_bf16_f32 v190, v170, v171
    v_lshlrev_b32 v170, 16, v190
    v_and_b32 v171, 0xffff0000, v190
    v_lshlrev_b32 v188, 16, v235
    v_and_b32 v189, 0xffff0000, v235
    v_pk_add_f32 v[170:171], v[170:171], v[188:189]
    v_cvt_pk_bf16_f32 v190, v170, v171
    v_lshlrev_b32 v170, 16, v190
    v_and_b32 v171, 0xffff0000, v190
    v_pk_add_f32 v[170:171], v[170:171], v[186:187]
    v_cvt_pk_bf16_f32 v205, v170, v171
    buffer_store_dwordx2 v[204:205], v224, s[8:11], s74 offen
    s_endpgm
fused_kernel_e0_w3:
    s_waitcnt lgkmcnt(0)
    s_barrier
    s_add_u32 s80, s76, 0x0
    buffer_load_dwordx4 v[88:91], v1, s[12:15], s80 offen sc1
    s_add_u32 s80, s76, 0x240000
    buffer_load_dwordx4 v[92:95], v1, s[12:15], s80 offen sc1
    s_add_u32 s80, s76, 0x480000
    buffer_load_dwordx4 v[96:99], v1, s[12:15], s80 offen sc1
    s_add_u32 s80, s76, 0x6c0000
    buffer_load_dwordx4 v[100:103], v1, s[12:15], s80 offen sc1
    s_add_u32 s80, s76, 0x900000
    buffer_load_dwordx4 v[104:107], v1, s[12:15], s80 offen sc1
    s_add_u32 s80, s76, 0xb40000
    buffer_load_dwordx4 v[108:111], v1, s[12:15], s80 offen sc1
    s_add_u32 s80, s76, 0xd80000
    buffer_load_dwordx4 v[112:115], v1, s[12:15], s80 offen sc1
    s_add_u32 s80, s76, 0xfc0000
    buffer_load_dwordx4 v[116:119], v1, s[12:15], s80 offen sc1
    s_add_u32 s80, s77, 0x0
    buffer_load_dwordx2 v[120:121], v1, s[12:15], s80 offen sc1
    s_add_u32 s80, s77, 0x240000
    buffer_load_dwordx2 v[122:123], v1, s[12:15], s80 offen sc1
    s_add_u32 s80, s77, 0x480000
    buffer_load_dwordx2 v[124:125], v1, s[12:15], s80 offen sc1
    s_add_u32 s80, s77, 0x6c0000
    buffer_load_dwordx2 v[126:127], v1, s[12:15], s80 offen sc1
    s_add_u32 s80, s77, 0x900000
    buffer_load_dwordx2 v[128:129], v1, s[12:15], s80 offen sc1
    s_add_u32 s80, s77, 0xb40000
    buffer_load_dwordx2 v[130:131], v1, s[12:15], s80 offen sc1
    s_add_u32 s80, s77, 0xd80000
    buffer_load_dwordx2 v[132:133], v1, s[12:15], s80 offen sc1
    s_add_u32 s80, s77, 0xfc0000
    buffer_load_dwordx2 v[134:135], v1, s[12:15], s80 offen sc1
    buffer_load_dwordx2 v[234:235], v224, s[4:7], s74 offen
    buffer_load_dwordx2 v[236:237], v226, s[16:19], s75 offen
    v_fmamk_f32 v216, v205, 0x41000000, v201
    v_fmamk_f32 v217, v205, 0x41000000, v202
    v_fmamk_f32 v218, v205, 0x41000000, v203
    v_fmamk_f32 v219, v205, 0x41000000, v204
    v_cos_f32 v208, v216
    v_sin_f32 v209, -v216
    v_cos_f32 v210, v217
    v_sin_f32 v211, -v217
    v_cos_f32 v212, v218
    v_sin_f32 v213, -v218
    v_cos_f32 v214, v219
    v_sin_f32 v215, -v219
    v_cvt_pk_bf16_f32 v48, v208, v209
    v_cvt_pk_bf16_f32 v49, v210, v211
    v_cvt_pk_bf16_f32 v50, v212, v213
    v_cvt_pk_bf16_f32 v51, v214, v215
    v_alignbit_b32 v84, v48, v48, v206
    v_alignbit_b32 v85, v49, v49, v206
    v_alignbit_b32 v86, v50, v50, v206
    v_alignbit_b32 v87, v51, v51, v206
    v_xor_b32 v84, v207, v84
    v_xor_b32 v85, v207, v85
    v_xor_b32 v86, v207, v86
    v_xor_b32 v87, v207, v87
    ds_read_b64_tr_b16 v[176:177], v222 offset:0
    ds_read_b64_tr_b16 v[178:179], v222 offset:1024
    ds_read_b64_tr_b16 v[180:181], v223 offset:0
    ds_read_b64_tr_b16 v[182:183], v223 offset:1024
    ds_read_b64_tr_b16 v[184:185], v222 offset:2048
    ds_read_b64_tr_b16 v[186:187], v222 offset:3072
    ds_read_b64_tr_b16 v[188:189], v223 offset:2048
    ds_read_b64_tr_b16 v[190:191], v223 offset:3072
    ds_read_b64_tr_b16 v[192:193], v222 offset:4096
    ds_read_b64_tr_b16 v[194:195], v222 offset:5120
    ds_read_b64_tr_b16 v[196:197], v223 offset:4096
    ds_read_b64_tr_b16 v[198:199], v223 offset:5120
    s_waitcnt lgkmcnt(10)
    v_mfma_f32_16x16x32_bf16 v[160:163], v[16:19], v[176:179], 0
    s_waitcnt lgkmcnt(8)
    v_mfma_f32_16x16x32_bf16 v[164:167], v[16:19], v[180:183], 0
    ds_read_b64_tr_b16 v[176:177], v222 offset:6144
    ds_read_b64_tr_b16 v[178:179], v222 offset:7168
    ds_read_b64_tr_b16 v[180:181], v223 offset:6144
    ds_read_b64_tr_b16 v[182:183], v223 offset:7168
    s_waitcnt lgkmcnt(10)
    v_mfma_f32_16x16x32_bf16 v[160:163], v[20:23], v[184:187], v[160:163]
    s_waitcnt lgkmcnt(8)
    v_mfma_f32_16x16x32_bf16 v[164:167], v[20:23], v[188:191], v[164:167]
    ds_read_b64_tr_b16 v[184:185], v222 offset:8192
    ds_read_b64_tr_b16 v[186:187], v222 offset:9216
    ds_read_b64_tr_b16 v[188:189], v223 offset:8192
    ds_read_b64_tr_b16 v[190:191], v223 offset:9216
    s_waitcnt lgkmcnt(10)
    v_mfma_f32_16x16x32_bf16 v[160:163], v[24:27], v[192:195], v[160:163]
    s_waitcnt lgkmcnt(8)
    v_mfma_f32_16x16x32_bf16 v[164:167], v[24:27], v[196:199], v[164:167]
    ds_read_b64_tr_b16 v[192:193], v222 offset:10240
    ds_read_b64_tr_b16 v[194:195], v222 offset:11264
    ds_read_b64_tr_b16 v[196:197], v223 offset:10240
    ds_read_b64_tr_b16 v[198:199], v223 offset:11264
    s_waitcnt lgkmcnt(10)
    v_mfma_f32_16x16x32_bf16 v[160:163], v[28:31], v[176:179], v[160:163]
    s_waitcnt lgkmcnt(8)
    v_mfma_f32_16x16x32_bf16 v[164:167], v[28:31], v[180:183], v[164:167]
    ds_read_b64_tr_b16 v[176:177], v222 offset:12288
    ds_read_b64_tr_b16 v[178:179], v222 offset:13312
    ds_read_b64_tr_b16 v[180:181], v223 offset:12288
    ds_read_b64_tr_b16 v[182:183], v223 offset:13312
    s_waitcnt lgkmcnt(10)
    v_mfma_f32_16x16x32_bf16 v[160:163], v[32:35], v[184:187], v[160:163]
    s_waitcnt lgkmcnt(8)
    v_mfma_f32_16x16x32_bf16 v[164:167], v[32:35], v[188:191], v[164:167]
    ds_read_b64_tr_b16 v[184:185], v222 offset:14336
    ds_read_b64_tr_b16 v[186:187], v222 offset:15360
    ds_read_b64_tr_b16 v[188:189], v223 offset:14336
    ds_read_b64_tr_b16 v[190:191], v223 offset:15360
    s_waitcnt lgkmcnt(10)
    v_mfma_f32_16x16x32_bf16 v[160:163], v[36:39], v[192:195], v[160:163]
    s_waitcnt lgkmcnt(8)
    v_mfma_f32_16x16x32_bf16 v[164:167], v[36:39], v[196:199], v[164:167]
    ds_read_b64_tr_b16 v[192:193], v222 offset:16384
    ds_read_b64_tr_b16 v[194:195], v222 offset:17408
    ds_read_b64_tr_b16 v[196:197], v223 offset:16384
    ds_read_b64_tr_b16 v[198:199], v223 offset:17408
    s_waitcnt lgkmcnt(10)
    v_mfma_f32_16x16x32_bf16 v[160:163], v[40:43], v[176:179], v[160:163]
    s_waitcnt lgkmcnt(8)
    v_mfma_f32_16x16x32_bf16 v[164:167], v[40:43], v[180:183], v[164:167]
    ds_read_b64_tr_b16 v[176:177], v222 offset:18432
    ds_read_b64_tr_b16 v[178:179], v222 offset:19456
    ds_read_b64_tr_b16 v[180:181], v223 offset:18432
    ds_read_b64_tr_b16 v[182:183], v223 offset:19456
    s_waitcnt lgkmcnt(10)
    v_mfma_f32_16x16x32_bf16 v[160:163], v[44:47], v[184:187], v[160:163]
    s_waitcnt lgkmcnt(8)
    v_mfma_f32_16x16x32_bf16 v[164:167], v[44:47], v[188:191], v[164:167]
    ds_read_b64_tr_b16 v[184:185], v222 offset:20480
    ds_read_b64_tr_b16 v[186:187], v222 offset:21504
    ds_read_b64_tr_b16 v[188:189], v223 offset:20480
    ds_read_b64_tr_b16 v[190:191], v223 offset:21504
    s_waitcnt lgkmcnt(10)
    v_mfma_f32_16x16x32_bf16 v[160:163], v[48:51], v[192:195], v[160:163]
    s_waitcnt lgkmcnt(8)
    v_mfma_f32_16x16x32_bf16 v[164:167], v[48:51], v[196:199], v[164:167]
    ds_read_b64_tr_b16 v[192:193], v222 offset:22528
    ds_read_b64_tr_b16 v[194:195], v222 offset:23552
    ds_read_b64_tr_b16 v[196:197], v223 offset:22528
    ds_read_b64_tr_b16 v[198:199], v223 offset:23552
    s_waitcnt lgkmcnt(10)
    v_mfma_f32_16x16x32_bf16 v[160:163], v[52:55], v[176:179], v[160:163]
    s_waitcnt lgkmcnt(8)
    v_mfma_f32_16x16x32_bf16 v[164:167], v[52:55], v[180:183], v[164:167]
    ds_read_b64_tr_b16 v[176:177], v222 offset:24576
    ds_read_b64_tr_b16 v[178:179], v222 offset:25600
    ds_read_b64_tr_b16 v[180:181], v223 offset:24576
    ds_read_b64_tr_b16 v[182:183], v223 offset:25600
    s_waitcnt lgkmcnt(10)
    v_mfma_f32_16x16x32_bf16 v[160:163], v[56:59], v[184:187], v[160:163]
    s_waitcnt lgkmcnt(8)
    v_mfma_f32_16x16x32_bf16 v[164:167], v[56:59], v[188:191], v[164:167]
    ds_read_b64_tr_b16 v[184:185], v222 offset:26624
    ds_read_b64_tr_b16 v[186:187], v222 offset:27648
    ds_read_b64_tr_b16 v[188:189], v223 offset:26624
    ds_read_b64_tr_b16 v[190:191], v223 offset:27648
    s_waitcnt lgkmcnt(10)
    v_mfma_f32_16x16x32_bf16 v[160:163], v[60:63], v[192:195], v[160:163]
    s_waitcnt lgkmcnt(8)
    v_mfma_f32_16x16x32_bf16 v[164:167], v[60:63], v[196:199], v[164:167]
    ds_read_b64_tr_b16 v[192:193], v222 offset:28672
    ds_read_b64_tr_b16 v[194:195], v222 offset:29696
    ds_read_b64_tr_b16 v[196:197], v223 offset:28672
    ds_read_b64_tr_b16 v[198:199], v223 offset:29696
    s_waitcnt lgkmcnt(10)
    v_mfma_f32_16x16x32_bf16 v[160:163], v[64:67], v[176:179], v[160:163]
    s_waitcnt lgkmcnt(8)
    v_mfma_f32_16x16x32_bf16 v[164:167], v[64:67], v[180:183], v[164:167]
    ds_read_b64_tr_b16 v[176:177], v222 offset:30720
    ds_read_b64_tr_b16 v[178:179], v222 offset:31744
    ds_read_b64_tr_b16 v[180:181], v223 offset:30720
    ds_read_b64_tr_b16 v[182:183], v223 offset:31744
    s_waitcnt lgkmcnt(10)
    v_mfma_f32_16x16x32_bf16 v[160:163], v[68:71], v[184:187], v[160:163]
    s_waitcnt lgkmcnt(8)
    v_mfma_f32_16x16x32_bf16 v[164:167], v[68:71], v[188:191], v[164:167]
    ds_read_b64_tr_b16 v[184:185], v222 offset:32768
    ds_read_b64_tr_b16 v[186:187], v222 offset:33792
    ds_read_b64_tr_b16 v[188:189], v223 offset:32768
    ds_read_b64_tr_b16 v[190:191], v223 offset:33792
    s_waitcnt lgkmcnt(10)
    v_mfma_f32_16x16x32_bf16 v[160:163], v[72:75], v[192:195], v[160:163]
    s_waitcnt lgkmcnt(8)
    v_mfma_f32_16x16x32_bf16 v[164:167], v[72:75], v[196:199], v[164:167]
    ds_read_b64_tr_b16 v[192:193], v222 offset:34816
    ds_read_b64_tr_b16 v[194:195], v222 offset:35840
    ds_read_b64_tr_b16 v[196:197], v223 offset:34816
    ds_read_b64_tr_b16 v[198:199], v223 offset:35840
    s_waitcnt lgkmcnt(10)
    v_mfma_f32_16x16x32_bf16 v[160:163], v[76:79], v[176:179], v[160:163]
    s_waitcnt lgkmcnt(8)
    v_mfma_f32_16x16x32_bf16 v[164:167], v[76:79], v[180:183], v[164:167]
    s_waitcnt lgkmcnt(6)
    v_mfma_f32_16x16x32_bf16 v[160:163], v[80:83], v[184:187], v[160:163]
    s_waitcnt lgkmcnt(4)
    v_mfma_f32_16x16x32_bf16 v[164:167], v[80:83], v[188:191], v[164:167]
    s_waitcnt lgkmcnt(2)
    v_mfma_f32_16x16x32_bf16 v[160:163], v[84:87], v[192:195], v[160:163]
    s_waitcnt lgkmcnt(0)
    v_mfma_f32_16x16x32_bf16 v[164:167], v[84:87], v[196:199], v[164:167]
    s_lshl_b32 s67, s69, 4
    v_add_u32 v200, s67, v220
    v_lshlrev_b32 v208, 4, v200
    v_mul_hi_u32 v209, v208, s64
    v_mul_u32_u24 v209, s65, v209
    v_sub_u32 v208, v208, v209
    v_cvt_f32_u32 v208, v208
    v_mul_f32 v205, s66, v208
    v_lshlrev_b32 v210, 1, v221
    v_add_u32 v208, 0, v210
    v_mul_u32_u24 v208, v208, v200
    v_mul_hi_u32 v209, v208, s64
    v_mul_u32_u24 v209, s65, v209
    v_sub_u32 v208, v208, v209
    v_cvt_f32_u32 v208, v208
    v_mul_f32 v201, s66, v208
    v_add_u32 v208, 1, v210
    v_mul_u32_u24 v208, v208, v200
    v_mul_hi_u32 v209, v208, s64
    v_mul_u32_u24 v209, s65, v209
    v_sub_u32 v208, v208, v209
    v_cvt_f32_u32 v208, v208
    v_mul_f32 v202, s66, v208
    v_add_u32 v208, 8, v210
    v_mul_u32_u24 v208, v208, v200
    v_mul_hi_u32 v209, v208, s64
    v_mul_u32_u24 v209, s65, v209
    v_sub_u32 v208, v208, v209
    v_cvt_f32_u32 v208, v208
    v_mul_f32 v203, s66, v208
    v_add_u32 v208, 9, v210
    v_mul_u32_u24 v208, v208, v200
    v_mul_hi_u32 v209, v208, s64
    v_mul_u32_u24 v209, s65, v209
    v_sub_u32 v208, v208, v209
    v_cvt_f32_u32 v208, v208
    v_mul_f32 v204, s66, v208
    v_and_b32 v206, 1, v200
    v_lshlrev_b32 v206, 4, v206
    v_add_u32 v208, 1, v200
    v_bfe_u32 v208, v208, 1, 1
    v_lshlrev_b32 v208, 31, v208
    v_bfe_u32 v209, v200, 1, 1
    v_lshl_or_b32 v207, v209, 15, v208
    v_cos_f32 v208, v201
    v_sin_f32 v209, -v201
    v_cos_f32 v210, v202
    v_sin_f32 v211, -v202
    v_cos_f32 v212, v203
    v_sin_f32 v213, -v203
    v_cos_f32 v214, v204
    v_sin_f32 v215, -v204
    v_cvt_pk_bf16_f32 v16, v208, v209
    v_cvt_pk_bf16_f32 v17, v210, v211
    v_cvt_pk_bf16_f32 v18, v212, v213
    v_cvt_pk_bf16_f32 v19, v214, v215
    v_alignbit_b32 v52, v16, v16, v206
    v_alignbit_b32 v53, v17, v17, v206
    v_alignbit_b32 v54, v18, v18, v206
    v_alignbit_b32 v55, v19, v19, v206
    v_xor_b32 v52, v207, v52
    v_xor_b32 v53, v207, v53
    v_xor_b32 v54, v207, v54
    v_xor_b32 v55, v207, v55
    v_lshlrev_b32 v208, 27, v206
    v_or_b32 v208, 0x3f803f80, v208
    v_cmp_eq_u32 vcc, 0, v221
    s_nop 1
    v_cndmask_b32 v16, v16, v208, vcc
    v_fmamk_f32 v216, v205, 0x3f800000, v201
    v_fmamk_f32 v217, v205, 0x3f800000, v202
    v_fmamk_f32 v218, v205, 0x3f800000, v203
    v_fmamk_f32 v219, v205, 0x3f800000, v204
    v_cos_f32 v208, v216
    v_sin_f32 v209, -v216
    v_cos_f32 v210, v217
    v_sin_f32 v211, -v217
    v_cos_f32 v212, v218
    v_sin_f32 v213, -v218
    v_cos_f32 v214, v219
    v_sin_f32 v215, -v219
    v_cvt_pk_bf16_f32 v20, v208, v209
    v_cvt_pk_bf16_f32 v21, v210, v211
    v_cvt_pk_bf16_f32 v22, v212, v213
    v_cvt_pk_bf16_f32 v23, v214, v215
    v_alignbit_b32 v56, v20, v20, v206
    v_alignbit_b32 v57, v21, v21, v206
    v_alignbit_b32 v58, v22, v22, v206
    v_alignbit_b32 v59, v23, v23, v206
    v_xor_b32 v56, v207, v56
    v_xor_b32 v57, v207, v57
    v_xor_b32 v58, v207, v58
    v_xor_b32 v59, v207, v59
    v_fmamk_f32 v216, v205, 0x40000000, v201
    v_fmamk_f32 v217, v205, 0x40000000, v202
    v_fmamk_f32 v218, v205, 0x40000000, v203
    v_fmamk_f32 v219, v205, 0x40000000, v204
    v_cos_f32 v208, v216
    v_sin_f32 v209, -v216
    v_cos_f32 v210, v217
    v_sin_f32 v211, -v217
    v_cos_f32 v212, v218
    v_sin_f32 v213, -v218
    v_cos_f32 v214, v219
    v_sin_f32 v215, -v219
    v_cvt_pk_bf16_f32 v24, v208, v209
    v_cvt_pk_bf16_f32 v25, v210, v211
    v_cvt_pk_bf16_f32 v26, v212, v213
    v_cvt_pk_bf16_f32 v27, v214, v215
    v_alignbit_b32 v60, v24, v24, v206
    v_alignbit_b32 v61, v25, v25, v206
    v_alignbit_b32 v62, v26, v26, v206
    v_alignbit_b32 v63, v27, v27, v206
    v_xor_b32 v60, v207, v60
    v_xor_b32 v61, v207, v61
    v_xor_b32 v62, v207, v62
    v_xor_b32 v63, v207, v63
    v_fmamk_f32 v216, v205, 0x40400000, v201
    v_fmamk_f32 v217, v205, 0x40400000, v202
    v_fmamk_f32 v218, v205, 0x40400000, v203
    v_fmamk_f32 v219, v205, 0x40400000, v204
    v_cos_f32 v208, v216
    v_sin_f32 v209, -v216
    v_cos_f32 v210, v217
    v_sin_f32 v211, -v217
    v_cos_f32 v212, v218
    v_sin_f32 v213, -v218
    v_cos_f32 v214, v219
    v_sin_f32 v215, -v219
    v_cvt_pk_bf16_f32 v28, v208, v209
    v_cvt_pk_bf16_f32 v29, v210, v211
    v_cvt_pk_bf16_f32 v30, v212, v213
    v_cvt_pk_bf16_f32 v31, v214, v215
    v_alignbit_b32 v64, v28, v28, v206
    v_alignbit_b32 v65, v29, v29, v206
    v_alignbit_b32 v66, v30, v30, v206
    v_alignbit_b32 v67, v31, v31, v206
    v_xor_b32 v64, v207, v64
    v_xor_b32 v65, v207, v65
    v_xor_b32 v66, v207, v66
    v_xor_b32 v67, v207, v67
    v_fmamk_f32 v216, v205, 0x40800000, v201
    v_fmamk_f32 v217, v205, 0x40800000, v202
    v_fmamk_f32 v218, v205, 0x40800000, v203
    v_fmamk_f32 v219, v205, 0x40800000, v204
    v_cos_f32 v208, v216
    v_sin_f32 v209, -v216
    v_cos_f32 v210, v217
    v_sin_f32 v211, -v217
    v_cos_f32 v212, v218
    v_sin_f32 v213, -v218
    v_cos_f32 v214, v219
    v_sin_f32 v215, -v219
    v_cvt_pk_bf16_f32 v32, v208, v209
    v_cvt_pk_bf16_f32 v33, v210, v211
    v_cvt_pk_bf16_f32 v34, v212, v213
    v_cvt_pk_bf16_f32 v35, v214, v215
    v_alignbit_b32 v68, v32, v32, v206
    v_alignbit_b32 v69, v33, v33, v206
    v_alignbit_b32 v70, v34, v34, v206
    v_alignbit_b32 v71, v35, v35, v206
    v_xor_b32 v68, v207, v68
    v_xor_b32 v69, v207, v69
    v_xor_b32 v70, v207, v70
    v_xor_b32 v71, v207, v71
    v_fmamk_f32 v216, v205, 0x40a00000, v201
    v_fmamk_f32 v217, v205, 0x40a00000, v202
    v_fmamk_f32 v218, v205, 0x40a00000, v203
    v_fmamk_f32 v219, v205, 0x40a00000, v204
    v_cos_f32 v208, v216
    v_sin_f32 v209, -v216
    v_cos_f32 v210, v217
    v_sin_f32 v211, -v217
    v_cos_f32 v212, v218
    v_sin_f32 v213, -v218
    v_cos_f32 v214, v219
    v_sin_f32 v215, -v219
    v_cvt_pk_bf16_f32 v36, v208, v209
    v_cvt_pk_bf16_f32 v37, v210, v211
    v_cvt_pk_bf16_f32 v38, v212, v213
    v_cvt_pk_bf16_f32 v39, v214, v215
    v_alignbit_b32 v72, v36, v36, v206
    v_alignbit_b32 v73, v37, v37, v206
    v_alignbit_b32 v74, v38, v38, v206
    v_alignbit_b32 v75, v39, v39, v206
    v_xor_b32 v72, v207, v72
    v_xor_b32 v73, v207, v73
    v_xor_b32 v74, v207, v74
    v_xor_b32 v75, v207, v75
    v_fmamk_f32 v216, v205, 0x40c00000, v201
    v_fmamk_f32 v217, v205, 0x40c00000, v202
    v_fmamk_f32 v218, v205, 0x40c00000, v203
    v_fmamk_f32 v219, v205, 0x40c00000, v204
    v_cos_f32 v208, v216
    v_sin_f32 v209, -v216
    v_cos_f32 v210, v217
    v_sin_f32 v211, -v217
    v_cos_f32 v212, v218
    v_sin_f32 v213, -v218
    v_cos_f32 v214, v219
    v_sin_f32 v215, -v219
    v_cvt_pk_bf16_f32 v40, v208, v209
    v_cvt_pk_bf16_f32 v41, v210, v211
    v_cvt_pk_bf16_f32 v42, v212, v213
    v_cvt_pk_bf16_f32 v43, v214, v215
    v_alignbit_b32 v76, v40, v40, v206
    v_alignbit_b32 v77, v41, v41, v206
    v_alignbit_b32 v78, v42, v42, v206
    v_alignbit_b32 v79, v43, v43, v206
    v_xor_b32 v76, v207, v76
    v_xor_b32 v77, v207, v77
    v_xor_b32 v78, v207, v78
    v_xor_b32 v79, v207, v79
    v_fmamk_f32 v216, v205, 0x40e00000, v201
    v_fmamk_f32 v217, v205, 0x40e00000, v202
    v_fmamk_f32 v218, v205, 0x40e00000, v203
    v_fmamk_f32 v219, v205, 0x40e00000, v204
    v_cos_f32 v208, v216
    v_sin_f32 v209, -v216
    v_cos_f32 v210, v217
    v_sin_f32 v211, -v217
    v_cos_f32 v212, v218
    v_sin_f32 v213, -v218
    v_cos_f32 v214, v219
    v_sin_f32 v215, -v219
    v_cvt_pk_bf16_f32 v44, v208, v209
    v_cvt_pk_bf16_f32 v45, v210, v211
    v_cvt_pk_bf16_f32 v46, v212, v213
    v_cvt_pk_bf16_f32 v47, v214, v215
    v_alignbit_b32 v80, v44, v44, v206
    v_alignbit_b32 v81, v45, v45, v206
    v_alignbit_b32 v82, v46, v46, v206
    v_alignbit_b32 v83, v47, v47, v206
    v_xor_b32 v80, v207, v80
    v_xor_b32 v81, v207, v81
    v_xor_b32 v82, v207, v82
    v_xor_b32 v83, v207, v83
    v_fmamk_f32 v216, v205, 0x41000000, v201
    v_fmamk_f32 v217, v205, 0x41000000, v202
    v_fmamk_f32 v218, v205, 0x41000000, v203
    v_fmamk_f32 v219, v205, 0x41000000, v204
    v_cos_f32 v208, v216
    v_sin_f32 v209, -v216
    v_cos_f32 v210, v217
    v_sin_f32 v211, -v217
    v_cos_f32 v212, v218
    v_sin_f32 v213, -v218
    v_cos_f32 v214, v219
    v_sin_f32 v215, -v219
    v_cvt_pk_bf16_f32 v48, v208, v209
    v_cvt_pk_bf16_f32 v49, v210, v211
    v_cvt_pk_bf16_f32 v50, v212, v213
    v_cvt_pk_bf16_f32 v51, v214, v215
    v_alignbit_b32 v84, v48, v48, v206
    v_alignbit_b32 v85, v49, v49, v206
    v_alignbit_b32 v86, v50, v50, v206
    v_alignbit_b32 v87, v51, v51, v206
    v_xor_b32 v84, v207, v84
    v_xor_b32 v85, v207, v85
    v_xor_b32 v86, v207, v86
    v_xor_b32 v87, v207, v87
    ds_read_b64_tr_b16 v[176:177], v223 offset:0
    ds_read_b64_tr_b16 v[178:179], v223 offset:1024
    ds_read_b64_tr_b16 v[184:185], v223 offset:2048
    ds_read_b64_tr_b16 v[186:187], v223 offset:3072
    ds_read_b64_tr_b16 v[192:193], v223 offset:4096
    ds_read_b64_tr_b16 v[194:195], v223 offset:5120
    s_waitcnt lgkmcnt(4)
    v_mfma_f32_16x16x32_bf16 v[168:171], v[16:19], v[176:179], 0
    ds_read_b64_tr_b16 v[176:177], v223 offset:6144
    ds_read_b64_tr_b16 v[178:179], v223 offset:7168
    s_waitcnt lgkmcnt(4)
    v_mfma_f32_16x16x32_bf16 v[168:171], v[20:23], v[184:187], v[168:171]
    ds_read_b64_tr_b16 v[184:185], v223 offset:8192
    ds_read_b64_tr_b16 v[186:187], v223 offset:9216
    s_waitcnt lgkmcnt(4)
    v_mfma_f32_16x16x32_bf16 v[168:171], v[24:27], v[192:195], v[168:171]
    ds_read_b64_tr_b16 v[192:193], v223 offset:10240
    ds_read_b64_tr_b16 v[194:195], v223 offset:11264
    s_waitcnt lgkmcnt(4)
    v_mfma_f32_16x16x32_bf16 v[168:171], v[28:31], v[176:179], v[168:171]
    ds_read_b64_tr_b16 v[176:177], v223 offset:12288
    ds_read_b64_tr_b16 v[178:179], v223 offset:13312
    s_waitcnt lgkmcnt(4)
    v_mfma_f32_16x16x32_bf16 v[168:171], v[32:35], v[184:187], v[168:171]
    ds_read_b64_tr_b16 v[184:185], v223 offset:14336
    ds_read_b64_tr_b16 v[186:187], v223 offset:15360
    s_waitcnt lgkmcnt(4)
    v_mfma_f32_16x16x32_bf16 v[168:171], v[36:39], v[192:195], v[168:171]
    ds_read_b64_tr_b16 v[192:193], v223 offset:16384
    ds_read_b64_tr_b16 v[194:195], v223 offset:17408
    s_waitcnt lgkmcnt(4)
    v_mfma_f32_16x16x32_bf16 v[168:171], v[40:43], v[176:179], v[168:171]
    ds_read_b64_tr_b16 v[176:177], v223 offset:18432
    ds_read_b64_tr_b16 v[178:179], v223 offset:19456
    s_waitcnt lgkmcnt(4)
    v_mfma_f32_16x16x32_bf16 v[168:171], v[44:47], v[184:187], v[168:171]
    ds_read_b64_tr_b16 v[184:185], v223 offset:20480
    ds_read_b64_tr_b16 v[186:187], v223 offset:21504
    s_waitcnt lgkmcnt(4)
    v_mfma_f32_16x16x32_bf16 v[168:171], v[48:51], v[192:195], v[168:171]
    ds_read_b64_tr_b16 v[192:193], v223 offset:22528
    ds_read_b64_tr_b16 v[194:195], v223 offset:23552
    s_waitcnt lgkmcnt(4)
    v_mfma_f32_16x16x32_bf16 v[168:171], v[52:55], v[176:179], v[168:171]
    ds_read_b64_tr_b16 v[176:177], v223 offset:24576
    ds_read_b64_tr_b16 v[178:179], v223 offset:25600
    s_waitcnt lgkmcnt(4)
    v_mfma_f32_16x16x32_bf16 v[168:171], v[56:59], v[184:187], v[168:171]
    ds_read_b64_tr_b16 v[184:185], v223 offset:26624
    ds_read_b64_tr_b16 v[186:187], v223 offset:27648
    s_waitcnt lgkmcnt(4)
    v_mfma_f32_16x16x32_bf16 v[168:171], v[60:63], v[192:195], v[168:171]
    ds_read_b64_tr_b16 v[192:193], v223 offset:28672
    ds_read_b64_tr_b16 v[194:195], v223 offset:29696
    s_waitcnt lgkmcnt(4)
    v_mfma_f32_16x16x32_bf16 v[168:171], v[64:67], v[176:179], v[168:171]
    ds_read_b64_tr_b16 v[176:177], v223 offset:30720
    ds_read_b64_tr_b16 v[178:179], v223 offset:31744
    s_waitcnt lgkmcnt(4)
    v_mfma_f32_16x16x32_bf16 v[168:171], v[68:71], v[184:187], v[168:171]
    ds_read_b64_tr_b16 v[184:185], v223 offset:32768
    ds_read_b64_tr_b16 v[186:187], v223 offset:33792
    s_waitcnt lgkmcnt(4)
    v_mfma_f32_16x16x32_bf16 v[168:171], v[72:75], v[192:195], v[168:171]
    ds_read_b64_tr_b16 v[192:193], v223 offset:34816
    ds_read_b64_tr_b16 v[194:195], v223 offset:35840
    s_waitcnt lgkmcnt(4)
    v_mfma_f32_16x16x32_bf16 v[168:171], v[76:79], v[176:179], v[168:171]
    s_waitcnt lgkmcnt(2)
    v_mfma_f32_16x16x32_bf16 v[168:171], v[80:83], v[184:187], v[168:171]
    s_waitcnt lgkmcnt(0)
    v_mfma_f32_16x16x32_bf16 v[168:171], v[84:87], v[192:195], v[168:171]
    s_waitcnt vmcnt(17)
    v_lshlrev_b32 v176, 16, v88
    v_and_b32 v177, 0xffff0000, v88
    v_lshlrev_b32 v178, 16, v89
    v_and_b32 v179, 0xffff0000, v89
    v_lshlrev_b32 v180, 16, v90
    v_and_b32 v181, 0xffff0000, v90
    v_lshlrev_b32 v182, 16, v91
    v_and_b32 v183, 0xffff0000, v91
    s_waitcnt vmcnt(16)
    v_lshlrev_b32 v188, 16, v92
    v_and_b32 v189, 0xffff0000, v92
    v_lshlrev_b32 v190, 16, v93
    v_and_b32 v191, 0xffff0000, v93
    v_lshlrev_b32 v192, 16, v94
    v_and_b32 v193, 0xffff0000, v94
    v_lshlrev_b32 v194, 16, v95
    v_and_b32 v195, 0xffff0000, v95
    v_pk_add_f32 v[176:177], v[176:177], v[188:189]
    v_pk_add_f32 v[178:179], v[178:179], v[190:191]
    v_pk_add_f32 v[180:181], v[180:181], v[192:193]
    v_pk_add_f32 v[182:183], v[182:183], v[194:195]
    s_waitcnt vmcnt(15)
    v_lshlrev_b32 v188, 16, v96
    v_and_b32 v189, 0xffff0000, v96
    v_lshlrev_b32 v190, 16, v97
    v_and_b32 v191, 0xffff0000, v97
    v_lshlrev_b32 v192, 16, v98
    v_and_b32 v193, 0xffff0000, v98
    v_lshlrev_b32 v194, 16, v99
    v_and_b32 v195, 0xffff0000, v99
    v_pk_add_f32 v[176:177], v[176:177], v[188:189]
    v_pk_add_f32 v[178:179], v[178:179], v[190:191]
    v_pk_add_f32 v[180:181], v[180:181], v[192:193]
    v_pk_add_f32 v[182:183], v[182:183], v[194:195]
    s_waitcnt vmcnt(14)
    v_lshlrev_b32 v188, 16, v100
    v_and_b32 v189, 0xffff0000, v100
    v_lshlrev_b32 v190, 16, v101
    v_and_b32 v191, 0xffff0000, v101
    v_lshlrev_b32 v192, 16, v102
    v_and_b32 v193, 0xffff0000, v102
    v_lshlrev_b32 v194, 16, v103
    v_and_b32 v195, 0xffff0000, v103
    v_pk_add_f32 v[176:177], v[176:177], v[188:189]
    v_pk_add_f32 v[178:179], v[178:179], v[190:191]
    v_pk_add_f32 v[180:181], v[180:181], v[192:193]
    v_pk_add_f32 v[182:183], v[182:183], v[194:195]
    s_waitcnt vmcnt(13)
    v_lshlrev_b32 v188, 16, v104
    v_and_b32 v189, 0xffff0000, v104
    v_lshlrev_b32 v190, 16, v105
    v_and_b32 v191, 0xffff0000, v105
    v_lshlrev_b32 v192, 16, v106
    v_and_b32 v193, 0xffff0000, v106
    v_lshlrev_b32 v194, 16, v107
    v_and_b32 v195, 0xffff0000, v107
    v_pk_add_f32 v[176:177], v[176:177], v[188:189]
    v_pk_add_f32 v[178:179], v[178:179], v[190:191]
    v_pk_add_f32 v[180:181], v[180:181], v[192:193]
    v_pk_add_f32 v[182:183], v[182:183], v[194:195]
    s_waitcnt vmcnt(12)
    v_lshlrev_b32 v188, 16, v108
    v_and_b32 v189, 0xffff0000, v108
    v_lshlrev_b32 v190, 16, v109
    v_and_b32 v191, 0xffff0000, v109
    v_lshlrev_b32 v192, 16, v110
    v_and_b32 v193, 0xffff0000, v110
    v_lshlrev_b32 v194, 16, v111
    v_and_b32 v195, 0xffff0000, v111
    v_pk_add_f32 v[176:177], v[176:177], v[188:189]
    v_pk_add_f32 v[178:179], v[178:179], v[190:191]
    v_pk_add_f32 v[180:181], v[180:181], v[192:193]
    v_pk_add_f32 v[182:183], v[182:183], v[194:195]
    s_waitcnt vmcnt(11)
    v_lshlrev_b32 v188, 16, v112
    v_and_b32 v189, 0xffff0000, v112
    v_lshlrev_b32 v190, 16, v113
    v_and_b32 v191, 0xffff0000, v113
    v_lshlrev_b32 v192, 16, v114
    v_and_b32 v193, 0xffff0000, v114
    v_lshlrev_b32 v194, 16, v115
    v_and_b32 v195, 0xffff0000, v115
    v_pk_add_f32 v[176:177], v[176:177], v[188:189]
    v_pk_add_f32 v[178:179], v[178:179], v[190:191]
    v_pk_add_f32 v[180:181], v[180:181], v[192:193]
    v_pk_add_f32 v[182:183], v[182:183], v[194:195]
    s_waitcnt vmcnt(10)
    v_lshlrev_b32 v188, 16, v116
    v_and_b32 v189, 0xffff0000, v116
    v_lshlrev_b32 v190, 16, v117
    v_and_b32 v191, 0xffff0000, v117
    v_lshlrev_b32 v192, 16, v118
    v_and_b32 v193, 0xffff0000, v118
    v_lshlrev_b32 v194, 16, v119
    v_and_b32 v195, 0xffff0000, v119
    v_pk_add_f32 v[176:177], v[176:177], v[188:189]
    v_pk_add_f32 v[178:179], v[178:179], v[190:191]
    v_pk_add_f32 v[180:181], v[180:181], v[192:193]
    v_pk_add_f32 v[182:183], v[182:183], v[194:195]
    v_lshlrev_b32 v196, 16, v232
    v_and_b32 v197, 0xffff0000, v232
    v_lshlrev_b32 v198, 16, v233
    v_and_b32 v199, 0xffff0000, v233
    v_cvt_pk_bf16_f32 v190, v176, v177
    v_lshlrev_b32 v176, 16, v190
    v_and_b32 v177, 0xffff0000, v190
    v_pk_add_f32 v[176:177], v[176:177], v[196:197]
    v_cvt_pk_bf16_f32 v190, v176, v177
    v_lshlrev_b32 v176, 16, v190
    v_and_b32 v177, 0xffff0000, v190
    v_cvt_pk_bf16_f32 v190, v160, v161
    v_lshlrev_b32 v160, 16, v190
    v_and_b32 v161, 0xffff0000, v190
    v_lshlrev_b32 v188, 16, v228
    v_and_b32 v189, 0xffff0000, v228
    v_pk_add_f32 v[160:161], v[160:161], v[188:189]
    v_cvt_pk_bf16_f32 v190, v160, v161
    v_lshlrev_b32 v160, 16, v190
    v_and_b32 v161, 0xffff0000, v190
    v_pk_add_f32 v[160:161], v[160:161], v[176:177]
    v_cvt_pk_bf16_f32 v200, v160, v161
    v_cvt_pk_bf16_f32 v190, v178, v179
    v_lshlrev_b32 v178, 16, v190
    v_and_b32 v179, 0xffff0000, v190
    v_pk_add_f32 v[178:179], v[178:179], v[198:199]
    v_cvt_pk_bf16_f32 v190, v178, v179
    v_lshlrev_b32 v178, 16, v190
    v_and_b32 v179, 0xffff0000, v190
    v_cvt_pk_bf16_f32 v190, v162, v163
    v_lshlrev_b32 v162, 16, v190
    v_and_b32 v163, 0xffff0000, v190
    v_lshlrev_b32 v188, 16, v229
    v_and_b32 v189, 0xffff0000, v229
    v_pk_add_f32 v[162:163], v[162:163], v[188:189]
    v_cvt_pk_bf16_f32 v190, v162, v163
    v_lshlrev_b32 v162, 16, v190
    v_and_b32 v163, 0xffff0000, v190
    v_pk_add_f32 v[162:163], v[162:163], v[178:179]
    v_cvt_pk_bf16_f32 v201, v162, v163
    v_cvt_pk_bf16_f32 v190, v180, v181
    v_lshlrev_b32 v180, 16, v190
    v_and_b32 v181, 0xffff0000, v190
    v_pk_add_f32 v[180:181], v[180:181], v[196:197]
    v_cvt_pk_bf16_f32 v190, v180, v181
    v_lshlrev_b32 v180, 16, v190
    v_and_b32 v181, 0xffff0000, v190
    v_cvt_pk_bf16_f32 v190, v164, v165
    v_lshlrev_b32 v164, 16, v190
    v_and_b32 v165, 0xffff0000, v190
    v_lshlrev_b32 v188, 16, v230
    v_and_b32 v189, 0xffff0000, v230
    v_pk_add_f32 v[164:165], v[164:165], v[188:189]
    v_cvt_pk_bf16_f32 v190, v164, v165
    v_lshlrev_b32 v164, 16, v190
    v_and_b32 v165, 0xffff0000, v190
    v_pk_add_f32 v[164:165], v[164:165], v[180:181]
    v_cvt_pk_bf16_f32 v202, v164, v165
    v_cvt_pk_bf16_f32 v190, v182, v183
    v_lshlrev_b32 v182, 16, v190
    v_and_b32 v183, 0xffff0000, v190
    v_pk_add_f32 v[182:183], v[182:183], v[198:199]
    v_cvt_pk_bf16_f32 v190, v182, v183
    v_lshlrev_b32 v182, 16, v190
    v_and_b32 v183, 0xffff0000, v190
    v_cvt_pk_bf16_f32 v190, v166, v167
    v_lshlrev_b32 v166, 16, v190
    v_and_b32 v167, 0xffff0000, v190
    v_lshlrev_b32 v188, 16, v231
    v_and_b32 v189, 0xffff0000, v231
    v_pk_add_f32 v[166:167], v[166:167], v[188:189]
    v_cvt_pk_bf16_f32 v190, v166, v167
    v_lshlrev_b32 v166, 16, v190
    v_and_b32 v167, 0xffff0000, v190
    v_pk_add_f32 v[166:167], v[166:167], v[182:183]
    v_cvt_pk_bf16_f32 v203, v166, v167
    buffer_store_dwordx2 v[200:201], v224, s[8:11], s72 offen
    buffer_store_dwordx2 v[202:203], v225, s[8:11], s72 offen
    s_waitcnt vmcnt(2)
    v_lshlrev_b32 v184, 16, v120
    v_and_b32 v185, 0xffff0000, v120
    v_lshlrev_b32 v186, 16, v121
    v_and_b32 v187, 0xffff0000, v121
    v_lshlrev_b32 v188, 16, v122
    v_and_b32 v189, 0xffff0000, v122
    v_lshlrev_b32 v190, 16, v123
    v_and_b32 v191, 0xffff0000, v123
    v_pk_add_f32 v[184:185], v[184:185], v[188:189]
    v_pk_add_f32 v[186:187], v[186:187], v[190:191]
    v_lshlrev_b32 v188, 16, v124
    v_and_b32 v189, 0xffff0000, v124
    v_lshlrev_b32 v190, 16, v125
    v_and_b32 v191, 0xffff0000, v125
    v_pk_add_f32 v[184:185], v[184:185], v[188:189]
    v_pk_add_f32 v[186:187], v[186:187], v[190:191]
    v_lshlrev_b32 v188, 16, v126
    v_and_b32 v189, 0xffff0000, v126
    v_lshlrev_b32 v190, 16, v127
    v_and_b32 v191, 0xffff0000, v127
    v_pk_add_f32 v[184:185], v[184:185], v[188:189]
    v_pk_add_f32 v[186:187], v[186:187], v[190:191]
    v_lshlrev_b32 v188, 16, v128
    v_and_b32 v189, 0xffff0000, v128
    v_lshlrev_b32 v190, 16, v129
    v_and_b32 v191, 0xffff0000, v129
    v_pk_add_f32 v[184:185], v[184:185], v[188:189]
    v_pk_add_f32 v[186:187], v[186:187], v[190:191]
    v_lshlrev_b32 v188, 16, v130
    v_and_b32 v189, 0xffff0000, v130
    v_lshlrev_b32 v190, 16, v131
    v_and_b32 v191, 0xffff0000, v131
    v_pk_add_f32 v[184:185], v[184:185], v[188:189]
    v_pk_add_f32 v[186:187], v[186:187], v[190:191]
    v_lshlrev_b32 v188, 16, v132
    v_and_b32 v189, 0xffff0000, v132
    v_lshlrev_b32 v190, 16, v133
    v_and_b32 v191, 0xffff0000, v133
    v_pk_add_f32 v[184:185], v[184:185], v[188:189]
    v_pk_add_f32 v[186:187], v[186:187], v[190:191]
    v_lshlrev_b32 v188, 16, v134
    v_and_b32 v189, 0xffff0000, v134
    v_lshlrev_b32 v190, 16, v135
    v_and_b32 v191, 0xffff0000, v135
    v_pk_add_f32 v[184:185], v[184:185], v[188:189]
    v_pk_add_f32 v[186:187], v[186:187], v[190:191]
    v_lshlrev_b32 v196, 16, v236
    v_and_b32 v197, 0xffff0000, v236
    v_lshlrev_b32 v198, 16, v237
    v_and_b32 v199, 0xffff0000, v237
    v_cvt_pk_bf16_f32 v190, v184, v185
    v_lshlrev_b32 v184, 16, v190
    v_and_b32 v185, 0xffff0000, v190
    v_pk_add_f32 v[184:185], v[184:185], v[196:197]
    v_cvt_pk_bf16_f32 v190, v184, v185
    v_lshlrev_b32 v184, 16, v190
    v_and_b32 v185, 0xffff0000, v190
    v_cvt_pk_bf16_f32 v190, v168, v169
    v_lshlrev_b32 v168, 16, v190
    v_and_b32 v169, 0xffff0000, v190
    v_lshlrev_b32 v188, 16, v234
    v_and_b32 v189, 0xffff0000, v234
    v_pk_add_f32 v[168:169], v[168:169], v[188:189]
    v_cvt_pk_bf16_f32 v190, v168, v169
    v_lshlrev_b32 v168, 16, v190
    v_and_b32 v169, 0xffff0000, v190
    v_pk_add_f32 v[168:169], v[168:169], v[184:185]
    v_cvt_pk_bf16_f32 v204, v168, v169
    v_cvt_pk_bf16_f32 v190, v186, v187
    v_lshlrev_b32 v186, 16, v190
    v_and_b32 v187, 0xffff0000, v190
    v_pk_add_f32 v[186:187], v[186:187], v[198:199]
    v_cvt_pk_bf16_f32 v190, v186, v187
    v_lshlrev_b32 v186, 16, v190
    v_and_b32 v187, 0xffff0000, v190
    v_cvt_pk_bf16_f32 v190, v170, v171
    v_lshlrev_b32 v170, 16, v190
    v_and_b32 v171, 0xffff0000, v190
    v_lshlrev_b32 v188, 16, v235
    v_and_b32 v189, 0xffff0000, v235
    v_pk_add_f32 v[170:171], v[170:171], v[188:189]
    v_cvt_pk_bf16_f32 v190, v170, v171
    v_lshlrev_b32 v170, 16, v190
    v_and_b32 v171, 0xffff0000, v190
    v_pk_add_f32 v[170:171], v[170:171], v[186:187]
    v_cvt_pk_bf16_f32 v205, v170, v171
    buffer_store_dwordx2 v[204:205], v224, s[8:11], s74 offen
    s_endpgm
fused_kernel_e0_plain:
    s_waitcnt lgkmcnt(0)
    s_barrier
    s_add_u32 s80, s76, 0x0
    buffer_load_dwordx4 v[88:91], v1, s[12:15], s80 offen sc1
    s_add_u32 s80, s76, 0x240000
    buffer_load_dwordx4 v[92:95], v1, s[12:15], s80 offen sc1
    s_add_u32 s80, s76, 0x480000
    buffer_load_dwordx4 v[96:99], v1, s[12:15], s80 offen sc1
    s_add_u32 s80, s76, 0x6c0000
    buffer_load_dwordx4 v[100:103], v1, s[12:15], s80 offen sc1
    s_add_u32 s80, s76, 0x900000
    buffer_load_dwordx4 v[104:107], v1, s[12:15], s80 offen sc1
    s_add_u32 s80, s76, 0xb40000
    buffer_load_dwordx4 v[108:111], v1, s[12:15], s80 offen sc1
    s_add_u32 s80, s76, 0xd80000
    buffer_load_dwordx4 v[112:115], v1, s[12:15], s80 offen sc1
    s_add_u32 s80, s76, 0xfc0000
    buffer_load_dwordx4 v[116:119], v1, s[12:15], s80 offen sc1
    v_fmamk_f32 v216, v205, 0x41000000, v201
    v_fmamk_f32 v217, v205, 0x41000000, v202
    v_fmamk_f32 v218, v205, 0x41000000, v203
    v_fmamk_f32 v219, v205, 0x41000000, v204
    v_cos_f32 v208, v216
    v_sin_f32 v209, -v216
    v_cos_f32 v210, v217
    v_sin_f32 v211, -v217
    v_cos_f32 v212, v218
    v_sin_f32 v213, -v218
    v_cos_f32 v214, v219
    v_sin_f32 v215, -v219
    v_cvt_pk_bf16_f32 v48, v208, v209
    v_cvt_pk_bf16_f32 v49, v210, v211
    v_cvt_pk_bf16_f32 v50, v212, v213
    v_cvt_pk_bf16_f32 v51, v214, v215
    v_alignbit_b32 v84, v48, v48, v206
    v_alignbit_b32 v85, v49, v49, v206
    v_alignbit_b32 v86, v50, v50, v206
    v_alignbit_b32 v87, v51, v51, v206
    v_xor_b32 v84, v207, v84
    v_xor_b32 v85, v207, v85
    v_xor_b32 v86, v207, v86
    v_xor_b32 v87, v207, v87
    ds_read_b64_tr_b16 v[176:177], v222 offset:0
    ds_read_b64_tr_b16 v[178:179], v222 offset:1024
    ds_read_b64_tr_b16 v[180:181], v223 offset:0
    ds_read_b64_tr_b16 v[182:183], v223 offset:1024
    ds_read_b64_tr_b16 v[184:185], v222 offset:2048
    ds_read_b64_tr_b16 v[186:187], v222 offset:3072
    ds_read_b64_tr_b16 v[188:189], v223 offset:2048
    ds_read_b64_tr_b16 v[190:191], v223 offset:3072
    ds_read_b64_tr_b16 v[192:193], v222 offset:4096
    ds_read_b64_tr_b16 v[194:195], v222 offset:5120
    ds_read_b64_tr_b16 v[196:197], v223 offset:4096
    ds_read_b64_tr_b16 v[198:199], v223 offset:5120
    s_waitcnt lgkmcnt(10)
    v_mfma_f32_16x16x32_bf16 v[160:163], v[16:19], v[176:179], 0
    s_waitcnt lgkmcnt(8)
    v_mfma_f32_16x16x32_bf16 v[164:167], v[16:19], v[180:183], 0
    ds_read_b64_tr_b16 v[176:177], v222 offset:6144
    ds_read_b64_tr_b16 v[178:179], v222 offset:7168
    ds_read_b64_tr_b16 v[180:181], v223 offset:6144
    ds_read_b64_tr_b16 v[182:183], v223 offset:7168
    s_waitcnt lgkmcnt(10)
    v_mfma_f32_16x16x32_bf16 v[160:163], v[20:23], v[184:187], v[160:163]
    s_waitcnt lgkmcnt(8)
    v_mfma_f32_16x16x32_bf16 v[164:167], v[20:23], v[188:191], v[164:167]
    ds_read_b64_tr_b16 v[184:185], v222 offset:8192
    ds_read_b64_tr_b16 v[186:187], v222 offset:9216
    ds_read_b64_tr_b16 v[188:189], v223 offset:8192
    ds_read_b64_tr_b16 v[190:191], v223 offset:9216
    s_waitcnt lgkmcnt(10)
    v_mfma_f32_16x16x32_bf16 v[160:163], v[24:27], v[192:195], v[160:163]
    s_waitcnt lgkmcnt(8)
    v_mfma_f32_16x16x32_bf16 v[164:167], v[24:27], v[196:199], v[164:167]
    ds_read_b64_tr_b16 v[192:193], v222 offset:10240
    ds_read_b64_tr_b16 v[194:195], v222 offset:11264
    ds_read_b64_tr_b16 v[196:197], v223 offset:10240
    ds_read_b64_tr_b16 v[198:199], v223 offset:11264
    s_waitcnt lgkmcnt(10)
    v_mfma_f32_16x16x32_bf16 v[160:163], v[28:31], v[176:179], v[160:163]
    s_waitcnt lgkmcnt(8)
    v_mfma_f32_16x16x32_bf16 v[164:167], v[28:31], v[180:183], v[164:167]
    ds_read_b64_tr_b16 v[176:177], v222 offset:12288
    ds_read_b64_tr_b16 v[178:179], v222 offset:13312
    ds_read_b64_tr_b16 v[180:181], v223 offset:12288
    ds_read_b64_tr_b16 v[182:183], v223 offset:13312
    s_waitcnt lgkmcnt(10)
    v_mfma_f32_16x16x32_bf16 v[160:163], v[32:35], v[184:187], v[160:163]
    s_waitcnt lgkmcnt(8)
    v_mfma_f32_16x16x32_bf16 v[164:167], v[32:35], v[188:191], v[164:167]
    ds_read_b64_tr_b16 v[184:185], v222 offset:14336
    ds_read_b64_tr_b16 v[186:187], v222 offset:15360
    ds_read_b64_tr_b16 v[188:189], v223 offset:14336
    ds_read_b64_tr_b16 v[190:191], v223 offset:15360
    s_waitcnt lgkmcnt(10)
    v_mfma_f32_16x16x32_bf16 v[160:163], v[36:39], v[192:195], v[160:163]
    s_waitcnt lgkmcnt(8)
    v_mfma_f32_16x16x32_bf16 v[164:167], v[36:39], v[196:199], v[164:167]
    ds_read_b64_tr_b16 v[192:193], v222 offset:16384
    ds_read_b64_tr_b16 v[194:195], v222 offset:17408
    ds_read_b64_tr_b16 v[196:197], v223 offset:16384
    ds_read_b64_tr_b16 v[198:199], v223 offset:17408
    s_waitcnt lgkmcnt(10)
    v_mfma_f32_16x16x32_bf16 v[160:163], v[40:43], v[176:179], v[160:163]
    s_waitcnt lgkmcnt(8)
    v_mfma_f32_16x16x32_bf16 v[164:167], v[40:43], v[180:183], v[164:167]
    ds_read_b64_tr_b16 v[176:177], v222 offset:18432
    ds_read_b64_tr_b16 v[178:179], v222 offset:19456
    ds_read_b64_tr_b16 v[180:181], v223 offset:18432
    ds_read_b64_tr_b16 v[182:183], v223 offset:19456
    s_waitcnt lgkmcnt(10)
    v_mfma_f32_16x16x32_bf16 v[160:163], v[44:47], v[184:187], v[160:163]
    s_waitcnt lgkmcnt(8)
    v_mfma_f32_16x16x32_bf16 v[164:167], v[44:47], v[188:191], v[164:167]
    ds_read_b64_tr_b16 v[184:185], v222 offset:20480
    ds_read_b64_tr_b16 v[186:187], v222 offset:21504
    ds_read_b64_tr_b16 v[188:189], v223 offset:20480
    ds_read_b64_tr_b16 v[190:191], v223 offset:21504
    s_waitcnt lgkmcnt(10)
    v_mfma_f32_16x16x32_bf16 v[160:163], v[48:51], v[192:195], v[160:163]
    s_waitcnt lgkmcnt(8)
    v_mfma_f32_16x16x32_bf16 v[164:167], v[48:51], v[196:199], v[164:167]
    ds_read_b64_tr_b16 v[192:193], v222 offset:22528
    ds_read_b64_tr_b16 v[194:195], v222 offset:23552
    ds_read_b64_tr_b16 v[196:197], v223 offset:22528
    ds_read_b64_tr_b16 v[198:199], v223 offset:23552
    s_waitcnt lgkmcnt(10)
    v_mfma_f32_16x16x32_bf16 v[160:163], v[52:55], v[176:179], v[160:163]
    s_waitcnt lgkmcnt(8)
    v_mfma_f32_16x16x32_bf16 v[164:167], v[52:55], v[180:183], v[164:167]
    ds_read_b64_tr_b16 v[176:177], v222 offset:24576
    ds_read_b64_tr_b16 v[178:179], v222 offset:25600
    ds_read_b64_tr_b16 v[180:181], v223 offset:24576
    ds_read_b64_tr_b16 v[182:183], v223 offset:25600
    s_waitcnt lgkmcnt(10)
    v_mfma_f32_16x16x32_bf16 v[160:163], v[56:59], v[184:187], v[160:163]
    s_waitcnt lgkmcnt(8)
    v_mfma_f32_16x16x32_bf16 v[164:167], v[56:59], v[188:191], v[164:167]
    ds_read_b64_tr_b16 v[184:185], v222 offset:26624
    ds_read_b64_tr_b16 v[186:187], v222 offset:27648
    ds_read_b64_tr_b16 v[188:189], v223 offset:26624
    ds_read_b64_tr_b16 v[190:191], v223 offset:27648
    s_waitcnt lgkmcnt(10)
    v_mfma_f32_16x16x32_bf16 v[160:163], v[60:63], v[192:195], v[160:163]
    s_waitcnt lgkmcnt(8)
    v_mfma_f32_16x16x32_bf16 v[164:167], v[60:63], v[196:199], v[164:167]
    ds_read_b64_tr_b16 v[192:193], v222 offset:28672
    ds_read_b64_tr_b16 v[194:195], v222 offset:29696
    ds_read_b64_tr_b16 v[196:197], v223 offset:28672
    ds_read_b64_tr_b16 v[198:199], v223 offset:29696
    s_waitcnt lgkmcnt(10)
    v_mfma_f32_16x16x32_bf16 v[160:163], v[64:67], v[176:179], v[160:163]
    s_waitcnt lgkmcnt(8)
    v_mfma_f32_16x16x32_bf16 v[164:167], v[64:67], v[180:183], v[164:167]
    ds_read_b64_tr_b16 v[176:177], v222 offset:30720
    ds_read_b64_tr_b16 v[178:179], v222 offset:31744
    ds_read_b64_tr_b16 v[180:181], v223 offset:30720
    ds_read_b64_tr_b16 v[182:183], v223 offset:31744
    s_waitcnt lgkmcnt(10)
    v_mfma_f32_16x16x32_bf16 v[160:163], v[68:71], v[184:187], v[160:163]
    s_waitcnt lgkmcnt(8)
    v_mfma_f32_16x16x32_bf16 v[164:167], v[68:71], v[188:191], v[164:167]
    ds_read_b64_tr_b16 v[184:185], v222 offset:32768
    ds_read_b64_tr_b16 v[186:187], v222 offset:33792
    ds_read_b64_tr_b16 v[188:189], v223 offset:32768
    ds_read_b64_tr_b16 v[190:191], v223 offset:33792
    s_waitcnt lgkmcnt(10)
    v_mfma_f32_16x16x32_bf16 v[160:163], v[72:75], v[192:195], v[160:163]
    s_waitcnt lgkmcnt(8)
    v_mfma_f32_16x16x32_bf16 v[164:167], v[72:75], v[196:199], v[164:167]
    ds_read_b64_tr_b16 v[192:193], v222 offset:34816
    ds_read_b64_tr_b16 v[194:195], v222 offset:35840
    ds_read_b64_tr_b16 v[196:197], v223 offset:34816
    ds_read_b64_tr_b16 v[198:199], v223 offset:35840
    s_waitcnt lgkmcnt(10)
    v_mfma_f32_16x16x32_bf16 v[160:163], v[76:79], v[176:179], v[160:163]
    s_waitcnt lgkmcnt(8)
    v_mfma_f32_16x16x32_bf16 v[164:167], v[76:79], v[180:183], v[164:167]
    s_waitcnt lgkmcnt(6)
    v_mfma_f32_16x16x32_bf16 v[160:163], v[80:83], v[184:187], v[160:163]
    s_waitcnt lgkmcnt(4)
    v_mfma_f32_16x16x32_bf16 v[164:167], v[80:83], v[188:191], v[164:167]
    s_waitcnt lgkmcnt(2)
    v_mfma_f32_16x16x32_bf16 v[160:163], v[84:87], v[192:195], v[160:163]
    s_waitcnt lgkmcnt(0)
    v_mfma_f32_16x16x32_bf16 v[164:167], v[84:87], v[196:199], v[164:167]
    s_waitcnt vmcnt(7)
    v_lshlrev_b32 v176, 16, v88
    v_and_b32 v177, 0xffff0000, v88
    v_lshlrev_b32 v178, 16, v89
    v_and_b32 v179, 0xffff0000, v89
    v_lshlrev_b32 v180, 16, v90
    v_and_b32 v181, 0xffff0000, v90
    v_lshlrev_b32 v182, 16, v91
    v_and_b32 v183, 0xffff0000, v91
    s_waitcnt vmcnt(6)
    v_lshlrev_b32 v188, 16, v92
    v_and_b32 v189, 0xffff0000, v92
    v_lshlrev_b32 v190, 16, v93
    v_and_b32 v191, 0xffff0000, v93
    v_lshlrev_b32 v192, 16, v94
    v_and_b32 v193, 0xffff0000, v94
    v_lshlrev_b32 v194, 16, v95
    v_and_b32 v195, 0xffff0000, v95
    v_pk_add_f32 v[176:177], v[176:177], v[188:189]
    v_pk_add_f32 v[178:179], v[178:179], v[190:191]
    v_pk_add_f32 v[180:181], v[180:181], v[192:193]
    v_pk_add_f32 v[182:183], v[182:183], v[194:195]
    s_waitcnt vmcnt(5)
    v_lshlrev_b32 v188, 16, v96
    v_and_b32 v189, 0xffff0000, v96
    v_lshlrev_b32 v190, 16, v97
    v_and_b32 v191, 0xffff0000, v97
    v_lshlrev_b32 v192, 16, v98
    v_and_b32 v193, 0xffff0000, v98
    v_lshlrev_b32 v194, 16, v99
    v_and_b32 v195, 0xffff0000, v99
    v_pk_add_f32 v[176:177], v[176:177], v[188:189]
    v_pk_add_f32 v[178:179], v[178:179], v[190:191]
    v_pk_add_f32 v[180:181], v[180:181], v[192:193]
    v_pk_add_f32 v[182:183], v[182:183], v[194:195]
    s_waitcnt vmcnt(4)
    v_lshlrev_b32 v188, 16, v100
    v_and_b32 v189, 0xffff0000, v100
    v_lshlrev_b32 v190, 16, v101
    v_and_b32 v191, 0xffff0000, v101
    v_lshlrev_b32 v192, 16, v102
    v_and_b32 v193, 0xffff0000, v102
    v_lshlrev_b32 v194, 16, v103
    v_and_b32 v195, 0xffff0000, v103
    v_pk_add_f32 v[176:177], v[176:177], v[188:189]
    v_pk_add_f32 v[178:179], v[178:179], v[190:191]
    v_pk_add_f32 v[180:181], v[180:181], v[192:193]
    v_pk_add_f32 v[182:183], v[182:183], v[194:195]
    s_waitcnt vmcnt(3)
    v_lshlrev_b32 v188, 16, v104
    v_and_b32 v189, 0xffff0000, v104
    v_lshlrev_b32 v190, 16, v105
    v_and_b32 v191, 0xffff0000, v105
    v_lshlrev_b32 v192, 16, v106
    v_and_b32 v193, 0xffff0000, v106
    v_lshlrev_b32 v194, 16, v107
    v_and_b32 v195, 0xffff0000, v107
    v_pk_add_f32 v[176:177], v[176:177], v[188:189]
    v_pk_add_f32 v[178:179], v[178:179], v[190:191]
    v_pk_add_f32 v[180:181], v[180:181], v[192:193]
    v_pk_add_f32 v[182:183], v[182:183], v[194:195]
    s_waitcnt vmcnt(2)
    v_lshlrev_b32 v188, 16, v108
    v_and_b32 v189, 0xffff0000, v108
    v_lshlrev_b32 v190, 16, v109
    v_and_b32 v191, 0xffff0000, v109
    v_lshlrev_b32 v192, 16, v110
    v_and_b32 v193, 0xffff0000, v110
    v_lshlrev_b32 v194, 16, v111
    v_and_b32 v195, 0xffff0000, v111
    v_pk_add_f32 v[176:177], v[176:177], v[188:189]
    v_pk_add_f32 v[178:179], v[178:179], v[190:191]
    v_pk_add_f32 v[180:181], v[180:181], v[192:193]
    v_pk_add_f32 v[182:183], v[182:183], v[194:195]
    s_waitcnt vmcnt(1)
    v_lshlrev_b32 v188, 16, v112
    v_and_b32 v189, 0xffff0000, v112
    v_lshlrev_b32 v190, 16, v113
    v_and_b32 v191, 0xffff0000, v113
    v_lshlrev_b32 v192, 16, v114
    v_and_b32 v193, 0xffff0000, v114
    v_lshlrev_b32 v194, 16, v115
    v_and_b32 v195, 0xffff0000, v115
    v_pk_add_f32 v[176:177], v[176:177], v[188:189]
    v_pk_add_f32 v[178:179], v[178:179], v[190:191]
    v_pk_add_f32 v[180:181], v[180:181], v[192:193]
    v_pk_add_f32 v[182:183], v[182:183], v[194:195]
    s_waitcnt vmcnt(0)
    v_lshlrev_b32 v188, 16, v116
    v_and_b32 v189, 0xffff0000, v116
    v_lshlrev_b32 v190, 16, v117
    v_and_b32 v191, 0xffff0000, v117
    v_lshlrev_b32 v192, 16, v118
    v_and_b32 v193, 0xffff0000, v118
    v_lshlrev_b32 v194, 16, v119
    v_and_b32 v195, 0xffff0000, v119
    v_pk_add_f32 v[176:177], v[176:177], v[188:189]
    v_pk_add_f32 v[178:179], v[178:179], v[190:191]
    v_pk_add_f32 v[180:181], v[180:181], v[192:193]
    v_pk_add_f32 v[182:183], v[182:183], v[194:195]
    v_lshlrev_b32 v196, 16, v232
    v_and_b32 v197, 0xffff0000, v232
    v_lshlrev_b32 v198, 16, v233
    v_and_b32 v199, 0xffff0000, v233
    v_cvt_pk_bf16_f32 v190, v176, v177
    v_lshlrev_b32 v176, 16, v190
    v_and_b32 v177, 0xffff0000, v190
    v_pk_add_f32 v[176:177], v[176:177], v[196:197]
    v_cvt_pk_bf16_f32 v190, v176, v177
    v_lshlrev_b32 v176, 16, v190
    v_and_b32 v177, 0xffff0000, v190
    v_cvt_pk_bf16_f32 v190, v160, v161
    v_lshlrev_b32 v160, 16, v190
    v_and_b32 v161, 0xffff0000, v190
    v_lshlrev_b32 v188, 16, v228
    v_and_b32 v189, 0xffff0000, v228
    v_pk_add_f32 v[160:161], v[160:161], v[188:189]
    v_cvt_pk_bf16_f32 v190, v160, v161
    v_lshlrev_b32 v160, 16, v190
    v_and_b32 v161, 0xffff0000, v190
    v_pk_add_f32 v[160:161], v[160:161], v[176:177]
    v_cvt_pk_bf16_f32 v200, v160, v161
    v_cvt_pk_bf16_f32 v190, v178, v179
    v_lshlrev_b32 v178, 16, v190
    v_and_b32 v179, 0xffff0000, v190
    v_pk_add_f32 v[178:179], v[178:179], v[198:199]
    v_cvt_pk_bf16_f32 v190, v178, v179
    v_lshlrev_b32 v178, 16, v190
    v_and_b32 v179, 0xffff0000, v190
    v_cvt_pk_bf16_f32 v190, v162, v163
    v_lshlrev_b32 v162, 16, v190
    v_and_b32 v163, 0xffff0000, v190
    v_lshlrev_b32 v188, 16, v229
    v_and_b32 v189, 0xffff0000, v229
    v_pk_add_f32 v[162:163], v[162:163], v[188:189]
    v_cvt_pk_bf16_f32 v190, v162, v163
    v_lshlrev_b32 v162, 16, v190
    v_and_b32 v163, 0xffff0000, v190
    v_pk_add_f32 v[162:163], v[162:163], v[178:179]
    v_cvt_pk_bf16_f32 v201, v162, v163
    v_cvt_pk_bf16_f32 v190, v180, v181
    v_lshlrev_b32 v180, 16, v190
    v_and_b32 v181, 0xffff0000, v190
    v_pk_add_f32 v[180:181], v[180:181], v[196:197]
    v_cvt_pk_bf16_f32 v190, v180, v181
    v_lshlrev_b32 v180, 16, v190
    v_and_b32 v181, 0xffff0000, v190
    v_cvt_pk_bf16_f32 v190, v164, v165
    v_lshlrev_b32 v164, 16, v190
    v_and_b32 v165, 0xffff0000, v190
    v_lshlrev_b32 v188, 16, v230
    v_and_b32 v189, 0xffff0000, v230
    v_pk_add_f32 v[164:165], v[164:165], v[188:189]
    v_cvt_pk_bf16_f32 v190, v164, v165
    v_lshlrev_b32 v164, 16, v190
    v_and_b32 v165, 0xffff0000, v190
    v_pk_add_f32 v[164:165], v[164:165], v[180:181]
    v_cvt_pk_bf16_f32 v202, v164, v165
    v_cvt_pk_bf16_f32 v190, v182, v183
    v_lshlrev_b32 v182, 16, v190
    v_and_b32 v183, 0xffff0000, v190
    v_pk_add_f32 v[182:183], v[182:183], v[198:199]
    v_cvt_pk_bf16_f32 v190, v182, v183
    v_lshlrev_b32 v182, 16, v190
    v_and_b32 v183, 0xffff0000, v190
    v_cvt_pk_bf16_f32 v190, v166, v167
    v_lshlrev_b32 v166, 16, v190
    v_and_b32 v167, 0xffff0000, v190
    v_lshlrev_b32 v188, 16, v231
    v_and_b32 v189, 0xffff0000, v231
    v_pk_add_f32 v[166:167], v[166:167], v[188:189]
    v_cvt_pk_bf16_f32 v190, v166, v167
    v_lshlrev_b32 v166, 16, v190
    v_and_b32 v167, 0xffff0000, v190
    v_pk_add_f32 v[166:167], v[166:167], v[182:183]
    v_cvt_pk_bf16_f32 v203, v166, v167
    buffer_store_dwordx2 v[200:201], v224, s[8:11], s72 offen
    buffer_store_dwordx2 v[202:203], v225, s[8:11], s72 offen
    s_endpgm
fused_kernel_h1:
    s_add_u32 s30, s25, 0xa40000
    buffer_load_dwordx4 v[16:19], v1, s[12:15], s30 offen offset:0 sc1
    s_add_u32 s31, s25, 0xa44800
    buffer_load_dwordx4 v[20:23], v1, s[12:15], s31 offen offset:0 sc1
    buffer_load_dwordx4 v[24:27], v1, s[12:15], s30 offen offset:1024 sc1
    buffer_load_dwordx4 v[28:31], v1, s[12:15], s31 offen offset:1024 sc1
    buffer_load_dwordx4 v[32:35], v1, s[12:15], s30 offen offset:2048 sc1
    buffer_load_dwordx4 v[36:39], v1, s[12:15], s31 offen offset:2048 sc1
    buffer_load_dwordx4 v[40:43], v1, s[12:15], s30 offen offset:3072 sc1
    buffer_load_dwordx4 v[44:47], v1, s[12:15], s31 offen offset:3072 sc1
    s_add_u32 s30, s25, 0xa41000
    buffer_load_dwordx4 v[48:51], v1, s[12:15], s30 offen offset:0 sc1
    s_add_u32 s31, s25, 0xa45800
    buffer_load_dwordx4 v[52:55], v1, s[12:15], s31 offen offset:0 sc1
    buffer_load_dwordx4 v[56:59], v1, s[12:15], s30 offen offset:1024 sc1
    buffer_load_dwordx4 v[60:63], v1, s[12:15], s31 offen offset:1024 sc1
    buffer_load_dwordx4 v[64:67], v1, s[12:15], s30 offen offset:2048 sc1
    buffer_load_dwordx4 v[68:71], v1, s[12:15], s31 offen offset:2048 sc1
    v_add_u32 v12, 73728, v10
    v_add_u32 v13, 73728, v11
    v_lshlrev_b32 v244, 6, v248
    v_lshl_add_u32 v244, v249, 4, v244
    s_lshl_b32 s33, s21, 1
    s_add_u32 s33, s33, s43
    s_mul_i32 s33, s33, 36864
    s_add_u32 s33, s33, 0x240000
    ds_read_b128 v[72:75], v12 offset:0
    ds_read_b128 v[76:79], v12 offset:18432
    ds_read_b128 v[80:83], v13 offset:1024
    ds_read_b128 v[84:87], v13 offset:19456
    ds_read_b128 v[88:91], v12 offset:2048
    ds_read_b128 v[92:95], v12 offset:20480
    s_waitcnt lgkmcnt(5)
    v_mfma_f32_16x16x32_f16 v[240:243], v[72:75], v[96:99], 0
    s_waitcnt lgkmcnt(4)
    v_mfma_f32_16x16x32_f16 v[252:255], v[76:79], v[96:99], 0
    ds_read_b128 v[72:75], v13 offset:3072
    ds_read_b128 v[76:79], v13 offset:21504
    s_waitcnt lgkmcnt(5)
    v_mfma_f32_16x16x32_f16 v[240:243], v[80:83], v[100:103], v[240:243]
    s_waitcnt lgkmcnt(4)
    v_mfma_f32_16x16x32_f16 v[252:255], v[84:87], v[100:103], v[252:255]
    ds_read_b128 v[80:83], v12 offset:4096
    ds_read_b128 v[84:87], v12 offset:22528
    s_waitcnt lgkmcnt(5)
    v_mfma_f32_16x16x32_f16 v[240:243], v[88:91], v[104:107], v[240:243]
    s_waitcnt lgkmcnt(4)
    v_mfma_f32_16x16x32_f16 v[252:255], v[92:95], v[104:107], v[252:255]
    ds_read_b128 v[88:91], v13 offset:5120
    ds_read_b128 v[92:95], v13 offset:23552
    s_waitcnt lgkmcnt(5)
    v_mfma_f32_16x16x32_f16 v[240:243], v[72:75], v[108:111], v[240:243]
    s_waitcnt lgkmcnt(4)
    v_mfma_f32_16x16x32_f16 v[252:255], v[76:79], v[108:111], v[252:255]
    ds_read_b128 v[72:75], v12 offset:6144
    ds_read_b128 v[76:79], v12 offset:24576
    s_waitcnt lgkmcnt(5)
    v_mfma_f32_16x16x32_f16 v[240:243], v[80:83], v[112:115], v[240:243]
    s_waitcnt lgkmcnt(4)
    v_mfma_f32_16x16x32_f16 v[252:255], v[84:87], v[112:115], v[252:255]
    ds_read_b128 v[80:83], v13 offset:7168
    ds_read_b128 v[84:87], v13 offset:25600
    s_waitcnt lgkmcnt(5)
    v_mfma_f32_16x16x32_f16 v[240:243], v[88:91], v[116:119], v[240:243]
    s_waitcnt lgkmcnt(4)
    v_mfma_f32_16x16x32_f16 v[252:255], v[92:95], v[116:119], v[252:255]
    ds_read_b128 v[88:91], v12 offset:8192
    ds_read_b128 v[92:95], v12 offset:26624
    s_waitcnt lgkmcnt(5)
    v_mfma_f32_16x16x32_f16 v[240:243], v[72:75], v[120:123], v[240:243]
    s_waitcnt lgkmcnt(4)
    v_mfma_f32_16x16x32_f16 v[252:255], v[76:79], v[120:123], v[252:255]
    ds_read_b128 v[72:75], v13 offset:9216
    ds_read_b128 v[76:79], v13 offset:27648
    s_waitcnt lgkmcnt(5)
    v_mfma_f32_16x16x32_f16 v[240:243], v[80:83], v[124:127], v[240:243]
    s_waitcnt lgkmcnt(4)
    v_mfma_f32_16x16x32_f16 v[252:255], v[84:87], v[124:127], v[252:255]
    ds_read_b128 v[80:83], v12 offset:10240
    ds_read_b128 v[84:87], v12 offset:28672
    s_waitcnt lgkmcnt(5)
    v_mfma_f32_16x16x32_f16 v[240:243], v[88:91], v[128:131], v[240:243]
    s_waitcnt lgkmcnt(4)
    v_mfma_f32_16x16x32_f16 v[252:255], v[92:95], v[128:131], v[252:255]
    ds_read_b128 v[88:91], v13 offset:11264
    ds_read_b128 v[92:95], v13 offset:29696
    s_waitcnt lgkmcnt(5)
    v_mfma_f32_16x16x32_f16 v[240:243], v[72:75], v[132:135], v[240:243]
    s_waitcnt lgkmcnt(4)
    v_mfma_f32_16x16x32_f16 v[252:255], v[76:79], v[132:135], v[252:255]
    ds_read_b128 v[72:75], v12 offset:12288
    ds_read_b128 v[76:79], v12 offset:30720
    s_waitcnt lgkmcnt(5)
    v_mfma_f32_16x16x32_f16 v[240:243], v[80:83], v[136:139], v[240:243]
    s_waitcnt lgkmcnt(4)
    v_mfma_f32_16x16x32_f16 v[252:255], v[84:87], v[136:139], v[252:255]
    ds_read_b128 v[80:83], v13 offset:13312
    ds_read_b128 v[84:87], v13 offset:31744
    s_waitcnt lgkmcnt(5)
    v_mfma_f32_16x16x32_f16 v[240:243], v[88:91], v[140:143], v[240:243]
    s_waitcnt lgkmcnt(4)
    v_mfma_f32_16x16x32_f16 v[252:255], v[92:95], v[140:143], v[252:255]
    ds_read_b128 v[88:91], v12 offset:14336
    ds_read_b128 v[92:95], v12 offset:32768
    s_waitcnt lgkmcnt(5)
    v_mfma_f32_16x16x32_f16 v[240:243], v[72:75], v[144:147], v[240:243]
    s_waitcnt lgkmcnt(4)
    v_mfma_f32_16x16x32_f16 v[252:255], v[76:79], v[144:147], v[252:255]
    ds_read_b128 v[72:75], v13 offset:15360
    ds_read_b128 v[76:79], v13 offset:33792
    s_waitcnt lgkmcnt(5)
    v_mfma_f32_16x16x32_f16 v[240:243], v[80:83], v[148:151], v[240:243]
    s_waitcnt lgkmcnt(4)
    v_mfma_f32_16x16x32_f16 v[252:255], v[84:87], v[148:151], v[252:255]
    ds_read_b128 v[80:83], v12 offset:16384
    ds_read_b128 v[84:87], v12 offset:34816
    s_waitcnt lgkmcnt(5)
    v_mfma_f32_16x16x32_f16 v[240:243], v[88:91], v[152:155], v[240:243]
    s_waitcnt lgkmcnt(4)
    v_mfma_f32_16x16x32_f16 v[252:255], v[92:95], v[152:155], v[252:255]
    ds_read_b128 v[88:91], v13 offset:17408
    ds_read_b128 v[92:95], v13 offset:35840
    s_waitcnt lgkmcnt(5)
    v_mfma_f32_16x16x32_f16 v[240:243], v[72:75], v[156:159], v[240:243]
    s_waitcnt lgkmcnt(4)
    v_mfma_f32_16x16x32_f16 v[252:255], v[76:79], v[156:159], v[252:255]
    s_waitcnt lgkmcnt(3)
    v_mfma_f32_16x16x32_f16 v[240:243], v[80:83], v[160:163], v[240:243]
    s_waitcnt lgkmcnt(2)
    v_mfma_f32_16x16x32_f16 v[252:255], v[84:87], v[160:163], v[252:255]
    s_waitcnt lgkmcnt(1)
    v_mfma_f32_16x16x32_f16 v[240:243], v[88:91], v[164:167], v[240:243]
    s_waitcnt lgkmcnt(0)
    v_mfma_f32_16x16x32_f16 v[252:255], v[92:95], v[164:167], v[252:255]
    s_nop 5
    v_mul_f32 v240, 0x3d000000, v240
    v_mul_f32 v241, 0x3d000000, v241
    v_mul_f32 v242, 0x3d000000, v242
    v_mul_f32 v243, 0x3d000000, v243
    v_cvt_pk_f16_f32 v72, v240, v241
    v_cvt_pk_f16_f32 v73, v242, v243
    v_mul_f32 v252, 0x3d000000, v252
    v_mul_f32 v253, 0x3d000000, v253
    v_mul_f32 v254, 0x3d000000, v254
    v_mul_f32 v255, 0x3d000000, v255
    v_cvt_pk_f16_f32 v74, v252, v253
    v_cvt_pk_f16_f32 v75, v254, v255
    s_lshl_b32 s34, s37, 10
    s_add_u32 s34, s34, s33
    buffer_store_dwordx4 v[72:75], v244, s[12:15], s34 offen sc1
    s_cmp_lg_u32 s22, 7
    s_cbranch_scc1 fused_kernel_r1_n7
    s_nop 1
    ds_read_b128 v[72:75], v12 offset:0
    ds_read_b128 v[76:79], v12 offset:18432
    ds_read_b128 v[80:83], v13 offset:1024
    ds_read_b128 v[84:87], v13 offset:19456
    ds_read_b128 v[88:91], v12 offset:2048
    ds_read_b128 v[92:95], v12 offset:20480
    s_waitcnt lgkmcnt(5)
    v_mfma_f32_16x16x32_f16 v[240:243], v[72:75], v[168:171], 0
    s_waitcnt lgkmcnt(4)
    v_mfma_f32_16x16x32_f16 v[252:255], v[76:79], v[168:171], 0
    ds_read_b128 v[72:75], v13 offset:3072
    ds_read_b128 v[76:79], v13 offset:21504
    s_waitcnt lgkmcnt(5)
    v_mfma_f32_16x16x32_f16 v[240:243], v[80:83], v[172:175], v[240:243]
    s_waitcnt lgkmcnt(4)
    v_mfma_f32_16x16x32_f16 v[252:255], v[84:87], v[172:175], v[252:255]
    ds_read_b128 v[80:83], v12 offset:4096
    ds_read_b128 v[84:87], v12 offset:22528
    s_waitcnt lgkmcnt(5)
    v_mfma_f32_16x16x32_f16 v[240:243], v[88:91], v[176:179], v[240:243]
    s_waitcnt lgkmcnt(4)
    v_mfma_f32_16x16x32_f16 v[252:255], v[92:95], v[176:179], v[252:255]
    ds_read_b128 v[88:91], v13 offset:5120
    ds_read_b128 v[92:95], v13 offset:23552
    s_waitcnt lgkmcnt(5)
    v_mfma_f32_16x16x32_f16 v[240:243], v[72:75], v[180:183], v[240:243]
    s_waitcnt lgkmcnt(4)
    v_mfma_f32_16x16x32_f16 v[252:255], v[76:79], v[180:183], v[252:255]
    ds_read_b128 v[72:75], v12 offset:6144
    ds_read_b128 v[76:79], v12 offset:24576
    s_waitcnt lgkmcnt(5)
    v_mfma_f32_16x16x32_f16 v[240:243], v[80:83], v[184:187], v[240:243]
    s_waitcnt lgkmcnt(4)
    v_mfma_f32_16x16x32_f16 v[252:255], v[84:87], v[184:187], v[252:255]
    ds_read_b128 v[80:83], v13 offset:7168
    ds_read_b128 v[84:87], v13 offset:25600
    s_waitcnt lgkmcnt(5)
    v_mfma_f32_16x16x32_f16 v[240:243], v[88:91], v[188:191], v[240:243]
    s_waitcnt lgkmcnt(4)
    v_mfma_f32_16x16x32_f16 v[252:255], v[92:95], v[188:191], v[252:255]
    ds_read_b128 v[88:91], v12 offset:8192
    ds_read_b128 v[92:95], v12 offset:26624
    s_waitcnt lgkmcnt(5)
    v_mfma_f32_16x16x32_f16 v[240:243], v[72:75], v[192:195], v[240:243]
    s_waitcnt lgkmcnt(4)
    v_mfma_f32_16x16x32_f16 v[252:255], v[76:79], v[192:195], v[252:255]
    ds_read_b128 v[72:75], v13 offset:9216
    ds_read_b128 v[76:79], v13 offset:27648
    s_waitcnt lgkmcnt(5)
    v_mfma_f32_16x16x32_f16 v[240:243], v[80:83], v[196:199], v[240:243]
    s_waitcnt lgkmcnt(4)
    v_mfma_f32_16x16x32_f16 v[252:255], v[84:87], v[196:199], v[252:255]
    ds_read_b128 v[80:83], v12 offset:10240
    ds_read_b128 v[84:87], v12 offset:28672
    s_waitcnt lgkmcnt(5)
    v_mfma_f32_16x16x32_f16 v[240:243], v[88:91], v[200:203], v[240:243]
    s_waitcnt lgkmcnt(4)
    v_mfma_f32_16x16x32_f16 v[252:255], v[92:95], v[200:203], v[252:255]
    ds_read_b128 v[88:91], v13 offset:11264
    ds_read_b128 v[92:95], v13 offset:29696
    s_waitcnt lgkmcnt(5)
    v_mfma_f32_16x16x32_f16 v[240:243], v[72:75], v[204:207], v[240:243]
    s_waitcnt lgkmcnt(4)
    v_mfma_f32_16x16x32_f16 v[252:255], v[76:79], v[204:207], v[252:255]
    ds_read_b128 v[72:75], v12 offset:12288
    ds_read_b128 v[76:79], v12 offset:30720
    s_waitcnt lgkmcnt(5)
    v_mfma_f32_16x16x32_f16 v[240:243], v[80:83], v[208:211], v[240:243]
    s_waitcnt lgkmcnt(4)
    v_mfma_f32_16x16x32_f16 v[252:255], v[84:87], v[208:211], v[252:255]
    ds_read_b128 v[80:83], v13 offset:13312
    ds_read_b128 v[84:87], v13 offset:31744
    s_waitcnt lgkmcnt(5)
    v_mfma_f32_16x16x32_f16 v[240:243], v[88:91], v[212:215], v[240:243]
    s_waitcnt lgkmcnt(4)
    v_mfma_f32_16x16x32_f16 v[252:255], v[92:95], v[212:215], v[252:255]
    ds_read_b128 v[88:91], v12 offset:14336
    ds_read_b128 v[92:95], v12 offset:32768
    s_waitcnt lgkmcnt(5)
    v_mfma_f32_16x16x32_f16 v[240:243], v[72:75], v[216:219], v[240:243]
    s_waitcnt lgkmcnt(4)
    v_mfma_f32_16x16x32_f16 v[252:255], v[76:79], v[216:219], v[252:255]
    ds_read_b128 v[72:75], v13 offset:15360
    ds_read_b128 v[76:79], v13 offset:33792
    s_waitcnt lgkmcnt(5)
    v_mfma_f32_16x16x32_f16 v[240:243], v[80:83], v[220:223], v[240:243]
    s_waitcnt lgkmcnt(4)
    v_mfma_f32_16x16x32_f16 v[252:255], v[84:87], v[220:223], v[252:255]
    ds_read_b128 v[80:83], v12 offset:16384
    ds_read_b128 v[84:87], v12 offset:34816
    s_waitcnt lgkmcnt(5)
    v_mfma_f32_16x16x32_f16 v[240:243], v[88:91], v[224:227], v[240:243]
    s_waitcnt lgkmcnt(4)
    v_mfma_f32_16x16x32_f16 v[252:255], v[92:95], v[224:227], v[252:255]
    ds_read_b128 v[88:91], v13 offset:17408
    ds_read_b128 v[92:95], v13 offset:35840
    s_waitcnt lgkmcnt(5)
    v_mfma_f32_16x16x32_f16 v[240:243], v[72:75], v[228:231], v[240:243]
    s_waitcnt lgkmcnt(4)
    v_mfma_f32_16x16x32_f16 v[252:255], v[76:79], v[228:231], v[252:255]
    s_waitcnt lgkmcnt(3)
    v_mfma_f32_16x16x32_f16 v[240:243], v[80:83], v[232:235], v[240:243]
    s_waitcnt lgkmcnt(2)
    v_mfma_f32_16x16x32_f16 v[252:255], v[84:87], v[232:235], v[252:255]
    s_waitcnt lgkmcnt(1)
    v_mfma_f32_16x16x32_f16 v[240:243], v[88:91], v[236:239], v[240:243]
    s_waitcnt lgkmcnt(0)
    v_mfma_f32_16x16x32_f16 v[252:255], v[92:95], v[236:239], v[252:255]
    s_nop 5
    v_mul_f32 v240, 0x3d000000, v240
    v_mul_f32 v241, 0x3d000000, v241
    v_mul_f32 v242, 0x3d000000, v242
    v_mul_f32 v243, 0x3d000000, v243
    v_cvt_pk_f16_f32 v72, v240, v241
    v_cvt_pk_f16_f32 v73, v242, v243
    v_mul_f32 v252, 0x3d000000, v252
    v_mul_f32 v253, 0x3d000000, v253
    v_mul_f32 v254, 0x3d000000, v254
    v_mul_f32 v255, 0x3d000000, v255
    v_cvt_pk_f16_f32 v74, v252, v253
    v_cvt_pk_f16_f32 v75, v254, v255
    s_lshl_b32 s34, s62, 10
    s_add_u32 s34, s34, s33
    buffer_store_dwordx4 v[72:75], v244, s[12:15], s34 offen sc1
fused_kernel_r1_n7:
    s_cmp_lg_u32 s22, 6
    s_cbranch_scc1 fused_kernel_r1_nc
    s_sub_u32 s32, s2, 128
    s_cmp_ge_u32 s32, 20
    s_cbranch_scc1 fused_kernel_r1_nc
    s_lshr_b32 s81, s32, 2
    s_bfe_u32 s82, s32, 0x10001
    s_and_b32 s83, s32, 1
    s_cmp_lt_u32 s32, 16
    s_cselect_b32 s80, 1, 0
    s_cselect_b32 s81, s81, s82
    s_cselect_b32 s82, s82, s83
    s_cselect_b32 s83, s83, 0
    s_cselect_b32 s84, 63, 31
    s_lshl_b32 s80, s80, 23
    s_sub_u32 s85, 0x3d000000, s80
    s_sub_u32 s86, 0x3e800000, s80
    s_cmp_eq_u32 s82, 0
    s_cselect_b32 s87, 0, 0x3f400000
    s_lshl_b32 s81, s81, 4
    v_add_u32 v96, s81, v248
    s_lshl_b32 s83, s83, 5
    v_lshl_add_u32 v97, v249, 2, s83
    v_mov_b32 v98, s87
    v_add_u32 v99, 0, v97
    v_mul_u32_u24 v99, v99, v96
    v_and_b32 v99, s84, v99
    v_cvt_f32_u32 v99, v99
    v_fma_f32 v99, v99, s85, v98
    v_cos_f32 v99, v99
    s_nop 0
    v_mul_f32 v100, s86, v99
    v_add_u32 v99, 1, v97
    v_mul_u32_u24 v99, v99, v96
    v_and_b32 v99, s84, v99
    v_cvt_f32_u32 v99, v99
    v_fma_f32 v99, v99, s85, v98
    v_cos_f32 v99, v99
    s_nop 0
    v_mul_f32 v101, s86, v99
    v_add_u32 v99, 2, v97
    v_mul_u32_u24 v99, v99, v96
    v_and_b32 v99, s84, v99
    v_cvt_f32_u32 v99, v99
    v_fma_f32 v99, v99, s85, v98
    v_cos_f32 v99, v99
    s_nop 0
    v_mul_f32 v102, s86, v99
    v_add_u32 v99, 3, v97
    v_mul_u32_u24 v99, v99, v96
    v_and_b32 v99, s84, v99
    v_cvt_f32_u32 v99, v99
    v_fma_f32 v99, v99, s85, v98
    v_cos_f32 v99, v99
    s_nop 0
    v_mul_f32 v103, s86, v99
    v_add_u32 v99, 16, v97
    v_mul_u32_u24 v99, v99, v96
    v_and_b32 v99, s84, v99
    v_cvt_f32_u32 v99, v99
    v_fma_f32 v99, v99, s85, v98
    v_cos_f32 v99, v99
    s_nop 0
    v_mul_f32 v104, s86, v99
    v_add_u32 v99, 17, v97
    v_mul_u32_u24 v99, v99, v96
    v_and_b32 v99, s84, v99
    v_cvt_f32_u32 v99, v99
    v_fma_f32 v99, v99, s85, v98
    v_cos_f32 v99, v99
    s_nop 0
    v_mul_f32 v105, s86, v99
    v_add_u32 v99, 18, v97
    v_mul_u32_u24 v99, v99, v96
    v_and_b32 v99, s84, v99
    v_cvt_f32_u32 v99, v99
    v_fma_f32 v99, v99, s85, v98
    v_cos_f32 v99, v99
    s_nop 0
    v_mul_f32 v106, s86, v99
    v_add_u32 v99, 19, v97
    v_mul_u32_u24 v99, v99, v96
    v_and_b32 v99, s84, v99
    v_cvt_f32_u32 v99, v99
    v_fma_f32 v99, v99, s85, v98
    v_cos_f32 v99, v99
    s_nop 0
    v_mul_f32 v107, s86, v99
    v_cvt_pk_f16_f32 v108, v100, v101
    v_cvt_pk_f16_f32 v109, v102, v103
    v_cvt_pk_f16_f32 v110, v104, v105
    v_cvt_pk_f16_f32 v111, v106, v107
    s_lshl_b32 s80, s32, 10
    s_add_u32 s80, s80, 0xa00000
    buffer_store_dwordx4 v[108:111], v1, s[12:15], s80 offen sc1
fused_kernel_r1_nc:
    s_cmp_ge_u32 s2, 128
    s_cbranch_scc1 fused_kernel_r1_nw
    s_mul_i32 s33, s2, 18560
    s_add_u32 s33, s33, 0x480000
    v_add_u32 v96, 0, v0
    v_and_b32 v97, 1, v96
    v_lshrrev_b32 v98, 1, v96
    v_min_u32 v98, 288, v98
    v_mul_u32_u24 v99, 578, v97
    v_lshl_add_u32 v99, v98, 1, v99
    v_add_u32 v99, 110592, v99
    ds_read_u16 v112, v99 offset:0
    ds_read_u16 v120, v99 offset:1160
    ds_read_u16 v113, v99 offset:4096
    ds_read_u16 v121, v99 offset:5256
    ds_read_u16 v114, v99 offset:8192
    ds_read_u16 v122, v99 offset:9352
    ds_read_u16 v115, v99 offset:12288
    ds_read_u16 v123, v99 offset:13448
    ds_read_u16 v116, v99 offset:16384
    ds_read_u16 v124, v99 offset:17544
    ds_read_u16 v117, v99 offset:20480
    ds_read_u16 v125, v99 offset:21640
    ds_read_u16 v118, v99 offset:24576
    ds_read_u16 v126, v99 offset:25736
    ds_read_u16 v119, v99 offset:28672
    ds_read_u16 v127, v99 offset:29832
    v_lshlrev_b32 v100, 6, v98
    v_lshl_add_u32 v100, v97, 5, v100
    s_waitcnt lgkmcnt(0)
    v_lshl_or_b32 v104, v120, 16, v112
    v_lshl_or_b32 v105, v121, 16, v113
    v_lshl_or_b32 v106, v122, 16, v114
    v_lshl_or_b32 v107, v123, 16, v115
    v_lshl_or_b32 v108, v124, 16, v116
    v_lshl_or_b32 v109, v125, 16, v117
    v_lshl_or_b32 v110, v126, 16, v118
    v_lshl_or_b32 v111, v127, 16, v119
    buffer_store_dwordx4 v[104:107], v100, s[12:15], s33 offen sc1
    buffer_store_dwordx4 v[108:111], v100, s[12:15], s33 offen offset:16 sc1
fused_kernel_r1_nw:
    v_mov_b32 v12, 149796
    v_mov_b32 v13, 1
    s_mov_b64 exec, 1
    ds_add_u32 v12, v13
    s_mov_b64 exec, -1
    ds_read_b128 v[192:195], v3 offset:0
    ds_read_b128 v[196:199], v3 offset:64
    ds_read_b128 v[80:83], v10 offset:0
    ds_read_b128 v[84:87], v10 offset:18432
    ds_read_b128 v[88:91], v10 offset:36864
    ds_read_b128 v[92:95], v10 offset:55296
    ds_read_b128 v[96:99], v11 offset:1024
    ds_read_b128 v[100:103], v11 offset:19456
    ds_read_b128 v[104:107], v11 offset:37888
    ds_read_b128 v[108:111], v11 offset:56320
    s_waitcnt vmcnt(14) lgkmcnt(7)
    v_mfma_f32_16x16x32_bf16 v[144:147], v[16:19], v[80:83], v[192:195]
    s_waitcnt vmcnt(12) lgkmcnt(3)
    v_mfma_f32_16x16x32_bf16 v[144:147], v[24:27], v[96:99], v[144:147]
    v_mfma_f32_16x16x32_bf16 v[160:163], v[20:23], v[80:83], v[196:199]
    s_waitcnt vmcnt(11)
    v_mfma_f32_16x16x32_bf16 v[160:163], v[28:31], v[96:99], v[160:163]
    ds_read_b128 v[80:83], v10 offset:2048
    ds_read_b128 v[96:99], v11 offset:3072
    v_mfma_f32_16x16x32_bf16 v[148:151], v[16:19], v[84:87], v[192:195]
    s_waitcnt lgkmcnt(4)
    v_mfma_f32_16x16x32_bf16 v[148:151], v[24:27], v[100:103], v[148:151]
    v_mfma_f32_16x16x32_bf16 v[164:167], v[20:23], v[84:87], v[196:199]
    v_mfma_f32_16x16x32_bf16 v[164:167], v[28:31], v[100:103], v[164:167]
    ds_read_b128 v[84:87], v10 offset:20480
    ds_read_b128 v[100:103], v11 offset:21504
    v_mfma_f32_16x16x32_bf16 v[152:155], v[16:19], v[88:91], v[192:195]
    s_waitcnt lgkmcnt(5)
    v_mfma_f32_16x16x32_bf16 v[152:155], v[24:27], v[104:107], v[152:155]
    v_mfma_f32_16x16x32_bf16 v[168:171], v[20:23], v[88:91], v[196:199]
    v_mfma_f32_16x16x32_bf16 v[168:171], v[28:31], v[104:107], v[168:171]
    ds_read_b128 v[88:91], v10 offset:38912
    ds_read_b128 v[104:107], v11 offset:39936
    v_mfma_f32_16x16x32_bf16 v[156:159], v[16:19], v[92:95], v[192:195]
    s_waitcnt lgkmcnt(6)
    v_mfma_f32_16x16x32_bf16 v[156:159], v[24:27], v[108:111], v[156:159]
    v_mfma_f32_16x16x32_bf16 v[172:175], v[20:23], v[92:95], v[196:199]
    v_mfma_f32_16x16x32_bf16 v[172:175], v[28:31], v[108:111], v[172:175]
    ds_read_b128 v[92:95], v10 offset:57344
    ds_read_b128 v[108:111], v11 offset:58368
    buffer_load_dwordx4 v[72:75], v1, s[12:15], s30 offen offset:3072 sc1
    buffer_load_dwordx4 v[76:79], v1, s[12:15], s31 offen offset:3072 sc1
    s_add_u32 s30, s25, 0xa42000
    buffer_load_dwordx4 v[16:19], v1, s[12:15], s30 offen offset:0 sc1
    s_add_u32 s31, s25, 0xa46800
    buffer_load_dwordx4 v[20:23], v1, s[12:15], s31 offen offset:0 sc1
    s_waitcnt vmcnt(14) lgkmcnt(7)
    v_mfma_f32_16x16x32_bf16 v[144:147], v[32:35], v[80:83], v[144:147]
    s_waitcnt vmcnt(12) lgkmcnt(6)
    v_mfma_f32_16x16x32_bf16 v[144:147], v[40:43], v[96:99], v[144:147]
    v_mfma_f32_16x16x32_bf16 v[160:163], v[36:39], v[80:83], v[160:163]
    s_waitcnt vmcnt(11)
    v_mfma_f32_16x16x32_bf16 v[160:163], v[44:47], v[96:99], v[160:163]
    ds_read_b128 v[80:83], v10 offset:4096
    ds_read_b128 v[96:99], v11 offset:5120
    s_waitcnt lgkmcnt(7)
    v_mfma_f32_16x16x32_bf16 v[148:151], v[32:35], v[84:87], v[148:151]
    s_waitcnt lgkmcnt(6)
    v_mfma_f32_16x16x32_bf16 v[148:151], v[40:43], v[100:103], v[148:151]
    v_mfma_f32_16x16x32_bf16 v[164:167], v[36:39], v[84:87], v[164:167]
    v_mfma_f32_16x16x32_bf16 v[164:167], v[44:47], v[100:103], v[164:167]
    ds_read_b128 v[84:87], v10 offset:22528
    ds_read_b128 v[100:103], v11 offset:23552
    s_waitcnt lgkmcnt(7)
    v_mfma_f32_16x16x32_bf16 v[152:155], v[32:35], v[88:91], v[152:155]
    s_waitcnt lgkmcnt(6)
    v_mfma_f32_16x16x32_bf16 v[152:155], v[40:43], v[104:107], v[152:155]
    v_mfma_f32_16x16x32_bf16 v[168:171], v[36:39], v[88:91], v[168:171]
    v_mfma_f32_16x16x32_bf16 v[168:171], v[44:47], v[104:107], v[168:171]
    ds_read_b128 v[88:91], v10 offset:40960
    ds_read_b128 v[104:107], v11 offset:41984
    s_waitcnt lgkmcnt(7)
    v_mfma_f32_16x16x32_bf16 v[156:159], v[32:35], v[92:95], v[156:159]
    s_waitcnt lgkmcnt(6)
    v_mfma_f32_16x16x32_bf16 v[156:159], v[40:43], v[108:111], v[156:159]
    v_mfma_f32_16x16x32_bf16 v[172:175], v[36:39], v[92:95], v[172:175]
    v_mfma_f32_16x16x32_bf16 v[172:175], v[44:47], v[108:111], v[172:175]
    ds_read_b128 v[92:95], v10 offset:59392
    ds_read_b128 v[108:111], v11 offset:60416
    buffer_load_dwordx4 v[24:27], v1, s[12:15], s30 offen offset:1024 sc1
    buffer_load_dwordx4 v[28:31], v1, s[12:15], s31 offen offset:1024 sc1
    ds_read_b128 v[192:195], v3 offset:1024
    ds_read_b128 v[196:199], v3 offset:1088
    buffer_load_dwordx4 v[32:35], v1, s[12:15], s30 offen offset:2048 sc1
    buffer_load_dwordx4 v[36:39], v1, s[12:15], s31 offen offset:2048 sc1
    s_waitcnt vmcnt(14) lgkmcnt(9)
    v_mfma_f32_16x16x32_bf16 v[144:147], v[48:51], v[80:83], v[144:147]
    s_waitcnt vmcnt(12) lgkmcnt(8)
    v_mfma_f32_16x16x32_bf16 v[144:147], v[56:59], v[96:99], v[144:147]
    v_mfma_f32_16x16x32_bf16 v[160:163], v[52:55], v[80:83], v[160:163]
    s_waitcnt vmcnt(11)
    v_mfma_f32_16x16x32_bf16 v[160:163], v[60:63], v[96:99], v[160:163]
    ds_read_b128 v[80:83], v10 offset:6144
    ds_read_b128 v[96:99], v11 offset:7168
    s_waitcnt lgkmcnt(9)
    v_mfma_f32_16x16x32_bf16 v[148:151], v[48:51], v[84:87], v[148:151]
    s_waitcnt lgkmcnt(8)
    v_mfma_f32_16x16x32_bf16 v[148:151], v[56:59], v[100:103], v[148:151]
    v_mfma_f32_16x16x32_bf16 v[164:167], v[52:55], v[84:87], v[164:167]
    v_mfma_f32_16x16x32_bf16 v[164:167], v[60:63], v[100:103], v[164:167]
    ds_read_b128 v[84:87], v10 offset:24576
    ds_read_b128 v[100:103], v11 offset:25600
    s_waitcnt lgkmcnt(9)
    v_mfma_f32_16x16x32_bf16 v[152:155], v[48:51], v[88:91], v[152:155]
    s_waitcnt lgkmcnt(8)
    v_mfma_f32_16x16x32_bf16 v[152:155], v[56:59], v[104:107], v[152:155]
    v_mfma_f32_16x16x32_bf16 v[168:171], v[52:55], v[88:91], v[168:171]
    v_mfma_f32_16x16x32_bf16 v[168:171], v[60:63], v[104:107], v[168:171]
    ds_read_b128 v[88:91], v10 offset:43008
    ds_read_b128 v[104:107], v11 offset:44032
    s_waitcnt lgkmcnt(9)
    v_mfma_f32_16x16x32_bf16 v[156:159], v[48:51], v[92:95], v[156:159]
    s_waitcnt lgkmcnt(8)
    v_mfma_f32_16x16x32_bf16 v[156:159], v[56:59], v[108:111], v[156:159]
    v_mfma_f32_16x16x32_bf16 v[172:175], v[52:55], v[92:95], v[172:175]
    v_mfma_f32_16x16x32_bf16 v[172:175], v[60:63], v[108:111], v[172:175]
    ds_read_b128 v[92:95], v10 offset:61440
    ds_read_b128 v[108:111], v11 offset:62464
    buffer_load_dwordx4 v[40:43], v1, s[12:15], s30 offen offset:3072 sc1
    buffer_load_dwordx4 v[44:47], v1, s[12:15], s31 offen offset:3072 sc1
    s_add_u32 s30, s25, 0xa43000
    buffer_load_dwordx4 v[48:51], v1, s[12:15], s30 offen offset:0 sc1
    s_add_u32 s31, s25, 0xa47800
    buffer_load_dwordx4 v[52:55], v1, s[12:15], s31 offen offset:0 sc1
    s_waitcnt vmcnt(14) lgkmcnt(7)
    v_mfma_f32_16x16x32_bf16 v[144:147], v[64:67], v[80:83], v[144:147]
    s_waitcnt vmcnt(11) lgkmcnt(6)
    v_mfma_f32_16x16x32_bf16 v[144:147], v[72:75], v[96:99], v[144:147]
    v_mfma_f32_16x16x32_bf16 v[160:163], v[68:71], v[80:83], v[160:163]
    s_waitcnt vmcnt(10)
    v_mfma_f32_16x16x32_bf16 v[160:163], v[76:79], v[96:99], v[160:163]
    ds_read_b128 v[80:83], v10 offset:8192
    ds_read_b128 v[96:99], v11 offset:9216
    s_waitcnt lgkmcnt(7)
    v_mfma_f32_16x16x32_bf16 v[148:151], v[64:67], v[84:87], v[148:151]
    s_waitcnt lgkmcnt(6)
    v_mfma_f32_16x16x32_bf16 v[148:151], v[72:75], v[100:103], v[148:151]
    v_mfma_f32_16x16x32_bf16 v[164:167], v[68:71], v[84:87], v[164:167]
    v_mfma_f32_16x16x32_bf16 v[164:167], v[76:79], v[100:103], v[164:167]
    ds_read_b128 v[84:87], v10 offset:26624
    ds_read_b128 v[100:103], v11 offset:27648
    s_waitcnt lgkmcnt(7)
    v_mfma_f32_16x16x32_bf16 v[152:155], v[64:67], v[88:91], v[152:155]
    s_waitcnt lgkmcnt(6)
    v_mfma_f32_16x16x32_bf16 v[152:155], v[72:75], v[104:107], v[152:155]
    v_mfma_f32_16x16x32_bf16 v[168:171], v[68:71], v[88:91], v[168:171]
    v_mfma_f32_16x16x32_bf16 v[168:171], v[76:79], v[104:107], v[168:171]
    ds_read_b128 v[88:91], v10 offset:45056
    ds_read_b128 v[104:107], v11 offset:46080
    s_waitcnt lgkmcnt(7)
    v_mfma_f32_16x16x32_bf16 v[156:159], v[64:67], v[92:95], v[156:159]
    s_waitcnt lgkmcnt(6)
    v_mfma_f32_16x16x32_bf16 v[156:159], v[72:75], v[108:111], v[156:159]
    v_mfma_f32_16x16x32_bf16 v[172:175], v[68:71], v[92:95], v[172:175]
    v_mfma_f32_16x16x32_bf16 v[172:175], v[76:79], v[108:111], v[172:175]
    ds_read_b128 v[92:95], v10 offset:63488
    ds_read_b128 v[108:111], v11 offset:64512
    buffer_load_dwordx4 v[56:59], v1, s[12:15], s30 offen offset:1024 sc1
    buffer_load_dwordx4 v[60:63], v1, s[12:15], s31 offen offset:1024 sc1
    buffer_load_dwordx4 v[64:67], v1, s[12:15], s30 offen offset:2048 sc1
    buffer_load_dwordx4 v[68:71], v1, s[12:15], s31 offen offset:2048 sc1
    s_waitcnt vmcnt(13) lgkmcnt(7)
    v_mfma_f32_16x16x32_bf16 v[144:147], v[16:19], v[80:83], v[144:147]
    s_waitcnt vmcnt(11) lgkmcnt(6)
    v_mfma_f32_16x16x32_bf16 v[144:147], v[24:27], v[96:99], v[144:147]
    v_mfma_f32_16x16x32_bf16 v[160:163], v[20:23], v[80:83], v[160:163]
    s_waitcnt vmcnt(10)
    v_mfma_f32_16x16x32_bf16 v[160:163], v[28:31], v[96:99], v[160:163]
    ds_read_b128 v[80:83], v10 offset:10240
    ds_read_b128 v[96:99], v11 offset:11264
    s_waitcnt lgkmcnt(7)
    v_mfma_f32_16x16x32_bf16 v[148:151], v[16:19], v[84:87], v[148:151]
    s_waitcnt lgkmcnt(6)
    v_mfma_f32_16x16x32_bf16 v[148:151], v[24:27], v[100:103], v[148:151]
    v_mfma_f32_16x16x32_bf16 v[164:167], v[20:23], v[84:87], v[164:167]
    v_mfma_f32_16x16x32_bf16 v[164:167], v[28:31], v[100:103], v[164:167]
    ds_read_b128 v[84:87], v10 offset:28672
    ds_read_b128 v[100:103], v11 offset:29696
    s_waitcnt lgkmcnt(7)
    v_mfma_f32_16x16x32_bf16 v[152:155], v[16:19], v[88:91], v[152:155]
    s_waitcnt lgkmcnt(6)
    v_mfma_f32_16x16x32_bf16 v[152:155], v[24:27], v[104:107], v[152:155]
    v_mfma_f32_16x16x32_bf16 v[168:171], v[20:23], v[88:91], v[168:171]
    v_mfma_f32_16x16x32_bf16 v[168:171], v[28:31], v[104:107], v[168:171]
    ds_read_b128 v[88:91], v10 offset:47104
    ds_read_b128 v[104:107], v11 offset:48128
    s_waitcnt lgkmcnt(7)
    v_mfma_f32_16x16x32_bf16 v[156:159], v[16:19], v[92:95], v[156:159]
    s_waitcnt lgkmcnt(6)
    v_mfma_f32_16x16x32_bf16 v[156:159], v[24:27], v[108:111], v[156:159]
    v_mfma_f32_16x16x32_bf16 v[172:175], v[20:23], v[92:95], v[172:175]
    v_mfma_f32_16x16x32_bf16 v[172:175], v[28:31], v[108:111], v[172:175]
    ds_read_b128 v[92:95], v14 offset:0
    ds_read_b128 v[108:111], v15 offset:1024
    buffer_load_dwordx4 v[72:75], v1, s[12:15], s30 offen offset:3072 sc1
    buffer_load_dwordx4 v[76:79], v1, s[12:15], s31 offen offset:3072 sc1
    v_mov_b32 v12, 149764
    v_mov_b32 v13, 1
    s_mov_b64 exec, 1
    ds_add_rtn_u32 v13, v12, v13
    s_waitcnt lgkmcnt(0)
    v_readfirstlane_b32 s35, v13
    s_mov_b64 exec, -1
    s_nop 1
    s_cmp_lg_u32 s35, 7
    s_cbranch_scc1 fused_kernel_r1_g2
    s_lshl_b32 s33, s2, 3
    s_add_u32 s33, s33, 0xa28000
    v_lshlrev_b32 v254, 11, v9
    v_mov_b32 v12, s100
    v_mov_b32 v13, s101
    s_mov_b64 exec, 0xffff
    buffer_store_dwordx2 v[12:13], v254, s[12:15], s33 offen sc1
    s_mov_b64 exec, -1
    s_lshl_b32 s33, s20, 8
    s_lshl_b32 s34, s21, 3
    s_add_u32 s33, s33, s34
    s_add_u32 s33, s33, 0xa20800
    v_mov_b32 v12, s100
    v_mov_b32 v13, s101
    s_mov_b64 exec, 1
    buffer_store_dwordx2 v[12:13], v1, s[12:15], s33 offen sc1
    s_mov_b64 exec, -1
fused_kernel_r1_g2:
    s_add_u32 s30, s25, 0xa44000
    buffer_load_dwordx4 v[16:19], v1, s[12:15], s30 offen offset:0 sc1
    s_add_u32 s31, s25, 0xa48800
    buffer_load_dwordx4 v[20:23], v1, s[12:15], s31 offen offset:0 sc1
    s_waitcnt vmcnt(13) lgkmcnt(7)
    v_mfma_f32_16x16x32_bf16 v[144:147], v[32:35], v[80:83], v[144:147]
    s_waitcnt vmcnt(11) lgkmcnt(6)
    v_mfma_f32_16x16x32_bf16 v[144:147], v[40:43], v[96:99], v[144:147]
    v_mfma_f32_16x16x32_bf16 v[160:163], v[36:39], v[80:83], v[160:163]
    s_waitcnt vmcnt(10)
    v_mfma_f32_16x16x32_bf16 v[160:163], v[44:47], v[96:99], v[160:163]
    ds_read_b128 v[80:83], v10 offset:12288
    ds_read_b128 v[96:99], v11 offset:13312
    s_waitcnt lgkmcnt(7)
    v_mfma_f32_16x16x32_bf16 v[148:151], v[32:35], v[84:87], v[148:151]
    s_waitcnt lgkmcnt(6)
    v_mfma_f32_16x16x32_bf16 v[148:151], v[40:43], v[100:103], v[148:151]
    v_mfma_f32_16x16x32_bf16 v[164:167], v[36:39], v[84:87], v[164:167]
    v_mfma_f32_16x16x32_bf16 v[164:167], v[44:47], v[100:103], v[164:167]
    ds_read_b128 v[84:87], v10 offset:30720
    ds_read_b128 v[100:103], v11 offset:31744
    s_waitcnt lgkmcnt(7)
    v_mfma_f32_16x16x32_bf16 v[152:155], v[32:35], v[88:91], v[152:155]
    s_waitcnt lgkmcnt(6)
    v_mfma_f32_16x16x32_bf16 v[152:155], v[40:43], v[104:107], v[152:155]
    v_mfma_f32_16x16x32_bf16 v[168:171], v[36:39], v[88:91], v[168:171]
    v_mfma_f32_16x16x32_bf16 v[168:171], v[44:47], v[104:107], v[168:171]
    ds_read_b128 v[88:91], v10 offset:49152
    ds_read_b128 v[104:107], v11 offset:50176
    s_waitcnt lgkmcnt(7)
    v_mfma_f32_16x16x32_bf16 v[156:159], v[32:35], v[92:95], v[156:159]
    s_waitcnt lgkmcnt(6)
    v_mfma_f32_16x16x32_bf16 v[156:159], v[40:43], v[108:111], v[156:159]
    v_mfma_f32_16x16x32_bf16 v[172:175], v[36:39], v[92:95], v[172:175]
    v_mfma_f32_16x16x32_bf16 v[172:175], v[44:47], v[108:111], v[172:175]
    ds_read_b128 v[92:95], v14 offset:2048
    ds_read_b128 v[108:111], v15 offset:3072
    buffer_load_dwordx4 v[24:27], v1, s[12:15], s30 offen offset:1024 sc1
    buffer_load_dwordx4 v[28:31], v1, s[12:15], s31 offen offset:1024 sc1
    s_add_u32 s30, s26, 0xa40000
    buffer_load_dwordx4 v[32:35], v1, s[12:15], s30 offen offset:0 sc1
    s_add_u32 s31, s26, 0xa44800
    buffer_load_dwordx4 v[36:39], v1, s[12:15], s31 offen offset:0 sc1
    s_waitcnt vmcnt(13) lgkmcnt(7)
    v_mfma_f32_16x16x32_bf16 v[144:147], v[48:51], v[80:83], v[144:147]
    s_waitcnt vmcnt(11) lgkmcnt(6)
    v_mfma_f32_16x16x32_bf16 v[144:147], v[56:59], v[96:99], v[144:147]
    v_mfma_f32_16x16x32_bf16 v[160:163], v[52:55], v[80:83], v[160:163]
    s_waitcnt vmcnt(10)
    v_mfma_f32_16x16x32_bf16 v[160:163], v[60:63], v[96:99], v[160:163]
    ds_read_b128 v[80:83], v10 offset:14336
    ds_read_b128 v[96:99], v11 offset:15360
    s_waitcnt lgkmcnt(7)
    v_mfma_f32_16x16x32_bf16 v[148:151], v[48:51], v[84:87], v[148:151]
    s_waitcnt lgkmcnt(6)
    v_mfma_f32_16x16x32_bf16 v[148:151], v[56:59], v[100:103], v[148:151]
    v_mfma_f32_16x16x32_bf16 v[164:167], v[52:55], v[84:87], v[164:167]
    v_mfma_f32_16x16x32_bf16 v[164:167], v[60:63], v[100:103], v[164:167]
    ds_read_b128 v[84:87], v10 offset:32768
    ds_read_b128 v[100:103], v11 offset:33792
    s_waitcnt lgkmcnt(7)
    v_mfma_f32_16x16x32_bf16 v[152:155], v[48:51], v[88:91], v[152:155]
    s_waitcnt lgkmcnt(6)
    v_mfma_f32_16x16x32_bf16 v[152:155], v[56:59], v[104:107], v[152:155]
    v_mfma_f32_16x16x32_bf16 v[168:171], v[52:55], v[88:91], v[168:171]
    v_mfma_f32_16x16x32_bf16 v[168:171], v[60:63], v[104:107], v[168:171]
    ds_read_b128 v[88:91], v10 offset:51200
    ds_read_b128 v[104:107], v11 offset:52224
    s_waitcnt lgkmcnt(7)
    v_mfma_f32_16x16x32_bf16 v[156:159], v[48:51], v[92:95], v[156:159]
    s_waitcnt lgkmcnt(6)
    v_mfma_f32_16x16x32_bf16 v[156:159], v[56:59], v[108:111], v[156:159]
    v_mfma_f32_16x16x32_bf16 v[172:175], v[52:55], v[92:95], v[172:175]
    v_mfma_f32_16x16x32_bf16 v[172:175], v[60:63], v[108:111], v[172:175]
    ds_read_b128 v[92:95], v14 offset:4096
    ds_read_b128 v[108:111], v15 offset:5120
    buffer_load_dwordx4 v[40:43], v1, s[12:15], s30 offen offset:1024 sc1
    buffer_load_dwordx4 v[44:47], v1, s[12:15], s31 offen offset:1024 sc1
    buffer_load_dwordx4 v[48:51], v1, s[12:15], s30 offen offset:2048 sc1
    buffer_load_dwordx4 v[52:55], v1, s[12:15], s31 offen offset:2048 sc1
    s_waitcnt vmcnt(13) lgkmcnt(7)
    v_mfma_f32_16x16x32_bf16 v[144:147], v[64:67], v[80:83], v[144:147]
    s_waitcnt vmcnt(11) lgkmcnt(6)
    v_mfma_f32_16x16x32_bf16 v[144:147], v[72:75], v[96:99], v[144:147]
    v_mfma_f32_16x16x32_bf16 v[160:163], v[68:71], v[80:83], v[160:163]
    s_waitcnt vmcnt(10)
    v_mfma_f32_16x16x32_bf16 v[160:163], v[76:79], v[96:99], v[160:163]
    ds_read_b128 v[80:83], v10 offset:16384
    ds_read_b128 v[96:99], v11 offset:17408
    s_waitcnt lgkmcnt(7)
    v_mfma_f32_16x16x32_bf16 v[148:151], v[64:67], v[84:87], v[148:151]
    s_waitcnt lgkmcnt(6)
    v_mfma_f32_16x16x32_bf16 v[148:151], v[72:75], v[100:103], v[148:151]
    v_mfma_f32_16x16x32_bf16 v[164:167], v[68:71], v[84:87], v[164:167]
    v_mfma_f32_16x16x32_bf16 v[164:167], v[76:79], v[100:103], v[164:167]
    ds_read_b128 v[84:87], v10 offset:34816
    ds_read_b128 v[100:103], v11 offset:35840
    s_waitcnt lgkmcnt(7)
    v_mfma_f32_16x16x32_bf16 v[152:155], v[64:67], v[88:91], v[152:155]
    s_waitcnt lgkmcnt(6)
    v_mfma_f32_16x16x32_bf16 v[152:155], v[72:75], v[104:107], v[152:155]
    v_mfma_f32_16x16x32_bf16 v[168:171], v[68:71], v[88:91], v[168:171]
    v_mfma_f32_16x16x32_bf16 v[168:171], v[76:79], v[104:107], v[168:171]
    ds_read_b128 v[88:91], v10 offset:53248
    ds_read_b128 v[104:107], v11 offset:54272
    s_waitcnt lgkmcnt(7)
    v_mfma_f32_16x16x32_bf16 v[156:159], v[64:67], v[92:95], v[156:159]
    s_waitcnt lgkmcnt(6)
    v_mfma_f32_16x16x32_bf16 v[156:159], v[72:75], v[108:111], v[156:159]
    v_mfma_f32_16x16x32_bf16 v[172:175], v[68:71], v[92:95], v[172:175]
    v_mfma_f32_16x16x32_bf16 v[172:175], v[76:79], v[108:111], v[172:175]
    ds_read_b128 v[92:95], v14 offset:6144
    ds_read_b128 v[108:111], v15 offset:7168
    buffer_load_dwordx4 v[56:59], v1, s[12:15], s30 offen offset:3072 sc1
    buffer_load_dwordx4 v[60:63], v1, s[12:15], s31 offen offset:3072 sc1
    s_add_u32 s30, s26, 0xa41000
    buffer_load_dwordx4 v[64:67], v1, s[12:15], s30 offen offset:0 sc1
    s_add_u32 s31, s26, 0xa45800
    buffer_load_dwordx4 v[68:71], v1, s[12:15], s31 offen offset:0 sc1
    s_waitcnt vmcnt(13) lgkmcnt(7)
    v_mfma_f32_16x16x32_bf16 v[144:147], v[16:19], v[80:83], v[144:147]
    s_waitcnt vmcnt(11) lgkmcnt(6)
    v_mfma_f32_16x16x32_bf16 v[144:147], v[24:27], v[96:99], v[144:147]
    v_mfma_f32_16x16x32_bf16 v[160:163], v[20:23], v[80:83], v[160:163]
    s_waitcnt vmcnt(10)
    v_mfma_f32_16x16x32_bf16 v[160:163], v[28:31], v[96:99], v[160:163]
    ds_read_b128 v[80:83], v10 offset:0
    ds_read_b128 v[96:99], v11 offset:1024
    s_waitcnt lgkmcnt(7)
    v_mfma_f32_16x16x32_bf16 v[148:151], v[16:19], v[84:87], v[148:151]
    s_waitcnt lgkmcnt(6)
    v_mfma_f32_16x16x32_bf16 v[148:151], v[24:27], v[100:103], v[148:151]
    v_mfma_f32_16x16x32_bf16 v[164:167], v[20:23], v[84:87], v[164:167]
    v_mfma_f32_16x16x32_bf16 v[164:167], v[28:31], v[100:103], v[164:167]
    ds_read_b128 v[84:87], v10 offset:18432
    ds_read_b128 v[100:103], v11 offset:19456
    s_waitcnt lgkmcnt(7)
    v_mfma_f32_16x16x32_bf16 v[152:155], v[16:19], v[88:91], v[152:155]
    s_waitcnt lgkmcnt(6)
    v_mfma_f32_16x16x32_bf16 v[152:155], v[24:27], v[104:107], v[152:155]
    v_mfma_f32_16x16x32_bf16 v[168:171], v[20:23], v[88:91], v[168:171]
    v_mfma_f32_16x16x32_bf16 v[168:171], v[28:31], v[104:107], v[168:171]
    ds_read_b128 v[88:91], v10 offset:36864
    ds_read_b128 v[104:107], v11 offset:37888
    s_waitcnt lgkmcnt(7)
    v_mfma_f32_16x16x32_bf16 v[156:159], v[16:19], v[92:95], v[156:159]
    s_waitcnt lgkmcnt(6)
    v_mfma_f32_16x16x32_bf16 v[156:159], v[24:27], v[108:111], v[156:159]
    v_mfma_f32_16x16x32_bf16 v[172:175], v[20:23], v[92:95], v[172:175]
    v_mfma_f32_16x16x32_bf16 v[172:175], v[28:31], v[108:111], v[172:175]
    ds_read_b128 v[92:95], v10 offset:55296
    ds_read_b128 v[108:111], v11 offset:56320
    buffer_load_dwordx4 v[72:75], v1, s[12:15], s30 offen offset:1024 sc1
    buffer_load_dwordx4 v[76:79], v1, s[12:15], s31 offen offset:1024 sc1
    buffer_load_dwordx4 v[16:19], v1, s[12:15], s30 offen offset:2048 sc1
    buffer_load_dwordx4 v[20:23], v1, s[12:15], s31 offen offset:2048 sc1
    s_waitcnt vmcnt(13) lgkmcnt(7)
    v_mfma_f32_16x16x32_bf16 v[212:215], v[32:35], v[80:83], v[192:195]
    s_waitcnt vmcnt(11) lgkmcnt(6)
    v_mfma_f32_16x16x32_bf16 v[212:215], v[40:43], v[96:99], v[212:215]
    v_mul_f32 v200, v144, v144
    v_mul_f32 v201, v145, v145
    v_mul_f32 v202, v146, v146
    v_mul_f32 v203, v147, v147
    v_mfma_f32_16x16x32_bf16 v[228:231], v[36:39], v[80:83], v[196:199]
    s_waitcnt vmcnt(10)
    v_mfma_f32_16x16x32_bf16 v[228:231], v[44:47], v[96:99], v[228:231]
    ds_read_b128 v[80:83], v10 offset:2048
    ds_read_b128 v[96:99], v11 offset:3072
    v_fmaak_f32 v200, v200, v5, 0xc0135761
    v_fmaak_f32 v201, v201, v5, 0xc0135761
    v_fmaak_f32 v202, v202, v5, 0xc0135761
    v_fmaak_f32 v203, v203, v5, 0xc0135761
    s_waitcnt lgkmcnt(7)
    v_mfma_f32_16x16x32_bf16 v[216:219], v[32:35], v[84:87], v[192:195]
    s_waitcnt lgkmcnt(6)
    v_mfma_f32_16x16x32_bf16 v[216:219], v[40:43], v[100:103], v[216:219]
    v_mul_f32 v200, v144, v200
    v_mul_f32 v201, v145, v201
    v_mul_f32 v202, v146, v202
    v_mul_f32 v203, v147, v203
    v_mfma_f32_16x16x32_bf16 v[232:235], v[36:39], v[84:87], v[196:199]
    v_mfma_f32_16x16x32_bf16 v[232:235], v[44:47], v[100:103], v[232:235]
    ds_read_b128 v[84:87], v10 offset:20480
    ds_read_b128 v[100:103], v11 offset:21504
    v_exp_f32 v200, v200
    v_exp_f32 v201, v201
    v_exp_f32 v202, v202
    s_waitcnt lgkmcnt(7)
    v_mfma_f32_16x16x32_bf16 v[220:223], v[32:35], v[88:91], v[192:195]
    s_waitcnt lgkmcnt(6)
    v_mfma_f32_16x16x32_bf16 v[220:223], v[40:43], v[104:107], v[220:223]
    v_exp_f32 v203, v203
    v_add_f32 v200, 1.0, v200
    v_mfma_f32_16x16x32_bf16 v[236:239], v[36:39], v[88:91], v[196:199]
    v_mfma_f32_16x16x32_bf16 v[236:239], v[44:47], v[104:107], v[236:239]
    ds_read_b128 v[88:91], v10 offset:38912
    ds_read_b128 v[104:107], v11 offset:39936
    v_add_f32 v201, 1.0, v201
    v_add_f32 v202, 1.0, v202
    v_add_f32 v203, 1.0, v203
    v_rcp_f32 v200, v200
    s_waitcnt lgkmcnt(7)
    v_mfma_f32_16x16x32_bf16 v[224:227], v[32:35], v[92:95], v[192:195]
    s_waitcnt lgkmcnt(6)
    v_mfma_f32_16x16x32_bf16 v[224:227], v[40:43], v[108:111], v[224:227]
    v_rcp_f32 v201, v201
    v_rcp_f32 v202, v202
    v_mfma_f32_16x16x32_bf16 v[240:243], v[36:39], v[92:95], v[196:199]
    v_mfma_f32_16x16x32_bf16 v[240:243], v[44:47], v[108:111], v[240:243]
    ds_read_b128 v[92:95], v10 offset:57344
    ds_read_b128 v[108:111], v11 offset:58368
    v_rcp_f32 v203, v203
    v_mul_f32 v200, v144, v200
    v_mul_f32 v201, v145, v201
    buffer_load_dwordx4 v[24:27], v1, s[12:15], s30 offen offset:3072 sc1
    buffer_load_dwordx4 v[28:31], v1, s[12:15], s31 offen offset:3072 sc1
    s_add_u32 s30, s26, 0xa42000
    buffer_load_dwordx4 v[32:35], v1, s[12:15], s30 offen offset:0 sc1
    s_add_u32 s31, s26, 0xa46800
    buffer_load_dwordx4 v[36:39], v1, s[12:15], s31 offen offset:0 sc1
    s_waitcnt vmcnt(13) lgkmcnt(7)
    v_mfma_f32_16x16x32_bf16 v[212:215], v[48:51], v[80:83], v[212:215]
    s_waitcnt vmcnt(11) lgkmcnt(6)
    v_mfma_f32_16x16x32_bf16 v[212:215], v[56:59], v[96:99], v[212:215]
    v_mul_f32 v202, v146, v202
    v_mul_f32 v203, v147, v203
    v_cvt_pk_bf16_f32 v204, v200, v201
    v_cvt_pk_bf16_f32 v205, v202, v203
    v_mfma_f32_16x16x32_bf16 v[228:231], v[52:55], v[80:83], v[228:231]
    s_waitcnt vmcnt(10)
    v_mfma_f32_16x16x32_bf16 v[228:231], v[60:63], v[96:99], v[228:231]
    ds_read_b128 v[80:83], v10 offset:4096
    ds_read_b128 v[96:99], v11 offset:5120
    v_mul_f32 v200, v160, v160
    v_mul_f32 v201, v161, v161
    v_mul_f32 v202, v162, v162
    v_mul_f32 v203, v163, v163
    s_waitcnt lgkmcnt(7)
    v_mfma_f32_16x16x32_bf16 v[216:219], v[48:51], v[84:87], v[216:219]
    s_waitcnt lgkmcnt(6)
    v_mfma_f32_16x16x32_bf16 v[216:219], v[56:59], v[100:103], v[216:219]
    v_fmaak_f32 v200, v200, v5, 0xc0135761
    v_fmaak_f32 v201, v201, v5, 0xc0135761
    v_fmaak_f32 v202, v202, v5, 0xc0135761
    v_fmaak_f32 v203, v203, v5, 0xc0135761
    v_mfma_f32_16x16x32_bf16 v[232:235], v[52:55], v[84:87], v[232:235]
    v_mfma_f32_16x16x32_bf16 v[232:235], v[60:63], v[100:103], v[232:235]
    ds_read_b128 v[84:87], v10 offset:22528
    ds_read_b128 v[100:103], v11 offset:23552
    v_mul_f32 v200, v160, v200
    v_mul_f32 v201, v161, v201
    v_mul_f32 v202, v162, v202
    v_mul_f32 v203, v163, v203
    v_exp_f32 v200, v200
    s_waitcnt lgkmcnt(7)
    v_mfma_f32_16x16x32_bf16 v[220:223], v[48:51], v[88:91], v[220:223]
    s_waitcnt lgkmcnt(6)
    v_mfma_f32_16x16x32_bf16 v[220:223], v[56:59], v[104:107], v[220:223]
    v_exp_f32 v201, v201
    v_exp_f32 v202, v202
    v_mfma_f32_16x16x32_bf16 v[236:239], v[52:55], v[88:91], v[236:239]
    v_mfma_f32_16x16x32_bf16 v[236:239], v[60:63], v[104:107], v[236:239]
    ds_read_b128 v[88:91], v10 offset:40960
    ds_read_b128 v[104:107], v11 offset:41984
    v_exp_f32 v203, v203
    v_add_f32 v200, 1.0, v200
    s_waitcnt lgkmcnt(7)
    v_mfma_f32_16x16x32_bf16 v[224:227], v[48:51], v[92:95], v[224:227]
    s_waitcnt lgkmcnt(6)
    v_mfma_f32_16x16x32_bf16 v[224:227], v[56:59], v[108:111], v[224:227]
    v_add_f32 v201, 1.0, v201
    v_add_f32 v202, 1.0, v202
    v_add_f32 v203, 1.0, v203
    v_rcp_f32 v200, v200
    v_mfma_f32_16x16x32_bf16 v[240:243], v[52:55], v[92:95], v[240:243]
    v_mfma_f32_16x16x32_bf16 v[240:243], v[60:63], v[108:111], v[240:243]
    ds_read_b128 v[92:95], v10 offset:59392
    ds_read_b128 v[108:111], v11 offset:60416
    v_rcp_f32 v201, v201
    v_rcp_f32 v202, v202
    buffer_load_dwordx4 v[40:43], v1, s[12:15], s30 offen offset:1024 sc1
    buffer_load_dwordx4 v[44:47], v1, s[12:15], s31 offen offset:1024 sc1
    buffer_load_dwordx4 v[48:51], v1, s[12:15], s30 offen offset:2048 sc1
    buffer_load_dwordx4 v[52:55], v1, s[12:15], s31 offen offset:2048 sc1
    s_waitcnt vmcnt(13) lgkmcnt(7)
    v_mfma_f32_16x16x32_bf16 v[212:215], v[64:67], v[80:83], v[212:215]
    s_waitcnt vmcnt(11) lgkmcnt(6)
    v_mfma_f32_16x16x32_bf16 v[212:215], v[72:75], v[96:99], v[212:215]
    v_rcp_f32 v203, v203
    v_mul_f32 v200, v160, v200
    v_mul_f32 v201, v161, v201
    v_mfma_f32_16x16x32_bf16 v[228:231], v[68:71], v[80:83], v[228:231]
    s_waitcnt vmcnt(10)
    v_mfma_f32_16x16x32_bf16 v[228:231], v[76:79], v[96:99], v[228:231]
    ds_read_b128 v[80:83], v10 offset:6144
    ds_read_b128 v[96:99], v11 offset:7168
    v_mul_f32 v202, v162, v202
    v_mul_f32 v203, v163, v203
    v_cvt_pk_bf16_f32 v206, v200, v201
    v_cvt_pk_bf16_f32 v207, v202, v203
    s_waitcnt lgkmcnt(7)
    v_mfma_f32_16x16x32_bf16 v[216:219], v[64:67], v[84:87], v[216:219]
    s_waitcnt lgkmcnt(6)
    v_mfma_f32_16x16x32_bf16 v[216:219], v[72:75], v[100:103], v[216:219]
    v_mov_b32 v12, 149796
fused_kernel_r1_pre:
    ds_read_b32 v13, v12
    s_waitcnt lgkmcnt(0)
    v_readfirstlane_b32 s35, v13
    s_nop 3
    s_cmp_ge_u32 s35, 8
    s_cbranch_scc1 fused_kernel_r1_pre_d
    s_sleep 1
    s_branch fused_kernel_r1_pre
fused_kernel_r1_pre_d:
    ds_write_b128 v4, v[204:207] offset:0
    v_mfma_f32_16x16x32_bf16 v[232:235], v[68:71], v[84:87], v[232:235]
    v_mfma_f32_16x16x32_bf16 v[232:235], v[76:79], v[100:103], v[232:235]
    ds_read_b128 v[84:87], v10 offset:24576
    ds_read_b128 v[100:103], v11 offset:25600
    v_mul_f32 v200, v148, v148
    v_mfma_f32_16x16x32_bf16 v[220:223], v[64:67], v[88:91], v[220:223]
    v_mfma_f32_16x16x32_bf16 v[220:223], v[72:75], v[104:107], v[220:223]
    v_mul_f32 v201, v149, v149
    v_mul_f32 v202, v150, v150
    v_mul_f32 v203, v151, v151
    v_fmaak_f32 v200, v200, v5, 0xc0135761
    v_mfma_f32_16x16x32_bf16 v[236:239], v[68:71], v[88:91], v[236:239]
    v_mfma_f32_16x16x32_bf16 v[236:239], v[76:79], v[104:107], v[236:239]
    ds_read_b128 v[88:91], v10 offset:43008
    ds_read_b128 v[104:107], v11 offset:44032
    v_fmaak_f32 v201, v201, v5, 0xc0135761
    v_fmaak_f32 v202, v202, v5, 0xc0135761
    v_fmaak_f32 v203, v203, v5, 0xc0135761
    v_mul_f32 v200, v148, v200
    v_mul_f32 v201, v149, v201
    v_mfma_f32_16x16x32_bf16 v[224:227], v[64:67], v[92:95], v[224:227]
    v_mfma_f32_16x16x32_bf16 v[224:227], v[72:75], v[108:111], v[224:227]
    v_mul_f32 v202, v150, v202
    v_mul_f32 v203, v151, v203
    v_exp_f32 v200, v200
    v_mfma_f32_16x16x32_bf16 v[240:243], v[68:71], v[92:95], v[240:243]
    v_mfma_f32_16x16x32_bf16 v[240:243], v[76:79], v[108:111], v[240:243]
    ds_read_b128 v[92:95], v10 offset:61440
    ds_read_b128 v[108:111], v11 offset:62464
    v_exp_f32 v201, v201
    v_exp_f32 v202, v202
    buffer_load_dwordx4 v[56:59], v1, s[12:15], s30 offen offset:3072 sc1
    buffer_load_dwordx4 v[60:63], v1, s[12:15], s31 offen offset:3072 sc1
    s_add_u32 s30, s26, 0xa43000
    buffer_load_dwordx4 v[64:67], v1, s[12:15], s30 offen offset:0 sc1
    s_add_u32 s31, s26, 0xa47800
    buffer_load_dwordx4 v[68:71], v1, s[12:15], s31 offen offset:0 sc1
    s_waitcnt vmcnt(13)
    v_mfma_f32_16x16x32_bf16 v[212:215], v[16:19], v[80:83], v[212:215]
    s_waitcnt vmcnt(11)
    v_mfma_f32_16x16x32_bf16 v[212:215], v[24:27], v[96:99], v[212:215]
    v_exp_f32 v203, v203
    v_add_f32 v200, 1.0, v200
    v_add_f32 v201, 1.0, v201
    v_mfma_f32_16x16x32_bf16 v[228:231], v[20:23], v[80:83], v[228:231]
    s_waitcnt vmcnt(10)
    v_mfma_f32_16x16x32_bf16 v[228:231], v[28:31], v[96:99], v[228:231]
    ds_read_b128 v[80:83], v10 offset:8192
    ds_read_b128 v[96:99], v11 offset:9216
    v_add_f32 v202, 1.0, v202
    v_add_f32 v203, 1.0, v203
    v_rcp_f32 v200, v200
    v_rcp_f32 v201, v201
    s_waitcnt lgkmcnt(7)
    v_mfma_f32_16x16x32_bf16 v[216:219], v[16:19], v[84:87], v[216:219]
    s_waitcnt lgkmcnt(6)
    v_mfma_f32_16x16x32_bf16 v[216:219], v[24:27], v[100:103], v[216:219]
    v_rcp_f32 v202, v202
    v_rcp_f32 v203, v203
    v_mfma_f32_16x16x32_bf16 v[232:235], v[20:23], v[84:87], v[232:235]
    v_mfma_f32_16x16x32_bf16 v[232:235], v[28:31], v[100:103], v[232:235]
    ds_read_b128 v[84:87], v10 offset:26624
    ds_read_b128 v[100:103], v11 offset:27648
    v_mul_f32 v200, v148, v200
    v_mul_f32 v201, v149, v201
    v_mul_f32 v202, v150, v202
    s_waitcnt lgkmcnt(7)
    v_mfma_f32_16x16x32_bf16 v[220:223], v[16:19], v[88:91], v[220:223]
    s_waitcnt lgkmcnt(6)
    v_mfma_f32_16x16x32_bf16 v[220:223], v[24:27], v[104:107], v[220:223]
    v_mul_f32 v203, v151, v203
    v_cvt_pk_bf16_f32 v208, v200, v201
    v_cvt_pk_bf16_f32 v209, v202, v203
    v_mul_f32 v200, v164, v164
    v_mfma_f32_16x16x32_bf16 v[236:239], v[20:23], v[88:91], v[236:239]
    v_mfma_f32_16x16x32_bf16 v[236:239], v[28:31], v[104:107], v[236:239]
    ds_read_b128 v[88:91], v10 offset:45056
    ds_read_b128 v[104:107], v11 offset:46080
    v_mul_f32 v201, v165, v165
    v_mul_f32 v202, v166, v166
    v_mul_f32 v203, v167, v167
    v_fmaak_f32 v200, v200, v5, 0xc0135761
    v_fmaak_f32 v201, v201, v5, 0xc0135761
    s_waitcnt lgkmcnt(7)
    v_mfma_f32_16x16x32_bf16 v[224:227], v[16:19], v[92:95], v[224:227]
    s_waitcnt lgkmcnt(6)
    v_mfma_f32_16x16x32_bf16 v[224:227], v[24:27], v[108:111], v[224:227]
    v_fmaak_f32 v202, v202, v5, 0xc0135761
    v_fmaak_f32 v203, v203, v5, 0xc0135761
    v_mul_f32 v200, v164, v200
    v_mul_f32 v201, v165, v201
    v_mfma_f32_16x16x32_bf16 v[240:243], v[20:23], v[92:95], v[240:243]
    v_mfma_f32_16x16x32_bf16 v[240:243], v[28:31], v[108:111], v[240:243]
    ds_read_b128 v[92:95], v10 offset:63488
    ds_read_b128 v[108:111], v11 offset:64512
    v_mul_f32 v202, v166, v202
    v_mul_f32 v203, v167, v203
    v_exp_f32 v200, v200
    buffer_load_dwordx4 v[72:75], v1, s[12:15], s30 offen offset:1024 sc1
    buffer_load_dwordx4 v[76:79], v1, s[12:15], s31 offen offset:1024 sc1
    buffer_load_dwordx4 v[16:19], v1, s[12:15], s30 offen offset:2048 sc1
    buffer_load_dwordx4 v[20:23], v1, s[12:15], s31 offen offset:2048 sc1
    s_waitcnt vmcnt(13) lgkmcnt(7)
    v_mfma_f32_16x16x32_bf16 v[212:215], v[32:35], v[80:83], v[212:215]
    s_waitcnt vmcnt(11) lgkmcnt(6)
    v_mfma_f32_16x16x32_bf16 v[212:215], v[40:43], v[96:99], v[212:215]
    v_exp_f32 v201, v201
    v_exp_f32 v202, v202
    v_mfma_f32_16x16x32_bf16 v[228:231], v[36:39], v[80:83], v[228:231]
    s_waitcnt vmcnt(10)
    v_mfma_f32_16x16x32_bf16 v[228:231], v[44:47], v[96:99], v[228:231]
    ds_read_b128 v[80:83], v10 offset:10240
    ds_read_b128 v[96:99], v11 offset:11264
    v_exp_f32 v203, v203
    v_add_f32 v200, 1.0, v200
    v_add_f32 v201, 1.0, v201
    v_add_f32 v202, 1.0, v202
    s_waitcnt lgkmcnt(7)
    v_mfma_f32_16x16x32_bf16 v[216:219], v[32:35], v[84:87], v[216:219]
    s_waitcnt lgkmcnt(6)
    v_mfma_f32_16x16x32_bf16 v[216:219], v[40:43], v[100:103], v[216:219]
    v_add_f32 v203, 1.0, v203
    v_rcp_f32 v200, v200
    v_rcp_f32 v201, v201
    v_mfma_f32_16x16x32_bf16 v[232:235], v[36:39], v[84:87], v[232:235]
    v_mfma_f32_16x16x32_bf16 v[232:235], v[44:47], v[100:103], v[232:235]
    ds_read_b128 v[84:87], v10 offset:28672
    ds_read_b128 v[100:103], v11 offset:29696
    v_rcp_f32 v202, v202
    v_rcp_f32 v203, v203
    s_waitcnt lgkmcnt(7)
    v_mfma_f32_16x16x32_bf16 v[220:223], v[32:35], v[88:91], v[220:223]
    s_waitcnt lgkmcnt(6)
    v_mfma_f32_16x16x32_bf16 v[220:223], v[40:43], v[104:107], v[220:223]
    v_mul_f32 v200, v164, v200
    v_mul_f32 v201, v165, v201
    v_mul_f32 v202, v166, v202
    v_mfma_f32_16x16x32_bf16 v[236:239], v[36:39], v[88:91], v[236:239]
    v_mfma_f32_16x16x32_bf16 v[236:239], v[44:47], v[104:107], v[236:239]
    ds_read_b128 v[88:91], v10 offset:47104
    ds_read_b128 v[104:107], v11 offset:48128
    v_mul_f32 v203, v167, v203
    v_cvt_pk_bf16_f32 v210, v200, v201
    v_cvt_pk_bf16_f32 v211, v202, v203
    ds_write_b128 v4, v[208:211] offset:18432
    v_mul_f32 v200, v152, v152
    s_waitcnt lgkmcnt(8)
    v_mfma_f32_16x16x32_bf16 v[224:227], v[32:35], v[92:95], v[224:227]
    s_waitcnt lgkmcnt(7)
    v_mfma_f32_16x16x32_bf16 v[224:227], v[40:43], v[108:111], v[224:227]
    v_mul_f32 v201, v153, v153
    v_mul_f32 v202, v154, v154
    v_mul_f32 v203, v155, v155
    v_fmaak_f32 v200, v200, v5, 0xc0135761
    v_mfma_f32_16x16x32_bf16 v[240:243], v[36:39], v[92:95], v[240:243]
    v_mfma_f32_16x16x32_bf16 v[240:243], v[44:47], v[108:111], v[240:243]
    ds_read_b128 v[92:95], v14 offset:0
    ds_read_b128 v[108:111], v15 offset:1024
    v_fmaak_f32 v201, v201, v5, 0xc0135761
    v_fmaak_f32 v202, v202, v5, 0xc0135761
    v_fmaak_f32 v203, v203, v5, 0xc0135761
    v_mul_f32 v200, v152, v200
    buffer_load_dwordx4 v[24:27], v1, s[12:15], s30 offen offset:3072 sc1
    buffer_load_dwordx4 v[28:31], v1, s[12:15], s31 offen offset:3072 sc1
    s_add_u32 s30, s26, 0xa44000
    buffer_load_dwordx4 v[32:35], v1, s[12:15], s30 offen offset:0 sc1
    s_add_u32 s31, s26, 0xa48800
    buffer_load_dwordx4 v[36:39], v1, s[12:15], s31 offen offset:0 sc1
    s_waitcnt vmcnt(13) lgkmcnt(8)
    v_mfma_f32_16x16x32_bf16 v[212:215], v[48:51], v[80:83], v[212:215]
    s_waitcnt vmcnt(11) lgkmcnt(7)
    v_mfma_f32_16x16x32_bf16 v[212:215], v[56:59], v[96:99], v[212:215]
    v_mul_f32 v201, v153, v201
    v_mul_f32 v202, v154, v202
    v_mul_f32 v203, v155, v203
    v_exp_f32 v200, v200
    v_mfma_f32_16x16x32_bf16 v[228:231], v[52:55], v[80:83], v[228:231]
    s_waitcnt vmcnt(10)
    v_mfma_f32_16x16x32_bf16 v[228:231], v[60:63], v[96:99], v[228:231]
    ds_read_b128 v[80:83], v10 offset:12288
    ds_read_b128 v[96:99], v11 offset:13312
    v_exp_f32 v201, v201
    v_exp_f32 v202, v202
    s_waitcnt lgkmcnt(8)
    v_mfma_f32_16x16x32_bf16 v[216:219], v[48:51], v[84:87], v[216:219]
    s_waitcnt lgkmcnt(7)
    v_mfma_f32_16x16x32_bf16 v[216:219], v[56:59], v[100:103], v[216:219]
    v_exp_f32 v203, v203
    v_add_f32 v200, 1.0, v200
    v_add_f32 v201, 1.0, v201
    v_mfma_f32_16x16x32_bf16 v[232:235], v[52:55], v[84:87], v[232:235]
    v_mfma_f32_16x16x32_bf16 v[232:235], v[60:63], v[100:103], v[232:235]
    ds_read_b128 v[84:87], v10 offset:30720
    ds_read_b128 v[100:103], v11 offset:31744
    v_add_f32 v202, 1.0, v202
    v_add_f32 v203, 1.0, v203
    v_rcp_f32 v200, v200
    s_waitcnt lgkmcnt(8)
    v_mfma_f32_16x16x32_bf16 v[220:223], v[48:51], v[88:91], v[220:223]
    s_waitcnt lgkmcnt(7)
    v_mfma_f32_16x16x32_bf16 v[220:223], v[56:59], v[104:107], v[220:223]
    v_rcp_f32 v201, v201
    v_rcp_f32 v202, v202
    v_mfma_f32_16x16x32_bf16 v[236:239], v[52:55], v[88:91], v[236:239]
    v_mfma_f32_16x16x32_bf16 v[236:239], v[60:63], v[104:107], v[236:239]
    ds_read_b128 v[88:91], v10 offset:49152
    ds_read_b128 v[104:107], v11 offset:50176
    v_rcp_f32 v203, v203
    v_mul_f32 v200, v152, v200
    v_mul_f32 v201, v153, v201
    v_mul_f32 v202, v154, v202
    s_waitcnt lgkmcnt(7)
    v_mfma_f32_16x16x32_bf16 v[224:227], v[48:51], v[92:95], v[224:227]
    s_waitcnt lgkmcnt(6)
    v_mfma_f32_16x16x32_bf16 v[224:227], v[56:59], v[108:111], v[224:227]
    v_mul_f32 v203, v155, v203
    v_cvt_pk_bf16_f32 v204, v200, v201
    v_cvt_pk_bf16_f32 v205, v202, v203
    v_mul_f32 v200, v168, v168
    v_mfma_f32_16x16x32_bf16 v[240:243], v[52:55], v[92:95], v[240:243]
    v_mfma_f32_16x16x32_bf16 v[240:243], v[60:63], v[108:111], v[240:243]
    ds_read_b128 v[92:95], v14 offset:2048
    ds_read_b128 v[108:111], v15 offset:3072
    v_mul_f32 v201, v169, v169
    v_mul_f32 v202, v170, v170
    v_mul_f32 v203, v171, v171
    v_fmaak_f32 v200, v200, v5, 0xc0135761
    buffer_load_dwordx4 v[40:43], v1, s[12:15], s30 offen offset:1024 sc1
    buffer_load_dwordx4 v[44:47], v1, s[12:15], s31 offen offset:1024 sc1
    s_waitcnt vmcnt(11) lgkmcnt(7)
    v_mfma_f32_16x16x32_bf16 v[212:215], v[64:67], v[80:83], v[212:215]
    s_waitcnt vmcnt(9) lgkmcnt(6)
    v_mfma_f32_16x16x32_bf16 v[212:215], v[72:75], v[96:99], v[212:215]
    v_fmaak_f32 v201, v201, v5, 0xc0135761
    v_fmaak_f32 v202, v202, v5, 0xc0135761
    v_fmaak_f32 v203, v203, v5, 0xc0135761
    v_mul_f32 v200, v168, v200
    v_mfma_f32_16x16x32_bf16 v[228:231], v[68:71], v[80:83], v[228:231]
    s_waitcnt vmcnt(8)
    v_mfma_f32_16x16x32_bf16 v[228:231], v[76:79], v[96:99], v[228:231]
    ds_read_b128 v[80:83], v10 offset:14336
    ds_read_b128 v[96:99], v11 offset:15360
    v_mul_f32 v201, v169, v201
    v_mul_f32 v202, v170, v202
    v_mul_f32 v203, v171, v203
    v_exp_f32 v200, v200
    s_waitcnt lgkmcnt(7)
    v_mfma_f32_16x16x32_bf16 v[216:219], v[64:67], v[84:87], v[216:219]
    s_waitcnt lgkmcnt(6)
    v_mfma_f32_16x16x32_bf16 v[216:219], v[72:75], v[100:103], v[216:219]
    v_exp_f32 v201, v201
    v_exp_f32 v202, v202
    v_mfma_f32_16x16x32_bf16 v[232:235], v[68:71], v[84:87], v[232:235]
    v_mfma_f32_16x16x32_bf16 v[232:235], v[76:79], v[100:103], v[232:235]
    ds_read_b128 v[84:87], v10 offset:32768
    ds_read_b128 v[100:103], v11 offset:33792
    v_exp_f32 v203, v203
    v_add_f32 v200, 1.0, v200
    v_add_f32 v201, 1.0, v201
    s_waitcnt lgkmcnt(7)
    v_mfma_f32_16x16x32_bf16 v[220:223], v[64:67], v[88:91], v[220:223]
    s_waitcnt lgkmcnt(6)
    v_mfma_f32_16x16x32_bf16 v[220:223], v[72:75], v[104:107], v[220:223]
    v_add_f32 v202, 1.0, v202
    v_add_f32 v203, 1.0, v203
    v_rcp_f32 v200, v200
    v_mfma_f32_16x16x32_bf16 v[236:239], v[68:71], v[88:91], v[236:239]
    v_mfma_f32_16x16x32_bf16 v[236:239], v[76:79], v[104:107], v[236:239]
    ds_read_b128 v[88:91], v10 offset:51200
    ds_read_b128 v[104:107], v11 offset:52224
    v_rcp_f32 v201, v201
    v_rcp_f32 v202, v202
    v_rcp_f32 v203, v203
    s_waitcnt lgkmcnt(7)
    v_mfma_f32_16x16x32_bf16 v[224:227], v[64:67], v[92:95], v[224:227]
    s_waitcnt lgkmcnt(6)
    v_mfma_f32_16x16x32_bf16 v[224:227], v[72:75], v[108:111], v[224:227]
    v_mul_f32 v200, v168, v200
    v_mul_f32 v201, v169, v201
    v_mul_f32 v202, v170, v202
    v_mfma_f32_16x16x32_bf16 v[240:243], v[68:71], v[92:95], v[240:243]
    v_mfma_f32_16x16x32_bf16 v[240:243], v[76:79], v[108:111], v[240:243]
    ds_read_b128 v[92:95], v14 offset:4096
    ds_read_b128 v[108:111], v15 offset:5120
    v_mul_f32 v203, v171, v203
    v_cvt_pk_bf16_f32 v206, v200, v201
    v_cvt_pk_bf16_f32 v207, v202, v203
    ds_write_b128 v4, v[204:207] offset:36864
    s_cmp_lg_u32 s22, 4
    s_cbranch_scc1 fused_kernel_r1_np2
    s_and_b32 s85, s2, 15
    s_lshl_b32 s85, s85, 11
    s_add_u32 s85, s85, 0xa28000
    v_lshlrev_b32 v254, 5, v9
    s_mov_b32 exec_lo, 0xffffffff
    s_mov_b32 exec_hi, 0xffffffff
    s_mov_b32 s35, 100000
fused_kernel_r1_p2_l:
    s_sub_u32 s35, s35, 1
    s_cbranch_scc1 fused_kernel_r1_p2_ok
    buffer_load_dwordx4 v[244:247], v254, s[12:15], s85 offen offset:0 sc1
    buffer_load_dwordx4 v[248:251], v254, s[12:15], s85 offen offset:16 sc1
    v_mov_b32 v13, s99
    s_waitcnt vmcnt(0)
    v_subrev_co_u32 v244, vcc, s98, v244
    s_nop 1
    v_subb_co_u32 v245, vcc, v245, v13, vcc
    v_lshrrev_b32 v244, 12, v244
    v_or_b32 v244, v244, v245
    v_subrev_co_u32 v246, vcc, s98, v246
    s_nop 1
    v_subb_co_u32 v247, vcc, v247, v13, vcc
    v_lshrrev_b32 v246, 12, v246
    v_or_b32 v246, v246, v247
    v_or_b32 v244, v244, v246
    v_subrev_co_u32 v248, vcc, s98, v248
    s_nop 1
    v_subb_co_u32 v249, vcc, v249, v13, vcc
    v_lshrrev_b32 v248, 12, v248
    v_or_b32 v248, v248, v249
    v_or_b32 v244, v244, v248
    v_subrev_co_u32 v250, vcc, s98, v250
    s_nop 1
    v_subb_co_u32 v251, vcc, v251, v13, vcc
    v_lshrrev_b32 v250, 12, v250
    v_or_b32 v250, v250, v251
    v_or_b32 v244, v244, v250
    v_cmp_ne_u32 vcc, 0, v244
    s_nop 1
    s_cmp_eq_u64 vcc, 0
    s_cbranch_scc1 fused_kernel_r1_p2_ok
    s_sleep 16
    s_branch fused_kernel_r1_p2_l
fused_kernel_r1_p2_ok:
    s_mov_b64 exec, -1
    v_mov_b32 v12, 149772
    v_mov_b32 v13, 1
    ds_write_b32 v12, v13
fused_kernel_r1_np2:
    v_mov_b32 v12, 149772
fused_kernel_r1_w2:
    ds_read_b32 v13, v12
    s_waitcnt lgkmcnt(0)
    v_readfirstlane_b32 s35, v13
    s_nop 3
    s_cmp_ge_u32 s35, 1
    s_cbranch_scc1 fused_kernel_r1_w2_d
    s_sleep 1
    s_branch fused_kernel_r1_w2
fused_kernel_r1_w2_d:
    v_lshlrev_b32 v116, 4, v9
    v_and_b32 v117, 15, v9
    v_lshrrev_b32 v118, 4, v9
    s_mov_b32 s72, 73728
    v_mul_lo_u32 v122, v117, s72
    v_lshl_add_u32 v122, v118, 4, v122
    v_mul_u32_u24 v124, 1280, v9
    v_lshrrev_b32 v123, 1, v117
    v_lshl_add_u32 v123, v118, 5, v123
    v_mul_u32_u24 v123, 18560, v123
    v_and_b32 v121, 1, v117
    v_lshl_add_u32 v123, v121, 5, v123
    s_lshl_b32 s78, s2, 13
    s_cmp_eq_u32 s2, 288
    s_cselect_b32 s78, 4096, s78
    s_cselect_b32 s74, 1, 0
    s_cmp_eq_u32 s2, 0
    s_cselect_b32 s74, 1, s74
    s_add_u32 s79, s78, 4096
    s_lshr_b32 s75, s78, 6
    s_add_u32 s75, s75, 0x240000
    s_add_u32 s76, s75, 64
    s_cmp_lg_u32 s74, 0
    s_cselect_b32 s79, 0x20000000, s79
    s_cselect_b32 s76, 0x20000000, s76
    s_cselect_b32 s80, 0, 0x800000
    s_add_u32 s80, s80, 0x3ce38e39
    s_cmp_ge_u32 s38, 2
    s_cselect_b32 s72, s76, s75
    s_and_b32 s73, s38, 1
    s_mul_i32 s73, s73, 1179648
    s_add_u32 s72, s72, s73
    s_add_u32 s73, s72, 36864
    buffer_load_dwordx4 v[176:179], v122, s[12:15], s72 offen offset:0 sc1
    buffer_load_dwordx4 v[180:183], v122, s[12:15], s73 offen offset:0 sc1
    s_lshl_b32 s72, s2, 6
    s_mul_i32 s73, s38, 148480
    s_add_u32 s72, s72, s73
    s_add_u32 s72, s72, 0x480000
    buffer_load_dwordx4 v[184:187], v123, s[12:15], s72 offen offset:0 sc1
    buffer_load_dwordx4 v[188:191], v123, s[12:15], s72 offen offset:16 sc1
    s_waitcnt vmcnt(11) lgkmcnt(8)
    v_mfma_f32_16x16x32_bf16 v[212:215], v[16:19], v[80:83], v[212:215]
    s_waitcnt vmcnt(9) lgkmcnt(7)
    v_mfma_f32_16x16x32_bf16 v[212:215], v[24:27], v[96:99], v[212:215]
    v_mul_f32 v200, v156, v156
    v_mul_f32 v201, v157, v157
    v_mul_f32 v202, v158, v158
    v_mul_f32 v203, v159, v159
    v_mfma_f32_16x16x32_bf16 v[228:231], v[20:23], v[80:83], v[228:231]
    s_waitcnt vmcnt(8)
    v_mfma_f32_16x16x32_bf16 v[228:231], v[28:31], v[96:99], v[228:231]
    ds_read_b128 v[80:83], v10 offset:16384
    ds_read_b128 v[96:99], v11 offset:17408
    v_fmaak_f32 v200, v200, v5, 0xc0135761
    v_fmaak_f32 v201, v201, v5, 0xc0135761
    v_fmaak_f32 v202, v202, v5, 0xc0135761
    v_fmaak_f32 v203, v203, v5, 0xc0135761
    v_mul_f32 v200, v156, v200
    s_waitcnt lgkmcnt(8)
    v_mfma_f32_16x16x32_bf16 v[216:219], v[16:19], v[84:87], v[216:219]
    s_waitcnt lgkmcnt(7)
    v_mfma_f32_16x16x32_bf16 v[216:219], v[24:27], v[100:103], v[216:219]
    v_mul_f32 v201, v157, v201
    v_mul_f32 v202, v158, v202
    v_mul_f32 v203, v159, v203
    v_exp_f32 v200, v200
    v_mfma_f32_16x16x32_bf16 v[232:235], v[20:23], v[84:87], v[232:235]
    v_mfma_f32_16x16x32_bf16 v[232:235], v[28:31], v[100:103], v[232:235]
    ds_read_b128 v[84:87], v10 offset:34816
    ds_read_b128 v[100:103], v11 offset:35840
    v_exp_f32 v201, v201
    v_exp_f32 v202, v202
    s_waitcnt lgkmcnt(8)
    v_mfma_f32_16x16x32_bf16 v[220:223], v[16:19], v[88:91], v[220:223]
    s_waitcnt lgkmcnt(7)
    v_mfma_f32_16x16x32_bf16 v[220:223], v[24:27], v[104:107], v[220:223]
    v_exp_f32 v203, v203
    v_add_f32 v200, 1.0, v200
    v_mfma_f32_16x16x32_bf16 v[236:239], v[20:23], v[88:91], v[236:239]
    v_mfma_f32_16x16x32_bf16 v[236:239], v[28:31], v[104:107], v[236:239]
    ds_read_b128 v[88:91], v10 offset:53248
    ds_read_b128 v[104:107], v11 offset:54272
    v_add_f32 v201, 1.0, v201
    v_add_f32 v202, 1.0, v202
    v_add_f32 v203, 1.0, v203
    v_rcp_f32 v200, v200
    s_waitcnt lgkmcnt(8)
    v_mfma_f32_16x16x32_bf16 v[224:227], v[16:19], v[92:95], v[224:227]
    s_waitcnt lgkmcnt(7)
    v_mfma_f32_16x16x32_bf16 v[224:227], v[24:27], v[108:111], v[224:227]
    v_rcp_f32 v201, v201
    v_rcp_f32 v202, v202
    v_mfma_f32_16x16x32_bf16 v[240:243], v[20:23], v[92:95], v[240:243]
    v_mfma_f32_16x16x32_bf16 v[240:243], v[28:31], v[108:111], v[240:243]
    ds_read_b128 v[92:95], v14 offset:6144
    ds_read_b128 v[108:111], v15 offset:7168
    v_rcp_f32 v203, v203
    v_mul_f32 v200, v156, v200
    v_mul_f32 v201, v157, v201
    s_waitcnt vmcnt(7) lgkmcnt(7)
    v_mfma_f32_16x16x32_bf16 v[212:215], v[32:35], v[80:83], v[212:215]
    s_waitcnt vmcnt(5) lgkmcnt(6)
    v_mfma_f32_16x16x32_bf16 v[212:215], v[40:43], v[96:99], v[212:215]
    v_mul_f32 v202, v158, v202
    v_mul_f32 v203, v159, v203
    v_cvt_pk_bf16_f32 v208, v200, v201
    v_cvt_pk_bf16_f32 v209, v202, v203
    v_mfma_f32_16x16x32_bf16 v[228:231], v[36:39], v[80:83], v[228:231]
    s_waitcnt vmcnt(4)
    v_mfma_f32_16x16x32_bf16 v[228:231], v[44:47], v[96:99], v[228:231]
    v_mul_f32 v200, v172, v172
    v_mul_f32 v201, v173, v173
    v_mul_f32 v202, v174, v174
    v_mul_f32 v203, v175, v175
    v_fmaak_f32 v200, v200, v5, 0xc0135761
    s_waitcnt lgkmcnt(5)
    v_mfma_f32_16x16x32_bf16 v[216:219], v[32:35], v[84:87], v[216:219]
    s_waitcnt lgkmcnt(4)
    v_mfma_f32_16x16x32_bf16 v[216:219], v[40:43], v[100:103], v[216:219]
    v_fmaak_f32 v201, v201, v5, 0xc0135761
    v_fmaak_f32 v202, v202, v5, 0xc0135761
    v_fmaak_f32 v203, v203, v5, 0xc0135761
    v_mul_f32 v200, v172, v200
    v_mfma_f32_16x16x32_bf16 v[232:235], v[36:39], v[84:87], v[232:235]
    v_mfma_f32_16x16x32_bf16 v[232:235], v[44:47], v[100:103], v[232:235]
    v_mul_f32 v201, v173, v201
    v_mul_f32 v202, v174, v202
    v_mul_f32 v203, v175, v203
    v_exp_f32 v200, v200
    s_waitcnt lgkmcnt(3)
    v_mfma_f32_16x16x32_bf16 v[220:223], v[32:35], v[88:91], v[220:223]
    s_waitcnt lgkmcnt(2)
    v_mfma_f32_16x16x32_bf16 v[220:223], v[40:43], v[104:107], v[220:223]
    v_exp_f32 v201, v201
    v_exp_f32 v202, v202
    v_mfma_f32_16x16x32_bf16 v[236:239], v[36:39], v[88:91], v[236:239]
    v_mfma_f32_16x16x32_bf16 v[236:239], v[44:47], v[104:107], v[236:239]
    v_exp_f32 v203, v203
    v_add_f32 v200, 1.0, v200
    v_add_f32 v201, 1.0, v201
    s_waitcnt lgkmcnt(1)
    v_mfma_f32_16x16x32_bf16 v[224:227], v[32:35], v[92:95], v[224:227]
    s_waitcnt lgkmcnt(0)
    v_mfma_f32_16x16x32_bf16 v[224:227], v[40:43], v[108:111], v[224:227]
    v_add_f32 v202, 1.0, v202
    v_add_f32 v203, 1.0, v203
    v_rcp_f32 v200, v200
    v_mfma_f32_16x16x32_bf16 v[240:243], v[36:39], v[92:95], v[240:243]
    v_mfma_f32_16x16x32_bf16 v[240:243], v[44:47], v[108:111], v[240:243]
    v_rcp_f32 v201, v201
    v_rcp_f32 v202, v202
    v_rcp_f32 v203, v203
    v_mul_f32 v200, v172, v200
    v_mul_f32 v201, v173, v201
    v_mul_f32 v202, v174, v202
    v_mul_f32 v203, v175, v203
    v_cvt_pk_bf16_f32 v210, v200, v201
    v_cvt_pk_bf16_f32 v211, v202, v203
    ds_write_b128 v4, v[208:211] offset:55296
    s_nop 0
    s_nop 0
    s_nop 0
    s_waitcnt lgkmcnt(0)
    v_mov_b32 v12, 149812
    v_mov_b32 v13, 1
    s_mov_b64 exec, 1
    ds_add_u32 v12, v13
    s_mov_b64 exec, -1
    v_mov_b32 v12, 149792
fused_kernel_r1_w5:
    ds_read_b32 v13, v12
    s_waitcnt lgkmcnt(0)
    v_readfirstlane_b32 s35, v13
    s_nop 3
    s_cmp_ge_u32 s35, 1
    s_cbranch_scc1 fused_kernel_r1_w5_d
    s_sleep 1
    s_branch fused_kernel_r1_w5
fused_kernel_r1_w5_d:
    s_mov_b32 s87, 0
    v_lshlrev_b32 v140, 4, v9
    v_and_b32 v141, 15, v9
    v_lshrrev_b32 v142, 4, v9
    s_mov_b32 s72, 73728
    v_mul_lo_u32 v146, v141, s72
    v_lshl_add_u32 v146, v142, 4, v146
    v_mul_u32_u24 v148, 1280, v9
    v_lshrrev_b32 v147, 1, v141
    v_lshl_add_u32 v147, v142, 5, v147
    v_mul_u32_u24 v147, 18560, v147
    v_and_b32 v145, 1, v141
    v_lshl_add_u32 v147, v145, 5, v147
    s_lshl_b32 s72, s38, 12
    s_add_u32 s72, s72, 0xa00000
    buffer_load_dwordx4 v[48:51], v140, s[12:15], s72 offen offset:0 sc1
    buffer_load_dwordx4 v[52:55], v140, s[12:15], s72 offen offset:1024 sc1
    buffer_load_dwordx4 v[56:59], v140, s[12:15], s72 offen offset:2048 sc1
    buffer_load_dwordx4 v[60:63], v140, s[12:15], s72 offen offset:3072 sc1
    s_mov_b32 s72, 0xa04000
    buffer_load_dwordx4 v[64:67], v140, s[12:15], s72 offen offset:0 sc1
    buffer_load_dwordx4 v[68:71], v140, s[12:15], s72 offen offset:1024 sc1
    buffer_load_dwordx4 v[72:75], v140, s[12:15], s72 offen offset:2048 sc1
    buffer_load_dwordx4 v[76:79], v140, s[12:15], s72 offen offset:3072 sc1
    s_lshr_b32 s73, s38, 1
    s_lshl_b32 s72, s73, 13
    s_add_u32 s72, s72, 0xa00000
    s_add_u32 s73, s72, 4096
    buffer_load_dwordx4 v[16:19], v140, s[12:15], s72 offen offset:0 sc1
    buffer_load_dwordx4 v[20:23], v140, s[12:15], s72 offen offset:1024 sc1
    buffer_load_dwordx4 v[24:27], v140, s[12:15], s72 offen offset:2048 sc1
    buffer_load_dwordx4 v[28:31], v140, s[12:15], s72 offen offset:3072 sc1
    buffer_load_dwordx4 v[32:35], v140, s[12:15], s73 offen offset:0 sc1
    buffer_load_dwordx4 v[36:39], v140, s[12:15], s73 offen offset:1024 sc1
    buffer_load_dwordx4 v[40:43], v140, s[12:15], s73 offen offset:2048 sc1
    buffer_load_dwordx4 v[44:47], v140, s[12:15], s73 offen offset:3072 sc1
    v_mul_f32 v200, v212, v212
    v_mul_f32 v201, v213, v213
    v_mul_f32 v202, v214, v214
    v_mul_f32 v203, v215, v215
    v_fmaak_f32 v200, v200, v5, 0xc0135761
    v_fmaak_f32 v201, v201, v5, 0xc0135761
    v_fmaak_f32 v202, v202, v5, 0xc0135761
    v_fmaak_f32 v203, v203, v5, 0xc0135761
    v_mul_f32 v200, v212, v200
    v_mul_f32 v201, v213, v201
    v_mul_f32 v202, v214, v202
    v_mul_f32 v203, v215, v203
    v_exp_f32 v200, v200
    v_exp_f32 v201, v201
    v_exp_f32 v202, v202
    v_exp_f32 v203, v203
    v_add_f32 v200, 1.0, v200
    v_add_f32 v201, 1.0, v201
    v_add_f32 v202, 1.0, v202
    v_add_f32 v203, 1.0, v203
    v_rcp_f32 v200, v200
    v_rcp_f32 v201, v201
    v_rcp_f32 v202, v202
    v_rcp_f32 v203, v203
    v_mul_f32 v200, v212, v200
    v_mul_f32 v201, v213, v201
    v_mul_f32 v202, v214, v202
    v_mul_f32 v203, v215, v203
    v_cvt_pk_bf16_f32 v204, v200, v201
    v_cvt_pk_bf16_f32 v205, v202, v203
    v_mul_f32 v200, v228, v228
    v_mul_f32 v201, v229, v229
    v_mul_f32 v202, v230, v230
    v_mul_f32 v203, v231, v231
    v_fmaak_f32 v200, v200, v5, 0xc0135761
    v_fmaak_f32 v201, v201, v5, 0xc0135761
    v_fmaak_f32 v202, v202, v5, 0xc0135761
    v_fmaak_f32 v203, v203, v5, 0xc0135761
    v_mul_f32 v200, v228, v200
    v_mul_f32 v201, v229, v201
    v_mul_f32 v202, v230, v202
    v_mul_f32 v203, v231, v203
    v_exp_f32 v200, v200
    v_exp_f32 v201, v201
    v_exp_f32 v202, v202
    v_exp_f32 v203, v203
    v_add_f32 v200, 1.0, v200
    v_add_f32 v201, 1.0, v201
    v_add_f32 v202, 1.0, v202
    v_add_f32 v203, 1.0, v203
    v_rcp_f32 v200, v200
    v_rcp_f32 v201, v201
    v_rcp_f32 v202, v202
    v_rcp_f32 v203, v203
    v_mul_f32 v200, v228, v200
    v_mul_f32 v201, v229, v201
    v_mul_f32 v202, v230, v202
    v_mul_f32 v203, v231, v203
    v_cvt_pk_bf16_f32 v206, v200, v201
    v_cvt_pk_bf16_f32 v207, v202, v203
    ds_write_b128 v4, v[204:207] offset:8192
    v_mul_f32 v200, v216, v216
    v_mul_f32 v201, v217, v217
    v_mul_f32 v202, v218, v218
    v_mul_f32 v203, v219, v219
    v_fmaak_f32 v200, v200, v5, 0xc0135761
    v_fmaak_f32 v201, v201, v5, 0xc0135761
    v_fmaak_f32 v202, v202, v5, 0xc0135761
    v_fmaak_f32 v203, v203, v5, 0xc0135761
    v_mul_f32 v200, v216, v200
    v_mul_f32 v201, v217, v201
    v_mul_f32 v202, v218, v202
    v_mul_f32 v203, v219, v203
    v_exp_f32 v200, v200
    v_exp_f32 v201, v201
    v_exp_f32 v202, v202
    v_exp_f32 v203, v203
    v_add_f32 v200, 1.0, v200
    v_add_f32 v201, 1.0, v201
    v_add_f32 v202, 1.0, v202
    v_add_f32 v203, 1.0, v203
    v_rcp_f32 v200, v200
    v_rcp_f32 v201, v201
    v_rcp_f32 v202, v202
    v_rcp_f32 v203, v203
    v_mul_f32 v200, v216, v200
    v_mul_f32 v201, v217, v201
    v_mul_f32 v202, v218, v202
    v_mul_f32 v203, v219, v203
    v_cvt_pk_bf16_f32 v208, v200, v201
    v_cvt_pk_bf16_f32 v209, v202, v203
    v_mul_f32 v200, v232, v232
    v_mul_f32 v201, v233, v233
    v_mul_f32 v202, v234, v234
    v_mul_f32 v203, v235, v235
    v_fmaak_f32 v200, v200, v5, 0xc0135761
    v_fmaak_f32 v201, v201, v5, 0xc0135761
    v_fmaak_f32 v202, v202, v5, 0xc0135761
    v_fmaak_f32 v203, v203, v5, 0xc0135761
    v_mul_f32 v200, v232, v200
    v_mul_f32 v201, v233, v201
    v_mul_f32 v202, v234, v202
    v_mul_f32 v203, v235, v203
    v_exp_f32 v200, v200
    v_exp_f32 v201, v201
    v_exp_f32 v202, v202
    v_exp_f32 v203, v203
    v_add_f32 v200, 1.0, v200
    v_add_f32 v201, 1.0, v201
    v_add_f32 v202, 1.0, v202
    v_add_f32 v203, 1.0, v203
    v_rcp_f32 v200, v200
    v_rcp_f32 v201, v201
    v_rcp_f32 v202, v202
    v_rcp_f32 v203, v203
    v_mul_f32 v200, v232, v200
    v_mul_f32 v201, v233, v201
    v_mul_f32 v202, v234, v202
    v_mul_f32 v203, v235, v203
    v_cvt_pk_bf16_f32 v210, v200, v201
    v_cvt_pk_bf16_f32 v211, v202, v203
    ds_write_b128 v4, v[208:211] offset:26624
    v_mul_f32 v200, v220, v220
    v_mul_f32 v201, v221, v221
    v_mul_f32 v202, v222, v222
    v_mul_f32 v203, v223, v223
    v_fmaak_f32 v200, v200, v5, 0xc0135761
    v_fmaak_f32 v201, v201, v5, 0xc0135761
    v_fmaak_f32 v202, v202, v5, 0xc0135761
    v_fmaak_f32 v203, v203, v5, 0xc0135761
    v_mul_f32 v200, v220, v200
    v_mul_f32 v201, v221, v201
    v_mul_f32 v202, v222, v202
    v_mul_f32 v203, v223, v203
    v_exp_f32 v200, v200
    v_exp_f32 v201, v201
    v_exp_f32 v202, v202
    v_exp_f32 v203, v203
    v_add_f32 v200, 1.0, v200
    v_add_f32 v201, 1.0, v201
    v_add_f32 v202, 1.0, v202
    v_add_f32 v203, 1.0, v203
    v_rcp_f32 v200, v200
    v_rcp_f32 v201, v201
    v_rcp_f32 v202, v202
    v_rcp_f32 v203, v203
    v_mul_f32 v200, v220, v200
    v_mul_f32 v201, v221, v201
    v_mul_f32 v202, v222, v202
    v_mul_f32 v203, v223, v203
    v_cvt_pk_bf16_f32 v204, v200, v201
    v_cvt_pk_bf16_f32 v205, v202, v203
    v_mul_f32 v200, v236, v236
    v_mul_f32 v201, v237, v237
    v_mul_f32 v202, v238, v238
    v_mul_f32 v203, v239, v239
    v_fmaak_f32 v200, v200, v5, 0xc0135761
    v_fmaak_f32 v201, v201, v5, 0xc0135761
    v_fmaak_f32 v202, v202, v5, 0xc0135761
    v_fmaak_f32 v203, v203, v5, 0xc0135761
    v_mul_f32 v200, v236, v200
    v_mul_f32 v201, v237, v201
    v_mul_f32 v202, v238, v202
    v_mul_f32 v203, v239, v203
    v_exp_f32 v200, v200
    v_exp_f32 v201, v201
    v_exp_f32 v202, v202
    v_exp_f32 v203, v203
    v_add_f32 v200, 1.0, v200
    v_add_f32 v201, 1.0, v201
    v_add_f32 v202, 1.0, v202
    v_add_f32 v203, 1.0, v203
    v_rcp_f32 v200, v200
    v_rcp_f32 v201, v201
    v_rcp_f32 v202, v202
    v_rcp_f32 v203, v203
    v_mul_f32 v200, v236, v200
    v_mul_f32 v201, v237, v201
    v_mul_f32 v202, v238, v202
    v_mul_f32 v203, v239, v203
    v_cvt_pk_bf16_f32 v206, v200, v201
    v_cvt_pk_bf16_f32 v207, v202, v203
    ds_write_b128 v4, v[204:207] offset:45056
    v_mul_f32 v200, v224, v224
    v_mul_f32 v201, v225, v225
    v_mul_f32 v202, v226, v226
    v_mul_f32 v203, v227, v227
    v_fmaak_f32 v200, v200, v5, 0xc0135761
    v_fmaak_f32 v201, v201, v5, 0xc0135761
    v_fmaak_f32 v202, v202, v5, 0xc0135761
    v_fmaak_f32 v203, v203, v5, 0xc0135761
    v_mul_f32 v200, v224, v200
    v_mul_f32 v201, v225, v201
    v_mul_f32 v202, v226, v202
    v_mul_f32 v203, v227, v203
    v_exp_f32 v200, v200
    v_exp_f32 v201, v201
    v_exp_f32 v202, v202
    v_exp_f32 v203, v203
    v_add_f32 v200, 1.0, v200
    v_add_f32 v201, 1.0, v201
    v_add_f32 v202, 1.0, v202
    v_add_f32 v203, 1.0, v203
    v_rcp_f32 v200, v200
    v_rcp_f32 v201, v201
    v_rcp_f32 v202, v202
    v_rcp_f32 v203, v203
    v_mul_f32 v200, v224, v200
    v_mul_f32 v201, v225, v201
    v_mul_f32 v202, v226, v202
    v_mul_f32 v203, v227, v203
    v_cvt_pk_bf16_f32 v208, v200, v201
    v_cvt_pk_bf16_f32 v209, v202, v203
    v_mul_f32 v200, v240, v240
    v_mul_f32 v201, v241, v241
    v_mul_f32 v202, v242, v242
    v_mul_f32 v203, v243, v243
    v_fmaak_f32 v200, v200, v5, 0xc0135761
    v_fmaak_f32 v201, v201, v5, 0xc0135761
    v_fmaak_f32 v202, v202, v5, 0xc0135761
    v_fmaak_f32 v203, v203, v5, 0xc0135761
    v_mul_f32 v200, v240, v200
    v_mul_f32 v201, v241, v201
    v_mul_f32 v202, v242, v202
    v_mul_f32 v203, v243, v203
    v_exp_f32 v200, v200
    v_exp_f32 v201, v201
    v_exp_f32 v202, v202
    v_exp_f32 v203, v203
    v_add_f32 v200, 1.0, v200
    v_add_f32 v201, 1.0, v201
    v_add_f32 v202, 1.0, v202
    v_add_f32 v203, 1.0, v203
    v_rcp_f32 v200, v200
    v_rcp_f32 v201, v201
    v_rcp_f32 v202, v202
    v_rcp_f32 v203, v203
    v_mul_f32 v200, v240, v200
    v_mul_f32 v201, v241, v201
    v_mul_f32 v202, v242, v202
    v_mul_f32 v203, v243, v203
    v_cvt_pk_bf16_f32 v210, v200, v201
    v_cvt_pk_bf16_f32 v211, v202, v203
    ds_write_b128 v4, v[208:211] offset:63488
    s_nop 0
    s_nop 0
    s_nop 0
    s_waitcnt lgkmcnt(0)
    v_mov_b32 v12, 149816
    v_mov_b32 v13, 1
    s_mov_b64 exec, 1
    ds_add_u32 v12, v13
    s_mov_b64 exec, -1
    s_setprio 2
    s_lshl_b32 s72, s38, 4
    v_add_u32 v136, s72, v141
    v_cvt_f32_u32 v136, v136
    v_mul_f32 v136, 0x3a000000, v136
    v_lshlrev_b32 v137, 2, v142
    v_cvt_f32_u32 v137, v137
    v_add_f32 v138, 0x0, v137
    v_mul_f32 v138, v136, v138
    v_cos_f32 v104, v138
    v_sin_f32 v105, v138
    v_add_f32 v139, 0x3f800000, v137
    v_mul_f32 v139, v136, v139
    v_cos_f32 v106, v139
    v_sin_f32 v107, v139
    v_add_f32 v138, 0x40000000, v137
    v_mul_f32 v138, v136, v138
    v_cos_f32 v108, v138
    v_sin_f32 v109, v138
    v_add_f32 v139, 0x40400000, v137
    v_mul_f32 v139, v136, v139
    v_cos_f32 v110, v139
    v_sin_f32 v111, v139
    v_add_f32 v138, 0x41800000, v137
    v_mul_f32 v138, v136, v138
    v_cos_f32 v112, v138
    v_sin_f32 v113, v138
    v_add_f32 v139, 0x41880000, v137
    v_mul_f32 v139, v136, v139
    v_cos_f32 v114, v139
    v_sin_f32 v115, v139
    v_add_f32 v138, 0x41900000, v137
    v_mul_f32 v138, v136, v138
    v_cos_f32 v116, v138
    v_sin_f32 v117, v138
    v_add_f32 v139, 0x41980000, v137
    v_mul_f32 v139, v136, v139
    v_cos_f32 v118, v139
    v_sin_f32 v119, v139
    v_lshl_add_u32 v136, v142, 2, s72
    v_cvt_f32_u32 v136, v136
    v_cvt_f32_u32 v137, v141
    v_mul_f32 v137, 0x3a000000, v137
    v_add_f32 v138, 0x3c000000, v137
    v_add_f32 v139, 0x0, v136
    v_mul_f32 v139, v139, v137
    v_cos_f32 v120, v139
    v_sin_f32 v121, v139
    v_add_f32 v139, 0x3f800000, v136
    v_mul_f32 v139, v139, v137
    v_cos_f32 v122, v139
    v_sin_f32 v123, v139
    v_add_f32 v139, 0x40000000, v136
    v_mul_f32 v139, v139, v137
    v_cos_f32 v124, v139
    v_sin_f32 v125, v139
    v_add_f32 v139, 0x40400000, v136
    v_mul_f32 v139, v139, v137
    v_cos_f32 v126, v139
    v_sin_f32 v127, v139
    v_add_f32 v139, 0x0, v136
    v_mul_f32 v139, v139, v138
    v_cos_f32 v128, v139
    v_sin_f32 v129, v139
    v_add_f32 v139, 0x3f800000, v136
    v_mul_f32 v139, v139, v138
    v_cos_f32 v130, v139
    v_sin_f32 v131, v139
    v_add_f32 v139, 0x40000000, v136
    v_mul_f32 v139, v139, v138
    v_cos_f32 v132, v139
    v_sin_f32 v133, v139
    v_add_f32 v139, 0x40400000, v136
    v_mul_f32 v139, v139, v138
    v_cos_f32 v134, v139
    v_sin_f32 v135, v139
    s_lshr_b32 s72, s38, 1
    s_and_b32 s73, s38, 1
    s_lshl_b32 s74, s72, 10
    s_lshl_b32 s75, s73, 3
    s_add_u32 s74, s74, s75
    s_add_u32 s74, s74, 150016
    v_add_u32 v143, s74, v140
    s_lshl_b32 s74, s73, 11
    s_add_u32 s74, s74, 150016
    v_add_u32 v144, s74, v140
    v_lshlrev_b32 v145, 6, v141
    v_lshl_add_u32 v145, v142, 4, v145
    s_lshl_b32 s73, s73, 10
    s_lshl_b32 s72, s72, 11
    s_add_u32 s72, s72, s73
    s_add_u32 s72, s72, 0x700000
    v_add_u32 v145, s72, v145
    s_cmp_lt_u32 s2, 223
    s_cbranch_scc1 fused_kernel_r1_f1
    s_add_u32 s82, s2, 33
    s_lshl_b32 s92, s82, 13
    s_cmp_eq_u32 s82, 288
    s_cselect_b32 s92, 4096, s92
    s_cselect_b32 s74, 1, 0
    s_cmp_eq_u32 s82, 0
    s_cselect_b32 s74, 1, s74
    s_add_u32 s93, s92, 4096
    s_lshr_b32 s75, s92, 6
    s_add_u32 s75, s75, 0x240000
    s_add_u32 s76, s75, 64
    s_cmp_lg_u32 s74, 0
    s_cselect_b32 s93, 0x20000000, s93
    s_cselect_b32 s76, 0x20000000, s76
    s_cselect_b32 s94, 0, 0x800000
    s_add_u32 s94, s94, 0x3ce38e39
    s_cmp_ge_u32 s38, 2
    s_cselect_b32 s72, s76, s75
    s_and_b32 s73, s38, 1
    s_mul_i32 s73, s73, 1179648
    s_add_u32 s72, s72, s73
    s_add_u32 s73, s72, 36864
    buffer_load_dwordx4 v[194:197], v146, s[12:15], s72 offen offset:0 sc1
    buffer_load_dwordx4 v[198:201], v146, s[12:15], s73 offen offset:0 sc1
    s_lshl_b32 s72, s82, 6
    s_mul_i32 s73, s38, 148480
    s_add_u32 s72, s72, s73
    s_add_u32 s72, s72, 0x480000
    buffer_load_dwordx4 v[226:229], v147, s[12:15], s72 offen offset:0 sc1
    buffer_load_dwordx4 v[230:233], v147, s[12:15], s72 offen offset:16 sc1
    s_waitcnt vmcnt(22)
    s_lshl_b32 s72, s38, 11
    s_add_u32 s72, s72, 150016
    v_add_u32 v136, s72, v140
    ds_write_b128 v136, v[176:179] offset:0
    ds_write_b128 v136, v[180:183] offset:1024
    s_waitcnt vmcnt(20)
    v_lshlrev_b32 v137, 16, v184
    v_and_b32 v139, 0x7fff0000, v184
    v_max_f32 v138, |v137|, v139
    v_lshlrev_b32 v137, 16, v185
    v_and_b32 v139, 0x7fff0000, v185
    v_max3_f32 v138, |v137|, v139, v138
    v_lshlrev_b32 v137, 16, v186
    v_and_b32 v139, 0x7fff0000, v186
    v_max3_f32 v138, |v137|, v139, v138
    v_lshlrev_b32 v137, 16, v187
    v_and_b32 v139, 0x7fff0000, v187
    v_max3_f32 v138, |v137|, v139, v138
    v_lshlrev_b32 v137, 16, v188
    v_and_b32 v139, 0x7fff0000, v188
    v_max3_f32 v138, |v137|, v139, v138
    v_lshlrev_b32 v137, 16, v189
    v_and_b32 v139, 0x7fff0000, v189
    v_max3_f32 v138, |v137|, v139, v138
    v_lshlrev_b32 v137, 16, v190
    v_and_b32 v139, 0x7fff0000, v190
    v_max3_f32 v138, |v137|, v139, v138
    v_lshlrev_b32 v137, 16, v191
    v_and_b32 v139, 0x7fff0000, v191
    v_max3_f32 v138, |v137|, v139, v138
    s_nop 1
    v_max_u32_dpp v138, v138, v138 row_ror:8 row_mask:0xf bank_mask:0xf
    s_nop 1
    v_max_u32_dpp v138, v138, v138 row_ror:4 row_mask:0xf bank_mask:0xf
    s_nop 1
    v_max_u32_dpp v138, v138, v138 row_ror:2 row_mask:0xf bank_mask:0xf
    s_nop 1
    v_max_u32_dpp v138, v138, v138 row_ror:1 row_mask:0xf bank_mask:0xf
    s_nop 0
    v_readlane_b32 s72, v138, 0
    v_readlane_b32 s73, v138, 16
    s_nop 0
    s_max_u32 s72, s72, s73
    v_readlane_b32 s74, v138, 32
    s_nop 0
    s_max_u32 s72, s72, s74
    v_readlane_b32 s74, v138, 48
    s_nop 0
    s_max_u32 s72, s72, s74
    v_mov_b32 v138, s72
    s_lshl_b32 s73, s38, 2
    s_add_u32 s73, s73, 158208
    v_mov_b32 v137, s73
    ds_write_b32 v137, v138
    s_waitcnt lgkmcnt(0)
    s_add_u32 s87, s87, 4
    v_mov_b32 v12, 149776
    v_mov_b32 v13, 1
    s_mov_b64 exec, 1
    ds_add_u32 v12, v13
    s_mov_b64 exec, -1
    v_mov_b32 v12, 149776
fused_kernel_r1_fs0:
    ds_read_b32 v13, v12
    s_waitcnt lgkmcnt(0)
    v_readfirstlane_b32 s35, v13
    s_nop 3
    s_cmp_ge_u32 s35, s87
    s_cbranch_scc1 fused_kernel_r1_fs0_d
    s_sleep 1
    s_branch fused_kernel_r1_fs0
fused_kernel_r1_fs0_d:
    v_add_u32 v136, 150016, v140
    v_mov_b32 v137, 158208
    ds_read_b128 v[80:83], v137
    ds_read_b128 v[152:155], v136 offset:0
    ds_read_b128 v[156:159], v136 offset:1024
    ds_read_b128 v[160:163], v136 offset:2048
    ds_read_b128 v[164:167], v136 offset:3072
    ds_read_b128 v[168:171], v136 offset:4096
    ds_read_b128 v[172:175], v136 offset:5120
    ds_read_b128 v[176:179], v136 offset:6144
    ds_read_b128 v[180:183], v136 offset:7168
    s_waitcnt lgkmcnt(8)
    v_max3_u32 v138, v80, v81, v82
    v_max_u32 v138, v138, v83
    s_nop 0
    v_readfirstlane_b32 s72, v138
    s_nop 0
    s_lshr_b32 s72, s72, 23
    s_max_u32 s72, s72, 1
    s_min_u32 s72, s72, 252
    s_sub_u32 s73, 253, s72
    s_lshl_b32 s73, s73, 23
    v_mov_b32 v149, s73
    s_add_u32 s72, s72, 1
    s_lshl_b32 s72, s72, 23
    v_mov_b32 v150, s72
    v_mul_f32 v150, s80, v150
    s_waitcnt vmcnt(16)
    s_waitcnt lgkmcnt(7)
    v_mfma_f32_16x16x32_f16 v[80:83], v[152:155], v[48:51], 0
    v_mfma_f32_16x16x32_f16 v[96:99], v[152:155], v[56:59], 0
    s_waitcnt lgkmcnt(5)
    v_mfma_f32_16x16x32_f16 v[84:87], v[160:163], v[48:51], 0
    v_mfma_f32_16x16x32_f16 v[100:103], v[160:163], v[56:59], 0
    v_mfma_f32_16x16x32_f16 v[80:83], v[156:159], v[52:55], v[80:83]
    v_mfma_f32_16x16x32_f16 v[96:99], v[156:159], v[60:63], v[96:99]
    s_waitcnt lgkmcnt(4)
    v_mfma_f32_16x16x32_f16 v[84:87], v[164:167], v[52:55], v[84:87]
    v_mfma_f32_16x16x32_f16 v[100:103], v[164:167], v[60:63], v[100:103]
    s_waitcnt lgkmcnt(3)
    v_mfma_f32_16x16x32_f16 v[80:83], v[168:171], v[56:59], v[80:83]
    v_mfma_f32_16x16x32_f16 v[88:91], v[168:171], v[48:51], 0
    s_waitcnt lgkmcnt(1)
    v_mfma_f32_16x16x32_f16 v[84:87], v[176:179], v[56:59], v[84:87]
    v_mfma_f32_16x16x32_f16 v[92:95], v[176:179], v[48:51], 0
    v_mfma_f32_16x16x32_f16 v[80:83], v[172:175], v[60:63], v[80:83]
    v_mfma_f32_16x16x32_f16 v[88:91], v[172:175], v[52:55], v[88:91]
    s_waitcnt lgkmcnt(0)
    v_mfma_f32_16x16x32_f16 v[84:87], v[180:183], v[60:63], v[84:87]
    v_mfma_f32_16x16x32_f16 v[92:95], v[180:183], v[52:55], v[92:95]
    s_nop 4
    v_sub_f32 v88, v88, v96
    v_sub_f32 v89, v89, v97
    v_sub_f32 v90, v90, v98
    v_sub_f32 v91, v91, v99
    v_sub_f32 v92, v92, v100
    v_sub_f32 v93, v93, v101
    v_sub_f32 v94, v94, v102
    v_sub_f32 v95, v95, v103
    v_mul_f32 v160, v80, v104
    v_mul_f32 v168, v88, v104
    v_fma_f32 v160, v88, v105, v160
    v_fma_f32 v168, -v80, v105, v168
    v_mul_f32 v161, v81, v106
    v_mul_f32 v169, v89, v106
    v_fma_f32 v161, v89, v107, v161
    v_fma_f32 v169, -v81, v107, v169
    v_mul_f32 v162, v82, v108
    v_mul_f32 v170, v90, v108
    v_fma_f32 v162, v90, v109, v162
    v_fma_f32 v170, -v82, v109, v170
    v_mul_f32 v163, v83, v110
    v_mul_f32 v171, v91, v110
    v_fma_f32 v163, v91, v111, v163
    v_fma_f32 v171, -v83, v111, v171
    v_mul_f32 v164, v84, v112
    v_mul_f32 v172, v92, v112
    v_fma_f32 v164, v92, v113, v164
    v_fma_f32 v172, -v84, v113, v172
    v_mul_f32 v165, v85, v114
    v_mul_f32 v173, v93, v114
    v_fma_f32 v165, v93, v115, v165
    v_fma_f32 v173, -v85, v115, v173
    v_mul_f32 v166, v86, v116
    v_mul_f32 v174, v94, v116
    v_fma_f32 v166, v94, v117, v166
    v_fma_f32 v174, -v86, v117, v174
    v_mul_f32 v167, v87, v118
    v_mul_f32 v175, v95, v118
    v_fma_f32 v167, v95, v119, v167
    v_fma_f32 v175, -v87, v119, v175
    v_cvt_pk_f16_f32 v152, v160, v161
    v_cvt_pk_f16_f32 v156, v168, v169
    v_cvt_pk_f16_f32 v153, v162, v163
    v_cvt_pk_f16_f32 v157, v170, v171
    v_cvt_pk_f16_f32 v154, v164, v165
    v_cvt_pk_f16_f32 v158, v172, v173
    v_cvt_pk_f16_f32 v155, v166, v167
    v_cvt_pk_f16_f32 v159, v174, v175
    s_waitcnt vmcnt(12)
    v_mfma_f32_16x16x32_f16 v[80:83], v[64:67], v[152:155], 0
    v_mfma_f32_16x16x32_f16 v[88:91], v[64:67], v[156:159], 0
    v_mfma_f32_16x16x32_f16 v[96:99], v[68:71], v[152:155], 0
    v_mfma_f32_16x16x32_f16 v[84:87], v[72:75], v[152:155], 0
    v_mfma_f32_16x16x32_f16 v[92:95], v[72:75], v[156:159], 0
    v_mfma_f32_16x16x32_f16 v[100:103], v[76:79], v[152:155], 0
    v_mfma_f32_16x16x32_f16 v[80:83], v[68:71], v[156:159], v[80:83]
    v_mfma_f32_16x16x32_f16 v[84:87], v[76:79], v[156:159], v[84:87]
    v_lshlrev_b32 v176, 16, v184
    v_and_b32 v184, 0xffff0000, v184
    v_mul_f32 v176, v176, v149
    v_mul_f32 v184, v184, v149
    v_lshlrev_b32 v177, 16, v185
    v_and_b32 v185, 0xffff0000, v185
    v_mul_f32 v177, v177, v149
    v_mul_f32 v185, v185, v149
    v_lshlrev_b32 v178, 16, v186
    v_and_b32 v186, 0xffff0000, v186
    v_mul_f32 v178, v178, v149
    v_mul_f32 v186, v186, v149
    v_lshlrev_b32 v179, 16, v187
    v_and_b32 v187, 0xffff0000, v187
    v_mul_f32 v179, v179, v149
    v_mul_f32 v187, v187, v149
    v_lshlrev_b32 v180, 16, v188
    v_and_b32 v188, 0xffff0000, v188
    v_mul_f32 v180, v180, v149
    v_mul_f32 v188, v188, v149
    v_lshlrev_b32 v181, 16, v189
    v_and_b32 v189, 0xffff0000, v189
    v_mul_f32 v181, v181, v149
    v_mul_f32 v189, v189, v149
    v_lshlrev_b32 v182, 16, v190
    v_and_b32 v190, 0xffff0000, v190
    v_mul_f32 v182, v182, v149
    v_mul_f32 v190, v190, v149
    v_lshlrev_b32 v183, 16, v191
    v_and_b32 v191, 0xffff0000, v191
    v_mul_f32 v183, v183, v149
    v_mul_f32 v191, v191, v149
    v_sub_f32 v88, v88, v96
    v_sub_f32 v89, v89, v97
    v_sub_f32 v90, v90, v98
    v_sub_f32 v91, v91, v99
    v_sub_f32 v92, v92, v100
    v_sub_f32 v93, v93, v101
    v_sub_f32 v94, v94, v102
    v_sub_f32 v95, v95, v103
    v_mul_f32 v160, v80, v176
    v_mul_f32 v168, v88, v176
    v_fma_f32 v160, -v88, v184, v160
    v_fma_f32 v168, v80, v184, v168
    v_mul_f32 v161, v81, v177
    v_mul_f32 v169, v89, v177
    v_fma_f32 v161, -v89, v185, v161
    v_fma_f32 v169, v81, v185, v169
    v_mul_f32 v162, v82, v178
    v_mul_f32 v170, v90, v178
    v_fma_f32 v162, -v90, v186, v162
    v_fma_f32 v170, v82, v186, v170
    v_mul_f32 v163, v83, v179
    v_mul_f32 v171, v91, v179
    v_fma_f32 v163, -v91, v187, v163
    v_fma_f32 v171, v83, v187, v171
    v_mul_f32 v164, v84, v180
    v_mul_f32 v172, v92, v180
    v_fma_f32 v164, -v92, v188, v164
    v_fma_f32 v172, v84, v188, v172
    v_mul_f32 v165, v85, v181
    v_mul_f32 v173, v93, v181
    v_fma_f32 v165, -v93, v189, v165
    v_fma_f32 v173, v85, v189, v173
    v_mul_f32 v166, v86, v182
    v_mul_f32 v174, v94, v182
    v_fma_f32 v166, -v94, v190, v166
    v_fma_f32 v174, v86, v190, v174
    v_mul_f32 v167, v87, v183
    v_mul_f32 v175, v95, v183
    v_fma_f32 v167, -v95, v191, v167
    v_fma_f32 v175, v87, v191, v175
    v_cvt_pk_f16_f32 v152, v160, v161
    v_cvt_pk_f16_f32 v156, v168, v169
    v_cvt_pk_f16_f32 v153, v162, v163
    v_cvt_pk_f16_f32 v157, v170, v171
    v_cvt_pk_f16_f32 v154, v164, v165
    v_cvt_pk_f16_f32 v158, v172, v173
    v_cvt_pk_f16_f32 v155, v166, v167
    v_cvt_pk_f16_f32 v159, v174, v175
    s_nop 1
    v_mfma_f32_16x16x32_f16 v[80:83], v[156:159], v[64:67], 0
    v_mfma_f32_16x16x32_f16 v[88:91], v[152:155], v[64:67], 0
    v_mfma_f32_16x16x32_f16 v[96:99], v[156:159], v[68:71], 0
    v_mfma_f32_16x16x32_f16 v[84:87], v[156:159], v[72:75], 0
    v_mfma_f32_16x16x32_f16 v[92:95], v[152:155], v[72:75], 0
    v_mfma_f32_16x16x32_f16 v[100:103], v[156:159], v[76:79], 0
    v_mfma_f32_16x16x32_f16 v[80:83], v[152:155], v[68:71], v[80:83]
    v_mfma_f32_16x16x32_f16 v[84:87], v[152:155], v[76:79], v[84:87]
    s_nop 2
    v_sub_f32 v88, v88, v96
    v_sub_f32 v89, v89, v97
    v_sub_f32 v90, v90, v98
    v_sub_f32 v91, v91, v99
    v_sub_f32 v92, v92, v100
    v_sub_f32 v93, v93, v101
    v_sub_f32 v94, v94, v102
    v_sub_f32 v95, v95, v103
    v_mul_f32 v160, v88, v120
    v_mul_f32 v168, v80, v120
    v_fma_f32 v160, -v80, v121, v160
    v_fma_f32 v168, v88, v121, v168
    v_mul_f32 v161, v89, v122
    v_mul_f32 v169, v81, v122
    v_fma_f32 v161, -v81, v123, v161
    v_fma_f32 v169, v89, v123, v169
    v_mul_f32 v162, v90, v124
    v_mul_f32 v170, v82, v124
    v_fma_f32 v162, -v82, v125, v162
    v_fma_f32 v170, v90, v125, v170
    v_mul_f32 v163, v91, v126
    v_mul_f32 v171, v83, v126
    v_fma_f32 v163, -v83, v127, v163
    v_fma_f32 v171, v91, v127, v171
    v_mul_f32 v164, v92, v128
    v_mul_f32 v172, v84, v128
    v_fma_f32 v164, -v84, v129, v164
    v_fma_f32 v172, v92, v129, v172
    v_mul_f32 v165, v93, v130
    v_mul_f32 v173, v85, v130
    v_fma_f32 v165, -v85, v131, v165
    v_fma_f32 v173, v93, v131, v173
    v_mul_f32 v166, v94, v132
    v_mul_f32 v174, v86, v132
    v_fma_f32 v166, -v86, v133, v166
    v_fma_f32 v174, v94, v133, v174
    v_mul_f32 v167, v95, v134
    v_mul_f32 v175, v87, v134
    v_fma_f32 v167, -v87, v135, v167
    v_fma_f32 v175, v95, v135, v175
    v_cvt_pk_f16_f32 v152, v160, v161
    v_cvt_pk_f16_f32 v156, v168, v169
    v_cvt_pk_f16_f32 v153, v162, v163
    v_cvt_pk_f16_f32 v157, v170, v171
    v_cvt_pk_f16_f32 v154, v164, v165
    v_cvt_pk_f16_f32 v158, v172, v173
    v_cvt_pk_f16_f32 v155, v166, v167
    v_cvt_pk_f16_f32 v159, v174, v175
    s_add_u32 s87, s87, 4
    v_mov_b32 v12, 149776
    v_mov_b32 v13, 1
    s_mov_b64 exec, 1
    ds_add_u32 v12, v13
    s_mov_b64 exec, -1
    v_mov_b32 v12, 149776
fused_kernel_r1_fs1:
    ds_read_b32 v13, v12
    s_waitcnt lgkmcnt(0)
    v_readfirstlane_b32 s35, v13
    s_nop 3
    s_cmp_ge_u32 s35, s87
    s_cbranch_scc1 fused_kernel_r1_fs1_d
    s_sleep 1
    s_branch fused_kernel_r1_fs1
fused_kernel_r1_fs1_d:
    ds_write_b64 v143, v[152:153] offset:0
    ds_write_b64 v143, v[154:155] offset:2048
    ds_write_b64 v143, v[156:157] offset:4096
    ds_write_b64 v143, v[158:159] offset:6144
    s_waitcnt lgkmcnt(0)
    s_add_u32 s87, s87, 4
    v_mov_b32 v12, 149776
    v_mov_b32 v13, 1
    s_mov_b64 exec, 1
    ds_add_u32 v12, v13
    s_mov_b64 exec, -1
    v_mov_b32 v12, 149776
fused_kernel_r1_fs2:
    ds_read_b32 v13, v12
    s_waitcnt lgkmcnt(0)
    v_readfirstlane_b32 s35, v13
    s_nop 3
    s_cmp_ge_u32 s35, s87
    s_cbranch_scc1 fused_kernel_r1_fs2_d
    s_sleep 1
    s_branch fused_kernel_r1_fs2
fused_kernel_r1_fs2_d:
    ds_read_b128 v[160:163], v144 offset:0
    ds_read_b128 v[168:171], v144 offset:4096
    ds_read_b128 v[164:167], v144 offset:1024
    ds_read_b128 v[172:175], v144 offset:5120
    s_waitcnt vmcnt(4)
    s_waitcnt lgkmcnt(3)
    v_mfma_f32_16x16x32_f16 v[88:91], v[16:19], v[160:163], 0
    v_mfma_f32_16x16x32_f16 v[80:83], v[24:27], v[160:163], 0
    v_mfma_f32_16x16x32_f16 v[92:95], v[32:35], v[160:163], 0
    v_mfma_f32_16x16x32_f16 v[84:87], v[40:43], v[160:163], 0
    s_waitcnt lgkmcnt(2)
    v_mfma_f32_16x16x32_f16 v[96:99], v[24:27], v[168:171], 0
    v_mfma_f32_16x16x32_f16 v[80:83], v[16:19], v[168:171], v[80:83]
    v_mfma_f32_16x16x32_f16 v[100:103], v[40:43], v[168:171], 0
    v_mfma_f32_16x16x32_f16 v[84:87], v[32:35], v[168:171], v[84:87]
    s_waitcnt lgkmcnt(1)
    v_mfma_f32_16x16x32_f16 v[88:91], v[20:23], v[164:167], v[88:91]
    v_mfma_f32_16x16x32_f16 v[80:83], v[28:31], v[164:167], v[80:83]
    v_mfma_f32_16x16x32_f16 v[92:95], v[36:39], v[164:167], v[92:95]
    v_mfma_f32_16x16x32_f16 v[84:87], v[44:47], v[164:167], v[84:87]
    s_waitcnt lgkmcnt(0)
    v_mfma_f32_16x16x32_f16 v[96:99], v[28:31], v[172:175], v[96:99]
    v_mfma_f32_16x16x32_f16 v[80:83], v[20:23], v[172:175], v[80:83]
    v_mfma_f32_16x16x32_f16 v[100:103], v[44:47], v[172:175], v[100:103]
    v_mfma_f32_16x16x32_f16 v[84:87], v[36:39], v[172:175], v[84:87]
    s_nop 4
    v_sub_f32 v88, v88, v96
    v_sub_f32 v89, v89, v97
    v_sub_f32 v90, v90, v98
    v_sub_f32 v91, v91, v99
    v_sub_f32 v92, v92, v100
    v_sub_f32 v93, v93, v101
    v_sub_f32 v94, v94, v102
    v_sub_f32 v95, v95, v103
    v_mul_f32 v88, v88, v150
    v_mul_f32 v80, v80, v150
    v_mul_f32 v89, v89, v150
    v_mul_f32 v81, v81, v150
    v_mul_f32 v90, v90, v150
    v_mul_f32 v82, v82, v150
    v_mul_f32 v91, v91, v150
    v_mul_f32 v83, v83, v150
    v_mul_f32 v92, v92, v150
    v_mul_f32 v84, v84, v150
    v_mul_f32 v93, v93, v150
    v_mul_f32 v85, v85, v150
    v_mul_f32 v94, v94, v150
    v_mul_f32 v86, v86, v150
    v_mul_f32 v95, v95, v150
    v_mul_f32 v87, v87, v150
    v_cvt_pk_bf16_f32 v152, v88, v89
    v_cvt_pk_bf16_f32 v156, v80, v81
    v_cvt_pk_bf16_f32 v153, v90, v91
    v_cvt_pk_bf16_f32 v157, v82, v83
    v_cvt_pk_bf16_f32 v154, v92, v93
    v_cvt_pk_bf16_f32 v158, v84, v85
    v_cvt_pk_bf16_f32 v155, v94, v95
    v_cvt_pk_bf16_f32 v159, v86, v87
    buffer_store_dwordx4 v[152:155], v145, s[12:15], s78 offen sc1
    buffer_store_dwordx4 v[156:159], v145, s[12:15], s79 offen sc1
    s_add_u32 s87, s87, 4
    v_mov_b32 v12, 149776
    v_mov_b32 v13, 1
    s_mov_b64 exec, 1
    ds_add_u32 v12, v13
    s_mov_b64 exec, -1
    v_mov_b32 v12, 149776
fused_kernel_r1_fs3:
    ds_read_b32 v13, v12
    s_waitcnt lgkmcnt(0)
    v_readfirstlane_b32 s35, v13
    s_nop 3
    s_cmp_ge_u32 s35, s87
    s_cbranch_scc1 fused_kernel_r1_fs3_d
    s_sleep 1
    s_branch fused_kernel_r1_fs3
fused_kernel_r1_fs3_d:
    s_waitcnt vmcnt(4)
    s_lshl_b32 s72, s38, 11
    s_add_u32 s72, s72, 150016
    v_add_u32 v136, s72, v140
    ds_write_b128 v136, v[194:197] offset:0
    ds_write_b128 v136, v[198:201] offset:1024
    s_waitcnt vmcnt(2)
    v_lshlrev_b32 v137, 16, v226
    v_and_b32 v139, 0x7fff0000, v226
    v_max_f32 v138, |v137|, v139
    v_lshlrev_b32 v137, 16, v227
    v_and_b32 v139, 0x7fff0000, v227
    v_max3_f32 v138, |v137|, v139, v138
    v_lshlrev_b32 v137, 16, v228
    v_and_b32 v139, 0x7fff0000, v228
    v_max3_f32 v138, |v137|, v139, v138
    v_lshlrev_b32 v137, 16, v229
    v_and_b32 v139, 0x7fff0000, v229
    v_max3_f32 v138, |v137|, v139, v138
    v_lshlrev_b32 v137, 16, v230
    v_and_b32 v139, 0x7fff0000, v230
    v_max3_f32 v138, |v137|, v139, v138
    v_lshlrev_b32 v137, 16, v231
    v_and_b32 v139, 0x7fff0000, v231
    v_max3_f32 v138, |v137|, v139, v138
    v_lshlrev_b32 v137, 16, v232
    v_and_b32 v139, 0x7fff0000, v232
    v_max3_f32 v138, |v137|, v139, v138
    v_lshlrev_b32 v137, 16, v233
    v_and_b32 v139, 0x7fff0000, v233
    v_max3_f32 v138, |v137|, v139, v138
    s_nop 1
    v_max_u32_dpp v138, v138, v138 row_ror:8 row_mask:0xf bank_mask:0xf
    s_nop 1
    v_max_u32_dpp v138, v138, v138 row_ror:4 row_mask:0xf bank_mask:0xf
    s_nop 1
    v_max_u32_dpp v138, v138, v138 row_ror:2 row_mask:0xf bank_mask:0xf
    s_nop 1
    v_max_u32_dpp v138, v138, v138 row_ror:1 row_mask:0xf bank_mask:0xf
    s_nop 0
    v_readlane_b32 s72, v138, 0
    v_readlane_b32 s73, v138, 16
    s_nop 0
    s_max_u32 s72, s72, s73
    v_readlane_b32 s74, v138, 32
    s_nop 0
    s_max_u32 s72, s72, s74
    v_readlane_b32 s74, v138, 48
    s_nop 0
    s_max_u32 s72, s72, s74
    v_mov_b32 v138, s72
    s_lshl_b32 s73, s38, 2
    s_add_u32 s73, s73, 158208
    v_mov_b32 v137, s73
    ds_write_b32 v137, v138
    s_waitcnt lgkmcnt(0)
    s_add_u32 s87, s87, 4
    v_mov_b32 v12, 149776
    v_mov_b32 v13, 1
    s_mov_b64 exec, 1
    ds_add_u32 v12, v13
    s_mov_b64 exec, -1
    v_mov_b32 v12, 149776
fused_kernel_r1_fs4:
    ds_read_b32 v13, v12
    s_waitcnt lgkmcnt(0)
    v_readfirstlane_b32 s35, v13
    s_nop 3
    s_cmp_ge_u32 s35, s87
    s_cbranch_scc1 fused_kernel_r1_fs4_d
    s_sleep 1
    s_branch fused_kernel_r1_fs4
fused_kernel_r1_fs4_d:
    v_add_u32 v136, 150016, v140
    v_mov_b32 v137, 158208
    ds_read_b128 v[80:83], v137
    ds_read_b128 v[194:197], v136 offset:0
    ds_read_b128 v[198:201], v136 offset:1024
    ds_read_b128 v[202:205], v136 offset:2048
    ds_read_b128 v[206:209], v136 offset:3072
    ds_read_b128 v[210:213], v136 offset:4096
    ds_read_b128 v[214:217], v136 offset:5120
    ds_read_b128 v[218:221], v136 offset:6144
    ds_read_b128 v[222:225], v136 offset:7168
    s_waitcnt lgkmcnt(8)
    v_max3_u32 v138, v80, v81, v82
    v_max_u32 v138, v138, v83
    s_nop 0
    v_readfirstlane_b32 s72, v138
    s_nop 0
    s_lshr_b32 s72, s72, 23
    s_max_u32 s72, s72, 1
    s_min_u32 s72, s72, 252
    s_sub_u32 s73, 253, s72
    s_lshl_b32 s73, s73, 23
    v_mov_b32 v149, s73
    s_add_u32 s72, s72, 1
    s_lshl_b32 s72, s72, 23
    v_mov_b32 v150, s72
    v_mul_f32 v150, s94, v150
    s_waitcnt lgkmcnt(7)
    v_mfma_f32_16x16x32_f16 v[80:83], v[194:197], v[48:51], 0
    v_mfma_f32_16x16x32_f16 v[96:99], v[194:197], v[56:59], 0
    s_waitcnt lgkmcnt(5)
    v_mfma_f32_16x16x32_f16 v[84:87], v[202:205], v[48:51], 0
    v_mfma_f32_16x16x32_f16 v[100:103], v[202:205], v[56:59], 0
    v_mfma_f32_16x16x32_f16 v[80:83], v[198:201], v[52:55], v[80:83]
    v_mfma_f32_16x16x32_f16 v[96:99], v[198:201], v[60:63], v[96:99]
    s_waitcnt lgkmcnt(4)
    v_mfma_f32_16x16x32_f16 v[84:87], v[206:209], v[52:55], v[84:87]
    v_mfma_f32_16x16x32_f16 v[100:103], v[206:209], v[60:63], v[100:103]
    s_waitcnt lgkmcnt(3)
    v_mfma_f32_16x16x32_f16 v[80:83], v[210:213], v[56:59], v[80:83]
    v_mfma_f32_16x16x32_f16 v[88:91], v[210:213], v[48:51], 0
    s_waitcnt lgkmcnt(1)
    v_mfma_f32_16x16x32_f16 v[84:87], v[218:221], v[56:59], v[84:87]
    v_mfma_f32_16x16x32_f16 v[92:95], v[218:221], v[48:51], 0
    v_mfma_f32_16x16x32_f16 v[80:83], v[214:217], v[60:63], v[80:83]
    v_mfma_f32_16x16x32_f16 v[88:91], v[214:217], v[52:55], v[88:91]
    s_waitcnt lgkmcnt(0)
    v_mfma_f32_16x16x32_f16 v[84:87], v[222:225], v[60:63], v[84:87]
    v_mfma_f32_16x16x32_f16 v[92:95], v[222:225], v[52:55], v[92:95]
    s_nop 4
    v_sub_f32 v88, v88, v96
    v_sub_f32 v89, v89, v97
    v_sub_f32 v90, v90, v98
    v_sub_f32 v91, v91, v99
    v_sub_f32 v92, v92, v100
    v_sub_f32 v93, v93, v101
    v_sub_f32 v94, v94, v102
    v_sub_f32 v95, v95, v103
    v_mul_f32 v202, v80, v104
    v_mul_f32 v210, v88, v104
    v_fma_f32 v202, v88, v105, v202
    v_fma_f32 v210, -v80, v105, v210
    v_mul_f32 v203, v81, v106
    v_mul_f32 v211, v89, v106
    v_fma_f32 v203, v89, v107, v203
    v_fma_f32 v211, -v81, v107, v211
    v_mul_f32 v204, v82, v108
    v_mul_f32 v212, v90, v108
    v_fma_f32 v204, v90, v109, v204
    v_fma_f32 v212, -v82, v109, v212
    v_mul_f32 v205, v83, v110
    v_mul_f32 v213, v91, v110
    v_fma_f32 v205, v91, v111, v205
    v_fma_f32 v213, -v83, v111, v213
    v_mul_f32 v206, v84, v112
    v_mul_f32 v214, v92, v112
    v_fma_f32 v206, v92, v113, v206
    v_fma_f32 v214, -v84, v113, v214
    v_mul_f32 v207, v85, v114
    v_mul_f32 v215, v93, v114
    v_fma_f32 v207, v93, v115, v207
    v_fma_f32 v215, -v85, v115, v215
    v_mul_f32 v208, v86, v116
    v_mul_f32 v216, v94, v116
    v_fma_f32 v208, v94, v117, v208
    v_fma_f32 v216, -v86, v117, v216
    v_mul_f32 v209, v87, v118
    v_mul_f32 v217, v95, v118
    v_fma_f32 v209, v95, v119, v209
    v_fma_f32 v217, -v87, v119, v217
    v_cvt_pk_f16_f32 v194, v202, v203
    v_cvt_pk_f16_f32 v198, v210, v211
    v_cvt_pk_f16_f32 v195, v204, v205
    v_cvt_pk_f16_f32 v199, v212, v213
    v_cvt_pk_f16_f32 v196, v206, v207
    v_cvt_pk_f16_f32 v200, v214, v215
    v_cvt_pk_f16_f32 v197, v208, v209
    v_cvt_pk_f16_f32 v201, v216, v217
    s_nop 0
    v_mfma_f32_16x16x32_f16 v[80:83], v[64:67], v[194:197], 0
    v_mfma_f32_16x16x32_f16 v[88:91], v[64:67], v[198:201], 0
    v_mfma_f32_16x16x32_f16 v[96:99], v[68:71], v[194:197], 0
    v_mfma_f32_16x16x32_f16 v[84:87], v[72:75], v[194:197], 0
    v_mfma_f32_16x16x32_f16 v[92:95], v[72:75], v[198:201], 0
    v_mfma_f32_16x16x32_f16 v[100:103], v[76:79], v[194:197], 0
    v_mfma_f32_16x16x32_f16 v[80:83], v[68:71], v[198:201], v[80:83]
    v_mfma_f32_16x16x32_f16 v[84:87], v[76:79], v[198:201], v[84:87]
    v_lshlrev_b32 v218, 16, v226
    v_and_b32 v226, 0xffff0000, v226
    v_mul_f32 v218, v218, v149
    v_mul_f32 v226, v226, v149
    v_lshlrev_b32 v219, 16, v227
    v_and_b32 v227, 0xffff0000, v227
    v_mul_f32 v219, v219, v149
    v_mul_f32 v227, v227, v149
    v_lshlrev_b32 v220, 16, v228
    v_and_b32 v228, 0xffff0000, v228
    v_mul_f32 v220, v220, v149
    v_mul_f32 v228, v228, v149
    v_lshlrev_b32 v221, 16, v229
    v_and_b32 v229, 0xffff0000, v229
    v_mul_f32 v221, v221, v149
    v_mul_f32 v229, v229, v149
    v_lshlrev_b32 v222, 16, v230
    v_and_b32 v230, 0xffff0000, v230
    v_mul_f32 v222, v222, v149
    v_mul_f32 v230, v230, v149
    v_lshlrev_b32 v223, 16, v231
    v_and_b32 v231, 0xffff0000, v231
    v_mul_f32 v223, v223, v149
    v_mul_f32 v231, v231, v149
    v_lshlrev_b32 v224, 16, v232
    v_and_b32 v232, 0xffff0000, v232
    v_mul_f32 v224, v224, v149
    v_mul_f32 v232, v232, v149
    v_lshlrev_b32 v225, 16, v233
    v_and_b32 v233, 0xffff0000, v233
    v_mul_f32 v225, v225, v149
    v_mul_f32 v233, v233, v149
    v_sub_f32 v88, v88, v96
    v_sub_f32 v89, v89, v97
    v_sub_f32 v90, v90, v98
    v_sub_f32 v91, v91, v99
    v_sub_f32 v92, v92, v100
    v_sub_f32 v93, v93, v101
    v_sub_f32 v94, v94, v102
    v_sub_f32 v95, v95, v103
    v_mul_f32 v202, v80, v218
    v_mul_f32 v210, v88, v218
    v_fma_f32 v202, -v88, v226, v202
    v_fma_f32 v210, v80, v226, v210
    v_mul_f32 v203, v81, v219
    v_mul_f32 v211, v89, v219
    v_fma_f32 v203, -v89, v227, v203
    v_fma_f32 v211, v81, v227, v211
    v_mul_f32 v204, v82, v220
    v_mul_f32 v212, v90, v220
    v_fma_f32 v204, -v90, v228, v204
    v_fma_f32 v212, v82, v228, v212
    v_mul_f32 v205, v83, v221
    v_mul_f32 v213, v91, v221
    v_fma_f32 v205, -v91, v229, v205
    v_fma_f32 v213, v83, v229, v213
    v_mul_f32 v206, v84, v222
    v_mul_f32 v214, v92, v222
    v_fma_f32 v206, -v92, v230, v206
    v_fma_f32 v214, v84, v230, v214
    v_mul_f32 v207, v85, v223
    v_mul_f32 v215, v93, v223
    v_fma_f32 v207, -v93, v231, v207
    v_fma_f32 v215, v85, v231, v215
    v_mul_f32 v208, v86, v224
    v_mul_f32 v216, v94, v224
    v_fma_f32 v208, -v94, v232, v208
    v_fma_f32 v216, v86, v232, v216
    v_mul_f32 v209, v87, v225
    v_mul_f32 v217, v95, v225
    v_fma_f32 v209, -v95, v233, v209
    v_fma_f32 v217, v87, v233, v217
    v_cvt_pk_f16_f32 v194, v202, v203
    v_cvt_pk_f16_f32 v198, v210, v211
    v_cvt_pk_f16_f32 v195, v204, v205
    v_cvt_pk_f16_f32 v199, v212, v213
    v_cvt_pk_f16_f32 v196, v206, v207
    v_cvt_pk_f16_f32 v200, v214, v215
    v_cvt_pk_f16_f32 v197, v208, v209
    v_cvt_pk_f16_f32 v201, v216, v217
    s_nop 1
    v_mfma_f32_16x16x32_f16 v[80:83], v[198:201], v[64:67], 0
    v_mfma_f32_16x16x32_f16 v[88:91], v[194:197], v[64:67], 0
    v_mfma_f32_16x16x32_f16 v[96:99], v[198:201], v[68:71], 0
    v_mfma_f32_16x16x32_f16 v[84:87], v[198:201], v[72:75], 0
    v_mfma_f32_16x16x32_f16 v[92:95], v[194:197], v[72:75], 0
    v_mfma_f32_16x16x32_f16 v[100:103], v[198:201], v[76:79], 0
    v_mfma_f32_16x16x32_f16 v[80:83], v[194:197], v[68:71], v[80:83]
    v_mfma_f32_16x16x32_f16 v[84:87], v[194:197], v[76:79], v[84:87]
    s_nop 2
    v_sub_f32 v88, v88, v96
    v_sub_f32 v89, v89, v97
    v_sub_f32 v90, v90, v98
    v_sub_f32 v91, v91, v99
    v_sub_f32 v92, v92, v100
    v_sub_f32 v93, v93, v101
    v_sub_f32 v94, v94, v102
    v_sub_f32 v95, v95, v103
    v_mul_f32 v202, v88, v120
    v_mul_f32 v210, v80, v120
    v_fma_f32 v202, -v80, v121, v202
    v_fma_f32 v210, v88, v121, v210
    v_mul_f32 v203, v89, v122
    v_mul_f32 v211, v81, v122
    v_fma_f32 v203, -v81, v123, v203
    v_fma_f32 v211, v89, v123, v211
    v_mul_f32 v204, v90, v124
    v_mul_f32 v212, v82, v124
    v_fma_f32 v204, -v82, v125, v204
    v_fma_f32 v212, v90, v125, v212
    v_mul_f32 v205, v91, v126
    v_mul_f32 v213, v83, v126
    v_fma_f32 v205, -v83, v127, v205
    v_fma_f32 v213, v91, v127, v213
    v_mul_f32 v206, v92, v128
    v_mul_f32 v214, v84, v128
    v_fma_f32 v206, -v84, v129, v206
    v_fma_f32 v214, v92, v129, v214
    v_mul_f32 v207, v93, v130
    v_mul_f32 v215, v85, v130
    v_fma_f32 v207, -v85, v131, v207
    v_fma_f32 v215, v93, v131, v215
    v_mul_f32 v208, v94, v132
    v_mul_f32 v216, v86, v132
    v_fma_f32 v208, -v86, v133, v208
    v_fma_f32 v216, v94, v133, v216
    v_mul_f32 v209, v95, v134
    v_mul_f32 v217, v87, v134
    v_fma_f32 v209, -v87, v135, v209
    v_fma_f32 v217, v95, v135, v217
    v_cvt_pk_f16_f32 v194, v202, v203
    v_cvt_pk_f16_f32 v198, v210, v211
    v_cvt_pk_f16_f32 v195, v204, v205
    v_cvt_pk_f16_f32 v199, v212, v213
    v_cvt_pk_f16_f32 v196, v206, v207
    v_cvt_pk_f16_f32 v200, v214, v215
    v_cvt_pk_f16_f32 v197, v208, v209
    v_cvt_pk_f16_f32 v201, v216, v217
    s_add_u32 s33, s38, 12
    s_mov_b32 s34, 0
    s_add_u32 s33, s33, s42
    s_sub_u32 s35, s33, 18
    s_cselect_b32 s33, s33, s35
    s_lshl_b32 s33, s33, 1
    s_add_u32 s33, s33, s34
    s_mul_i32 s23, s33, 18432
    s_add_u32 s23, s23, s41
    s_lshl_b32 s33, s33, 10
    s_add_u32 s64, s33, s40
    s_add_u32 s30, s23, 0xf54000
    buffer_load_dwordx4 v[48:51], v1, s[12:15], s30 offen offset:0 sc1
    s_add_u32 s31, s23, 0xf58800
    buffer_load_dwordx4 v[52:55], v1, s[12:15], s31 offen offset:0 sc1
    buffer_load_dwordx4 v[56:59], v1, s[12:15], s30 offen offset:1024 sc1
    buffer_load_dwordx4 v[60:63], v1, s[12:15], s31 offen offset:1024 sc1
    s_add_u32 s30, s23, 0xf50000
    buffer_load_dwordx4 v[64:67], v1, s[12:15], s30 offen offset:0 sc1
    s_add_u32 s31, s23, 0xf54800
    buffer_load_dwordx4 v[68:71], v1, s[12:15], s31 offen offset:0 sc1
    buffer_load_dwordx4 v[72:75], v1, s[12:15], s30 offen offset:1024 sc1
    buffer_load_dwordx4 v[76:79], v1, s[12:15], s31 offen offset:1024 sc1
    s_add_u32 s87, s87, 4
    v_mov_b32 v12, 149776
    v_mov_b32 v13, 1
    s_mov_b64 exec, 1
    ds_add_u32 v12, v13
    s_mov_b64 exec, -1
    v_mov_b32 v12, 149776
fused_kernel_r1_fs5:
    ds_read_b32 v13, v12
    s_waitcnt lgkmcnt(0)
    v_readfirstlane_b32 s35, v13
    s_nop 3
    s_cmp_ge_u32 s35, s87
    s_cbranch_scc1 fused_kernel_r1_fs5_d
    s_sleep 1
    s_branch fused_kernel_r1_fs5
fused_kernel_r1_fs5_d:
    ds_write_b64 v143, v[194:195] offset:0
    ds_write_b64 v143, v[196:197] offset:2048
    ds_write_b64 v143, v[198:199] offset:4096
    ds_write_b64 v143, v[200:201] offset:6144
    s_waitcnt lgkmcnt(0)
    s_add_u32 s87, s87, 4
    v_mov_b32 v12, 149776
    v_mov_b32 v13, 1
    s_mov_b64 exec, 1
    ds_add_u32 v12, v13
    s_mov_b64 exec, -1
    v_mov_b32 v12, 149776
fused_kernel_r1_fs6:
    ds_read_b32 v13, v12
    s_waitcnt lgkmcnt(0)
    v_readfirstlane_b32 s35, v13
    s_nop 3
    s_cmp_ge_u32 s35, s87
    s_cbranch_scc1 fused_kernel_r1_fs6_d
    s_sleep 1
    s_branch fused_kernel_r1_fs6
fused_kernel_r1_fs6_d:
    ds_read_b128 v[202:205], v144 offset:0
    ds_read_b128 v[210:213], v144 offset:4096
    ds_read_b128 v[206:209], v144 offset:1024
    ds_read_b128 v[214:217], v144 offset:5120
    s_waitcnt lgkmcnt(3)
    v_mfma_f32_16x16x32_f16 v[88:91], v[16:19], v[202:205], 0
    v_mfma_f32_16x16x32_f16 v[80:83], v[24:27], v[202:205], 0
    v_mfma_f32_16x16x32_f16 v[92:95], v[32:35], v[202:205], 0
    v_mfma_f32_16x16x32_f16 v[84:87], v[40:43], v[202:205], 0
    s_waitcnt lgkmcnt(2)
    v_mfma_f32_16x16x32_f16 v[96:99], v[24:27], v[210:213], 0
    v_mfma_f32_16x16x32_f16 v[80:83], v[16:19], v[210:213], v[80:83]
    v_mfma_f32_16x16x32_f16 v[100:103], v[40:43], v[210:213], 0
    v_mfma_f32_16x16x32_f16 v[84:87], v[32:35], v[210:213], v[84:87]
    s_waitcnt lgkmcnt(1)
    v_mfma_f32_16x16x32_f16 v[88:91], v[20:23], v[206:209], v[88:91]
    v_mfma_f32_16x16x32_f16 v[80:83], v[28:31], v[206:209], v[80:83]
    v_mfma_f32_16x16x32_f16 v[92:95], v[36:39], v[206:209], v[92:95]
    v_mfma_f32_16x16x32_f16 v[84:87], v[44:47], v[206:209], v[84:87]
    s_waitcnt lgkmcnt(0)
    v_mfma_f32_16x16x32_f16 v[96:99], v[28:31], v[214:217], v[96:99]
    v_mfma_f32_16x16x32_f16 v[80:83], v[20:23], v[214:217], v[80:83]
    v_mfma_f32_16x16x32_f16 v[100:103], v[44:47], v[214:217], v[100:103]
    v_mfma_f32_16x16x32_f16 v[84:87], v[36:39], v[214:217], v[84:87]
    s_nop 4
    v_sub_f32 v88, v88, v96
    v_sub_f32 v89, v89, v97
    v_sub_f32 v90, v90, v98
    v_sub_f32 v91, v91, v99
    v_sub_f32 v92, v92, v100
    v_sub_f32 v93, v93, v101
    v_sub_f32 v94, v94, v102
    v_sub_f32 v95, v95, v103
    v_mul_f32 v88, v88, v150
    v_mul_f32 v80, v80, v150
    v_mul_f32 v89, v89, v150
    v_mul_f32 v81, v81, v150
    v_mul_f32 v90, v90, v150
    v_mul_f32 v82, v82, v150
    v_mul_f32 v91, v91, v150
    v_mul_f32 v83, v83, v150
    v_mul_f32 v92, v92, v150
    v_mul_f32 v84, v84, v150
    v_mul_f32 v93, v93, v150
    v_mul_f32 v85, v85, v150
    v_mul_f32 v94, v94, v150
    v_mul_f32 v86, v86, v150
    v_mul_f32 v95, v95, v150
    v_mul_f32 v87, v87, v150
    v_cvt_pk_bf16_f32 v194, v88, v89
    v_cvt_pk_bf16_f32 v198, v80, v81
    v_cvt_pk_bf16_f32 v195, v90, v91
    v_cvt_pk_bf16_f32 v199, v82, v83
    v_cvt_pk_bf16_f32 v196, v92, v93
    v_cvt_pk_bf16_f32 v200, v84, v85
    v_cvt_pk_bf16_f32 v197, v94, v95
    v_cvt_pk_bf16_f32 v201, v86, v87
    buffer_store_dwordx4 v[194:197], v145, s[12:15], s92 offen sc1
    buffer_store_dwordx4 v[198:201], v145, s[12:15], s93 offen sc1
    s_branch fused_kernel_r1_f2
fused_kernel_r1_f1:
    s_waitcnt vmcnt(18)
    s_lshl_b32 s72, s38, 11
    s_add_u32 s72, s72, 150016
    v_add_u32 v136, s72, v140
    ds_write_b128 v136, v[176:179] offset:0
    ds_write_b128 v136, v[180:183] offset:1024
    s_waitcnt vmcnt(16)
    v_lshlrev_b32 v137, 16, v184
    v_and_b32 v139, 0x7fff0000, v184
    v_max_f32 v138, |v137|, v139
    v_lshlrev_b32 v137, 16, v185
    v_and_b32 v139, 0x7fff0000, v185
    v_max3_f32 v138, |v137|, v139, v138
    v_lshlrev_b32 v137, 16, v186
    v_and_b32 v139, 0x7fff0000, v186
    v_max3_f32 v138, |v137|, v139, v138
    v_lshlrev_b32 v137, 16, v187
    v_and_b32 v139, 0x7fff0000, v187
    v_max3_f32 v138, |v137|, v139, v138
    v_lshlrev_b32 v137, 16, v188
    v_and_b32 v139, 0x7fff0000, v188
    v_max3_f32 v138, |v137|, v139, v138
    v_lshlrev_b32 v137, 16, v189
    v_and_b32 v139, 0x7fff0000, v189
    v_max3_f32 v138, |v137|, v139, v138
    v_lshlrev_b32 v137, 16, v190
    v_and_b32 v139, 0x7fff0000, v190
    v_max3_f32 v138, |v137|, v139, v138
    v_lshlrev_b32 v137, 16, v191
    v_and_b32 v139, 0x7fff0000, v191
    v_max3_f32 v138, |v137|, v139, v138
    s_nop 1
    v_max_u32_dpp v138, v138, v138 row_ror:8 row_mask:0xf bank_mask:0xf
    s_nop 1
    v_max_u32_dpp v138, v138, v138 row_ror:4 row_mask:0xf bank_mask:0xf
    s_nop 1
    v_max_u32_dpp v138, v138, v138 row_ror:2 row_mask:0xf bank_mask:0xf
    s_nop 1
    v_max_u32_dpp v138, v138, v138 row_ror:1 row_mask:0xf bank_mask:0xf
    s_nop 0
    v_readlane_b32 s72, v138, 0
    v_readlane_b32 s73, v138, 16
    s_nop 0
    s_max_u32 s72, s72, s73
    v_readlane_b32 s74, v138, 32
    s_nop 0
    s_max_u32 s72, s72, s74
    v_readlane_b32 s74, v138, 48
    s_nop 0
    s_max_u32 s72, s72, s74
    v_mov_b32 v138, s72
    s_lshl_b32 s73, s38, 2
    s_add_u32 s73, s73, 158208
    v_mov_b32 v137, s73
    ds_write_b32 v137, v138
    s_waitcnt lgkmcnt(0)
    s_add_u32 s87, s87, 4
    v_mov_b32 v12, 149776
    v_mov_b32 v13, 1
    s_mov_b64 exec, 1
    ds_add_u32 v12, v13
    s_mov_b64 exec, -1
    v_mov_b32 v12, 149776
fused_kernel_r1_fs7:
    ds_read_b32 v13, v12
    s_waitcnt lgkmcnt(0)
    v_readfirstlane_b32 s35, v13
    s_nop 3
    s_cmp_ge_u32 s35, s87
    s_cbranch_scc1 fused_kernel_r1_fs7_d
    s_sleep 1
    s_branch fused_kernel_r1_fs7
fused_kernel_r1_fs7_d:
    v_add_u32 v136, 150016, v140
    v_mov_b32 v137, 158208
    ds_read_b128 v[80:83], v137
    ds_read_b128 v[152:155], v136 offset:0
    ds_read_b128 v[156:159], v136 offset:1024
    ds_read_b128 v[160:163], v136 offset:2048
    ds_read_b128 v[164:167], v136 offset:3072
    ds_read_b128 v[168:171], v136 offset:4096
    ds_read_b128 v[172:175], v136 offset:5120
    ds_read_b128 v[176:179], v136 offset:6144
    ds_read_b128 v[180:183], v136 offset:7168
    s_waitcnt lgkmcnt(8)
    v_max3_u32 v138, v80, v81, v82
    v_max_u32 v138, v138, v83
    s_nop 0
    v_readfirstlane_b32 s72, v138
    s_nop 0
    s_lshr_b32 s72, s72, 23
    s_max_u32 s72, s72, 1
    s_min_u32 s72, s72, 252
    s_sub_u32 s73, 253, s72
    s_lshl_b32 s73, s73, 23
    v_mov_b32 v149, s73
    s_add_u32 s72, s72, 1
    s_lshl_b32 s72, s72, 23
    v_mov_b32 v150, s72
    v_mul_f32 v150, s80, v150
    s_waitcnt vmcnt(12)
    s_waitcnt lgkmcnt(7)
    v_mfma_f32_16x16x32_f16 v[80:83], v[152:155], v[48:51], 0
    v_mfma_f32_16x16x32_f16 v[96:99], v[152:155], v[56:59], 0
    s_waitcnt lgkmcnt(5)
    v_mfma_f32_16x16x32_f16 v[84:87], v[160:163], v[48:51], 0
    v_mfma_f32_16x16x32_f16 v[100:103], v[160:163], v[56:59], 0
    v_mfma_f32_16x16x32_f16 v[80:83], v[156:159], v[52:55], v[80:83]
    v_mfma_f32_16x16x32_f16 v[96:99], v[156:159], v[60:63], v[96:99]
    s_waitcnt lgkmcnt(4)
    v_mfma_f32_16x16x32_f16 v[84:87], v[164:167], v[52:55], v[84:87]
    v_mfma_f32_16x16x32_f16 v[100:103], v[164:167], v[60:63], v[100:103]
    s_waitcnt lgkmcnt(3)
    v_mfma_f32_16x16x32_f16 v[80:83], v[168:171], v[56:59], v[80:83]
    v_mfma_f32_16x16x32_f16 v[88:91], v[168:171], v[48:51], 0
    s_waitcnt lgkmcnt(1)
    v_mfma_f32_16x16x32_f16 v[84:87], v[176:179], v[56:59], v[84:87]
    v_mfma_f32_16x16x32_f16 v[92:95], v[176:179], v[48:51], 0
    v_mfma_f32_16x16x32_f16 v[80:83], v[172:175], v[60:63], v[80:83]
    v_mfma_f32_16x16x32_f16 v[88:91], v[172:175], v[52:55], v[88:91]
    s_waitcnt lgkmcnt(0)
    v_mfma_f32_16x16x32_f16 v[84:87], v[180:183], v[60:63], v[84:87]
    v_mfma_f32_16x16x32_f16 v[92:95], v[180:183], v[52:55], v[92:95]
    s_nop 4
    v_sub_f32 v88, v88, v96
    v_sub_f32 v89, v89, v97
    v_sub_f32 v90, v90, v98
    v_sub_f32 v91, v91, v99
    v_sub_f32 v92, v92, v100
    v_sub_f32 v93, v93, v101
    v_sub_f32 v94, v94, v102
    v_sub_f32 v95, v95, v103
    v_mul_f32 v160, v80, v104
    v_mul_f32 v168, v88, v104
    v_fma_f32 v160, v88, v105, v160
    v_fma_f32 v168, -v80, v105, v168
    v_mul_f32 v161, v81, v106
    v_mul_f32 v169, v89, v106
    v_fma_f32 v161, v89, v107, v161
    v_fma_f32 v169, -v81, v107, v169
    v_mul_f32 v162, v82, v108
    v_mul_f32 v170, v90, v108
    v_fma_f32 v162, v90, v109, v162
    v_fma_f32 v170, -v82, v109, v170
    v_mul_f32 v163, v83, v110
    v_mul_f32 v171, v91, v110
    v_fma_f32 v163, v91, v111, v163
    v_fma_f32 v171, -v83, v111, v171
    v_mul_f32 v164, v84, v112
    v_mul_f32 v172, v92, v112
    v_fma_f32 v164, v92, v113, v164
    v_fma_f32 v172, -v84, v113, v172
    v_mul_f32 v165, v85, v114
    v_mul_f32 v173, v93, v114
    v_fma_f32 v165, v93, v115, v165
    v_fma_f32 v173, -v85, v115, v173
    v_mul_f32 v166, v86, v116
    v_mul_f32 v174, v94, v116
    v_fma_f32 v166, v94, v117, v166
    v_fma_f32 v174, -v86, v117, v174
    v_mul_f32 v167, v87, v118
    v_mul_f32 v175, v95, v118
    v_fma_f32 v167, v95, v119, v167
    v_fma_f32 v175, -v87, v119, v175
    v_cvt_pk_f16_f32 v152, v160, v161
    v_cvt_pk_f16_f32 v156, v168, v169
    v_cvt_pk_f16_f32 v153, v162, v163
    v_cvt_pk_f16_f32 v157, v170, v171
    v_cvt_pk_f16_f32 v154, v164, v165
    v_cvt_pk_f16_f32 v158, v172, v173
    v_cvt_pk_f16_f32 v155, v166, v167
    v_cvt_pk_f16_f32 v159, v174, v175
    s_waitcnt vmcnt(8)
    v_mfma_f32_16x16x32_f16 v[80:83], v[64:67], v[152:155], 0
    v_mfma_f32_16x16x32_f16 v[88:91], v[64:67], v[156:159], 0
    v_mfma_f32_16x16x32_f16 v[96:99], v[68:71], v[152:155], 0
    v_mfma_f32_16x16x32_f16 v[84:87], v[72:75], v[152:155], 0
    v_mfma_f32_16x16x32_f16 v[92:95], v[72:75], v[156:159], 0
    v_mfma_f32_16x16x32_f16 v[100:103], v[76:79], v[152:155], 0
    v_mfma_f32_16x16x32_f16 v[80:83], v[68:71], v[156:159], v[80:83]
    v_mfma_f32_16x16x32_f16 v[84:87], v[76:79], v[156:159], v[84:87]
    v_lshlrev_b32 v176, 16, v184
    v_and_b32 v184, 0xffff0000, v184
    v_mul_f32 v176, v176, v149
    v_mul_f32 v184, v184, v149
    v_lshlrev_b32 v177, 16, v185
    v_and_b32 v185, 0xffff0000, v185
    v_mul_f32 v177, v177, v149
    v_mul_f32 v185, v185, v149
    v_lshlrev_b32 v178, 16, v186
    v_and_b32 v186, 0xffff0000, v186
    v_mul_f32 v178, v178, v149
    v_mul_f32 v186, v186, v149
    v_lshlrev_b32 v179, 16, v187
    v_and_b32 v187, 0xffff0000, v187
    v_mul_f32 v179, v179, v149
    v_mul_f32 v187, v187, v149
    v_lshlrev_b32 v180, 16, v188
    v_and_b32 v188, 0xffff0000, v188
    v_mul_f32 v180, v180, v149
    v_mul_f32 v188, v188, v149
    v_lshlrev_b32 v181, 16, v189
    v_and_b32 v189, 0xffff0000, v189
    v_mul_f32 v181, v181, v149
    v_mul_f32 v189, v189, v149
    v_lshlrev_b32 v182, 16, v190
    v_and_b32 v190, 0xffff0000, v190
    v_mul_f32 v182, v182, v149
    v_mul_f32 v190, v190, v149
    v_lshlrev_b32 v183, 16, v191
    v_and_b32 v191, 0xffff0000, v191
    v_mul_f32 v183, v183, v149
    v_mul_f32 v191, v191, v149
    v_sub_f32 v88, v88, v96
    v_sub_f32 v89, v89, v97
    v_sub_f32 v90, v90, v98
    v_sub_f32 v91, v91, v99
    v_sub_f32 v92, v92, v100
    v_sub_f32 v93, v93, v101
    v_sub_f32 v94, v94, v102
    v_sub_f32 v95, v95, v103
    v_mul_f32 v160, v80, v176
    v_mul_f32 v168, v88, v176
    v_fma_f32 v160, -v88, v184, v160
    v_fma_f32 v168, v80, v184, v168
    v_mul_f32 v161, v81, v177
    v_mul_f32 v169, v89, v177
    v_fma_f32 v161, -v89, v185, v161
    v_fma_f32 v169, v81, v185, v169
    v_mul_f32 v162, v82, v178
    v_mul_f32 v170, v90, v178
    v_fma_f32 v162, -v90, v186, v162
    v_fma_f32 v170, v82, v186, v170
    v_mul_f32 v163, v83, v179
    v_mul_f32 v171, v91, v179
    v_fma_f32 v163, -v91, v187, v163
    v_fma_f32 v171, v83, v187, v171
    v_mul_f32 v164, v84, v180
    v_mul_f32 v172, v92, v180
    v_fma_f32 v164, -v92, v188, v164
    v_fma_f32 v172, v84, v188, v172
    v_mul_f32 v165, v85, v181
    v_mul_f32 v173, v93, v181
    v_fma_f32 v165, -v93, v189, v165
    v_fma_f32 v173, v85, v189, v173
    v_mul_f32 v166, v86, v182
    v_mul_f32 v174, v94, v182
    v_fma_f32 v166, -v94, v190, v166
    v_fma_f32 v174, v86, v190, v174
    v_mul_f32 v167, v87, v183
    v_mul_f32 v175, v95, v183
    v_fma_f32 v167, -v95, v191, v167
    v_fma_f32 v175, v87, v191, v175
    v_cvt_pk_f16_f32 v152, v160, v161
    v_cvt_pk_f16_f32 v156, v168, v169
    v_cvt_pk_f16_f32 v153, v162, v163
    v_cvt_pk_f16_f32 v157, v170, v171
    v_cvt_pk_f16_f32 v154, v164, v165
    v_cvt_pk_f16_f32 v158, v172, v173
    v_cvt_pk_f16_f32 v155, v166, v167
    v_cvt_pk_f16_f32 v159, v174, v175
    s_nop 1
    v_mfma_f32_16x16x32_f16 v[80:83], v[156:159], v[64:67], 0
    v_mfma_f32_16x16x32_f16 v[88:91], v[152:155], v[64:67], 0
    v_mfma_f32_16x16x32_f16 v[96:99], v[156:159], v[68:71], 0
    v_mfma_f32_16x16x32_f16 v[84:87], v[156:159], v[72:75], 0
    v_mfma_f32_16x16x32_f16 v[92:95], v[152:155], v[72:75], 0
    v_mfma_f32_16x16x32_f16 v[100:103], v[156:159], v[76:79], 0
    v_mfma_f32_16x16x32_f16 v[80:83], v[152:155], v[68:71], v[80:83]
    v_mfma_f32_16x16x32_f16 v[84:87], v[152:155], v[76:79], v[84:87]
    s_nop 2
    v_sub_f32 v88, v88, v96
    v_sub_f32 v89, v89, v97
    v_sub_f32 v90, v90, v98
    v_sub_f32 v91, v91, v99
    v_sub_f32 v92, v92, v100
    v_sub_f32 v93, v93, v101
    v_sub_f32 v94, v94, v102
    v_sub_f32 v95, v95, v103
    v_mul_f32 v160, v88, v120
    v_mul_f32 v168, v80, v120
    v_fma_f32 v160, -v80, v121, v160
    v_fma_f32 v168, v88, v121, v168
    v_mul_f32 v161, v89, v122
    v_mul_f32 v169, v81, v122
    v_fma_f32 v161, -v81, v123, v161
    v_fma_f32 v169, v89, v123, v169
    v_mul_f32 v162, v90, v124
    v_mul_f32 v170, v82, v124
    v_fma_f32 v162, -v82, v125, v162
    v_fma_f32 v170, v90, v125, v170
    v_mul_f32 v163, v91, v126
    v_mul_f32 v171, v83, v126
    v_fma_f32 v163, -v83, v127, v163
    v_fma_f32 v171, v91, v127, v171
    v_mul_f32 v164, v92, v128
    v_mul_f32 v172, v84, v128
    v_fma_f32 v164, -v84, v129, v164
    v_fma_f32 v172, v92, v129, v172
    v_mul_f32 v165, v93, v130
    v_mul_f32 v173, v85, v130
    v_fma_f32 v165, -v85, v131, v165
    v_fma_f32 v173, v93, v131, v173
    v_mul_f32 v166, v94, v132
    v_mul_f32 v174, v86, v132
    v_fma_f32 v166, -v86, v133, v166
    v_fma_f32 v174, v94, v133, v174
    v_mul_f32 v167, v95, v134
    v_mul_f32 v175, v87, v134
    v_fma_f32 v167, -v87, v135, v167
    v_fma_f32 v175, v95, v135, v175
    v_cvt_pk_f16_f32 v152, v160, v161
    v_cvt_pk_f16_f32 v156, v168, v169
    v_cvt_pk_f16_f32 v153, v162, v163
    v_cvt_pk_f16_f32 v157, v170, v171
    v_cvt_pk_f16_f32 v154, v164, v165
    v_cvt_pk_f16_f32 v158, v172, v173
    v_cvt_pk_f16_f32 v155, v166, v167
    v_cvt_pk_f16_f32 v159, v174, v175
    s_add_u32 s33, s38, 12
    s_mov_b32 s34, 0
    s_add_u32 s33, s33, s42
    s_sub_u32 s35, s33, 18
    s_cselect_b32 s33, s33, s35
    s_lshl_b32 s33, s33, 1
    s_add_u32 s33, s33, s34
    s_mul_i32 s23, s33, 18432
    s_add_u32 s23, s23, s41
    s_lshl_b32 s33, s33, 10
    s_add_u32 s64, s33, s40
    s_add_u32 s30, s23, 0xf54000
    buffer_load_dwordx4 v[48:51], v1, s[12:15], s30 offen offset:0 sc1
    s_add_u32 s31, s23, 0xf58800
    buffer_load_dwordx4 v[52:55], v1, s[12:15], s31 offen offset:0 sc1
    buffer_load_dwordx4 v[56:59], v1, s[12:15], s30 offen offset:1024 sc1
    buffer_load_dwordx4 v[60:63], v1, s[12:15], s31 offen offset:1024 sc1
    s_add_u32 s30, s23, 0xf50000
    buffer_load_dwordx4 v[64:67], v1, s[12:15], s30 offen offset:0 sc1
    s_add_u32 s31, s23, 0xf54800
    buffer_load_dwordx4 v[68:71], v1, s[12:15], s31 offen offset:0 sc1
    buffer_load_dwordx4 v[72:75], v1, s[12:15], s30 offen offset:1024 sc1
    buffer_load_dwordx4 v[76:79], v1, s[12:15], s31 offen offset:1024 sc1
    s_add_u32 s87, s87, 4
    v_mov_b32 v12, 149776
    v_mov_b32 v13, 1
    s_mov_b64 exec, 1
    ds_add_u32 v12, v13
    s_mov_b64 exec, -1
    v_mov_b32 v12, 149776
fused_kernel_r1_fs8:
    ds_read_b32 v13, v12
    s_waitcnt lgkmcnt(0)
    v_readfirstlane_b32 s35, v13
    s_nop 3
    s_cmp_ge_u32 s35, s87
    s_cbranch_scc1 fused_kernel_r1_fs8_d
    s_sleep 1
    s_branch fused_kernel_r1_fs8
fused_kernel_r1_fs8_d:
    ds_write_b64 v143, v[152:153] offset:0
    ds_write_b64 v143, v[154:155] offset:2048
    ds_write_b64 v143, v[156:157] offset:4096
    ds_write_b64 v143, v[158:159] offset:6144
    s_waitcnt lgkmcnt(0)
    s_add_u32 s87, s87, 4
    v_mov_b32 v12, 149776
    v_mov_b32 v13, 1
    s_mov_b64 exec, 1
    ds_add_u32 v12, v13
    s_mov_b64 exec, -1
    v_mov_b32 v12, 149776
fused_kernel_r1_fs9:
    ds_read_b32 v13, v12
    s_waitcnt lgkmcnt(0)
    v_readfirstlane_b32 s35, v13
    s_nop 3
    s_cmp_ge_u32 s35, s87
    s_cbranch_scc1 fused_kernel_r1_fs9_d
    s_sleep 1
    s_branch fused_kernel_r1_fs9
fused_kernel_r1_fs9_d:
    ds_read_b128 v[160:163], v144 offset:0
    ds_read_b128 v[168:171], v144 offset:4096
    ds_read_b128 v[164:167], v144 offset:1024
    ds_read_b128 v[172:175], v144 offset:5120
    s_waitcnt vmcnt(8)
    s_waitcnt lgkmcnt(3)
    v_mfma_f32_16x16x32_f16 v[88:91], v[16:19], v[160:163], 0
    v_mfma_f32_16x16x32_f16 v[80:83], v[24:27], v[160:163], 0
    v_mfma_f32_16x16x32_f16 v[92:95], v[32:35], v[160:163], 0
    v_mfma_f32_16x16x32_f16 v[84:87], v[40:43], v[160:163], 0
    s_waitcnt lgkmcnt(2)
    v_mfma_f32_16x16x32_f16 v[96:99], v[24:27], v[168:171], 0
    v_mfma_f32_16x16x32_f16 v[80:83], v[16:19], v[168:171], v[80:83]
    v_mfma_f32_16x16x32_f16 v[100:103], v[40:43], v[168:171], 0
    v_mfma_f32_16x16x32_f16 v[84:87], v[32:35], v[168:171], v[84:87]
    s_waitcnt lgkmcnt(1)
    v_mfma_f32_16x16x32_f16 v[88:91], v[20:23], v[164:167], v[88:91]
    v_mfma_f32_16x16x32_f16 v[80:83], v[28:31], v[164:167], v[80:83]
    v_mfma_f32_16x16x32_f16 v[92:95], v[36:39], v[164:167], v[92:95]
    v_mfma_f32_16x16x32_f16 v[84:87], v[44:47], v[164:167], v[84:87]
    s_waitcnt lgkmcnt(0)
    v_mfma_f32_16x16x32_f16 v[96:99], v[28:31], v[172:175], v[96:99]
    v_mfma_f32_16x16x32_f16 v[80:83], v[20:23], v[172:175], v[80:83]
    v_mfma_f32_16x16x32_f16 v[100:103], v[44:47], v[172:175], v[100:103]
    v_mfma_f32_16x16x32_f16 v[84:87], v[36:39], v[172:175], v[84:87]
    s_nop 4
    v_sub_f32 v88, v88, v96
    v_sub_f32 v89, v89, v97
    v_sub_f32 v90, v90, v98
    v_sub_f32 v91, v91, v99
    v_sub_f32 v92, v92, v100
    v_sub_f32 v93, v93, v101
    v_sub_f32 v94, v94, v102
    v_sub_f32 v95, v95, v103
    v_mul_f32 v88, v88, v150
    v_mul_f32 v80, v80, v150
    v_mul_f32 v89, v89, v150
    v_mul_f32 v81, v81, v150
    v_mul_f32 v90, v90, v150
    v_mul_f32 v82, v82, v150
    v_mul_f32 v91, v91, v150
    v_mul_f32 v83, v83, v150
    v_mul_f32 v92, v92, v150
    v_mul_f32 v84, v84, v150
    v_mul_f32 v93, v93, v150
    v_mul_f32 v85, v85, v150
    v_mul_f32 v94, v94, v150
    v_mul_f32 v86, v86, v150
    v_mul_f32 v95, v95, v150
    v_mul_f32 v87, v87, v150
    v_cvt_pk_bf16_f32 v152, v88, v89
    v_cvt_pk_bf16_f32 v156, v80, v81
    v_cvt_pk_bf16_f32 v153, v90, v91
    v_cvt_pk_bf16_f32 v157, v82, v83
    v_cvt_pk_bf16_f32 v154, v92, v93
    v_cvt_pk_bf16_f32 v158, v84, v85
    v_cvt_pk_bf16_f32 v155, v94, v95
    v_cvt_pk_bf16_f32 v159, v86, v87
    buffer_store_dwordx4 v[152:155], v145, s[12:15], s78 offen sc1
    buffer_store_dwordx4 v[156:159], v145, s[12:15], s79 offen sc1
fused_kernel_r1_f2:
    s_setprio 1
    s_nop 1
    buffer_load_dwordx4 v[16:19], v1, s[12:15], s30 offen offset:2048 sc1
    buffer_load_dwordx4 v[20:23], v1, s[12:15], s31 offen offset:2048 sc1
    buffer_load_dwordx4 v[24:27], v1, s[12:15], s30 offen offset:3072 sc1
    buffer_load_dwordx4 v[28:31], v1, s[12:15], s31 offen offset:3072 sc1
    s_add_u32 s30, s23, 0xf51000
    buffer_load_dwordx4 v[32:35], v1, s[12:15], s30 offen offset:0 sc1
    s_add_u32 s31, s23, 0xf55800
    buffer_load_dwordx4 v[36:39], v1, s[12:15], s31 offen offset:0 sc1
    v_mov_b32 v12, 149808
fused_kernel_r1_pg2:
    ds_read_b32 v13, v12
    s_waitcnt lgkmcnt(0)
    v_readfirstlane_b32 s35, v13
    s_nop 3
    s_cmp_ge_u32 s35, 4
    s_cbranch_scc1 fused_kernel_r1_pg2_d
    s_sleep 1
    s_branch fused_kernel_r1_pg2
fused_kernel_r1_pg2_d:
    ds_read_b128 v[80:83], v2 offset:16384
    ds_read_b128 v[84:87], v2 offset:34816
    ds_read_b128 v[88:91], v2 offset:53248
    ds_read_b128 v[92:95], v8 offset:6144
    ds_read_b128 v[96:99], v2 offset:17408
    ds_read_b128 v[100:103], v2 offset:35840
    ds_read_b128 v[104:107], v2 offset:54272
    ds_read_b128 v[108:111], v8 offset:7168
    v_mov_b32 v12, 149800
fused_kernel_r1_pg0:
    ds_read_b32 v13, v12
    s_waitcnt lgkmcnt(0)
    v_readfirstlane_b32 s35, v13
    s_nop 3
    s_cmp_ge_u32 s35, 4
    s_cbranch_scc1 fused_kernel_r1_pg0_d
    s_sleep 1
    s_branch fused_kernel_r1_pg0
fused_kernel_r1_pg0_d:
    s_waitcnt vmcnt(15)
    v_mfma_f32_16x16x32_bf16 v[112:115], v[48:51], v[80:83], 0
    s_waitcnt vmcnt(13)
    v_mfma_f32_16x16x32_bf16 v[112:115], v[56:59], v[96:99], v[112:115]
    v_mfma_f32_16x16x32_bf16 v[128:131], v[52:55], v[80:83], 0
    s_waitcnt vmcnt(12)
    v_mfma_f32_16x16x32_bf16 v[128:131], v[60:63], v[96:99], v[128:131]
    ds_read_b128 v[80:83], v2 offset:0
    ds_read_b128 v[96:99], v2 offset:1024
    v_mfma_f32_16x16x32_bf16 v[116:119], v[48:51], v[84:87], 0
    v_mfma_f32_16x16x32_bf16 v[116:119], v[56:59], v[100:103], v[116:119]
    v_mfma_f32_16x16x32_bf16 v[132:135], v[52:55], v[84:87], 0
    v_mfma_f32_16x16x32_bf16 v[132:135], v[60:63], v[100:103], v[132:135]
    ds_read_b128 v[84:87], v2 offset:18432
    ds_read_b128 v[100:103], v2 offset:19456
    v_mfma_f32_16x16x32_bf16 v[120:123], v[48:51], v[88:91], 0
    v_mfma_f32_16x16x32_bf16 v[120:123], v[56:59], v[104:107], v[120:123]
    v_mfma_f32_16x16x32_bf16 v[136:139], v[52:55], v[88:91], 0
    v_mfma_f32_16x16x32_bf16 v[136:139], v[60:63], v[104:107], v[136:139]
    ds_read_b128 v[88:91], v2 offset:36864
    ds_read_b128 v[104:107], v2 offset:37888
    v_mfma_f32_16x16x32_bf16 v[124:127], v[48:51], v[92:95], 0
    v_mfma_f32_16x16x32_bf16 v[124:127], v[56:59], v[108:111], v[124:127]
    v_mfma_f32_16x16x32_bf16 v[140:143], v[52:55], v[92:95], 0
    v_mfma_f32_16x16x32_bf16 v[140:143], v[60:63], v[108:111], v[140:143]
    ds_read_b128 v[92:95], v2 offset:55296
    ds_read_b128 v[108:111], v2 offset:56320
    buffer_load_dwordx4 v[40:43], v1, s[12:15], s30 offen offset:1024 sc1
    buffer_load_dwordx4 v[44:47], v1, s[12:15], s31 offen offset:1024 sc1
    buffer_load_dwordx4 v[48:51], v1, s[12:15], s30 offen offset:2048 sc1
    buffer_load_dwordx4 v[52:55], v1, s[12:15], s31 offen offset:2048 sc1
    s_waitcnt vmcnt(15) lgkmcnt(7)
    v_mfma_f32_16x16x32_bf16 v[112:115], v[64:67], v[80:83], v[112:115]
    s_waitcnt vmcnt(13) lgkmcnt(6)
    v_mfma_f32_16x16x32_bf16 v[112:115], v[72:75], v[96:99], v[112:115]
    v_mfma_f32_16x16x32_bf16 v[128:131], v[68:71], v[80:83], v[128:131]
    s_waitcnt vmcnt(12)
    v_mfma_f32_16x16x32_bf16 v[128:131], v[76:79], v[96:99], v[128:131]
    ds_read_b128 v[80:83], v2 offset:2048
    ds_read_b128 v[96:99], v2 offset:3072
    s_waitcnt lgkmcnt(7)
    v_mfma_f32_16x16x32_bf16 v[116:119], v[64:67], v[84:87], v[116:119]
    s_waitcnt lgkmcnt(6)
    v_mfma_f32_16x16x32_bf16 v[116:119], v[72:75], v[100:103], v[116:119]
    v_mfma_f32_16x16x32_bf16 v[132:135], v[68:71], v[84:87], v[132:135]
    v_mfma_f32_16x16x32_bf16 v[132:135], v[76:79], v[100:103], v[132:135]
    ds_read_b128 v[84:87], v2 offset:20480
    ds_read_b128 v[100:103], v2 offset:21504
    s_waitcnt lgkmcnt(7)
    v_mfma_f32_16x16x32_bf16 v[120:123], v[64:67], v[88:91], v[120:123]
    s_waitcnt lgkmcnt(6)
    v_mfma_f32_16x16x32_bf16 v[120:123], v[72:75], v[104:107], v[120:123]
    v_mfma_f32_16x16x32_bf16 v[136:139], v[68:71], v[88:91], v[136:139]
    v_mfma_f32_16x16x32_bf16 v[136:139], v[76:79], v[104:107], v[136:139]
    ds_read_b128 v[88:91], v2 offset:38912
    ds_read_b128 v[104:107], v2 offset:39936
    s_waitcnt lgkmcnt(7)
    v_mfma_f32_16x16x32_bf16 v[124:127], v[64:67], v[92:95], v[124:127]
    s_waitcnt lgkmcnt(6)
    v_mfma_f32_16x16x32_bf16 v[124:127], v[72:75], v[108:111], v[124:127]
    v_mfma_f32_16x16x32_bf16 v[140:143], v[68:71], v[92:95], v[140:143]
    v_mfma_f32_16x16x32_bf16 v[140:143], v[76:79], v[108:111], v[140:143]
    ds_read_b128 v[92:95], v2 offset:57344
    ds_read_b128 v[108:111], v2 offset:58368
    buffer_load_dwordx4 v[56:59], v1, s[12:15], s30 offen offset:3072 sc1
    buffer_load_dwordx4 v[60:63], v1, s[12:15], s31 offen offset:3072 sc1
    s_add_u32 s30, s23, 0xf53000
    buffer_load_dwordx4 v[64:67], v1, s[12:15], s30 offen offset:0 sc1
    s_add_u32 s31, s23, 0xf57800
    buffer_load_dwordx4 v[68:71], v1, s[12:15], s31 offen offset:0 sc1
    v_mov_b32 v12, 149812
fused_kernel_r1_pg3:
    ds_read_b32 v13, v12
    s_waitcnt lgkmcnt(0)
    v_readfirstlane_b32 s35, v13
    s_nop 3
    s_cmp_ge_u32 s35, 4
    s_cbranch_scc1 fused_kernel_r1_pg3_d
    s_sleep 1
    s_branch fused_kernel_r1_pg3
fused_kernel_r1_pg3_d:
    s_waitcnt vmcnt(13)
    v_mfma_f32_16x16x32_bf16 v[112:115], v[16:19], v[80:83], v[112:115]
    s_waitcnt vmcnt(11)
    v_mfma_f32_16x16x32_bf16 v[112:115], v[24:27], v[96:99], v[112:115]
    v_mfma_f32_16x16x32_bf16 v[128:131], v[20:23], v[80:83], v[128:131]
    s_waitcnt vmcnt(10)
    v_mfma_f32_16x16x32_bf16 v[128:131], v[28:31], v[96:99], v[128:131]
    ds_read_b128 v[80:83], v2 offset:4096
    ds_read_b128 v[96:99], v2 offset:5120
    v_mfma_f32_16x16x32_bf16 v[116:119], v[16:19], v[84:87], v[116:119]
    v_mfma_f32_16x16x32_bf16 v[116:119], v[24:27], v[100:103], v[116:119]
    v_mfma_f32_16x16x32_bf16 v[132:135], v[20:23], v[84:87], v[132:135]
    v_mfma_f32_16x16x32_bf16 v[132:135], v[28:31], v[100:103], v[132:135]
    ds_read_b128 v[84:87], v2 offset:22528
    ds_read_b128 v[100:103], v2 offset:23552
    v_mfma_f32_16x16x32_bf16 v[120:123], v[16:19], v[88:91], v[120:123]
    v_mfma_f32_16x16x32_bf16 v[120:123], v[24:27], v[104:107], v[120:123]
    v_mfma_f32_16x16x32_bf16 v[136:139], v[20:23], v[88:91], v[136:139]
    v_mfma_f32_16x16x32_bf16 v[136:139], v[28:31], v[104:107], v[136:139]
    ds_read_b128 v[88:91], v2 offset:40960
    ds_read_b128 v[104:107], v2 offset:41984
    v_mfma_f32_16x16x32_bf16 v[124:127], v[16:19], v[92:95], v[124:127]
    v_mfma_f32_16x16x32_bf16 v[124:127], v[24:27], v[108:111], v[124:127]
    v_mfma_f32_16x16x32_bf16 v[140:143], v[20:23], v[92:95], v[140:143]
    v_mfma_f32_16x16x32_bf16 v[140:143], v[28:31], v[108:111], v[140:143]
    ds_read_b128 v[92:95], v2 offset:59392
    ds_read_b128 v[108:111], v2 offset:60416
    buffer_load_dwordx4 v[72:75], v1, s[12:15], s30 offen offset:1024 sc1
    buffer_load_dwordx4 v[76:79], v1, s[12:15], s31 offen offset:1024 sc1
    buffer_load_dwordx4 v[16:19], v1, s[12:15], s30 offen offset:2048 sc1
    buffer_load_dwordx4 v[20:23], v1, s[12:15], s31 offen offset:2048 sc1
    v_mov_b32 v12, 149780
    v_mov_b32 v13, 1
    s_mov_b64 exec, 1
    ds_add_rtn_u32 v13, v12, v13
    s_waitcnt lgkmcnt(0)
    v_readfirstlane_b32 s35, v13
    s_mov_b64 exec, -1
    s_nop 1
    s_cmp_lg_u32 s35, 3
    s_cbranch_scc1 fused_kernel_r1_g3
    s_lshl_b32 s33, s2, 3
    s_add_u32 s33, s33, 0xa22000
    v_mov_b32 v12, s100
    v_mov_b32 v13, s101
    s_mov_b64 exec, 1
    buffer_store_dwordx2 v[12:13], v1, s[12:15], s33 offen sc1
    s_mov_b64 exec, -1
    s_cmp_lt_u32 s2, 223
    s_cbranch_scc1 fused_kernel_r1_g3
    s_add_u32 s33, s33, 264
    v_mov_b32 v12, s100
    v_mov_b32 v13, s101
    s_mov_b64 exec, 1
    buffer_store_dwordx2 v[12:13], v1, s[12:15], s33 offen sc1
    s_mov_b64 exec, -1
fused_kernel_r1_g3:
    s_waitcnt vmcnt(13) lgkmcnt(7)
    v_mfma_f32_16x16x32_bf16 v[112:115], v[32:35], v[80:83], v[112:115]
    s_waitcnt vmcnt(11) lgkmcnt(6)
    v_mfma_f32_16x16x32_bf16 v[112:115], v[40:43], v[96:99], v[112:115]
    v_mfma_f32_16x16x32_bf16 v[128:131], v[36:39], v[80:83], v[128:131]
    s_waitcnt vmcnt(10)
    v_mfma_f32_16x16x32_bf16 v[128:131], v[44:47], v[96:99], v[128:131]
    ds_read_b128 v[80:83], v2 offset:6144
    ds_read_b128 v[96:99], v2 offset:7168
    s_waitcnt lgkmcnt(7)
    v_mfma_f32_16x16x32_bf16 v[116:119], v[32:35], v[84:87], v[116:119]
    s_waitcnt lgkmcnt(6)
    v_mfma_f32_16x16x32_bf16 v[116:119], v[40:43], v[100:103], v[116:119]
    v_mfma_f32_16x16x32_bf16 v[132:135], v[36:39], v[84:87], v[132:135]
    v_mfma_f32_16x16x32_bf16 v[132:135], v[44:47], v[100:103], v[132:135]
    ds_read_b128 v[84:87], v2 offset:24576
    ds_read_b128 v[100:103], v2 offset:25600
    s_waitcnt lgkmcnt(7)
    v_mfma_f32_16x16x32_bf16 v[120:123], v[32:35], v[88:91], v[120:123]
    s_waitcnt lgkmcnt(6)
    v_mfma_f32_16x16x32_bf16 v[120:123], v[40:43], v[104:107], v[120:123]
    v_mfma_f32_16x16x32_bf16 v[136:139], v[36:39], v[88:91], v[136:139]
    v_mfma_f32_16x16x32_bf16 v[136:139], v[44:47], v[104:107], v[136:139]
    ds_read_b128 v[88:91], v2 offset:43008
    ds_read_b128 v[104:107], v2 offset:44032
    s_waitcnt lgkmcnt(7)
    v_mfma_f32_16x16x32_bf16 v[124:127], v[32:35], v[92:95], v[124:127]
    s_waitcnt lgkmcnt(6)
    v_mfma_f32_16x16x32_bf16 v[124:127], v[40:43], v[108:111], v[124:127]
    v_mfma_f32_16x16x32_bf16 v[140:143], v[36:39], v[92:95], v[140:143]
    v_mfma_f32_16x16x32_bf16 v[140:143], v[44:47], v[108:111], v[140:143]
    ds_read_b128 v[92:95], v2 offset:61440
    ds_read_b128 v[108:111], v2 offset:62464
    buffer_load_dwordx4 v[24:27], v1, s[12:15], s30 offen offset:3072 sc1
    buffer_load_dwordx4 v[28:31], v1, s[12:15], s31 offen offset:3072 sc1
    s_add_u32 s30, s23, 0xf52000
    buffer_load_dwordx4 v[32:35], v1, s[12:15], s30 offen offset:0 sc1
    s_add_u32 s31, s23, 0xf56800
    buffer_load_dwordx4 v[36:39], v1, s[12:15], s31 offen offset:0 sc1
    v_mov_b32 v12, 149816
fused_kernel_r1_pg4:
    ds_read_b32 v13, v12
    s_waitcnt lgkmcnt(0)
    v_readfirstlane_b32 s35, v13
    s_nop 3
    s_cmp_ge_u32 s35, 4
    s_cbranch_scc1 fused_kernel_r1_pg4_d
    s_sleep 1
    s_branch fused_kernel_r1_pg4
fused_kernel_r1_pg4_d:
    s_waitcnt vmcnt(13)
    v_mfma_f32_16x16x32_bf16 v[112:115], v[48:51], v[80:83], v[112:115]
    s_waitcnt vmcnt(11)
    v_mfma_f32_16x16x32_bf16 v[112:115], v[56:59], v[96:99], v[112:115]
    v_mfma_f32_16x16x32_bf16 v[128:131], v[52:55], v[80:83], v[128:131]
    s_waitcnt vmcnt(10)
    v_mfma_f32_16x16x32_bf16 v[128:131], v[60:63], v[96:99], v[128:131]
    ds_read_b128 v[80:83], v2 offset:12288
    ds_read_b128 v[96:99], v2 offset:13312
    v_mfma_f32_16x16x32_bf16 v[116:119], v[48:51], v[84:87], v[116:119]
    v_mfma_f32_16x16x32_bf16 v[116:119], v[56:59], v[100:103], v[116:119]
    v_mfma_f32_16x16x32_bf16 v[132:135], v[52:55], v[84:87], v[132:135]
    v_mfma_f32_16x16x32_bf16 v[132:135], v[60:63], v[100:103], v[132:135]
    ds_read_b128 v[84:87], v2 offset:30720
    ds_read_b128 v[100:103], v2 offset:31744
    v_mfma_f32_16x16x32_bf16 v[120:123], v[48:51], v[88:91], v[120:123]
    v_mfma_f32_16x16x32_bf16 v[120:123], v[56:59], v[104:107], v[120:123]
    v_mfma_f32_16x16x32_bf16 v[136:139], v[52:55], v[88:91], v[136:139]
    v_mfma_f32_16x16x32_bf16 v[136:139], v[60:63], v[104:107], v[136:139]
    ds_read_b128 v[88:91], v2 offset:49152
    ds_read_b128 v[104:107], v2 offset:50176
    v_mfma_f32_16x16x32_bf16 v[124:127], v[48:51], v[92:95], v[124:127]
    v_mfma_f32_16x16x32_bf16 v[124:127], v[56:59], v[108:111], v[124:127]
    v_mfma_f32_16x16x32_bf16 v[140:143], v[52:55], v[92:95], v[140:143]
    v_mfma_f32_16x16x32_bf16 v[140:143], v[60:63], v[108:111], v[140:143]
    ds_read_b128 v[92:95], v8 offset:2048
    ds_read_b128 v[108:111], v8 offset:3072
    buffer_load_dwordx4 v[40:43], v1, s[12:15], s30 offen offset:1024 sc1
    buffer_load_dwordx4 v[44:47], v1, s[12:15], s31 offen offset:1024 sc1
    buffer_load_dwordx4 v[48:51], v1, s[12:15], s30 offen offset:2048 sc1
    buffer_load_dwordx4 v[52:55], v1, s[12:15], s31 offen offset:2048 sc1
    s_waitcnt vmcnt(13) lgkmcnt(7)
    v_mfma_f32_16x16x32_bf16 v[112:115], v[64:67], v[80:83], v[112:115]
    s_waitcnt vmcnt(11) lgkmcnt(6)
    v_mfma_f32_16x16x32_bf16 v[112:115], v[72:75], v[96:99], v[112:115]
    v_mfma_f32_16x16x32_bf16 v[128:131], v[68:71], v[80:83], v[128:131]
    s_waitcnt vmcnt(10)
    v_mfma_f32_16x16x32_bf16 v[128:131], v[76:79], v[96:99], v[128:131]
    ds_read_b128 v[80:83], v2 offset:14336
    ds_read_b128 v[96:99], v2 offset:15360
    s_waitcnt lgkmcnt(7)
    v_mfma_f32_16x16x32_bf16 v[116:119], v[64:67], v[84:87], v[116:119]
    s_waitcnt lgkmcnt(6)
    v_mfma_f32_16x16x32_bf16 v[116:119], v[72:75], v[100:103], v[116:119]
    v_mfma_f32_16x16x32_bf16 v[132:135], v[68:71], v[84:87], v[132:135]
    v_mfma_f32_16x16x32_bf16 v[132:135], v[76:79], v[100:103], v[132:135]
    ds_read_b128 v[84:87], v2 offset:32768
    ds_read_b128 v[100:103], v2 offset:33792
    s_waitcnt lgkmcnt(7)
    v_mfma_f32_16x16x32_bf16 v[120:123], v[64:67], v[88:91], v[120:123]
    s_waitcnt lgkmcnt(6)
    v_mfma_f32_16x16x32_bf16 v[120:123], v[72:75], v[104:107], v[120:123]
    v_mfma_f32_16x16x32_bf16 v[136:139], v[68:71], v[88:91], v[136:139]
    v_mfma_f32_16x16x32_bf16 v[136:139], v[76:79], v[104:107], v[136:139]
    ds_read_b128 v[88:91], v2 offset:51200
    ds_read_b128 v[104:107], v2 offset:52224
    s_waitcnt lgkmcnt(7)
    v_mfma_f32_16x16x32_bf16 v[124:127], v[64:67], v[92:95], v[124:127]
    s_waitcnt lgkmcnt(6)
    v_mfma_f32_16x16x32_bf16 v[124:127], v[72:75], v[108:111], v[124:127]
    v_mfma_f32_16x16x32_bf16 v[140:143], v[68:71], v[92:95], v[140:143]
    v_mfma_f32_16x16x32_bf16 v[140:143], v[76:79], v[108:111], v[140:143]
    ds_read_b128 v[92:95], v8 offset:4096
    ds_read_b128 v[108:111], v8 offset:5120
    buffer_load_dwordx4 v[56:59], v1, s[12:15], s30 offen offset:3072 sc1
    buffer_load_dwordx4 v[60:63], v1, s[12:15], s31 offen offset:3072 sc1
    s_lshr_b32 s33, s38, 1
    s_add_u32 s33, s33, 16
    s_and_b32 s34, s38, 1
    s_add_u32 s33, s33, s42
    s_sub_u32 s35, s33, 18
    s_cselect_b32 s33, s33, s35
    s_lshl_b32 s33, s33, 1
    s_add_u32 s33, s33, s34
    s_mul_i32 s23, s33, 18432
    s_add_u32 s23, s23, s41
    s_lshl_b32 s33, s33, 10
    s_add_u32 s65, s33, s40
    s_add_u32 s30, s23, 0xf54000
    buffer_load_dwordx4 v[64:67], v1, s[12:15], s30 offen offset:0 sc1
    v_mov_b32 v12, 149804
fused_kernel_r1_pg1:
    ds_read_b32 v13, v12
    s_waitcnt lgkmcnt(0)
    v_readfirstlane_b32 s35, v13
    s_nop 3
    s_cmp_ge_u32 s35, 4
    s_cbranch_scc1 fused_kernel_r1_pg1_d
    s_sleep 1
    s_branch fused_kernel_r1_pg1
fused_kernel_r1_pg1_d:
    s_waitcnt vmcnt(12)
    v_mfma_f32_16x16x32_bf16 v[112:115], v[16:19], v[80:83], v[112:115]
    s_waitcnt vmcnt(10)
    v_mfma_f32_16x16x32_bf16 v[112:115], v[24:27], v[96:99], v[112:115]
    v_mfma_f32_16x16x32_bf16 v[128:131], v[20:23], v[80:83], v[128:131]
    s_waitcnt vmcnt(9)
    v_mfma_f32_16x16x32_bf16 v[128:131], v[28:31], v[96:99], v[128:131]
    ds_read_b128 v[80:83], v2 offset:8192
    ds_read_b128 v[96:99], v2 offset:9216
    v_mfma_f32_16x16x32_bf16 v[116:119], v[16:19], v[84:87], v[116:119]
    v_mfma_f32_16x16x32_bf16 v[116:119], v[24:27], v[100:103], v[116:119]
    v_mfma_f32_16x16x32_bf16 v[132:135], v[20:23], v[84:87], v[132:135]
    v_mfma_f32_16x16x32_bf16 v[132:135], v[28:31], v[100:103], v[132:135]
    ds_read_b128 v[84:87], v2 offset:26624
    ds_read_b128 v[100:103], v2 offset:27648
    v_mfma_f32_16x16x32_bf16 v[120:123], v[16:19], v[88:91], v[120:123]
    v_mfma_f32_16x16x32_bf16 v[120:123], v[24:27], v[104:107], v[120:123]
    v_mfma_f32_16x16x32_bf16 v[136:139], v[20:23], v[88:91], v[136:139]
    v_mfma_f32_16x16x32_bf16 v[136:139], v[28:31], v[104:107], v[136:139]
    ds_read_b128 v[88:91], v2 offset:45056
    ds_read_b128 v[104:107], v2 offset:46080
    v_mfma_f32_16x16x32_bf16 v[124:127], v[16:19], v[92:95], v[124:127]
    v_mfma_f32_16x16x32_bf16 v[124:127], v[24:27], v[108:111], v[124:127]
    v_mfma_f32_16x16x32_bf16 v[140:143], v[20:23], v[92:95], v[140:143]
    v_mfma_f32_16x16x32_bf16 v[140:143], v[28:31], v[108:111], v[140:143]
    ds_read_b128 v[92:95], v2 offset:63488
    ds_read_b128 v[108:111], v2 offset:64512
    buffer_load_dwordx4 v[72:75], v1, s[12:15], s30 offen offset:1024 sc1
    s_add_u32 s30, s23, 0xf50000
    buffer_load_dwordx4 v[16:19], v1, s[12:15], s30 offen offset:0 sc1
    s_waitcnt vmcnt(10) lgkmcnt(7)
    v_mfma_f32_16x16x32_bf16 v[112:115], v[32:35], v[80:83], v[112:115]
    s_waitcnt vmcnt(8) lgkmcnt(6)
    v_mfma_f32_16x16x32_bf16 v[112:115], v[40:43], v[96:99], v[112:115]
    v_mfma_f32_16x16x32_bf16 v[128:131], v[36:39], v[80:83], v[128:131]
    s_waitcnt vmcnt(7)
    v_mfma_f32_16x16x32_bf16 v[128:131], v[44:47], v[96:99], v[128:131]
    ds_read_b128 v[80:83], v2 offset:10240
    ds_read_b128 v[96:99], v2 offset:11264
    s_waitcnt lgkmcnt(7)
    v_mfma_f32_16x16x32_bf16 v[116:119], v[32:35], v[84:87], v[116:119]
    s_waitcnt lgkmcnt(6)
    v_mfma_f32_16x16x32_bf16 v[116:119], v[40:43], v[100:103], v[116:119]
    v_mfma_f32_16x16x32_bf16 v[132:135], v[36:39], v[84:87], v[132:135]
    v_mfma_f32_16x16x32_bf16 v[132:135], v[44:47], v[100:103], v[132:135]
    ds_read_b128 v[84:87], v2 offset:28672
    ds_read_b128 v[100:103], v2 offset:29696
    s_waitcnt lgkmcnt(7)
    v_mfma_f32_16x16x32_bf16 v[120:123], v[32:35], v[88:91], v[120:123]
    s_waitcnt lgkmcnt(6)
    v_mfma_f32_16x16x32_bf16 v[120:123], v[40:43], v[104:107], v[120:123]
    v_mfma_f32_16x16x32_bf16 v[136:139], v[36:39], v[88:91], v[136:139]
    v_mfma_f32_16x16x32_bf16 v[136:139], v[44:47], v[104:107], v[136:139]
    ds_read_b128 v[88:91], v2 offset:47104
    ds_read_b128 v[104:107], v2 offset:48128
    s_waitcnt lgkmcnt(7)
    v_mfma_f32_16x16x32_bf16 v[124:127], v[32:35], v[92:95], v[124:127]
    s_waitcnt lgkmcnt(6)
    v_mfma_f32_16x16x32_bf16 v[124:127], v[40:43], v[108:111], v[124:127]
    v_mfma_f32_16x16x32_bf16 v[140:143], v[36:39], v[92:95], v[140:143]
    v_mfma_f32_16x16x32_bf16 v[140:143], v[44:47], v[108:111], v[140:143]
    ds_read_b128 v[92:95], v8 offset:0
    ds_read_b128 v[108:111], v8 offset:1024
    buffer_load_dwordx4 v[24:27], v1, s[12:15], s30 offen offset:1024 sc1
    buffer_load_dwordx4 v[32:35], v1, s[12:15], s30 offen offset:2048 sc1
    s_waitcnt vmcnt(8) lgkmcnt(7)
    v_mfma_f32_16x16x32_bf16 v[112:115], v[48:51], v[80:83], v[112:115]
    s_waitcnt vmcnt(6) lgkmcnt(6)
    v_mfma_f32_16x16x32_bf16 v[112:115], v[56:59], v[96:99], v[112:115]
    v_mfma_f32_16x16x32_bf16 v[128:131], v[52:55], v[80:83], v[128:131]
    s_waitcnt vmcnt(5)
    v_mfma_f32_16x16x32_bf16 v[128:131], v[60:63], v[96:99], v[128:131]
    ds_read_b128 v[80:83], v2 offset:16384
    ds_read_b128 v[96:99], v2 offset:17408
    s_waitcnt lgkmcnt(7)
    v_mfma_f32_16x16x32_bf16 v[116:119], v[48:51], v[84:87], v[116:119]
    s_waitcnt lgkmcnt(6)
    v_mfma_f32_16x16x32_bf16 v[116:119], v[56:59], v[100:103], v[116:119]
    v_mfma_f32_16x16x32_bf16 v[132:135], v[52:55], v[84:87], v[132:135]
    v_mfma_f32_16x16x32_bf16 v[132:135], v[60:63], v[100:103], v[132:135]
    ds_read_b128 v[84:87], v2 offset:34816
    ds_read_b128 v[100:103], v2 offset:35840
    s_waitcnt lgkmcnt(7)
    v_mfma_f32_16x16x32_bf16 v[120:123], v[48:51], v[88:91], v[120:123]
    s_waitcnt lgkmcnt(6)
    v_mfma_f32_16x16x32_bf16 v[120:123], v[56:59], v[104:107], v[120:123]
    v_mfma_f32_16x16x32_bf16 v[136:139], v[52:55], v[88:91], v[136:139]
    v_mfma_f32_16x16x32_bf16 v[136:139], v[60:63], v[104:107], v[136:139]
    ds_read_b128 v[88:91], v2 offset:53248
    ds_read_b128 v[104:107], v2 offset:54272
    s_waitcnt lgkmcnt(7)
    v_mfma_f32_16x16x32_bf16 v[124:127], v[48:51], v[92:95], v[124:127]
    s_waitcnt lgkmcnt(6)
    v_mfma_f32_16x16x32_bf16 v[124:127], v[56:59], v[108:111], v[124:127]
    v_mfma_f32_16x16x32_bf16 v[140:143], v[52:55], v[92:95], v[140:143]
    v_mfma_f32_16x16x32_bf16 v[140:143], v[60:63], v[108:111], v[140:143]
    ds_read_b128 v[92:95], v8 offset:6144
    ds_read_b128 v[108:111], v8 offset:7168
    buffer_load_dwordx4 v[40:43], v1, s[12:15], s30 offen offset:3072 sc1
    s_add_u32 s30, s23, 0xf51000
    buffer_load_dwordx4 v[48:51], v1, s[12:15], s30 offen offset:0 sc1
    v_cvt_pk_bf16_f32 v204, v112, v113
    v_cvt_pk_bf16_f32 v205, v114, v115
    v_cvt_pk_bf16_f32 v206, v116, v117
    v_cvt_pk_bf16_f32 v207, v118, v119
    s_add_u32 s34, s64, 0
    buffer_store_dwordx4 v[204:207], v1, s[12:15], s34 offen offset:0 sc1
    v_cvt_pk_bf16_f32 v208, v120, v121
    v_cvt_pk_bf16_f32 v209, v122, v123
    v_cvt_pk_bf16_f32 v210, v124, v125
    v_cvt_pk_bf16_f32 v211, v126, v127
    s_add_u32 s34, s64, 36864
    buffer_store_dwordx4 v[208:211], v1, s[12:15], s34 offen offset:0 sc1
    v_cvt_pk_bf16_f32 v204, v128, v129
    v_cvt_pk_bf16_f32 v205, v130, v131
    v_cvt_pk_bf16_f32 v206, v132, v133
    v_cvt_pk_bf16_f32 v207, v134, v135
    s_add_u32 s34, s64, 0
    buffer_store_dwordx4 v[204:207], v1, s[12:15], s34 offen offset:1024 sc1
    v_cvt_pk_bf16_f32 v208, v136, v137
    v_cvt_pk_bf16_f32 v209, v138, v139
    v_cvt_pk_bf16_f32 v210, v140, v141
    v_cvt_pk_bf16_f32 v211, v142, v143
    s_add_u32 s34, s64, 36864
    buffer_store_dwordx4 v[208:211], v1, s[12:15], s34 offen offset:1024 sc1
    s_cmp_ge_u32 s2, 223
    s_cbranch_scc0 fused_kernel_r1_opt
    s_waitcnt vmcnt(4) lgkmcnt(0)
    s_branch fused_kernel_e1start
fused_kernel_r1_opt:
    s_waitcnt vmcnt(10) lgkmcnt(7)
    v_mfma_f32_16x16x32_bf16 v[144:147], v[64:67], v[80:83], 0
    s_waitcnt vmcnt(9) lgkmcnt(6)
    v_mfma_f32_16x16x32_bf16 v[144:147], v[72:75], v[96:99], v[144:147]
    ds_read_b128 v[80:83], v2 offset:0
    ds_read_b128 v[96:99], v2 offset:1024
    s_waitcnt lgkmcnt(7)
    v_mfma_f32_16x16x32_bf16 v[148:151], v[64:67], v[84:87], 0
    s_waitcnt lgkmcnt(6)
    v_mfma_f32_16x16x32_bf16 v[148:151], v[72:75], v[100:103], v[148:151]
    ds_read_b128 v[84:87], v2 offset:18432
    ds_read_b128 v[100:103], v2 offset:19456
    s_waitcnt lgkmcnt(7)
    v_mfma_f32_16x16x32_bf16 v[152:155], v[64:67], v[88:91], 0
    s_waitcnt lgkmcnt(6)
    v_mfma_f32_16x16x32_bf16 v[152:155], v[72:75], v[104:107], v[152:155]
    ds_read_b128 v[88:91], v2 offset:36864
    ds_read_b128 v[104:107], v2 offset:37888
    s_waitcnt lgkmcnt(7)
    v_mfma_f32_16x16x32_bf16 v[156:159], v[64:67], v[92:95], 0
    s_waitcnt lgkmcnt(6)
    v_mfma_f32_16x16x32_bf16 v[156:159], v[72:75], v[108:111], v[156:159]
    ds_read_b128 v[92:95], v2 offset:55296
    ds_read_b128 v[108:111], v2 offset:56320
    buffer_load_dwordx4 v[56:59], v1, s[12:15], s30 offen offset:1024 sc1
    buffer_load_dwordx4 v[64:67], v1, s[12:15], s30 offen offset:2048 sc1
    s_waitcnt vmcnt(10) lgkmcnt(7)
    v_mfma_f32_16x16x32_bf16 v[144:147], v[16:19], v[80:83], v[144:147]
    s_waitcnt vmcnt(9) lgkmcnt(6)
    v_mfma_f32_16x16x32_bf16 v[144:147], v[24:27], v[96:99], v[144:147]
    ds_read_b128 v[80:83], v2 offset:2048
    ds_read_b128 v[96:99], v2 offset:3072
    s_waitcnt lgkmcnt(7)
    v_mfma_f32_16x16x32_bf16 v[148:151], v[16:19], v[84:87], v[148:151]
    s_waitcnt lgkmcnt(6)
    v_mfma_f32_16x16x32_bf16 v[148:151], v[24:27], v[100:103], v[148:151]
    ds_read_b128 v[84:87], v2 offset:20480
    ds_read_b128 v[100:103], v2 offset:21504
    s_waitcnt lgkmcnt(7)
    v_mfma_f32_16x16x32_bf16 v[152:155], v[16:19], v[88:91], v[152:155]
    s_waitcnt lgkmcnt(6)
    v_mfma_f32_16x16x32_bf16 v[152:155], v[24:27], v[104:107], v[152:155]
    ds_read_b128 v[88:91], v2 offset:38912
    ds_read_b128 v[104:107], v2 offset:39936
    s_waitcnt lgkmcnt(7)
    v_mfma_f32_16x16x32_bf16 v[156:159], v[16:19], v[92:95], v[156:159]
    s_waitcnt lgkmcnt(6)
    v_mfma_f32_16x16x32_bf16 v[156:159], v[24:27], v[108:111], v[156:159]
    ds_read_b128 v[92:95], v2 offset:57344
    ds_read_b128 v[108:111], v2 offset:58368
    buffer_load_dwordx4 v[72:75], v1, s[12:15], s30 offen offset:3072 sc1
    s_add_u32 s30, s23, 0xf53000
    buffer_load_dwordx4 v[16:19], v1, s[12:15], s30 offen offset:0 sc1
    s_waitcnt vmcnt(10) lgkmcnt(7)
    v_mfma_f32_16x16x32_bf16 v[144:147], v[32:35], v[80:83], v[144:147]
    s_waitcnt vmcnt(9) lgkmcnt(6)
    v_mfma_f32_16x16x32_bf16 v[144:147], v[40:43], v[96:99], v[144:147]
    ds_read_b128 v[80:83], v2 offset:4096
    ds_read_b128 v[96:99], v2 offset:5120
    s_waitcnt lgkmcnt(7)
    v_mfma_f32_16x16x32_bf16 v[148:151], v[32:35], v[84:87], v[148:151]
    s_waitcnt lgkmcnt(6)
    v_mfma_f32_16x16x32_bf16 v[148:151], v[40:43], v[100:103], v[148:151]
    ds_read_b128 v[84:87], v2 offset:22528
    ds_read_b128 v[100:103], v2 offset:23552
    s_waitcnt lgkmcnt(7)
    v_mfma_f32_16x16x32_bf16 v[152:155], v[32:35], v[88:91], v[152:155]
    s_waitcnt lgkmcnt(6)
    v_mfma_f32_16x16x32_bf16 v[152:155], v[40:43], v[104:107], v[152:155]
    ds_read_b128 v[88:91], v2 offset:40960
    ds_read_b128 v[104:107], v2 offset:41984
    s_waitcnt lgkmcnt(7)
    v_mfma_f32_16x16x32_bf16 v[156:159], v[32:35], v[92:95], v[156:159]
    s_waitcnt lgkmcnt(6)
    v_mfma_f32_16x16x32_bf16 v[156:159], v[40:43], v[108:111], v[156:159]
    ds_read_b128 v[92:95], v2 offset:59392
    ds_read_b128 v[108:111], v2 offset:60416
    buffer_load_dwordx4 v[24:27], v1, s[12:15], s30 offen offset:1024 sc1
    buffer_load_dwordx4 v[32:35], v1, s[12:15], s30 offen offset:2048 sc1
    s_waitcnt vmcnt(10) lgkmcnt(7)
    v_mfma_f32_16x16x32_bf16 v[144:147], v[48:51], v[80:83], v[144:147]
    s_waitcnt vmcnt(5) lgkmcnt(6)
    v_mfma_f32_16x16x32_bf16 v[144:147], v[56:59], v[96:99], v[144:147]
    ds_read_b128 v[80:83], v2 offset:6144
    ds_read_b128 v[96:99], v2 offset:7168
    s_waitcnt lgkmcnt(7)
    v_mfma_f32_16x16x32_bf16 v[148:151], v[48:51], v[84:87], v[148:151]
    s_waitcnt lgkmcnt(6)
    v_mfma_f32_16x16x32_bf16 v[148:151], v[56:59], v[100:103], v[148:151]
    ds_read_b128 v[84:87], v2 offset:24576
    ds_read_b128 v[100:103], v2 offset:25600
    s_waitcnt lgkmcnt(7)
    v_mfma_f32_16x16x32_bf16 v[152:155], v[48:51], v[88:91], v[152:155]
    s_waitcnt lgkmcnt(6)
    v_mfma_f32_16x16x32_bf16 v[152:155], v[56:59], v[104:107], v[152:155]
    ds_read_b128 v[88:91], v2 offset:43008
    ds_read_b128 v[104:107], v2 offset:44032
    s_waitcnt lgkmcnt(7)
    v_mfma_f32_16x16x32_bf16 v[156:159], v[48:51], v[92:95], v[156:159]
    s_waitcnt lgkmcnt(6)
    v_mfma_f32_16x16x32_bf16 v[156:159], v[56:59], v[108:111], v[156:159]
    ds_read_b128 v[92:95], v2 offset:61440
    ds_read_b128 v[108:111], v2 offset:62464
    buffer_load_dwordx4 v[40:43], v1, s[12:15], s30 offen offset:3072 sc1
    s_add_u32 s30, s23, 0xf52000
    buffer_load_dwordx4 v[48:51], v1, s[12:15], s30 offen offset:0 sc1
    s_waitcnt vmcnt(6) lgkmcnt(7)
    v_mfma_f32_16x16x32_bf16 v[144:147], v[64:67], v[80:83], v[144:147]
    s_waitcnt vmcnt(5) lgkmcnt(6)
    v_mfma_f32_16x16x32_bf16 v[144:147], v[72:75], v[96:99], v[144:147]
    ds_read_b128 v[80:83], v2 offset:12288
    ds_read_b128 v[96:99], v2 offset:13312
    s_waitcnt lgkmcnt(7)
    v_mfma_f32_16x16x32_bf16 v[148:151], v[64:67], v[84:87], v[148:151]
    s_waitcnt lgkmcnt(6)
    v_mfma_f32_16x16x32_bf16 v[148:151], v[72:75], v[100:103], v[148:151]
    ds_read_b128 v[84:87], v2 offset:30720
    ds_read_b128 v[100:103], v2 offset:31744
    s_waitcnt lgkmcnt(7)
    v_mfma_f32_16x16x32_bf16 v[152:155], v[64:67], v[88:91], v[152:155]
    s_waitcnt lgkmcnt(6)
    v_mfma_f32_16x16x32_bf16 v[152:155], v[72:75], v[104:107], v[152:155]
    ds_read_b128 v[88:91], v2 offset:49152
    ds_read_b128 v[104:107], v2 offset:50176
    s_waitcnt lgkmcnt(7)
    v_mfma_f32_16x16x32_bf16 v[156:159], v[64:67], v[92:95], v[156:159]
    s_waitcnt lgkmcnt(6)
    v_mfma_f32_16x16x32_bf16 v[156:159], v[72:75], v[108:111], v[156:159]
    ds_read_b128 v[92:95], v8 offset:2048
    ds_read_b128 v[108:111], v8 offset:3072
    buffer_load_dwordx4 v[56:59], v1, s[12:15], s30 offen offset:1024 sc1
    buffer_load_dwordx4 v[64:67], v1, s[12:15], s30 offen offset:2048 sc1
    s_waitcnt vmcnt(6) lgkmcnt(7)
    v_mfma_f32_16x16x32_bf16 v[144:147], v[16:19], v[80:83], v[144:147]
    s_waitcnt vmcnt(5) lgkmcnt(6)
    v_mfma_f32_16x16x32_bf16 v[144:147], v[24:27], v[96:99], v[144:147]
    ds_read_b128 v[80:83], v2 offset:14336
    ds_read_b128 v[96:99], v2 offset:15360
    s_waitcnt lgkmcnt(7)
    v_mfma_f32_16x16x32_bf16 v[148:151], v[16:19], v[84:87], v[148:151]
    s_waitcnt lgkmcnt(6)
    v_mfma_f32_16x16x32_bf16 v[148:151], v[24:27], v[100:103], v[148:151]
    ds_read_b128 v[84:87], v2 offset:32768
    ds_read_b128 v[100:103], v2 offset:33792
    s_waitcnt lgkmcnt(7)
    v_mfma_f32_16x16x32_bf16 v[152:155], v[16:19], v[88:91], v[152:155]
    s_waitcnt lgkmcnt(6)
    v_mfma_f32_16x16x32_bf16 v[152:155], v[24:27], v[104:107], v[152:155]
    ds_read_b128 v[88:91], v2 offset:51200
    ds_read_b128 v[104:107], v2 offset:52224
    s_waitcnt lgkmcnt(7)
    v_mfma_f32_16x16x32_bf16 v[156:159], v[16:19], v[92:95], v[156:159]
    s_waitcnt lgkmcnt(6)
    v_mfma_f32_16x16x32_bf16 v[156:159], v[24:27], v[108:111], v[156:159]
    ds_read_b128 v[92:95], v8 offset:4096
    ds_read_b128 v[108:111], v8 offset:5120
    buffer_load_dwordx4 v[72:75], v1, s[12:15], s30 offen offset:3072 sc1
    s_waitcnt vmcnt(5) lgkmcnt(7)
    v_mfma_f32_16x16x32_bf16 v[144:147], v[32:35], v[80:83], v[144:147]
    s_waitcnt vmcnt(4) lgkmcnt(6)
    v_mfma_f32_16x16x32_bf16 v[144:147], v[40:43], v[96:99], v[144:147]
    ds_read_b128 v[80:83], v2 offset:8192
    ds_read_b128 v[96:99], v2 offset:9216
    s_waitcnt lgkmcnt(7)
    v_mfma_f32_16x16x32_bf16 v[148:151], v[32:35], v[84:87], v[148:151]
    s_waitcnt lgkmcnt(6)
    v_mfma_f32_16x16x32_bf16 v[148:151], v[40:43], v[100:103], v[148:151]
    ds_read_b128 v[84:87], v2 offset:26624
    ds_read_b128 v[100:103], v2 offset:27648
    s_waitcnt lgkmcnt(7)
    v_mfma_f32_16x16x32_bf16 v[152:155], v[32:35], v[88:91], v[152:155]
    s_waitcnt lgkmcnt(6)
    v_mfma_f32_16x16x32_bf16 v[152:155], v[40:43], v[104:107], v[152:155]
    ds_read_b128 v[88:91], v2 offset:45056
    ds_read_b128 v[104:107], v2 offset:46080
    s_waitcnt lgkmcnt(7)
    v_mfma_f32_16x16x32_bf16 v[156:159], v[32:35], v[92:95], v[156:159]
    s_waitcnt lgkmcnt(6)
    v_mfma_f32_16x16x32_bf16 v[156:159], v[40:43], v[108:111], v[156:159]
    ds_read_b128 v[92:95], v2 offset:63488
    ds_read_b128 v[108:111], v2 offset:64512
    s_waitcnt vmcnt(3) lgkmcnt(7)
    v_mfma_f32_16x16x32_bf16 v[144:147], v[48:51], v[80:83], v[144:147]
    s_waitcnt vmcnt(2) lgkmcnt(6)
    v_mfma_f32_16x16x32_bf16 v[144:147], v[56:59], v[96:99], v[144:147]
    ds_read_b128 v[80:83], v2 offset:10240
    ds_read_b128 v[96:99], v2 offset:11264
    s_waitcnt lgkmcnt(7)
    v_mfma_f32_16x16x32_bf16 v[148:151], v[48:51], v[84:87], v[148:151]
    s_waitcnt lgkmcnt(6)
    v_mfma_f32_16x16x32_bf16 v[148:151], v[56:59], v[100:103], v[148:151]
    ds_read_b128 v[84:87], v2 offset:28672
    ds_read_b128 v[100:103], v2 offset:29696
    s_waitcnt lgkmcnt(7)
    v_mfma_f32_16x16x32_bf16 v[152:155], v[48:51], v[88:91], v[152:155]
    s_waitcnt lgkmcnt(6)
    v_mfma_f32_16x16x32_bf16 v[152:155], v[56:59], v[104:107], v[152:155]
    ds_read_b128 v[88:91], v2 offset:47104
    ds_read_b128 v[104:107], v2 offset:48128
    s_waitcnt lgkmcnt(7)
    v_mfma_f32_16x16x32_bf16 v[156:159], v[48:51], v[92:95], v[156:159]
    s_waitcnt lgkmcnt(6)
    v_mfma_f32_16x16x32_bf16 v[156:159], v[56:59], v[108:111], v[156:159]
    ds_read_b128 v[92:95], v8 offset:0
    ds_read_b128 v[108:111], v8 offset:1024
    s_waitcnt vmcnt(1) lgkmcnt(7)
    v_mfma_f32_16x16x32_bf16 v[144:147], v[64:67], v[80:83], v[144:147]
    s_waitcnt vmcnt(0) lgkmcnt(6)
    v_mfma_f32_16x16x32_bf16 v[144:147], v[72:75], v[96:99], v[144:147]
    s_waitcnt lgkmcnt(5)
    v_mfma_f32_16x16x32_bf16 v[148:151], v[64:67], v[84:87], v[148:151]
    s_waitcnt lgkmcnt(4)
    v_mfma_f32_16x16x32_bf16 v[148:151], v[72:75], v[100:103], v[148:151]
    s_waitcnt lgkmcnt(3)
    v_mfma_f32_16x16x32_bf16 v[152:155], v[64:67], v[88:91], v[152:155]
    s_waitcnt lgkmcnt(2)
    v_mfma_f32_16x16x32_bf16 v[152:155], v[72:75], v[104:107], v[152:155]
    s_waitcnt lgkmcnt(1)
    v_mfma_f32_16x16x32_bf16 v[156:159], v[64:67], v[92:95], v[156:159]
    s_waitcnt lgkmcnt(0)
    v_mfma_f32_16x16x32_bf16 v[156:159], v[72:75], v[108:111], v[156:159]
    v_cvt_pk_bf16_f32 v204, v144, v145
    v_cvt_pk_bf16_f32 v205, v146, v147
    v_cvt_pk_bf16_f32 v206, v148, v149
    v_cvt_pk_bf16_f32 v207, v150, v151
    s_add_u32 s34, s65, 0
    buffer_store_dwordx4 v[204:207], v1, s[12:15], s34 offen offset:0 sc1
    v_cvt_pk_bf16_f32 v208, v152, v153
    v_cvt_pk_bf16_f32 v209, v154, v155
    v_cvt_pk_bf16_f32 v210, v156, v157
    v_cvt_pk_bf16_f32 v211, v158, v159
    s_add_u32 s34, s65, 36864
    buffer_store_dwordx4 v[208:211], v1, s[12:15], s34 offen offset:0 sc1
fused_kernel_e1start:
    s_load_dwordx2 s[40:41], s[0:1], 0
    s_load_dwordx4 s[44:47], s[0:1], 56
    s_load_dwordx2 s[42:43], s[0:1], 72
    s_mov_b32 s64, 7456541
    s_movk_i32 s65, 576
    s_mov_b32 s66, 0x3ae38e39
    v_lshrrev_b32 v200, 4, v1
    v_and_b32 v220, 15, v200
    v_lshrrev_b32 v221, 4, v200
    s_lshr_b32 s68, s20, 1
    s_mul_i32 s68, s68, 9
    s_add_u32 s69, s68, 8
    s_add_u32 s68, s68, s22
    s_and_b32 s70, s20, 1
    s_lshl_b32 s71, s21, 1
    s_add_u32 s70, s70, s71
    v_bfe_u32 v222, v200, 2, 4
    v_lshlrev_b32 v222, 6, v222
    v_and_b32 v201, 3, v200
    v_lshl_add_u32 v222, v201, 3, v222
    v_and_b32 v201, 1, v221
    v_lshl_add_u32 v222, v201, 5, v222
    v_add_u32 v222, 0x0, v222
    v_xor_b32 v223, 32, v222
    v_and_b32 v224, 3, v220
    v_bfe_u32 v201, v220, 2, 1
    v_lshl_add_u32 v224, v201, 4, v224
    v_bfe_u32 v201, v220, 3, 1
    v_lshl_add_u32 v224, v201, 2, v224
    s_mov_b32 s71, 36864
    v_mul_lo_u32 v224, v224, s71
    v_lshl_add_u32 v224, v221, 3, v224
    v_add_u32 v225, 294912, v224
    v_lshlrev_b32 v226, 3, v221
    s_lshr_b32 s72, s70, 1
    s_and_b32 s73, s70, 1
    s_lshl_b32 s73, s73, 10
    s_add_u32 s72, s72, s73
    s_mul_i32 s72, s72, 1152
    s_lshl_b32 s73, s68, 5
    s_lshl_b32 s75, s69, 5
    s_add_u32 s74, s72, s75
    s_and_b32 s78, s22, 1
    s_mul_i32 s76, s78, 294912
    s_add_u32 s74, s74, s76
    s_add_u32 s72, s72, s73
    s_mul_i32 s76, s70, 36
    s_add_u32 s77, s76, s69
    s_add_u32 s76, s76, s68
    s_lshl_b32 s76, s76, 10
    s_add_u32 s76, s76, 0x1460000
    s_lshl_b32 s77, s77, 10
    s_lshl_b32 s78, s78, 3
    s_add_u32 s77, s77, s78
    s_add_u32 s77, s77, 0x1460000
    v_lshrrev_b32 v240, 6, v1
    v_bfe_u32 v241, v1, 8, 1
    v_lshlrev_b32 v241, 5, v241
    v_and_b32 v242, 48, v1
    v_xor_b32 v241, v241, v242
    v_lshl_add_u32 v240, v240, 12, v241
    s_and_b32 s83, s70, 1
    s_lshl_b32 s83, s83, 11
    s_lshl_b32 s84, s21, 6
    s_add_u32 s83, s83, s84
    s_lshl_b32 s84, s22, 16
    s_add_u32 s83, s83, s84
    s_add_u32 s83, s83, 0x700000
    s_lshl_b32 s84, s22, 10
    s_add_u32 s84, s84, 0x0
    v_add_u32 v241, s84, v1
    s_lshl_b32 s67, s68, 4
    v_add_u32 v200, s67, v220
    v_lshlrev_b32 v208, 4, v200
    v_mul_hi_u32 v209, v208, s64
    v_mul_u32_u24 v209, s65, v209
    v_sub_u32 v208, v208, v209
    v_cvt_f32_u32 v208, v208
    v_mul_f32 v205, s66, v208
    v_lshlrev_b32 v210, 1, v221
    v_add_u32 v208, 0, v210
    v_mul_u32_u24 v208, v208, v200
    v_mul_hi_u32 v209, v208, s64
    v_mul_u32_u24 v209, s65, v209
    v_sub_u32 v208, v208, v209
    v_cvt_f32_u32 v208, v208
    v_mul_f32 v201, s66, v208
    v_add_u32 v208, 1, v210
    v_mul_u32_u24 v208, v208, v200
    v_mul_hi_u32 v209, v208, s64
    v_mul_u32_u24 v209, s65, v209
    v_sub_u32 v208, v208, v209
    v_cvt_f32_u32 v208, v208
    v_mul_f32 v202, s66, v208
    v_add_u32 v208, 8, v210
    v_mul_u32_u24 v208, v208, v200
    v_mul_hi_u32 v209, v208, s64
    v_mul_u32_u24 v209, s65, v209
    v_sub_u32 v208, v208, v209
    v_cvt_f32_u32 v208, v208
    v_mul_f32 v203, s66, v208
    v_add_u32 v208, 9, v210
    v_mul_u32_u24 v208, v208, v200
    v_mul_hi_u32 v209, v208, s64
    v_mul_u32_u24 v209, s65, v209
    v_sub_u32 v208, v208, v209
    v_cvt_f32_u32 v208, v208
    v_mul_f32 v204, s66, v208
    v_and_b32 v206, 1, v200
    v_lshlrev_b32 v206, 4, v206
    v_add_u32 v208, 1, v200
    v_bfe_u32 v208, v208, 1, 1
    v_lshlrev_b32 v208, 31, v208
    v_bfe_u32 v209, v200, 1, 1
    v_lshl_or_b32 v207, v209, 15, v208
    v_cos_f32 v208, v201
    v_sin_f32 v209, -v201
    v_cos_f32 v210, v202
    v_sin_f32 v211, -v202
    v_cos_f32 v212, v203
    v_sin_f32 v213, -v203
    v_cos_f32 v214, v204
    v_sin_f32 v215, -v204
    v_cvt_pk_bf16_f32 v16, v208, v209
    v_cvt_pk_bf16_f32 v17, v210, v211
    v_cvt_pk_bf16_f32 v18, v212, v213
    v_cvt_pk_bf16_f32 v19, v214, v215
    v_alignbit_b32 v52, v16, v16, v206
    v_alignbit_b32 v53, v17, v17, v206
    v_alignbit_b32 v54, v18, v18, v206
    v_alignbit_b32 v55, v19, v19, v206
    v_xor_b32 v52, v207, v52
    v_xor_b32 v53, v207, v53
    v_xor_b32 v54, v207, v54
    v_xor_b32 v55, v207, v55
    v_lshlrev_b32 v208, 27, v206
    v_or_b32 v208, 0x3f803f80, v208
    v_cmp_eq_u32 vcc, 0, v221
    s_nop 1
    v_cndmask_b32 v16, v16, v208, vcc
    v_mov_b32 v12, 149820
fused_kernel_e1_uok:
    ds_read_b32 v13, v12
    s_waitcnt lgkmcnt(0)
    v_readfirstlane_b32 s35, v13
    s_nop 3
    s_cmp_ge_u32 s35, 1
    s_cbranch_scc1 fused_kernel_e1_uok_d
    s_sleep 1
    s_branch fused_kernel_e1_uok
fused_kernel_e1_uok_d:
    s_mov_b32 s86, s35
    s_cmp_lg_u32 s86, 1
    s_cbranch_scc1 fused_kernel_e1_u1
    s_add_u32 s80, s83, 0
    buffer_load_dwordx4 v[136:139], v240, s[12:15], s80 offen sc1
    s_add_u32 s80, s83, 524288
    buffer_load_dwordx4 v[140:143], v240, s[12:15], s80 offen sc1
    s_add_u32 s80, s83, 1048576
    buffer_load_dwordx4 v[144:147], v240, s[12:15], s80 offen sc1
    s_add_u32 s80, s83, 1572864
    buffer_load_dwordx4 v[148:151], v240, s[12:15], s80 offen sc1
fused_kernel_e1_u1:
    v_fmamk_f32 v216, v205, 0x3f800000, v201
    v_fmamk_f32 v217, v205, 0x3f800000, v202
    v_fmamk_f32 v218, v205, 0x3f800000, v203
    v_fmamk_f32 v219, v205, 0x3f800000, v204
    v_cos_f32 v208, v216
    v_sin_f32 v209, -v216
    v_cos_f32 v210, v217
    v_sin_f32 v211, -v217
    v_cos_f32 v212, v218
    v_sin_f32 v213, -v218
    v_cos_f32 v214, v219
    v_sin_f32 v215, -v219
    v_cvt_pk_bf16_f32 v20, v208, v209
    v_cvt_pk_bf16_f32 v21, v210, v211
    v_cvt_pk_bf16_f32 v22, v212, v213
    v_cvt_pk_bf16_f32 v23, v214, v215
    v_alignbit_b32 v56, v20, v20, v206
    v_alignbit_b32 v57, v21, v21, v206
    v_alignbit_b32 v58, v22, v22, v206
    v_alignbit_b32 v59, v23, v23, v206
    v_xor_b32 v56, v207, v56
    v_xor_b32 v57, v207, v57
    v_xor_b32 v58, v207, v58
    v_xor_b32 v59, v207, v59
    v_fmamk_f32 v216, v205, 0x40000000, v201
    v_fmamk_f32 v217, v205, 0x40000000, v202
    v_fmamk_f32 v218, v205, 0x40000000, v203
    v_fmamk_f32 v219, v205, 0x40000000, v204
    v_cos_f32 v208, v216
    v_sin_f32 v209, -v216
    v_cos_f32 v210, v217
    v_sin_f32 v211, -v217
    v_cos_f32 v212, v218
    v_sin_f32 v213, -v218
    v_cos_f32 v214, v219
    v_sin_f32 v215, -v219
    v_cvt_pk_bf16_f32 v24, v208, v209
    v_cvt_pk_bf16_f32 v25, v210, v211
    v_cvt_pk_bf16_f32 v26, v212, v213
    v_cvt_pk_bf16_f32 v27, v214, v215
    v_alignbit_b32 v60, v24, v24, v206
    v_alignbit_b32 v61, v25, v25, v206
    v_alignbit_b32 v62, v26, v26, v206
    v_alignbit_b32 v63, v27, v27, v206
    v_xor_b32 v60, v207, v60
    v_xor_b32 v61, v207, v61
    v_xor_b32 v62, v207, v62
    v_xor_b32 v63, v207, v63
    s_waitcnt vmcnt(0) lgkmcnt(0)
    s_cmp_lg_u32 s86, 1
    s_cbranch_scc1 fused_kernel_e1_u2
    ds_write_b128 v241, v[136:139] offset:0
    ds_write_b128 v241, v[140:143] offset:8192
    ds_write_b128 v241, v[144:147] offset:16384
    ds_write_b128 v241, v[148:151] offset:24576
fused_kernel_e1_u2:
    s_barrier
    s_mov_b32 s4, s40
    s_and_b32 s5, s41, 0xffff
    s_mov_b32 s6, 0x240000
    s_mov_b32 s7, 0x20000
    s_mov_b32 s8, s46
    s_and_b32 s9, s47, 0xffff
    s_mov_b32 s10, 0x240000
    s_mov_b32 s11, 0x20000
    s_mov_b32 s16, s44
    s_and_b32 s17, s45, 0xffff
    s_mov_b32 s18, 0x480
    s_mov_b32 s19, 0x20000
    s_lshl_b32 s79, s21, 8
    s_add_u32 s79, s79, 0xa23000
    v_mov_b32 v238, 0
    v_mov_b32 v239, 1
    buffer_load_dwordx2 v[228:229], v224, s[4:7], s72 offen
    buffer_load_dwordx2 v[230:231], v225, s[4:7], s72 offen
    buffer_load_dwordx2 v[232:233], v226, s[16:19], s73 offen
    v_fmamk_f32 v216, v205, 0x40400000, v201
    v_fmamk_f32 v217, v205, 0x40400000, v202
    v_fmamk_f32 v218, v205, 0x40400000, v203
    v_fmamk_f32 v219, v205, 0x40400000, v204
    v_cos_f32 v208, v216
    v_sin_f32 v209, -v216
    v_cos_f32 v210, v217
    v_sin_f32 v211, -v217
    v_cos_f32 v212, v218
    v_sin_f32 v213, -v218
    v_cos_f32 v214, v219
    v_sin_f32 v215, -v219
    v_cvt_pk_bf16_f32 v28, v208, v209
    v_cvt_pk_bf16_f32 v29, v210, v211
    v_cvt_pk_bf16_f32 v30, v212, v213
    v_cvt_pk_bf16_f32 v31, v214, v215
    v_alignbit_b32 v64, v28, v28, v206
    v_alignbit_b32 v65, v29, v29, v206
    v_alignbit_b32 v66, v30, v30, v206
    v_alignbit_b32 v67, v31, v31, v206
    v_xor_b32 v64, v207, v64
    v_xor_b32 v65, v207, v65
    v_xor_b32 v66, v207, v66
    v_xor_b32 v67, v207, v67
    v_fmamk_f32 v216, v205, 0x40800000, v201
    v_fmamk_f32 v217, v205, 0x40800000, v202
    v_fmamk_f32 v218, v205, 0x40800000, v203
    v_fmamk_f32 v219, v205, 0x40800000, v204
    v_cos_f32 v208, v216
    v_sin_f32 v209, -v216
    v_cos_f32 v210, v217
    v_sin_f32 v211, -v217
    v_cos_f32 v212, v218
    v_sin_f32 v213, -v218
    v_cos_f32 v214, v219
    v_sin_f32 v215, -v219
    v_cvt_pk_bf16_f32 v32, v208, v209
    v_cvt_pk_bf16_f32 v33, v210, v211
    v_cvt_pk_bf16_f32 v34, v212, v213
    v_cvt_pk_bf16_f32 v35, v214, v215
    v_alignbit_b32 v68, v32, v32, v206
    v_alignbit_b32 v69, v33, v33, v206
    v_alignbit_b32 v70, v34, v34, v206
    v_alignbit_b32 v71, v35, v35, v206
    v_xor_b32 v68, v207, v68
    v_xor_b32 v69, v207, v69
    v_xor_b32 v70, v207, v70
    v_xor_b32 v71, v207, v71
    v_fmamk_f32 v216, v205, 0x40a00000, v201
    v_fmamk_f32 v217, v205, 0x40a00000, v202
    v_fmamk_f32 v218, v205, 0x40a00000, v203
    v_fmamk_f32 v219, v205, 0x40a00000, v204
    v_cos_f32 v208, v216
    v_sin_f32 v209, -v216
    v_cos_f32 v210, v217
    v_sin_f32 v211, -v217
    v_cos_f32 v212, v218
    v_sin_f32 v213, -v218
    v_cos_f32 v214, v219
    v_sin_f32 v215, -v219
    v_cvt_pk_bf16_f32 v36, v208, v209
    v_cvt_pk_bf16_f32 v37, v210, v211
    v_cvt_pk_bf16_f32 v38, v212, v213
    v_cvt_pk_bf16_f32 v39, v214, v215
    v_alignbit_b32 v72, v36, v36, v206
    v_alignbit_b32 v73, v37, v37, v206
    v_alignbit_b32 v74, v38, v38, v206
    v_alignbit_b32 v75, v39, v39, v206
    v_xor_b32 v72, v207, v72
    v_xor_b32 v73, v207, v73
    v_xor_b32 v74, v207, v74
    v_xor_b32 v75, v207, v75
    v_fmamk_f32 v216, v205, 0x40c00000, v201
    v_fmamk_f32 v217, v205, 0x40c00000, v202
    v_fmamk_f32 v218, v205, 0x40c00000, v203
    v_fmamk_f32 v219, v205, 0x40c00000, v204
    v_cos_f32 v208, v216
    v_sin_f32 v209, -v216
    v_cos_f32 v210, v217
    v_sin_f32 v211, -v217
    v_cos_f32 v212, v218
    v_sin_f32 v213, -v218
    v_cos_f32 v214, v219
    v_sin_f32 v215, -v219
    v_cvt_pk_bf16_f32 v40, v208, v209
    v_cvt_pk_bf16_f32 v41, v210, v211
    v_cvt_pk_bf16_f32 v42, v212, v213
    v_cvt_pk_bf16_f32 v43, v214, v215
    v_alignbit_b32 v76, v40, v40, v206
    v_alignbit_b32 v77, v41, v41, v206
    v_alignbit_b32 v78, v42, v42, v206
    v_alignbit_b32 v79, v43, v43, v206
    v_xor_b32 v76, v207, v76
    v_xor_b32 v77, v207, v77
    v_xor_b32 v78, v207, v78
    v_xor_b32 v79, v207, v79
    v_fmamk_f32 v216, v205, 0x40e00000, v201
    v_fmamk_f32 v217, v205, 0x40e00000, v202
    v_fmamk_f32 v218, v205, 0x40e00000, v203
    v_fmamk_f32 v219, v205, 0x40e00000, v204
    v_cos_f32 v208, v216
    v_sin_f32 v209, -v216
    v_cos_f32 v210, v217
    v_sin_f32 v211, -v217
    v_cos_f32 v212, v218
    v_sin_f32 v213, -v218
    v_cos_f32 v214, v219
    v_sin_f32 v215, -v219
    v_cvt_pk_bf16_f32 v44, v208, v209
    v_cvt_pk_bf16_f32 v45, v210, v211
    v_cvt_pk_bf16_f32 v46, v212, v213
    v_cvt_pk_bf16_f32 v47, v214, v215
    v_alignbit_b32 v80, v44, v44, v206
    v_alignbit_b32 v81, v45, v45, v206
    v_alignbit_b32 v82, v46, v46, v206
    v_alignbit_b32 v83, v47, v47, v206
    v_xor_b32 v80, v207, v80
    v_xor_b32 v81, v207, v81
    v_xor_b32 v82, v207, v82
    v_xor_b32 v83, v207, v83
    s_cmp_eq_u32 s86, 1
    s_cbranch_scc1 fused_kernel_e1_u3
    v_mov_b32 v12, 149768
fused_kernel_e1_uok2:
    ds_read_b32 v13, v12
    s_waitcnt lgkmcnt(0)
    v_readfirstlane_b32 s35, v13
    s_nop 3
    s_cmp_ge_u32 s35, 1
    s_cbranch_scc1 fused_kernel_e1_uok2_d
    s_sleep 1
    s_branch fused_kernel_e1_uok2
fused_kernel_e1_uok2_d:
    s_add_u32 s80, s83, 0
    buffer_load_dwordx4 v[136:139], v240, s[12:15], s80 offen sc1
    s_add_u32 s80, s83, 524288
    buffer_load_dwordx4 v[140:143], v240, s[12:15], s80 offen sc1
    s_add_u32 s80, s83, 1048576
    buffer_load_dwordx4 v[144:147], v240, s[12:15], s80 offen sc1
    s_add_u32 s80, s83, 1572864
    buffer_load_dwordx4 v[148:151], v240, s[12:15], s80 offen sc1
    s_waitcnt vmcnt(0)
    ds_write_b128 v241, v[136:139] offset:0
    ds_write_b128 v241, v[140:143] offset:8192
    ds_write_b128 v241, v[144:147] offset:16384
    ds_write_b128 v241, v[148:151] offset:24576
fused_kernel_e1_u3:
    s_waitcnt lgkmcnt(0)
    s_barrier
    s_add_u32 s80, s76, 0x0
    buffer_load_dwordx4 v[88:91], v1, s[12:15], s80 offen sc1
    s_add_u32 s80, s76, 0x240000
    buffer_load_dwordx4 v[92:95], v1, s[12:15], s80 offen sc1
    s_add_u32 s80, s76, 0x480000
    buffer_load_dwordx4 v[96:99], v1, s[12:15], s80 offen sc1
    s_add_u32 s80, s76, 0x6c0000
    buffer_load_dwordx4 v[100:103], v1, s[12:15], s80 offen sc1
    s_add_u32 s80, s76, 0x900000
    buffer_load_dwordx4 v[104:107], v1, s[12:15], s80 offen sc1
    s_add_u32 s80, s76, 0xb40000
    buffer_load_dwordx4 v[108:111], v1, s[12:15], s80 offen sc1
    s_add_u32 s80, s76, 0xd80000
    buffer_load_dwordx4 v[112:115], v1, s[12:15], s80 offen sc1
    s_add_u32 s80, s76, 0xfc0000
    buffer_load_dwordx4 v[116:119], v1, s[12:15], s80 offen sc1
    v_fmamk_f32 v216, v205, 0x41000000, v201
    v_fmamk_f32 v217, v205, 0x41000000, v202
    v_fmamk_f32 v218, v205, 0x41000000, v203
    v_fmamk_f32 v219, v205, 0x41000000, v204
    v_cos_f32 v208, v216
    v_sin_f32 v209, -v216
    v_cos_f32 v210, v217
    v_sin_f32 v211, -v217
    v_cos_f32 v212, v218
    v_sin_f32 v213, -v218
    v_cos_f32 v214, v219
    v_sin_f32 v215, -v219
    v_cvt_pk_bf16_f32 v48, v208, v209
    v_cvt_pk_bf16_f32 v49, v210, v211
    v_cvt_pk_bf16_f32 v50, v212, v213
    v_cvt_pk_bf16_f32 v51, v214, v215
    v_alignbit_b32 v84, v48, v48, v206
    v_alignbit_b32 v85, v49, v49, v206
    v_alignbit_b32 v86, v50, v50, v206
    v_alignbit_b32 v87, v51, v51, v206
    v_xor_b32 v84, v207, v84
    v_xor_b32 v85, v207, v85
    v_xor_b32 v86, v207, v86
    v_xor_b32 v87, v207, v87
    ds_read_b64_tr_b16 v[176:177], v222 offset:0
    ds_read_b64_tr_b16 v[178:179], v222 offset:1024
    ds_read_b64_tr_b16 v[180:181], v223 offset:0
    ds_read_b64_tr_b16 v[182:183], v223 offset:1024
    ds_read_b64_tr_b16 v[184:185], v222 offset:2048
    ds_read_b64_tr_b16 v[186:187], v222 offset:3072
    ds_read_b64_tr_b16 v[188:189], v223 offset:2048
    ds_read_b64_tr_b16 v[190:191], v223 offset:3072
    ds_read_b64_tr_b16 v[192:193], v222 offset:4096
    ds_read_b64_tr_b16 v[194:195], v222 offset:5120
    ds_read_b64_tr_b16 v[196:197], v223 offset:4096
    ds_read_b64_tr_b16 v[198:199], v223 offset:5120
    s_waitcnt lgkmcnt(10)
    v_mfma_f32_16x16x32_bf16 v[160:163], v[16:19], v[176:179], 0
    s_waitcnt lgkmcnt(8)
    v_mfma_f32_16x16x32_bf16 v[164:167], v[16:19], v[180:183], 0
    ds_read_b64_tr_b16 v[176:177], v222 offset:6144
    ds_read_b64_tr_b16 v[178:179], v222 offset:7168
    ds_read_b64_tr_b16 v[180:181], v223 offset:6144
    ds_read_b64_tr_b16 v[182:183], v223 offset:7168
    s_waitcnt lgkmcnt(10)
    v_mfma_f32_16x16x32_bf16 v[160:163], v[20:23], v[184:187], v[160:163]
    s_waitcnt lgkmcnt(8)
    v_mfma_f32_16x16x32_bf16 v[164:167], v[20:23], v[188:191], v[164:167]
    ds_read_b64_tr_b16 v[184:185], v222 offset:8192
    ds_read_b64_tr_b16 v[186:187], v222 offset:9216
    ds_read_b64_tr_b16 v[188:189], v223 offset:8192
    ds_read_b64_tr_b16 v[190:191], v223 offset:9216
    s_waitcnt lgkmcnt(10)
    v_mfma_f32_16x16x32_bf16 v[160:163], v[24:27], v[192:195], v[160:163]
    s_waitcnt lgkmcnt(8)
    v_mfma_f32_16x16x32_bf16 v[164:167], v[24:27], v[196:199], v[164:167]
    ds_read_b64_tr_b16 v[192:193], v222 offset:10240
    ds_read_b64_tr_b16 v[194:195], v222 offset:11264
    ds_read_b64_tr_b16 v[196:197], v223 offset:10240
    ds_read_b64_tr_b16 v[198:199], v223 offset:11264
    s_waitcnt lgkmcnt(10)
    v_mfma_f32_16x16x32_bf16 v[160:163], v[28:31], v[176:179], v[160:163]
    s_waitcnt lgkmcnt(8)
    v_mfma_f32_16x16x32_bf16 v[164:167], v[28:31], v[180:183], v[164:167]
    ds_read_b64_tr_b16 v[176:177], v222 offset:12288
    ds_read_b64_tr_b16 v[178:179], v222 offset:13312
    ds_read_b64_tr_b16 v[180:181], v223 offset:12288
    ds_read_b64_tr_b16 v[182:183], v223 offset:13312
    s_waitcnt lgkmcnt(10)
    v_mfma_f32_16x16x32_bf16 v[160:163], v[32:35], v[184:187], v[160:163]
    s_waitcnt lgkmcnt(8)
    v_mfma_f32_16x16x32_bf16 v[164:167], v[32:35], v[188:191], v[164:167]
    ds_read_b64_tr_b16 v[184:185], v222 offset:14336
    ds_read_b64_tr_b16 v[186:187], v222 offset:15360
    ds_read_b64_tr_b16 v[188:189], v223 offset:14336
    ds_read_b64_tr_b16 v[190:191], v223 offset:15360
    s_waitcnt lgkmcnt(10)
    v_mfma_f32_16x16x32_bf16 v[160:163], v[36:39], v[192:195], v[160:163]
    s_waitcnt lgkmcnt(8)
    v_mfma_f32_16x16x32_bf16 v[164:167], v[36:39], v[196:199], v[164:167]
    ds_read_b64_tr_b16 v[192:193], v222 offset:16384
    ds_read_b64_tr_b16 v[194:195], v222 offset:17408
    ds_read_b64_tr_b16 v[196:197], v223 offset:16384
    ds_read_b64_tr_b16 v[198:199], v223 offset:17408
    s_waitcnt lgkmcnt(10)
    v_mfma_f32_16x16x32_bf16 v[160:163], v[40:43], v[176:179], v[160:163]
    s_waitcnt lgkmcnt(8)
    v_mfma_f32_16x16x32_bf16 v[164:167], v[40:43], v[180:183], v[164:167]
    ds_read_b64_tr_b16 v[176:177], v222 offset:18432
    ds_read_b64_tr_b16 v[178:179], v222 offset:19456
    ds_read_b64_tr_b16 v[180:181], v223 offset:18432
    ds_read_b64_tr_b16 v[182:183], v223 offset:19456
    s_waitcnt lgkmcnt(10)
    v_mfma_f32_16x16x32_bf16 v[160:163], v[44:47], v[184:187], v[160:163]
    s_waitcnt lgkmcnt(8)
    v_mfma_f32_16x16x32_bf16 v[164:167], v[44:47], v[188:191], v[164:167]
    ds_read_b64_tr_b16 v[184:185], v222 offset:20480
    ds_read_b64_tr_b16 v[186:187], v222 offset:21504
    ds_read_b64_tr_b16 v[188:189], v223 offset:20480
    ds_read_b64_tr_b16 v[190:191], v223 offset:21504
    s_waitcnt lgkmcnt(10)
    v_mfma_f32_16x16x32_bf16 v[160:163], v[48:51], v[192:195], v[160:163]
    s_waitcnt lgkmcnt(8)
    v_mfma_f32_16x16x32_bf16 v[164:167], v[48:51], v[196:199], v[164:167]
    ds_read_b64_tr_b16 v[192:193], v222 offset:22528
    ds_read_b64_tr_b16 v[194:195], v222 offset:23552
    ds_read_b64_tr_b16 v[196:197], v223 offset:22528
    ds_read_b64_tr_b16 v[198:199], v223 offset:23552
    s_waitcnt lgkmcnt(10)
    v_mfma_f32_16x16x32_bf16 v[160:163], v[52:55], v[176:179], v[160:163]
    s_waitcnt lgkmcnt(8)
    v_mfma_f32_16x16x32_bf16 v[164:167], v[52:55], v[180:183], v[164:167]
    ds_read_b64_tr_b16 v[176:177], v222 offset:24576
    ds_read_b64_tr_b16 v[178:179], v222 offset:25600
    ds_read_b64_tr_b16 v[180:181], v223 offset:24576
    ds_read_b64_tr_b16 v[182:183], v223 offset:25600
    s_waitcnt lgkmcnt(10)
    v_mfma_f32_16x16x32_bf16 v[160:163], v[56:59], v[184:187], v[160:163]
    s_waitcnt lgkmcnt(8)
    v_mfma_f32_16x16x32_bf16 v[164:167], v[56:59], v[188:191], v[164:167]
    ds_read_b64_tr_b16 v[184:185], v222 offset:26624
    ds_read_b64_tr_b16 v[186:187], v222 offset:27648
    ds_read_b64_tr_b16 v[188:189], v223 offset:26624
    ds_read_b64_tr_b16 v[190:191], v223 offset:27648
    s_waitcnt lgkmcnt(10)
    v_mfma_f32_16x16x32_bf16 v[160:163], v[60:63], v[192:195], v[160:163]
    s_waitcnt lgkmcnt(8)
    v_mfma_f32_16x16x32_bf16 v[164:167], v[60:63], v[196:199], v[164:167]
    ds_read_b64_tr_b16 v[192:193], v222 offset:28672
    ds_read_b64_tr_b16 v[194:195], v222 offset:29696
    ds_read_b64_tr_b16 v[196:197], v223 offset:28672
    ds_read_b64_tr_b16 v[198:199], v223 offset:29696
    s_waitcnt lgkmcnt(10)
    v_mfma_f32_16x16x32_bf16 v[160:163], v[64:67], v[176:179], v[160:163]
    s_waitcnt lgkmcnt(8)
    v_mfma_f32_16x16x32_bf16 v[164:167], v[64:67], v[180:183], v[164:167]
    ds_read_b64_tr_b16 v[176:177], v222 offset:30720
    ds_read_b64_tr_b16 v[178:179], v222 offset:31744
    ds_read_b64_tr_b16 v[180:181], v223 offset:30720
    ds_read_b64_tr_b16 v[182:183], v223 offset:31744
    s_waitcnt lgkmcnt(10)
    v_mfma_f32_16x16x32_bf16 v[160:163], v[68:71], v[184:187], v[160:163]
    s_waitcnt lgkmcnt(8)
    v_mfma_f32_16x16x32_bf16 v[164:167], v[68:71], v[188:191], v[164:167]
    ds_read_b64_tr_b16 v[184:185], v222 offset:32768
    ds_read_b64_tr_b16 v[186:187], v222 offset:33792
    ds_read_b64_tr_b16 v[188:189], v223 offset:32768
    ds_read_b64_tr_b16 v[190:191], v223 offset:33792
    s_waitcnt lgkmcnt(10)
    v_mfma_f32_16x16x32_bf16 v[160:163], v[72:75], v[192:195], v[160:163]
    s_waitcnt lgkmcnt(8)
    v_mfma_f32_16x16x32_bf16 v[164:167], v[72:75], v[196:199], v[164:167]
    ds_read_b64_tr_b16 v[192:193], v222 offset:34816
    ds_read_b64_tr_b16 v[194:195], v222 offset:35840
    ds_read_b64_tr_b16 v[196:197], v223 offset:34816
    ds_read_b64_tr_b16 v[198:199], v223 offset:35840
    s_waitcnt lgkmcnt(10)
    v_mfma_f32_16x16x32_bf16 v[160:163], v[76:79], v[176:179], v[160:163]
    s_waitcnt lgkmcnt(8)
    v_mfma_f32_16x16x32_bf16 v[164:167], v[76:79], v[180:183], v[164:167]
    s_waitcnt lgkmcnt(6)
    v_mfma_f32_16x16x32_bf16 v[160:163], v[80:83], v[184:187], v[160:163]
    s_waitcnt lgkmcnt(4)
    v_mfma_f32_16x16x32_bf16 v[164:167], v[80:83], v[188:191], v[164:167]
    s_waitcnt lgkmcnt(2)
    v_mfma_f32_16x16x32_bf16 v[160:163], v[84:87], v[192:195], v[160:163]
    s_waitcnt lgkmcnt(0)
    v_mfma_f32_16x16x32_bf16 v[164:167], v[84:87], v[196:199], v[164:167]
    s_waitcnt vmcnt(7)
    v_lshlrev_b32 v176, 16, v88
    v_and_b32 v177, 0xffff0000, v88
    v_lshlrev_b32 v178, 16, v89
    v_and_b32 v179, 0xffff0000, v89
    v_lshlrev_b32 v180, 16, v90
    v_and_b32 v181, 0xffff0000, v90
    v_lshlrev_b32 v182, 16, v91
    v_and_b32 v183, 0xffff0000, v91
    s_waitcnt vmcnt(6)
    v_lshlrev_b32 v188, 16, v92
    v_and_b32 v189, 0xffff0000, v92
    v_lshlrev_b32 v190, 16, v93
    v_and_b32 v191, 0xffff0000, v93
    v_lshlrev_b32 v192, 16, v94
    v_and_b32 v193, 0xffff0000, v94
    v_lshlrev_b32 v194, 16, v95
    v_and_b32 v195, 0xffff0000, v95
    v_pk_add_f32 v[176:177], v[176:177], v[188:189]
    v_pk_add_f32 v[178:179], v[178:179], v[190:191]
    v_pk_add_f32 v[180:181], v[180:181], v[192:193]
    v_pk_add_f32 v[182:183], v[182:183], v[194:195]
    s_waitcnt vmcnt(5)
    v_lshlrev_b32 v188, 16, v96
    v_and_b32 v189, 0xffff0000, v96
    v_lshlrev_b32 v190, 16, v97
    v_and_b32 v191, 0xffff0000, v97
    v_lshlrev_b32 v192, 16, v98
    v_and_b32 v193, 0xffff0000, v98
    v_lshlrev_b32 v194, 16, v99
    v_and_b32 v195, 0xffff0000, v99
    v_pk_add_f32 v[176:177], v[176:177], v[188:189]
    v_pk_add_f32 v[178:179], v[178:179], v[190:191]
    v_pk_add_f32 v[180:181], v[180:181], v[192:193]
    v_pk_add_f32 v[182:183], v[182:183], v[194:195]
    s_waitcnt vmcnt(4)
    v_lshlrev_b32 v188, 16, v100
    v_and_b32 v189, 0xffff0000, v100
    v_lshlrev_b32 v190, 16, v101
    v_and_b32 v191, 0xffff0000, v101
    v_lshlrev_b32 v192, 16, v102
    v_and_b32 v193, 0xffff0000, v102
    v_lshlrev_b32 v194, 16, v103
    v_and_b32 v195, 0xffff0000, v103
    v_pk_add_f32 v[176:177], v[176:177], v[188:189]
    v_pk_add_f32 v[178:179], v[178:179], v[190:191]
    v_pk_add_f32 v[180:181], v[180:181], v[192:193]
    v_pk_add_f32 v[182:183], v[182:183], v[194:195]
    s_waitcnt vmcnt(3)
    v_lshlrev_b32 v188, 16, v104
    v_and_b32 v189, 0xffff0000, v104
    v_lshlrev_b32 v190, 16, v105
    v_and_b32 v191, 0xffff0000, v105
    v_lshlrev_b32 v192, 16, v106
    v_and_b32 v193, 0xffff0000, v106
    v_lshlrev_b32 v194, 16, v107
    v_and_b32 v195, 0xffff0000, v107
    v_pk_add_f32 v[176:177], v[176:177], v[188:189]
    v_pk_add_f32 v[178:179], v[178:179], v[190:191]
    v_pk_add_f32 v[180:181], v[180:181], v[192:193]
    v_pk_add_f32 v[182:183], v[182:183], v[194:195]
    s_waitcnt vmcnt(2)
    v_lshlrev_b32 v188, 16, v108
    v_and_b32 v189, 0xffff0000, v108
    v_lshlrev_b32 v190, 16, v109
    v_and_b32 v191, 0xffff0000, v109
    v_lshlrev_b32 v192, 16, v110
    v_and_b32 v193, 0xffff0000, v110
    v_lshlrev_b32 v194, 16, v111
    v_and_b32 v195, 0xffff0000, v111
    v_pk_add_f32 v[176:177], v[176:177], v[188:189]
    v_pk_add_f32 v[178:179], v[178:179], v[190:191]
    v_pk_add_f32 v[180:181], v[180:181], v[192:193]
    v_pk_add_f32 v[182:183], v[182:183], v[194:195]
    s_waitcnt vmcnt(1)
    v_lshlrev_b32 v188, 16, v112
    v_and_b32 v189, 0xffff0000, v112
    v_lshlrev_b32 v190, 16, v113
    v_and_b32 v191, 0xffff0000, v113
    v_lshlrev_b32 v192, 16, v114
    v_and_b32 v193, 0xffff0000, v114
    v_lshlrev_b32 v194, 16, v115
    v_and_b32 v195, 0xffff0000, v115
    v_pk_add_f32 v[176:177], v[176:177], v[188:189]
    v_pk_add_f32 v[178:179], v[178:179], v[190:191]
    v_pk_add_f32 v[180:181], v[180:181], v[192:193]
    v_pk_add_f32 v[182:183], v[182:183], v[194:195]
    s_waitcnt vmcnt(0)
    v_lshlrev_b32 v188, 16, v116
    v_and_b32 v189, 0xffff0000, v116
    v_lshlrev_b32 v190, 16, v117
    v_and_b32 v191, 0xffff0000, v117
    v_lshlrev_b32 v192, 16, v118
    v_and_b32 v193, 0xffff0000, v118
    v_lshlrev_b32 v194, 16, v119
    v_and_b32 v195, 0xffff0000, v119
    v_pk_add_f32 v[176:177], v[176:177], v[188:189]
    v_pk_add_f32 v[178:179], v[178:179], v[190:191]
    v_pk_add_f32 v[180:181], v[180:181], v[192:193]
    v_pk_add_f32 v[182:183], v[182:183], v[194:195]
    v_lshlrev_b32 v196, 16, v232
    v_and_b32 v197, 0xffff0000, v232
    v_lshlrev_b32 v198, 16, v233
    v_and_b32 v199, 0xffff0000, v233
    v_cvt_pk_bf16_f32 v190, v176, v177
    v_lshlrev_b32 v176, 16, v190
    v_and_b32 v177, 0xffff0000, v190
    v_pk_add_f32 v[176:177], v[176:177], v[196:197]
    v_cvt_pk_bf16_f32 v190, v176, v177
    v_lshlrev_b32 v176, 16, v190
    v_and_b32 v177, 0xffff0000, v190
    v_cvt_pk_bf16_f32 v190, v160, v161
    v_lshlrev_b32 v160, 16, v190
    v_and_b32 v161, 0xffff0000, v190
    v_lshlrev_b32 v188, 16, v228
    v_and_b32 v189, 0xffff0000, v228
    v_pk_add_f32 v[160:161], v[160:161], v[188:189]
    v_cvt_pk_bf16_f32 v190, v160, v161
    v_lshlrev_b32 v160, 16, v190
    v_and_b32 v161, 0xffff0000, v190
    v_pk_add_f32 v[160:161], v[160:161], v[176:177]
    v_cvt_pk_bf16_f32 v200, v160, v161
    v_cvt_pk_bf16_f32 v190, v178, v179
    v_lshlrev_b32 v178, 16, v190
    v_and_b32 v179, 0xffff0000, v190
    v_pk_add_f32 v[178:179], v[178:179], v[198:199]
    v_cvt_pk_bf16_f32 v190, v178, v179
    v_lshlrev_b32 v178, 16, v190
    v_and_b32 v179, 0xffff0000, v190
    v_cvt_pk_bf16_f32 v190, v162, v163
    v_lshlrev_b32 v162, 16, v190
    v_and_b32 v163, 0xffff0000, v190
    v_lshlrev_b32 v188, 16, v229
    v_and_b32 v189, 0xffff0000, v229
    v_pk_add_f32 v[162:163], v[162:163], v[188:189]
    v_cvt_pk_bf16_f32 v190, v162, v163
    v_lshlrev_b32 v162, 16, v190
    v_and_b32 v163, 0xffff0000, v190
    v_pk_add_f32 v[162:163], v[162:163], v[178:179]
    v_cvt_pk_bf16_f32 v201, v162, v163
    v_cvt_pk_bf16_f32 v190, v180, v181
    v_lshlrev_b32 v180, 16, v190
    v_and_b32 v181, 0xffff0000, v190
    v_pk_add_f32 v[180:181], v[180:181], v[196:197]
    v_cvt_pk_bf16_f32 v190, v180, v181
    v_lshlrev_b32 v180, 16, v190
    v_and_b32 v181, 0xffff0000, v190
    v_cvt_pk_bf16_f32 v190, v164, v165
    v_lshlrev_b32 v164, 16, v190
    v_and_b32 v165, 0xffff0000, v190
    v_lshlrev_b32 v188, 16, v230
    v_and_b32 v189, 0xffff0000, v230
    v_pk_add_f32 v[164:165], v[164:165], v[188:189]
    v_cvt_pk_bf16_f32 v190, v164, v165
    v_lshlrev_b32 v164, 16, v190
    v_and_b32 v165, 0xffff0000, v190
    v_pk_add_f32 v[164:165], v[164:165], v[180:181]
    v_cvt_pk_bf16_f32 v202, v164, v165
    v_cvt_pk_bf16_f32 v190, v182, v183
    v_lshlrev_b32 v182, 16, v190
    v_and_b32 v183, 0xffff0000, v190
    v_pk_add_f32 v[182:183], v[182:183], v[198:199]
    v_cvt_pk_bf16_f32 v190, v182, v183
    v_lshlrev_b32 v182, 16, v190
    v_and_b32 v183, 0xffff0000, v190
    v_cvt_pk_bf16_f32 v190, v166, v167
    v_lshlrev_b32 v166, 16, v190
    v_and_b32 v167, 0xffff0000, v190
    v_lshlrev_b32 v188, 16, v231
    v_and_b32 v189, 0xffff0000, v231
    v_pk_add_f32 v[166:167], v[166:167], v[188:189]
    v_cvt_pk_bf16_f32 v190, v166, v167
    v_lshlrev_b32 v166, 16, v190
    v_and_b32 v167, 0xffff0000, v190
    v_pk_add_f32 v[166:167], v[166:167], v[182:183]
    v_cvt_pk_bf16_f32 v203, v166, v167
    buffer_store_dwordx2 v[200:201], v224, s[8:11], s72 offen
    buffer_store_dwordx2 v[202:203], v225, s[8:11], s72 offen
    s_endpgm
fused_kernel_end:
    s_endpgm
.section .rodata,"a"
.p2align 6
.amdhsa_kernel fused_kernel
  .amdhsa_next_free_vgpr 256
  .amdhsa_next_free_sgpr 102
  .amdhsa_accum_offset 256
  .amdhsa_group_segment_fixed_size 0
  .amdhsa_kernarg_size 88
  .amdhsa_user_sgpr_count 2
  .amdhsa_user_sgpr_kernarg_segment_ptr 1
  .amdhsa_system_sgpr_workgroup_id_x 1
.end_amdhsa_kernel
```
